```python
import torch

def _softmax(x, axis=-1):
    return torch.softmax(x, dim=axis)
def _gelu(x):
    return torch.nn.functional.gelu(x, approximate="tanh")
def _silu(x):
    return torch.nn.functional.silu(x)
def _sigmoid(x):
    return torch.sigmoid(x)
def _layernorm(x, axis=-1, eps=1e-5):
    m = x.mean(dim=axis, keepdim=True)
    v = x.var(dim=axis, keepdim=True, unbiased=False)
    return (x - m) / torch.sqrt(v + eps)
def _scatter_add(tgt, idx, src, axis=0):
    return tgt.clone().index_add_(axis, idx, src)
def _segment_sum(src, seg, n):
    out = torch.zeros((n,) + src.shape[1:], dtype=src.dtype)
    return out.index_add_(0, seg, src)
def _pad(x, pw):
    flat = tuple(v for pair in reversed(pw) for v in pair)
    return torch.nn.functional.pad(x, flat)

kernel_name = 'interleave_layers__gqa_block_cached__glu_gated_reglu__decode'

def setup_inputs():

    _w = (lambda a: (lambda t: t.to(torch.bfloat16) if t.is_floating_point() else t)(torch.as_tensor(a)))
    def _A_setup():
        B, Sq, D = 1, 1, 512
        Hq, Hkv, Sk, Dh = 32, 8, 65536, 128
        assert Hq % Hkv == 0, (Hq, Hkv)
        return {
            "x": _w((lambda *s: torch.randn(*s, dtype=torch.bfloat16) * 0.05)(B, Sq, D)),
            "k_cache": _w((lambda *s: torch.randn(*s, dtype=torch.bfloat16) * 0.8)(B, Hkv, Sk, Dh)),
            "v_cache": _w((lambda *s: torch.randn(*s, dtype=torch.bfloat16) * 1.6)(B, Hkv, Sk, Dh)),
            "wq": _w((lambda *s: torch.randn(*s, dtype=torch.bfloat16) * 0.8)(D, Hq * Dh) * (D ** -0.5)),
            "wo": _w((lambda *s: torch.randn(*s, dtype=torch.bfloat16) * 1.6)(Hq * Dh, D) * ((Hq * Dh) ** -0.5)),
        }
    _A_in = _A_setup()

    def _B_setup():
        B, S, D, F = 1, 1, 512, 1792
        return {
            "x": _w((lambda *s: torch.randn(*s, dtype=torch.bfloat16) * 0.05)(B, S, D)),
            "W_gate": _w((lambda *s: torch.randn(*s, dtype=torch.bfloat16) * 0.2)(D, F) * (2.0 / D) ** 0.5),
            "W_up": _w((lambda *s: torch.randn(*s, dtype=torch.bfloat16) * 0.2)(D, F) * (2.0 / D) ** 0.5),
            "W_down": _w((lambda *s: torch.randn(*s, dtype=torch.bfloat16) * 0.2)(F, D) * (1.0 / F) ** 0.5),
        }
    _B_in = _B_setup()

    return {
        "A_x": _A_in["x"],
        "A_k_cache": _A_in["k_cache"],
        "A_v_cache": _A_in["v_cache"],
        "A_wq": _A_in["wq"],
        "A_wo": _A_in["wo"],
        "B_x": _B_in["x"],
        "B_W_gate": _B_in["W_gate"],
        "B_W_up": _B_in["W_up"],
        "B_W_down": _B_in["W_down"],
    }

def reference(A_x, A_k_cache, A_v_cache, A_wq, A_wo, B_x, B_W_gate, B_W_up, B_W_down):
    def _A_ref(x, k_cache, v_cache, wq, wo):
        B, Sq, D = x.shape
        Hq, Dh = 32, 128
        Hkv = k_cache.shape[1]
        rep = Hq // Hkv
        q = (lambda x, *d: x.permute(*d))((x @ wq).reshape(B, Sq, Hq, Dh), 0, 2, 1, 3)
        k = (lambda x, n, axis: torch.repeat_interleave(x, n, dim=axis))(k_cache, rep, axis=1)
        v = (lambda x, n, axis: torch.repeat_interleave(x, n, dim=axis))(v_cache, rep, axis=1)
        scores = torch.einsum("bhqd,bhkd->bhqk", q, k) * (Dh ** -0.5)
        p = _softmax(scores, axis=-1)
        o = torch.einsum("bhqk,bhkd->bhqd", p, v)
        return (lambda x, *d: x.permute(*d))(o, 0, 2, 1, 3).reshape(B, Sq, Hq * Dh) @ wo

    def _B_ref(x, W_gate, W_up, W_down):
        gate = torch.einsum("bsd,df->bsf", x, W_gate)
        up = torch.einsum("bsd,df->bsf", x, W_up)
        gate = gate * (lambda x, dt: x.to(dt))(gate > 0, gate.dtype)
        h = gate * up
        return torch.einsum("bsf,fd->bsd", h, W_down)

    x = A_x
    x = x + _A_ref(_layernorm(x, axis=-1), A_k_cache, A_v_cache, A_wq, A_wo)
    x = x + _B_ref(_layernorm(x, axis=-1), B_W_gate, B_W_up, B_W_down)
    x = x + _A_ref(_layernorm(x, axis=-1), A_k_cache, A_v_cache, A_wq, A_wo)
    x = x + _B_ref(_layernorm(x, axis=-1), B_W_gate, B_W_up, B_W_down)
    return x
```

```asm
; @launch grid=(256,1,1) block=(256,1,1) lds=163840
.amdgcn_target "amdgcn-amd-amdhsa--gfx950"
.text
.globl interleave_layers__gqa_block_cached__glu_gated_reglu__decode_kernel
.p2align 8
.type interleave_layers__gqa_block_cached__glu_gated_reglu__decode_kernel,@function
interleave_layers__gqa_block_cached__glu_gated_reglu__decode_kernel:
  s_cmp_ge_u32 s2, 256
  s_cbranch_scc1 L_end
  s_load_dwordx16 s[64:79], s[0:1], 0
  s_load_dwordx8 s[80:87], s[0:1], 64
  v_lshrrev_b32 v24, 6, v0
  s_nop 0
  v_readfirstlane_b32 s3, v24
  s_waitcnt lgkmcnt(0)
  s_mov_b32 s8, s66
  s_and_b32 s9, s67, 0xffff
  s_mov_b32 s10, 0x8000000
  s_mov_b32 s11, 0x00020000
  s_mov_b32 s12, s68
  s_and_b32 s13, s69, 0xffff
  s_mov_b32 s14, 0x8000000
  s_mov_b32 s15, 0x00020000
  s_mov_b32 s16, s70
  s_and_b32 s17, s71, 0xffff
  s_mov_b32 s18, 0x400000
  s_mov_b32 s19, 0x00020000
  s_mov_b32 s20, s72
  s_and_b32 s21, s73, 0xffff
  s_mov_b32 s22, 0x400000
  s_mov_b32 s23, 0x00020000
  s_mov_b32 s24, s76
  s_and_b32 s25, s77, 0xffff
  s_mov_b32 s26, 0x1c0000
  s_mov_b32 s27, 0x00020000
  s_mov_b32 s28, s78
  s_and_b32 s29, s79, 0xffff
  s_mov_b32 s30, 0x1c0000
  s_mov_b32 s31, 0x00020000
  s_mov_b32 s32, s80
  s_and_b32 s33, s81, 0xffff
  s_mov_b32 s34, 0x1c0000
  s_mov_b32 s35, 0x00020000
  s_mov_b32 s36, s86
  s_and_b32 s37, s87, 0xffff
  s_mov_b32 s38, 0x300000
  s_mov_b32 s39, 0x00020000
  s_mov_b32 s40, s64
  s_and_b32 s41, s65, 0xffff
  s_mov_b32 s42, 0x400
  s_mov_b32 s43, 0x00020000
  s_mov_b32 s44, s82
  s_and_b32 s45, s83, 0xffff
  s_mov_b32 s46, 0x400
  s_mov_b32 s47, 0x00020000
  s_mov_b32 s88, s84
  s_and_b32 s89, s85, 0xffff
  s_mov_b32 s90, 0x100
  s_mov_b32 s91, 0x00020000
  s_mov_b32 s56, 0x3db504f3
  s_mov_b32 s57, 0x3fb8aa3b
  s_mov_b32 s58, 0xffff
  s_mov_b32 s59, 0
  s_mov_b32 s6, 0x3f80
  s_mov_b32 s7, 0x3f800000
  s_mov_b32 s55, 0x40000
  s_and_b32 s51, s2, 7
  s_lshr_b32 s52, s2, 3
  s_lshl_b32 s4, s51, 5
  s_add_u32 s4, s4, s52
  v_and_b32 v24, 63, v0
  v_lshlrev_b32 v2, 4, v24
  v_bfe_u32 v25, v24, 2, 2
  v_lshlrev_b32 v1, 8, v25
  v_lshrrev_b32 v26, 4, v24
  v_lshl_add_u32 v1, v26, 6, v1
  v_and_b32 v27, 3, v24
  v_lshl_add_u32 v1, v27, 4, v1
  s_mul_i32 s61, s3, 37888
  s_add_u32 s61, s61, 12288
  v_lshlrev_b32 v28, 2, v0
  buffer_load_dword v4, v28, s[40:43], 0 offen
  s_lshr_b32 s60, s2, 5
  s_lshl_b32 s60, s60, 11
  s_add_u32 s54, s60, 0x200000
  s_lshl_b32 s49, s2, 19
  s_lshl_b32 s60, s3, 12
  s_add_u32 s49, s49, s60
  s_mov_b32 s48, 0
  s_mov_b32 s53, 0
  v_and_b32 v30, 63, v0
  v_lshrrev_b32 v29, 3, v30
  s_mov_b32 s63, 16384
  v_mul_lo_u32 v29, v29, s63
  v_and_b32 v30, 7, v30
  v_lshl_add_u32 v29, v30, 4, v29
  s_lshr_b32 s51, s4, 6
  s_lshl_b32 s51, s51, 20
  s_lshl_b32 s52, s3, 17
  s_add_u32 s51, s51, s52
  s_and_b32 s52, s4, 63
  s_lshl_b32 s52, s52, 7
  s_add_u32 s51, s51, s52
  buffer_load_dwordx4 v[32:35], v29, s[16:19], s51 offen
  s_add_u32 s51, s51, 8192
  buffer_load_dwordx4 v[36:39], v29, s[16:19], s51 offen
  s_add_u32 s51, s51, 516096
  buffer_load_dwordx4 v[40:43], v29, s[16:19], s51 offen
  s_add_u32 s51, s51, 8192
  buffer_load_dwordx4 v[44:47], v29, s[16:19], s51 offen
  v_mov_b32 v12, 0
  ds_write_b32 v12, v12 offset:11424
  s_xor_b32 s72, s49, 0
  buffer_load_dwordx4 v[64:67], v1, s[8:11], s72 offen nt
  buffer_load_dwordx4 v[68:71], v1, s[8:11], s72 offen offset:1024 nt
  buffer_load_dwordx4 v[72:75], v1, s[8:11], s72 offen offset:2048 nt
  buffer_load_dwordx4 v[76:79], v1, s[8:11], s72 offen offset:3072 nt
  s_xor_b32 s72, s49, 16384
  buffer_load_dwordx4 v[80:83], v1, s[8:11], s72 offen nt
  buffer_load_dwordx4 v[84:87], v1, s[8:11], s72 offen offset:1024 nt
  buffer_load_dwordx4 v[88:91], v1, s[8:11], s72 offen offset:2048 nt
  buffer_load_dwordx4 v[92:95], v1, s[8:11], s72 offen offset:3072 nt
  s_xor_b32 s72, s49, 0
  buffer_load_dwordx4 v[96:99], v2, s[12:15], s72 offen nt
  buffer_load_dwordx4 v[100:103], v2, s[12:15], s72 offen offset:1024 nt
  buffer_load_dwordx4 v[104:107], v2, s[12:15], s72 offen offset:2048 nt
  buffer_load_dwordx4 v[108:111], v2, s[12:15], s72 offen offset:3072 nt
  s_xor_b32 s72, s49, 16384
  buffer_load_dwordx4 v[112:115], v2, s[12:15], s72 offen nt
  buffer_load_dwordx4 v[116:119], v2, s[12:15], s72 offen offset:1024 nt
  buffer_load_dwordx4 v[120:123], v2, s[12:15], s72 offen offset:2048 nt
  buffer_load_dwordx4 v[124:127], v2, s[12:15], s72 offen offset:3072 nt
  s_waitcnt vmcnt(16)
  v_and_b32 v5, 0xffff0000, v4
  v_lshlrev_b32 v4, 16, v4
  v_lshlrev_b32 v27, 3, v0
  ds_write_b64 v27, v[4:5]
  s_lshr_b32 s51, s4, 6
  s_cmp_lg_u32 s51, s3
  s_cbranch_scc1 L_nox
  v_lshrrev_b32 v27, 1, v2
  ds_write_b64 v27, v[4:5] offset:9728
L_nox:
  s_waitcnt lgkmcnt(0)
  s_barrier
  s_xor_b32 s72, s49, 32768
  buffer_load_dwordx4 v[128:131], v1, s[8:11], s72 offen nt
  buffer_load_dwordx4 v[132:135], v1, s[8:11], s72 offen offset:1024 nt
  v_bfe_u32 v29, v0, 3, 3
  v_lshlrev_b32 v29, 3, v29
  s_lshl_b32 s52, s3, 6
  s_lshr_b32 s51, s4, 6
  s_lshl_b32 s51, s51, 9
  s_add_u32 s52, s51, s52
  v_add_u32 v29, s52, v29
  v_and_b32 v28, 63, v0
  v_lshlrev_b32 v28, 5, v28
  ds_read_b128 v[8:11], v28
  ds_read_b128 v[12:15], v28 offset:16
  ds_read_b32 v16, v29
  ds_read_b32 v17, v29 offset:4
  ds_read_b32 v18, v29 offset:256
  ds_read_b32 v19, v29 offset:260
  s_waitcnt lgkmcnt(4)
  v_add_f32 v24, v8, v9
  v_add_f32 v26, v10, v11
  v_add_f32 v24, v24, v12
  v_add_f32 v26, v26, v13
  v_add_f32 v24, v24, v14
  v_add_f32 v26, v26, v15
  v_add_f32 v24, v24, v26
  s_nop 1
  v_add_f32_dpp v24, v24, v24 quad_perm:[1,0,3,2] row_mask:0xf bank_mask:0xf
  s_nop 1
  v_add_f32_dpp v24, v24, v24 quad_perm:[2,3,0,1] row_mask:0xf bank_mask:0xf
  s_nop 1
  v_add_f32_dpp v24, v24, v24 row_half_mirror row_mask:0xf bank_mask:0xf
  s_nop 1
  v_add_f32_dpp v24, v24, v24 row_mirror row_mask:0xf bank_mask:0xf
  v_mov_b32 v26, v24
  s_nop 1
  v_permlane32_swap_b32 v24, v26
  v_add_f32 v24, v24, v26
  v_mov_b32 v26, v24
  s_nop 1
  v_permlane16_swap_b32 v24, v26
  v_add_f32 v24, v24, v26
  v_mul_f32 v25, 0x3b000000, v24
  v_sub_f32 v8, v8, v25
  v_sub_f32 v9, v9, v25
  v_sub_f32 v10, v10, v25
  v_sub_f32 v11, v11, v25
  v_sub_f32 v12, v12, v25
  v_sub_f32 v13, v13, v25
  v_sub_f32 v14, v14, v25
  v_sub_f32 v15, v15, v25
  v_mul_f32 v24, v8, v8
  v_mul_f32 v26, v9, v9
  v_fmac_f32 v24, v10, v10
  v_fmac_f32 v26, v11, v11
  v_fmac_f32 v24, v12, v12
  v_fmac_f32 v26, v13, v13
  v_fmac_f32 v24, v14, v14
  v_fmac_f32 v26, v15, v15
  v_add_f32 v24, v24, v26
  s_nop 1
  v_add_f32_dpp v24, v24, v24 quad_perm:[1,0,3,2] row_mask:0xf bank_mask:0xf
  s_nop 1
  v_add_f32_dpp v24, v24, v24 quad_perm:[2,3,0,1] row_mask:0xf bank_mask:0xf
  s_nop 1
  v_add_f32_dpp v24, v24, v24 row_half_mirror row_mask:0xf bank_mask:0xf
  s_nop 1
  v_add_f32_dpp v24, v24, v24 row_mirror row_mask:0xf bank_mask:0xf
  v_mov_b32 v26, v24
  s_nop 1
  v_permlane32_swap_b32 v24, v26
  v_add_f32 v24, v24, v26
  v_mov_b32 v26, v24
  s_nop 1
  v_permlane16_swap_b32 v24, v26
  v_add_f32 v24, v24, v26
  v_mul_f32 v24, 0x3b000000, v24
  v_cvt_pk_bf16_f32 v27, v25, v24
  v_lshlrev_b32 v25, 16, v27
  v_and_b32 v24, 0xffff0000, v27
  v_add_f32 v24, 0x3727c5ac, v24
  v_cvt_pk_bf16_f32 v27, v24, v24
  v_lshlrev_b32 v24, 16, v27
  v_sqrt_f32 v24, v24
  s_nop 0
  v_cvt_pk_bf16_f32 v27, v24, v24
  v_lshlrev_b32 v24, 16, v27
  v_rcp_f32 v24, v24
  s_waitcnt lgkmcnt(0)
  v_sub_f32 v16, v16, v25
  v_sub_f32 v17, v17, v25
  v_cvt_pk_bf16_f32 v27, v16, v17
  v_lshlrev_b32 v16, 16, v27
  v_and_b32 v17, 0xffff0000, v27
  v_mul_f32 v16, v16, v24
  v_mul_f32 v17, v17, v24
  v_cvt_pk_bf16_f32 v27, v16, v17
  v_lshlrev_b32 v16, 16, v27
  v_and_b32 v17, 0xffff0000, v27
  v_sub_f32 v18, v18, v25
  v_sub_f32 v19, v19, v25
  v_cvt_pk_bf16_f32 v27, v18, v19
  v_lshlrev_b32 v18, 16, v27
  v_and_b32 v19, 0xffff0000, v27
  v_mul_f32 v18, v18, v24
  v_mul_f32 v19, v19, v24
  v_cvt_pk_bf16_f32 v27, v18, v19
  v_lshlrev_b32 v18, 16, v27
  v_and_b32 v19, 0xffff0000, v27
  buffer_load_dwordx4 v[136:139], v1, s[8:11], s72 offen offset:2048 nt
  buffer_load_dwordx4 v[140:143], v1, s[8:11], s72 offen offset:3072 nt
  v_lshrrev_b32 v20, 16, v16
  v_lshrrev_b32 v21, 16, v17
  v_lshrrev_b32 v22, 16, v18
  v_lshrrev_b32 v23, 16, v19
  v_dot2_f32_bf16 v48, v32, v20, 0
  v_dot2_f32_bf16 v49, v32, v16, 0
  v_dot2_f32_bf16 v50, v33, v20, 0
  v_dot2_f32_bf16 v51, v33, v16, 0
  v_dot2_f32_bf16 v52, v34, v20, 0
  v_dot2_f32_bf16 v53, v34, v16, 0
  v_dot2_f32_bf16 v54, v35, v20, 0
  v_dot2_f32_bf16 v55, v35, v16, 0
  v_dot2_f32_bf16 v56, v32, s6, 0
  v_dot2_f32_bf16 v57, v32, s7, 0
  v_dot2_f32_bf16 v58, v33, s6, 0
  v_dot2_f32_bf16 v59, v33, s7, 0
  v_dot2_f32_bf16 v60, v34, s6, 0
  v_dot2_f32_bf16 v61, v34, s7, 0
  v_dot2_f32_bf16 v62, v35, s6, 0
  v_dot2_f32_bf16 v63, v35, s7, 0
  v_dot2_f32_bf16 v48, v36, v21, v48
  v_dot2_f32_bf16 v49, v36, v17, v49
  v_dot2_f32_bf16 v50, v37, v21, v50
  v_dot2_f32_bf16 v51, v37, v17, v51
  v_dot2_f32_bf16 v52, v38, v21, v52
  v_dot2_f32_bf16 v53, v38, v17, v53
  v_dot2_f32_bf16 v54, v39, v21, v54
  v_dot2_f32_bf16 v55, v39, v17, v55
  v_dot2_f32_bf16 v56, v36, s6, v56
  v_dot2_f32_bf16 v57, v36, s7, v57
  v_dot2_f32_bf16 v58, v37, s6, v58
  v_dot2_f32_bf16 v59, v37, s7, v59
  v_dot2_f32_bf16 v60, v38, s6, v60
  v_dot2_f32_bf16 v61, v38, s7, v61
  v_dot2_f32_bf16 v62, v39, s6, v62
  v_dot2_f32_bf16 v63, v39, s7, v63
  v_dot2_f32_bf16 v48, v40, v22, v48
  v_dot2_f32_bf16 v49, v40, v18, v49
  v_dot2_f32_bf16 v50, v41, v22, v50
  v_dot2_f32_bf16 v51, v41, v18, v51
  v_dot2_f32_bf16 v52, v42, v22, v52
  v_dot2_f32_bf16 v53, v42, v18, v53
  v_dot2_f32_bf16 v54, v43, v22, v54
  v_dot2_f32_bf16 v55, v43, v18, v55
  v_dot2_f32_bf16 v56, v40, s6, v56
  v_dot2_f32_bf16 v57, v40, s7, v57
  v_dot2_f32_bf16 v58, v41, s6, v58
  v_dot2_f32_bf16 v59, v41, s7, v59
  v_dot2_f32_bf16 v60, v42, s6, v60
  v_dot2_f32_bf16 v61, v42, s7, v61
  v_dot2_f32_bf16 v62, v43, s6, v62
  v_dot2_f32_bf16 v63, v43, s7, v63
  v_dot2_f32_bf16 v48, v44, v23, v48
  v_dot2_f32_bf16 v49, v44, v19, v49
  v_dot2_f32_bf16 v50, v45, v23, v50
  v_dot2_f32_bf16 v51, v45, v19, v51
  v_dot2_f32_bf16 v52, v46, v23, v52
  v_dot2_f32_bf16 v53, v46, v19, v53
  v_dot2_f32_bf16 v54, v47, v23, v54
  v_dot2_f32_bf16 v55, v47, v19, v55
  v_dot2_f32_bf16 v56, v44, s6, v56
  v_dot2_f32_bf16 v57, v44, s7, v57
  v_dot2_f32_bf16 v58, v45, s6, v58
  v_dot2_f32_bf16 v59, v45, s7, v59
  v_dot2_f32_bf16 v60, v46, s6, v60
  v_dot2_f32_bf16 v61, v46, s7, v61
  v_dot2_f32_bf16 v62, v47, s6, v62
  v_dot2_f32_bf16 v63, v47, s7, v63
  v_permlane32_swap_b32 v48, v52
  v_permlane32_swap_b32 v49, v53
  v_permlane32_swap_b32 v50, v54
  v_permlane32_swap_b32 v51, v55
  v_permlane32_swap_b32 v56, v60
  v_permlane32_swap_b32 v57, v61
  v_permlane32_swap_b32 v58, v62
  v_permlane32_swap_b32 v59, v63
  v_add_f32 v48, v48, v52
  v_add_f32 v49, v49, v53
  v_add_f32 v50, v50, v54
  v_add_f32 v51, v51, v55
  v_add_f32 v56, v56, v60
  v_add_f32 v57, v57, v61
  v_add_f32 v58, v58, v62
  v_add_f32 v59, v59, v63
  v_permlane16_swap_b32 v48, v50
  v_permlane16_swap_b32 v49, v51
  v_permlane16_swap_b32 v56, v58
  v_permlane16_swap_b32 v57, v59
  v_add_f32 v48, v48, v50
  v_add_f32 v49, v49, v51
  v_add_f32 v56, v56, v58
  v_add_f32 v57, v57, v59
  v_add_f32_dpp v48, v48, v48 row_ror:8 row_mask:0xf bank_mask:0xf
  v_add_f32_dpp v49, v49, v49 row_ror:8 row_mask:0xf bank_mask:0xf
  v_add_f32_dpp v56, v56, v56 row_ror:8 row_mask:0xf bank_mask:0xf
  v_add_f32_dpp v57, v57, v57 row_ror:8 row_mask:0xf bank_mask:0xf
  v_and_b32 v30, 7, v0
  v_lshlrev_b32 v29, 5, v30
  v_bfe_u32 v30, v0, 4, 2
  v_lshl_add_u32 v29, v30, 3, v29
  s_mul_i32 s63, s3, 256
  v_add_u32 v29, s63, v29
  s_mov_b32 exec_lo, 0xff00ff
  s_mov_b32 exec_hi, 0xff00ff
  ds_write_b64 v29, v[48:49] offset:8192
  ds_write_b64 v29, v[56:57] offset:10240
  s_mov_b64 exec, -1
  s_bitcmp1_b32 s2, 0
  s_cselect_b32 s10, 0, 0x8000000
  s_xor_b32 s72, s49, 491520
  buffer_load_dwordx4 a[0:3], v1, s[8:11], s72 offen nt
  buffer_load_dwordx4 a[4:7], v1, s[8:11], s72 offen offset:1024 nt
  s_waitcnt lgkmcnt(0)
  s_barrier
  s_mov_b32 s64, 0x87878787
  s_mov_b32 s67, 0x06040200
  s_mov_b32 s68, 0x07050301
  s_mov_b32 s69, 0x7fff7fff
  s_mov_b32 s0, 0
  s_mov_b32 s5, 0
  s_mov_b32 s50, 0
  v_mov_b32 v31, -1
  v_add_u32 v3, s61, v2
  s_mov_b32 s65, 3
  s_cmp_lg_u32 s3, 0
  s_cbranch_scc1 L_w123
  s_mov_b32 s65, 0
  v_and_b32 v29, 63, v0
  v_lshlrev_b32 v29, 2, v29
  s_lshr_b32 s51, s4, 6
  s_lshl_b32 s51, s51, 14
  s_add_u32 s51, s51, 0x200000
  v_bfe_u32 v28, v0, 2, 1
  v_lshlrev_b32 v28, 10, v28
  v_bfe_u32 v30, v0, 5, 1
  v_lshl_add_u32 v28, v30, 8, v28
  v_bfe_u32 v30, v0, 3, 2
  v_lshl_add_u32 v28, v30, 6, v28
  v_and_b32 v30, 3, v0
  v_lshl_add_u32 v28, v30, 2, v28
  s_bfe_u32 s52, s4, 0x30003
  s_lshl_b32 s52, s52, 11
  s_add_u32 s51, s51, s52
  s_and_b32 s52, s4, 1
  s_lshl_b32 s52, s52, 9
  s_add_u32 s51, s51, s52
  s_and_b32 s52, s4, 6
  s_lshl_b32 s52, s52, 3
  s_add_u32 s51, s51, s52
  ds_read_b32 v8, v29 offset:8192
  ds_read_b32 v9, v29 offset:8448
  ds_read_b32 v10, v29 offset:8704
  ds_read_b32 v11, v29 offset:8960
  s_waitcnt lgkmcnt(0)
  v_add_f32 v8, v8, v9
  v_add_f32 v10, v10, v11
  v_add_f32 v24, v8, v10
  v_min_u32 v24, 0xfffffffe, v24
  buffer_store_dword v24, v28, s[36:39], s51 offen sc1
  v_mov_b32 v8, -1
  v_mov_b32 v9, -1
  v_mov_b32 v10, -1
  v_mov_b32 v11, -1
  s_mul_i32 s51, s2, 3072
  s_add_u32 s52, s51, 0x100000
  buffer_store_dwordx4 v[8:11], v2, s[36:39], s51 offen sc1
  buffer_store_dwordx4 v[8:11], v2, s[36:39], s52 offen sc1
  buffer_store_dwordx4 v[8:11], v2, s[36:39], s51 offen offset:1024 sc1
  buffer_store_dwordx4 v[8:11], v2, s[36:39], s52 offen offset:1024 sc1
  buffer_store_dwordx4 v[8:11], v2, s[36:39], s51 offen offset:2048 sc1
  buffer_store_dwordx4 v[8:11], v2, s[36:39], s52 offen offset:2048 sc1
  s_lshl_b32 s51, s2, 10
  s_add_u32 s51, s51, 0xc0000
  buffer_store_dwordx4 v[8:11], v2, s[36:39], s51 offen sc1
L_w123:
  s_cmp_lg_u32 s3, 1
  s_cbranch_scc1 L_w23
  v_and_b32 v29, 63, v0
  v_lshlrev_b32 v29, 2, v29
  s_lshr_b32 s51, s4, 6
  s_lshl_b32 s51, s51, 14
  s_add_u32 s51, s51, 0x210000
  v_bfe_u32 v28, v0, 2, 1
  v_lshlrev_b32 v28, 10, v28
  v_bfe_u32 v30, v0, 5, 1
  v_lshl_add_u32 v28, v30, 8, v28
  v_bfe_u32 v30, v0, 3, 2
  v_lshl_add_u32 v28, v30, 6, v28
  v_and_b32 v30, 3, v0
  v_lshl_add_u32 v28, v30, 2, v28
  s_bfe_u32 s52, s4, 0x30003
  s_lshl_b32 s52, s52, 11
  s_add_u32 s51, s51, s52
  s_and_b32 s52, s4, 1
  s_lshl_b32 s52, s52, 9
  s_add_u32 s51, s51, s52
  s_and_b32 s52, s4, 6
  s_lshl_b32 s52, s52, 3
  s_add_u32 s51, s51, s52
  ds_read_b32 v8, v29 offset:10240
  ds_read_b32 v9, v29 offset:10496
  ds_read_b32 v10, v29 offset:10752
  ds_read_b32 v11, v29 offset:11008
  s_waitcnt lgkmcnt(0)
  v_add_f32 v8, v8, v9
  v_add_f32 v10, v10, v11
  v_add_f32 v24, v8, v10
  v_min_u32 v24, 0xfffffffe, v24
  buffer_store_dword v24, v28, s[36:39], s51 offen sc1
L_w23:
  s_xor_b32 s72, s49, 491520
  buffer_load_dwordx4 a[8:11], v1, s[8:11], s72 offen offset:2048 nt
  v_mov_b32 v28, 0
  v_mov_b32 v29, 0
  s_waitcnt vmcnt(19)
  v_mov_b64 v[48:49], v[64:65]
  v_mov_b64 v[50:51], v[66:67]
  v_mov_b64 v[52:53], v[68:69]
  v_mov_b64 v[54:55], v[70:71]
  v_mov_b64 v[56:57], v[72:73]
  v_mov_b64 v[58:59], v[74:75]
  v_mov_b64 v[60:61], v[76:77]
  v_mov_b64 v[62:63], v[78:79]
  v_and_b32 v32, s69, v48
  v_and_b32 v33, s69, v49
  v_and_b32 v34, s69, v50
  v_and_b32 v35, s69, v51
  v_and_b32 v36, s69, v52
  v_and_b32 v37, s69, v53
  v_and_b32 v38, s69, v54
  v_and_b32 v39, s69, v55
  v_and_b32 v40, s69, v56
  v_and_b32 v41, s69, v57
  v_and_b32 v42, s69, v58
  v_and_b32 v43, s69, v59
  v_and_b32 v44, s69, v60
  v_and_b32 v45, s69, v61
  v_and_b32 v46, s69, v62
  v_and_b32 v47, s69, v63
  v_pk_max_u16 v28, v28, v32
  v_pk_max_u16 v28, v28, v33
  v_pk_max_u16 v28, v28, v34
  v_pk_max_u16 v28, v28, v35
  v_pk_max_u16 v28, v28, v36
  v_pk_max_u16 v28, v28, v37
  v_pk_max_u16 v28, v28, v38
  v_pk_max_u16 v28, v28, v39
  v_pk_max_u16 v28, v28, v40
  v_pk_max_u16 v28, v28, v41
  v_pk_max_u16 v28, v28, v42
  v_pk_max_u16 v28, v28, v43
  v_pk_max_u16 v28, v28, v44
  v_pk_max_u16 v28, v28, v45
  v_pk_max_u16 v28, v28, v46
  v_pk_max_u16 v28, v28, v47
  buffer_load_dwordx4 a[12:15], v1, s[8:11], s72 offen offset:3072 nt
  s_waitcnt vmcnt(16)
  v_mov_b64 v[48:49], v[80:81]
  v_mov_b64 v[50:51], v[82:83]
  v_mov_b64 v[52:53], v[84:85]
  v_mov_b64 v[54:55], v[86:87]
  v_mov_b64 v[56:57], v[88:89]
  v_mov_b64 v[58:59], v[90:91]
  v_mov_b64 v[60:61], v[92:93]
  v_mov_b64 v[62:63], v[94:95]
  v_and_b32 v32, s69, v48
  v_and_b32 v33, s69, v49
  v_and_b32 v34, s69, v50
  v_and_b32 v35, s69, v51
  v_and_b32 v36, s69, v52
  v_and_b32 v37, s69, v53
  v_and_b32 v38, s69, v54
  v_and_b32 v39, s69, v55
  v_and_b32 v40, s69, v56
  v_and_b32 v41, s69, v57
  v_and_b32 v42, s69, v58
  v_and_b32 v43, s69, v59
  v_and_b32 v44, s69, v60
  v_and_b32 v45, s69, v61
  v_and_b32 v46, s69, v62
  v_and_b32 v47, s69, v63
  v_pk_max_u16 v28, v28, v32
  v_pk_max_u16 v28, v28, v33
  v_pk_max_u16 v28, v28, v34
  v_pk_max_u16 v28, v28, v35
  v_pk_max_u16 v28, v28, v36
  v_pk_max_u16 v28, v28, v37
  v_pk_max_u16 v28, v28, v38
  v_pk_max_u16 v28, v28, v39
  v_pk_max_u16 v28, v28, v40
  v_pk_max_u16 v28, v28, v41
  v_pk_max_u16 v28, v28, v42
  v_pk_max_u16 v28, v28, v43
  v_pk_max_u16 v28, v28, v44
  v_pk_max_u16 v28, v28, v45
  v_pk_max_u16 v28, v28, v46
  v_pk_max_u16 v28, v28, v47
  s_mov_b32 s10, 0x8000000
  s_xor_b32 s72, s49, 49152
  buffer_load_dwordx4 v[144:147], v1, s[8:11], s72 offen nt
  s_waitcnt vmcnt(13)
  v_mov_b64 v[48:49], v[96:97]
  v_mov_b64 v[50:51], v[98:99]
  v_mov_b64 v[52:53], v[100:101]
  v_mov_b64 v[54:55], v[102:103]
  v_mov_b64 v[56:57], v[104:105]
  v_mov_b64 v[58:59], v[106:107]
  v_mov_b64 v[60:61], v[108:109]
  v_mov_b64 v[62:63], v[110:111]
  v_and_b32 v32, s69, v48
  v_and_b32 v33, s69, v49
  v_and_b32 v34, s69, v50
  v_and_b32 v35, s69, v51
  v_and_b32 v36, s69, v52
  v_and_b32 v37, s69, v53
  v_and_b32 v38, s69, v54
  v_and_b32 v39, s69, v55
  v_and_b32 v40, s69, v56
  v_and_b32 v41, s69, v57
  v_and_b32 v42, s69, v58
  v_and_b32 v43, s69, v59
  v_and_b32 v44, s69, v60
  v_and_b32 v45, s69, v61
  v_and_b32 v46, s69, v62
  v_and_b32 v47, s69, v63
  v_pk_max_u16 v29, v29, v32
  v_pk_max_u16 v29, v29, v33
  v_pk_max_u16 v29, v29, v34
  v_pk_max_u16 v29, v29, v35
  v_pk_max_u16 v29, v29, v36
  v_pk_max_u16 v29, v29, v37
  v_pk_max_u16 v29, v29, v38
  v_pk_max_u16 v29, v29, v39
  v_pk_max_u16 v29, v29, v40
  v_pk_max_u16 v29, v29, v41
  v_pk_max_u16 v29, v29, v42
  v_pk_max_u16 v29, v29, v43
  v_pk_max_u16 v29, v29, v44
  v_pk_max_u16 v29, v29, v45
  v_pk_max_u16 v29, v29, v46
  v_pk_max_u16 v29, v29, v47
  buffer_load_dwordx4 v[148:151], v1, s[8:11], s72 offen offset:1024 nt
  s_waitcnt vmcnt(10)
  v_mov_b64 v[48:49], v[112:113]
  v_mov_b64 v[50:51], v[114:115]
  v_mov_b64 v[52:53], v[116:117]
  v_mov_b64 v[54:55], v[118:119]
  v_mov_b64 v[56:57], v[120:121]
  v_mov_b64 v[58:59], v[122:123]
  v_mov_b64 v[60:61], v[124:125]
  v_mov_b64 v[62:63], v[126:127]
  v_and_b32 v32, s69, v48
  v_and_b32 v33, s69, v49
  v_and_b32 v34, s69, v50
  v_and_b32 v35, s69, v51
  v_and_b32 v36, s69, v52
  v_and_b32 v37, s69, v53
  v_and_b32 v38, s69, v54
  v_and_b32 v39, s69, v55
  v_and_b32 v40, s69, v56
  v_and_b32 v41, s69, v57
  v_and_b32 v42, s69, v58
  v_and_b32 v43, s69, v59
  v_and_b32 v44, s69, v60
  v_and_b32 v45, s69, v61
  v_and_b32 v46, s69, v62
  v_and_b32 v47, s69, v63
  v_pk_max_u16 v29, v29, v32
  v_pk_max_u16 v29, v29, v33
  v_pk_max_u16 v29, v29, v34
  v_pk_max_u16 v29, v29, v35
  v_pk_max_u16 v29, v29, v36
  v_pk_max_u16 v29, v29, v37
  v_pk_max_u16 v29, v29, v38
  v_pk_max_u16 v29, v29, v39
  v_pk_max_u16 v29, v29, v40
  v_pk_max_u16 v29, v29, v41
  v_pk_max_u16 v29, v29, v42
  v_pk_max_u16 v29, v29, v43
  v_pk_max_u16 v29, v29, v44
  v_pk_max_u16 v29, v29, v45
  v_pk_max_u16 v29, v29, v46
  v_pk_max_u16 v29, v29, v47
  buffer_load_dwordx4 v[152:155], v1, s[8:11], s72 offen offset:2048 nt
  s_cmp_lg_u32 s65, 0
  s_cbranch_scc1 L_h0
  s_waitcnt vmcnt(5)
  v_mov_b32 v4, 1
  v_mov_b32 v5, 0
  s_mov_b32 exec_lo, 0x1
  s_mov_b32 exec_hi, 0x0
  buffer_atomic_add v4, v5, s[88:91], 0 offen sc1
  s_mov_b64 exec, -1
L_h0:
  v_lshrrev_b32 v32, 16, v28
  v_and_b32 v28, 0xffff, v28
  v_max_u32 v28, v28, v32
  v_lshrrev_b32 v32, 16, v29
  v_and_b32 v29, 0xffff, v29
  v_max_u32 v29, v29, v32
  v_max_u32_dpp v28, v28, v28 quad_perm:[1,0,3,2] row_mask:0xf bank_mask:0xf
  s_nop 0
  v_max_u32_dpp v29, v29, v29 quad_perm:[1,0,3,2] row_mask:0xf bank_mask:0xf
  v_max_u32_dpp v28, v28, v28 quad_perm:[2,3,0,1] row_mask:0xf bank_mask:0xf
  s_nop 0
  v_max_u32_dpp v29, v29, v29 quad_perm:[2,3,0,1] row_mask:0xf bank_mask:0xf
  v_max_u32_dpp v28, v28, v28 row_half_mirror row_mask:0xf bank_mask:0xf
  s_nop 0
  v_max_u32_dpp v29, v29, v29 row_half_mirror row_mask:0xf bank_mask:0xf
  v_max_u32_dpp v28, v28, v28 row_mirror row_mask:0xf bank_mask:0xf
  s_nop 0
  v_max_u32_dpp v29, v29, v29 row_mirror row_mask:0xf bank_mask:0xf
  v_mov_b32 v32, v28
  s_nop 1
  v_permlane16_swap_b32 v28, v32
  v_max_u32 v28, v28, v32
  v_mov_b32 v33, v29
  s_nop 1
  v_permlane16_swap_b32 v29, v33
  v_max_u32 v29, v29, v33
  v_mov_b32 v32, v28
  s_nop 1
  v_permlane32_swap_b32 v28, v32
  v_max_u32 v28, v28, v32
  v_mov_b32 v33, v29
  s_nop 1
  v_permlane32_swap_b32 v29, v33
  v_max_u32 v29, v29, v33
  v_readfirstlane_b32 s42, v28
  s_nop 1
  s_lshr_b32 s42, s42, 7
  s_max_u32 s42, s42, 15
  s_sub_u32 s42, s42, 15
  s_min_u32 s42, s42, 127
  s_mul_i32 s42, s42, 0x00800080
  v_readfirstlane_b32 s43, v29
  s_nop 1
  s_lshr_b32 s43, s43, 7
  s_max_u32 s43, s43, 15
  s_sub_u32 s43, s43, 15
  s_min_u32 s43, s43, 127
  s_add_u32 s51, s43, 127
  s_lshl_b32 s41, s51, 23
  s_mul_i32 s43, s43, 0x00800080
  v_mov_b64 v[48:49], v[64:65]
  v_mov_b64 v[50:51], v[66:67]
  v_mov_b64 v[52:53], v[68:69]
  v_mov_b64 v[54:55], v[70:71]
  v_mov_b64 v[56:57], v[72:73]
  v_mov_b64 v[58:59], v[74:75]
  v_mov_b64 v[60:61], v[76:77]
  v_mov_b64 v[62:63], v[78:79]
  s_mov_b32 s70, 0
  s_mov_b32 s71, s42
  s_call_b64 s[74:75], L_enc
  s_nop 1
  v_accvgpr_write_b32 a16, v32
  v_accvgpr_write_b32 a17, v33
  v_accvgpr_write_b32 a18, v34
  v_accvgpr_write_b32 a19, v35
  v_accvgpr_write_b32 a20, v36
  v_accvgpr_write_b32 a21, v37
  v_accvgpr_write_b32 a22, v38
  v_accvgpr_write_b32 a23, v39
  v_accvgpr_write_b32 a24, v40
  v_accvgpr_write_b32 a25, v41
  v_accvgpr_write_b32 a26, v42
  v_accvgpr_write_b32 a27, v43
  buffer_load_dwordx4 v[156:159], v1, s[8:11], s72 offen offset:3072 nt
  s_xor_b32 s72, s49, 32768
  buffer_load_dwordx4 v[160:163], v2, s[12:15], s72 offen nt
  buffer_load_dwordx4 v[164:167], v2, s[12:15], s72 offen offset:1024 nt
  v_mov_b64 v[48:49], v[80:81]
  v_mov_b64 v[50:51], v[82:83]
  v_mov_b64 v[52:53], v[84:85]
  v_mov_b64 v[54:55], v[86:87]
  v_mov_b64 v[56:57], v[88:89]
  v_mov_b64 v[58:59], v[90:91]
  v_mov_b64 v[60:61], v[92:93]
  v_mov_b64 v[62:63], v[94:95]
  s_mov_b32 s70, 1
  s_mov_b32 s71, s42
  s_call_b64 s[74:75], L_enc
  s_nop 1
  ds_write_b128 v3, v[32:35] offset:6144
  ds_write_b128 v3, v[36:39] offset:7168
  ds_write_b128 v3, v[40:43] offset:8192
  buffer_load_dwordx4 v[168:171], v2, s[12:15], s72 offen offset:2048 nt
  buffer_load_dwordx4 v[172:175], v2, s[12:15], s72 offen offset:3072 nt
  s_bitcmp1_b32 s2, 0
  s_cselect_b32 s10, 0, 0x8000000
  s_xor_b32 s72, s49, 507904
  buffer_load_dwordx4 a[28:31], v1, s[8:11], s72 offen nt
  v_mov_b64 v[48:49], v[96:97]
  v_mov_b64 v[50:51], v[98:99]
  v_mov_b64 v[52:53], v[100:101]
  v_mov_b64 v[54:55], v[102:103]
  v_mov_b64 v[56:57], v[104:105]
  v_mov_b64 v[58:59], v[106:107]
  v_mov_b64 v[60:61], v[108:109]
  v_mov_b64 v[62:63], v[110:111]
  s_mov_b32 s70, 256
  s_mov_b32 s71, s43
  s_call_b64 s[74:75], L_enc
  s_nop 1
  v_accvgpr_write_b32 a32, v32
  v_accvgpr_write_b32 a33, v33
  v_accvgpr_write_b32 a34, v34
  v_accvgpr_write_b32 a35, v35
  v_accvgpr_write_b32 a36, v36
  v_accvgpr_write_b32 a37, v37
  v_accvgpr_write_b32 a38, v38
  v_accvgpr_write_b32 a39, v39
  v_accvgpr_write_b32 a40, v40
  v_accvgpr_write_b32 a41, v41
  v_accvgpr_write_b32 a42, v42
  v_accvgpr_write_b32 a43, v43
  buffer_load_dwordx4 a[44:47], v1, s[8:11], s72 offen offset:1024 nt
  buffer_load_dwordx4 a[48:51], v1, s[8:11], s72 offen offset:2048 nt
  buffer_load_dwordx4 a[52:55], v1, s[8:11], s72 offen offset:3072 nt
  v_mov_b64 v[48:49], v[112:113]
  v_mov_b64 v[50:51], v[114:115]
  v_mov_b64 v[52:53], v[116:117]
  v_mov_b64 v[54:55], v[118:119]
  v_mov_b64 v[56:57], v[120:121]
  v_mov_b64 v[58:59], v[122:123]
  v_mov_b64 v[60:61], v[124:125]
  v_mov_b64 v[62:63], v[126:127]
  s_mov_b32 s70, 257
  s_mov_b32 s71, s43
  s_call_b64 s[74:75], L_enc
  s_nop 1
  v_accvgpr_write_b32 a56, v32
  v_accvgpr_write_b32 a57, v33
  v_accvgpr_write_b32 a58, v34
  v_accvgpr_write_b32 a59, v35
  v_accvgpr_write_b32 a60, v36
  v_accvgpr_write_b32 a61, v37
  v_accvgpr_write_b32 a62, v38
  v_accvgpr_write_b32 a63, v39
  v_accvgpr_write_b32 a64, v40
  v_accvgpr_write_b32 a65, v41
  v_accvgpr_write_b32 a66, v42
  v_accvgpr_write_b32 a67, v43
  s_xor_b32 s72, s49, 49152
  buffer_load_dwordx4 v[176:179], v2, s[12:15], s72 offen nt
  buffer_load_dwordx4 v[180:183], v2, s[12:15], s72 offen offset:1024 nt
  buffer_load_dwordx4 v[184:187], v2, s[12:15], s72 offen offset:2048 nt
  buffer_load_dwordx4 v[188:191], v2, s[12:15], s72 offen offset:3072 nt
  s_waitcnt vmcnt(20)
  v_mov_b64 v[48:49], v[128:129]
  v_mov_b64 v[50:51], v[130:131]
  v_mov_b64 v[52:53], v[132:133]
  v_mov_b64 v[54:55], v[134:135]
  v_mov_b64 v[56:57], v[136:137]
  v_mov_b64 v[58:59], v[138:139]
  v_mov_b64 v[60:61], v[140:141]
  v_mov_b64 v[62:63], v[142:143]
  s_mov_b32 s70, 2
  s_mov_b32 s71, s42
  s_call_b64 s[74:75], L_enc
  s_nop 1
  v_accvgpr_write_b32 a68, v32
  v_accvgpr_write_b32 a69, v33
  v_accvgpr_write_b32 a70, v34
  v_accvgpr_write_b32 a71, v35
  v_accvgpr_write_b32 a72, v36
  v_accvgpr_write_b32 a73, v37
  v_accvgpr_write_b32 a74, v38
  v_accvgpr_write_b32 a75, v39
  v_accvgpr_write_b32 a76, v40
  v_accvgpr_write_b32 a77, v41
  v_accvgpr_write_b32 a78, v42
  v_accvgpr_write_b32 a79, v43
  s_mov_b32 s10, 0x8000000
  s_xor_b32 s72, s49, 65536
  buffer_load_dwordx4 v[192:195], v1, s[8:11], s72 offen nt
  buffer_load_dwordx4 v[196:199], v1, s[8:11], s72 offen offset:1024 nt
  s_waitcnt vmcnt(14)
  v_mov_b64 v[48:49], v[144:145]
  v_mov_b64 v[50:51], v[146:147]
  v_mov_b64 v[52:53], v[148:149]
  v_mov_b64 v[54:55], v[150:151]
  v_mov_b64 v[56:57], v[152:153]
  v_mov_b64 v[58:59], v[154:155]
  v_mov_b64 v[60:61], v[156:157]
  v_mov_b64 v[62:63], v[158:159]
  s_mov_b32 s70, 3
  s_mov_b32 s71, s42
  s_call_b64 s[74:75], L_enc
  s_nop 1
  ds_write_b128 v3, v[32:35] offset:9216
  ds_write_b128 v3, v[36:39] offset:10240
  ds_write_b128 v3, v[40:43] offset:11264
  buffer_load_dwordx4 v[200:203], v1, s[8:11], s72 offen offset:2048 nt
  buffer_load_dwordx4 v[204:207], v1, s[8:11], s72 offen offset:3072 nt
  s_bitcmp1_b32 s2, 0
  s_cselect_b32 s14, 0, 0x8000000
  s_xor_b32 s72, s49, 491520
  buffer_load_dwordx4 a[80:83], v2, s[12:15], s72 offen nt
  s_waitcnt vmcnt(13)
  v_mov_b64 v[48:49], v[160:161]
  v_mov_b64 v[50:51], v[162:163]
  v_mov_b64 v[52:53], v[164:165]
  v_mov_b64 v[54:55], v[166:167]
  v_mov_b64 v[56:57], v[168:169]
  v_mov_b64 v[58:59], v[170:171]
  v_mov_b64 v[60:61], v[172:173]
  v_mov_b64 v[62:63], v[174:175]
  s_mov_b32 s70, 258
  s_mov_b32 s71, s43
  s_call_b64 s[74:75], L_enc
  s_nop 1
  v_accvgpr_write_b32 a84, v32
  v_accvgpr_write_b32 a85, v33
  v_accvgpr_write_b32 a86, v34
  v_accvgpr_write_b32 a87, v35
  v_accvgpr_write_b32 a88, v36
  v_accvgpr_write_b32 a89, v37
  v_accvgpr_write_b32 a90, v38
  v_accvgpr_write_b32 a91, v39
  v_accvgpr_write_b32 a92, v40
  v_accvgpr_write_b32 a93, v41
  v_accvgpr_write_b32 a94, v42
  v_accvgpr_write_b32 a95, v43
  buffer_load_dwordx4 a[96:99], v2, s[12:15], s72 offen offset:1024 nt
  buffer_load_dwordx4 a[100:103], v2, s[12:15], s72 offen offset:2048 nt
  buffer_load_dwordx4 a[104:107], v2, s[12:15], s72 offen offset:3072 nt
  s_xor_b32 s72, s49, 81920
  buffer_load_dwordx4 v[208:211], v1, s[8:11], s72 offen nt
  s_waitcnt vmcnt(9)
  v_mov_b64 v[48:49], v[176:177]
  v_mov_b64 v[50:51], v[178:179]
  v_mov_b64 v[52:53], v[180:181]
  v_mov_b64 v[54:55], v[182:183]
  v_mov_b64 v[56:57], v[184:185]
  v_mov_b64 v[58:59], v[186:187]
  v_mov_b64 v[60:61], v[188:189]
  v_mov_b64 v[62:63], v[190:191]
  s_mov_b32 s70, 259
  s_mov_b32 s71, s43
  s_call_b64 s[74:75], L_enc
  s_nop 1
  v_accvgpr_write_b32 a108, v32
  v_accvgpr_write_b32 a109, v33
  v_accvgpr_write_b32 a110, v34
  v_accvgpr_write_b32 a111, v35
  v_accvgpr_write_b32 a112, v36
  v_accvgpr_write_b32 a113, v37
  v_accvgpr_write_b32 a114, v38
  v_accvgpr_write_b32 a115, v39
  v_accvgpr_write_b32 a116, v40
  v_accvgpr_write_b32 a117, v41
  v_accvgpr_write_b32 a118, v42
  v_accvgpr_write_b32 a119, v43
  buffer_load_dwordx4 v[212:215], v1, s[8:11], s72 offen offset:1024 nt
  buffer_load_dwordx4 v[216:219], v1, s[8:11], s72 offen offset:2048 nt
  buffer_load_dwordx4 v[220:223], v1, s[8:11], s72 offen offset:3072 nt
  s_mov_b32 s14, 0x8000000
  s_xor_b32 s72, s49, 65536
  buffer_load_dwordx4 v[224:227], v2, s[12:15], s72 offen nt
  buffer_load_dwordx4 v[228:231], v2, s[12:15], s72 offen offset:1024 nt
  buffer_load_dwordx4 v[232:235], v2, s[12:15], s72 offen offset:2048 nt
  buffer_load_dwordx4 v[236:239], v2, s[12:15], s72 offen offset:3072 nt
  s_bitcmp1_b32 s2, 0
  s_cselect_b32 s14, 0, 0x8000000
  s_xor_b32 s72, s49, 507904
  buffer_load_dwordx4 a[120:123], v2, s[12:15], s72 offen nt
  s_cmp_lg_u32 s65, 0
  s_cbranch_scc1 L_h1
  v_mov_b32 v5, 0
  buffer_load_dword v4, v5, s[88:91], 0 offen sc1
L_h1:
  buffer_load_dwordx4 a[124:127], v2, s[12:15], s72 offen offset:1024 nt
  buffer_load_dwordx4 a[128:131], v2, s[12:15], s72 offen offset:2048 nt
  buffer_load_dwordx4 a[132:135], v2, s[12:15], s72 offen offset:3072 nt
  s_mov_b32 s14, 0x8000000
  s_xor_b32 s72, s49, 81920
  buffer_load_dwordx4 v[240:243], v2, s[12:15], s72 offen nt
  buffer_load_dwordx4 v[244:247], v2, s[12:15], s72 offen offset:1024 nt
  buffer_load_dwordx4 v[64:67], v2, s[12:15], s72 offen offset:2048 nt
  buffer_load_dwordx4 v[68:71], v2, s[12:15], s72 offen offset:3072 nt
  s_waitcnt vmcnt(20)
  v_mov_b64 v[48:49], v[192:193]
  v_mov_b64 v[50:51], v[194:195]
  v_mov_b64 v[52:53], v[196:197]
  v_mov_b64 v[54:55], v[198:199]
  v_mov_b64 v[56:57], v[200:201]
  v_mov_b64 v[58:59], v[202:203]
  v_mov_b64 v[60:61], v[204:205]
  v_mov_b64 v[62:63], v[206:207]
  s_mov_b32 s70, 4
  s_mov_b32 s71, s42
  s_call_b64 s[74:75], L_enc
  s_nop 1
  v_accvgpr_write_b32 a136, v32
  v_accvgpr_write_b32 a137, v33
  v_accvgpr_write_b32 a138, v34
  v_accvgpr_write_b32 a139, v35
  v_accvgpr_write_b32 a140, v36
  v_accvgpr_write_b32 a141, v37
  v_accvgpr_write_b32 a142, v38
  v_accvgpr_write_b32 a143, v39
  v_accvgpr_write_b32 a144, v40
  v_accvgpr_write_b32 a145, v41
  v_accvgpr_write_b32 a146, v42
  v_accvgpr_write_b32 a147, v43
  s_waitcnt vmcnt(12)
  v_mov_b64 v[48:49], v[208:209]
  v_mov_b64 v[50:51], v[210:211]
  v_mov_b64 v[52:53], v[212:213]
  v_mov_b64 v[54:55], v[214:215]
  v_mov_b64 v[56:57], v[216:217]
  v_mov_b64 v[58:59], v[218:219]
  v_mov_b64 v[60:61], v[220:221]
  v_mov_b64 v[62:63], v[222:223]
  s_mov_b32 s70, 5
  s_mov_b32 s71, s42
  s_call_b64 s[74:75], L_enc
  s_nop 1
  ds_write_b128 v3, v[32:35] offset:12288
  ds_write_b128 v3, v[36:39] offset:13312
  ds_write_b128 v3, v[40:43] offset:14336
  s_xor_b32 s72, s49, 98304
  buffer_load_dwordx4 v[72:75], v1, s[8:11], s72 offen nt
  buffer_load_dwordx4 v[76:79], v1, s[8:11], s72 offen offset:1024 nt
  buffer_load_dwordx4 v[80:83], v1, s[8:11], s72 offen offset:2048 nt
  buffer_load_dwordx4 v[84:87], v1, s[8:11], s72 offen offset:3072 nt
  s_bitcmp1_b32 s2, 0
  s_cselect_b32 s10, 0, 0x8000000
  s_xor_b32 s72, s49, 1015808
  buffer_load_dwordx4 a[148:151], v1, s[8:11], s72 offen nt
  s_waitcnt vmcnt(13)
  v_mov_b64 v[48:49], v[224:225]
  v_mov_b64 v[50:51], v[226:227]
  v_mov_b64 v[52:53], v[228:229]
  v_mov_b64 v[54:55], v[230:231]
  v_mov_b64 v[56:57], v[232:233]
  v_mov_b64 v[58:59], v[234:235]
  v_mov_b64 v[60:61], v[236:237]
  v_mov_b64 v[62:63], v[238:239]
  s_mov_b32 s70, 260
  s_mov_b32 s71, s43
  s_call_b64 s[74:75], L_enc
  s_nop 1
  v_accvgpr_write_b32 a152, v32
  v_accvgpr_write_b32 a153, v33
  v_accvgpr_write_b32 a154, v34
  v_accvgpr_write_b32 a155, v35
  v_accvgpr_write_b32 a156, v36
  v_accvgpr_write_b32 a157, v37
  v_accvgpr_write_b32 a158, v38
  v_accvgpr_write_b32 a159, v39
  v_accvgpr_write_b32 a160, v40
  v_accvgpr_write_b32 a161, v41
  v_accvgpr_write_b32 a162, v42
  v_accvgpr_write_b32 a163, v43
  buffer_load_dwordx4 a[164:167], v1, s[8:11], s72 offen offset:1024 nt
  buffer_load_dwordx4 a[168:171], v1, s[8:11], s72 offen offset:2048 nt
  buffer_load_dwordx4 a[172:175], v1, s[8:11], s72 offen offset:3072 nt
  s_mov_b32 s10, 0x8000000
  s_xor_b32 s72, s49, 114688
  buffer_load_dwordx4 v[88:91], v1, s[8:11], s72 offen nt
  s_waitcnt vmcnt(9)
  v_mov_b64 v[48:49], v[240:241]
  v_mov_b64 v[50:51], v[242:243]
  v_mov_b64 v[52:53], v[244:245]
  v_mov_b64 v[54:55], v[246:247]
  v_mov_b64 v[56:57], v[64:65]
  v_mov_b64 v[58:59], v[66:67]
  v_mov_b64 v[60:61], v[68:69]
  v_mov_b64 v[62:63], v[70:71]
  s_mov_b32 s70, 261
  s_mov_b32 s71, s43
  s_call_b64 s[74:75], L_enc
  s_nop 1
  v_accvgpr_write_b32 a176, v32
  v_accvgpr_write_b32 a177, v33
  v_accvgpr_write_b32 a178, v34
  v_accvgpr_write_b32 a179, v35
  v_accvgpr_write_b32 a180, v36
  v_accvgpr_write_b32 a181, v37
  v_accvgpr_write_b32 a182, v38
  v_accvgpr_write_b32 a183, v39
  v_accvgpr_write_b32 a184, v40
  v_accvgpr_write_b32 a185, v41
  v_accvgpr_write_b32 a186, v42
  v_accvgpr_write_b32 a187, v43
  buffer_load_dwordx4 v[92:95], v1, s[8:11], s72 offen offset:1024 nt
  buffer_load_dwordx4 v[96:99], v1, s[8:11], s72 offen offset:2048 nt
  buffer_load_dwordx4 v[100:103], v1, s[8:11], s72 offen offset:3072 nt
  s_xor_b32 s72, s49, 98304
  buffer_load_dwordx4 v[104:107], v2, s[12:15], s72 offen nt
  buffer_load_dwordx4 v[108:111], v2, s[12:15], s72 offen offset:1024 nt
  buffer_load_dwordx4 v[112:115], v2, s[12:15], s72 offen offset:2048 nt
  buffer_load_dwordx4 v[116:119], v2, s[12:15], s72 offen offset:3072 nt
  s_bitcmp1_b32 s2, 0
  s_cselect_b32 s10, 0, 0x8000000
  s_xor_b32 s72, s49, 1032192
  buffer_load_dwordx4 a[188:191], v1, s[8:11], s72 offen nt
  buffer_load_dwordx4 a[192:195], v1, s[8:11], s72 offen offset:1024 nt
  buffer_load_dwordx4 a[196:199], v1, s[8:11], s72 offen offset:2048 nt
  buffer_load_dwordx4 a[200:203], v1, s[8:11], s72 offen offset:3072 nt
  s_xor_b32 s72, s49, 114688
  buffer_load_dwordx4 v[120:123], v2, s[12:15], s72 offen nt
  buffer_load_dwordx4 v[124:127], v2, s[12:15], s72 offen offset:1024 nt
  buffer_load_dwordx4 v[128:131], v2, s[12:15], s72 offen offset:2048 nt
  buffer_load_dwordx4 v[132:135], v2, s[12:15], s72 offen offset:3072 nt
  s_waitcnt vmcnt(20)
  v_mov_b64 v[48:49], v[72:73]
  v_mov_b64 v[50:51], v[74:75]
  v_mov_b64 v[52:53], v[76:77]
  v_mov_b64 v[54:55], v[78:79]
  v_mov_b64 v[56:57], v[80:81]
  v_mov_b64 v[58:59], v[82:83]
  v_mov_b64 v[60:61], v[84:85]
  v_mov_b64 v[62:63], v[86:87]
  s_mov_b32 s70, 6
  s_mov_b32 s71, s42
  s_call_b64 s[74:75], L_enc
  s_nop 1
  v_accvgpr_write_b32 a204, v32
  v_accvgpr_write_b32 a205, v33
  v_accvgpr_write_b32 a206, v34
  v_accvgpr_write_b32 a207, v35
  v_accvgpr_write_b32 a208, v36
  v_accvgpr_write_b32 a209, v37
  v_accvgpr_write_b32 a210, v38
  v_accvgpr_write_b32 a211, v39
  v_accvgpr_write_b32 a212, v40
  v_accvgpr_write_b32 a213, v41
  v_accvgpr_write_b32 a214, v42
  v_accvgpr_write_b32 a215, v43
  s_cmp_lg_u32 s65, 0
  s_cbranch_scc1 L_h2
  s_waitcnt vmcnt(31)
  v_readfirstlane_b32 s51, v4
  s_nop 0
  s_cmp_lt_u32 s51, 256
  s_cbranch_scc1 L_h2
  s_mov_b32 s65, 1
  s_add_u32 s51, s54, 0
  buffer_load_dwordx4 v[4:7], v2, s[36:39], s51 offen sc1
  buffer_load_dwordx4 v[8:11], v2, s[36:39], s51 offen offset:1024 sc1
  s_add_u32 s51, s54, 16384
  buffer_load_dwordx4 v[12:15], v2, s[36:39], s51 offen sc1
  buffer_load_dwordx4 v[16:19], v2, s[36:39], s51 offen offset:1024 sc1
  s_add_u32 s51, s54, 32768
  buffer_load_dwordx4 v[20:23], v2, s[36:39], s51 offen sc1
  buffer_load_dwordx4 v[24:27], v2, s[36:39], s51 offen offset:1024 sc1
  s_add_u32 s51, s54, 49152
  buffer_load_dwordx4 v[248:251], v2, s[36:39], s51 offen sc1
  buffer_load_dwordx4 v[252:255], v2, s[36:39], s51 offen offset:1024 sc1
L_h2:
  s_waitcnt vmcnt(12)
  v_mov_b64 v[48:49], v[88:89]
  v_mov_b64 v[50:51], v[90:91]
  v_mov_b64 v[52:53], v[92:93]
  v_mov_b64 v[54:55], v[94:95]
  v_mov_b64 v[56:57], v[96:97]
  v_mov_b64 v[58:59], v[98:99]
  v_mov_b64 v[60:61], v[100:101]
  v_mov_b64 v[62:63], v[102:103]
  s_mov_b32 s70, 7
  s_mov_b32 s71, s42
  s_call_b64 s[74:75], L_enc
  s_nop 1
  ds_write_b128 v3, v[32:35] offset:15360
  ds_write_b128 v3, v[36:39] offset:16384
  ds_write_b128 v3, v[40:43] offset:17408
  s_mov_b32 s10, 0x8000000
  s_xor_b32 s72, s49, 131072
  buffer_load_dwordx4 v[136:139], v1, s[8:11], s72 offen nt
  buffer_load_dwordx4 v[140:143], v1, s[8:11], s72 offen offset:1024 nt
  buffer_load_dwordx4 v[144:147], v1, s[8:11], s72 offen offset:2048 nt
  buffer_load_dwordx4 v[148:151], v1, s[8:11], s72 offen offset:3072 nt
  s_bitcmp1_b32 s2, 0
  s_cselect_b32 s14, 0, 0x8000000
  s_xor_b32 s72, s49, 1015808
  buffer_load_dwordx4 a[216:219], v2, s[12:15], s72 offen nt
  s_waitcnt vmcnt(13)
  v_mov_b64 v[48:49], v[104:105]
  v_mov_b64 v[50:51], v[106:107]
  v_mov_b64 v[52:53], v[108:109]
  v_mov_b64 v[54:55], v[110:111]
  v_mov_b64 v[56:57], v[112:113]
  v_mov_b64 v[58:59], v[114:115]
  v_mov_b64 v[60:61], v[116:117]
  v_mov_b64 v[62:63], v[118:119]
  s_mov_b32 s70, 262
  s_mov_b32 s71, s43
  s_call_b64 s[74:75], L_enc
  s_nop 1
  v_accvgpr_write_b32 a220, v32
  v_accvgpr_write_b32 a221, v33
  v_accvgpr_write_b32 a222, v34
  v_accvgpr_write_b32 a223, v35
  v_accvgpr_write_b32 a224, v36
  v_accvgpr_write_b32 a225, v37
  v_accvgpr_write_b32 a226, v38
  v_accvgpr_write_b32 a227, v39
  v_accvgpr_write_b32 a228, v40
  v_accvgpr_write_b32 a229, v41
  v_accvgpr_write_b32 a230, v42
  v_accvgpr_write_b32 a231, v43
  buffer_load_dwordx4 a[232:235], v2, s[12:15], s72 offen offset:1024 nt
  buffer_load_dwordx4 a[236:239], v2, s[12:15], s72 offen offset:2048 nt
  buffer_load_dwordx4 a[240:243], v2, s[12:15], s72 offen offset:3072 nt
  s_xor_b32 s72, s49, 147456
  buffer_load_dwordx4 v[152:155], v1, s[8:11], s72 offen nt
  s_waitcnt vmcnt(9)
  v_mov_b64 v[48:49], v[120:121]
  v_mov_b64 v[50:51], v[122:123]
  v_mov_b64 v[52:53], v[124:125]
  v_mov_b64 v[54:55], v[126:127]
  v_mov_b64 v[56:57], v[128:129]
  v_mov_b64 v[58:59], v[130:131]
  v_mov_b64 v[60:61], v[132:133]
  v_mov_b64 v[62:63], v[134:135]
  s_mov_b32 s70, 263
  s_mov_b32 s71, s43
  s_call_b64 s[74:75], L_enc
  s_nop 1
  v_accvgpr_write_b32 a244, v32
  v_accvgpr_write_b32 a245, v33
  v_accvgpr_write_b32 a246, v34
  v_accvgpr_write_b32 a247, v35
  v_accvgpr_write_b32 a248, v36
  v_accvgpr_write_b32 a249, v37
  v_accvgpr_write_b32 a250, v38
  v_accvgpr_write_b32 a251, v39
  v_accvgpr_write_b32 a252, v40
  v_accvgpr_write_b32 a253, v41
  v_accvgpr_write_b32 a254, v42
  v_accvgpr_write_b32 a255, v43
  buffer_load_dwordx4 v[156:159], v1, s[8:11], s72 offen offset:1024 nt
  buffer_load_dwordx4 v[160:163], v1, s[8:11], s72 offen offset:2048 nt
  buffer_load_dwordx4 v[164:167], v1, s[8:11], s72 offen offset:3072 nt
  s_mov_b32 s14, 0x8000000
  s_xor_b32 s72, s49, 131072
  buffer_load_dwordx4 v[168:171], v2, s[12:15], s72 offen nt
  buffer_load_dwordx4 v[172:175], v2, s[12:15], s72 offen offset:1024 nt
  buffer_load_dwordx4 v[176:179], v2, s[12:15], s72 offen offset:2048 nt
  buffer_load_dwordx4 v[180:183], v2, s[12:15], s72 offen offset:3072 nt
  s_bitcmp1_b32 s2, 0
  s_cselect_b32 s14, 0, 0x8000000
  s_xor_b32 s72, s49, 1032192
  buffer_load_dwordx4 v[184:187], v2, s[12:15], s72 offen nt
  buffer_load_dwordx4 v[188:191], v2, s[12:15], s72 offen offset:1024 nt
  buffer_load_dwordx4 v[192:195], v2, s[12:15], s72 offen offset:2048 nt
  buffer_load_dwordx4 v[196:199], v2, s[12:15], s72 offen offset:3072 nt
  s_mov_b32 s14, 0x8000000
  s_xor_b32 s72, s49, 147456
  buffer_load_dwordx4 v[200:203], v2, s[12:15], s72 offen nt
  buffer_load_dwordx4 v[204:207], v2, s[12:15], s72 offen offset:1024 nt
  buffer_load_dwordx4 v[208:211], v2, s[12:15], s72 offen offset:2048 nt
  buffer_load_dwordx4 v[212:215], v2, s[12:15], s72 offen offset:3072 nt
  s_waitcnt vmcnt(20)
  v_mov_b64 v[48:49], v[136:137]
  v_mov_b64 v[50:51], v[138:139]
  v_mov_b64 v[52:53], v[140:141]
  v_mov_b64 v[54:55], v[142:143]
  v_mov_b64 v[56:57], v[144:145]
  v_mov_b64 v[58:59], v[146:147]
  v_mov_b64 v[60:61], v[148:149]
  v_mov_b64 v[62:63], v[150:151]
  s_mov_b32 s70, 8
  s_mov_b32 s71, s42
  s_call_b64 s[74:75], L_enc
  s_nop 1
  v_mov_b64 v[216:217], v[32:33]
  v_mov_b64 v[218:219], v[34:35]
  v_mov_b64 v[220:221], v[36:37]
  v_mov_b64 v[222:223], v[38:39]
  v_mov_b64 v[224:225], v[40:41]
  v_mov_b64 v[226:227], v[42:43]
  s_waitcnt vmcnt(12)
  v_mov_b64 v[48:49], v[152:153]
  v_mov_b64 v[50:51], v[154:155]
  v_mov_b64 v[52:53], v[156:157]
  v_mov_b64 v[54:55], v[158:159]
  v_mov_b64 v[56:57], v[160:161]
  v_mov_b64 v[58:59], v[162:163]
  v_mov_b64 v[60:61], v[164:165]
  v_mov_b64 v[62:63], v[166:167]
  s_mov_b32 s70, 9
  s_mov_b32 s71, s42
  s_call_b64 s[74:75], L_enc
  s_nop 1
  ds_write_b128 v3, v[32:35] offset:18432
  ds_write_b128 v3, v[36:39] offset:19456
  ds_write_b128 v3, v[40:43] offset:20480
  s_xor_b32 s72, s49, 163840
  buffer_load_dwordx4 v[228:231], v1, s[8:11], s72 offen nt
  buffer_load_dwordx4 v[232:235], v1, s[8:11], s72 offen offset:1024 nt
  buffer_load_dwordx4 v[236:239], v1, s[8:11], s72 offen offset:2048 nt
  buffer_load_dwordx4 v[240:243], v1, s[8:11], s72 offen offset:3072 nt
  s_xor_b32 s72, s49, 180224
  buffer_load_dwordx4 v[244:247], v1, s[8:11], s72 offen nt
  s_waitcnt vmcnt(13)
  v_mov_b64 v[48:49], v[168:169]
  v_mov_b64 v[50:51], v[170:171]
  v_mov_b64 v[52:53], v[172:173]
  v_mov_b64 v[54:55], v[174:175]
  v_mov_b64 v[56:57], v[176:177]
  v_mov_b64 v[58:59], v[178:179]
  v_mov_b64 v[60:61], v[180:181]
  v_mov_b64 v[62:63], v[182:183]
  s_mov_b32 s70, 264
  s_mov_b32 s71, s43
  s_call_b64 s[74:75], L_enc
  s_nop 1
  v_mov_b64 v[64:65], v[32:33]
  v_mov_b64 v[66:67], v[34:35]
  v_mov_b64 v[68:69], v[36:37]
  v_mov_b64 v[70:71], v[38:39]
  v_mov_b64 v[72:73], v[40:41]
  v_mov_b64 v[74:75], v[42:43]
  buffer_load_dwordx4 v[76:79], v1, s[8:11], s72 offen offset:1024 nt
  buffer_load_dwordx4 v[80:83], v1, s[8:11], s72 offen offset:2048 nt
  buffer_load_dwordx4 v[84:87], v1, s[8:11], s72 offen offset:3072 nt
  s_xor_b32 s72, s49, 163840
  buffer_load_dwordx4 v[88:91], v2, s[12:15], s72 offen nt
  s_waitcnt vmcnt(9)
  v_mov_b64 v[48:49], v[200:201]
  v_mov_b64 v[50:51], v[202:203]
  v_mov_b64 v[52:53], v[204:205]
  v_mov_b64 v[54:55], v[206:207]
  v_mov_b64 v[56:57], v[208:209]
  v_mov_b64 v[58:59], v[210:211]
  v_mov_b64 v[60:61], v[212:213]
  v_mov_b64 v[62:63], v[214:215]
  s_mov_b32 s70, 265
  s_mov_b32 s71, s43
  s_call_b64 s[74:75], L_enc
  s_nop 1
  v_mov_b64 v[92:93], v[32:33]
  v_mov_b64 v[94:95], v[34:35]
  v_mov_b64 v[96:97], v[36:37]
  v_mov_b64 v[98:99], v[38:39]
  v_mov_b64 v[100:101], v[40:41]
  v_mov_b64 v[102:103], v[42:43]
  buffer_load_dwordx4 v[104:107], v2, s[12:15], s72 offen offset:1024 nt
  buffer_load_dwordx4 v[108:111], v2, s[12:15], s72 offen offset:2048 nt
  buffer_load_dwordx4 v[112:115], v2, s[12:15], s72 offen offset:3072 nt
  s_xor_b32 s72, s49, 180224
  buffer_load_dwordx4 v[116:119], v2, s[12:15], s72 offen nt
  buffer_load_dwordx4 v[120:123], v2, s[12:15], s72 offen offset:1024 nt
  buffer_load_dwordx4 v[124:127], v2, s[12:15], s72 offen offset:2048 nt
  buffer_load_dwordx4 v[128:131], v2, s[12:15], s72 offen offset:3072 nt
  s_xor_b32 s72, s49, 196608
  buffer_load_dwordx4 v[132:135], v1, s[8:11], s72 offen nt
  s_cmp_lg_u32 s65, 1
  s_cbranch_scc1 L_h3
  s_waitcnt vmcnt(41)
  v_max_u32 v30, v4, v5
  v_max3_u32 v30, v30, v6, v7
  v_max3_u32 v30, v30, v8, v9
  v_max3_u32 v30, v30, v10, v11
  v_max3_u32 v30, v30, v12, v13
  v_max3_u32 v30, v30, v14, v15
  v_max3_u32 v30, v30, v16, v17
  v_max3_u32 v30, v30, v18, v19
  v_max3_u32 v30, v30, v20, v21
  v_max3_u32 v30, v30, v22, v23
  v_max3_u32 v30, v30, v24, v25
  v_max3_u32 v30, v30, v26, v27
  v_max3_u32 v30, v30, v248, v249
  v_max3_u32 v30, v30, v250, v251
  v_max3_u32 v30, v30, v252, v253
  v_max3_u32 v30, v30, v254, v255
  v_cmp_eq_u32 vcc, -1, v30
  s_nop 0
  s_cbranch_vccnz L_h3
  v_add_f32 v4, v4, v12
  v_add_f32 v248, v20, v248
  v_add_f32 v5, v5, v13
  v_add_f32 v249, v21, v249
  v_add_f32 v6, v6, v14
  v_add_f32 v250, v22, v250
  v_add_f32 v7, v7, v15
  v_add_f32 v251, v23, v251
  v_add_f32 v8, v8, v16
  v_add_f32 v252, v24, v252
  v_add_f32 v9, v9, v17
  v_add_f32 v253, v25, v253
  v_add_f32 v10, v10, v18
  v_add_f32 v254, v26, v254
  v_add_f32 v11, v11, v19
  v_add_f32 v255, v27, v255
  v_add_f32 v248, v4, v248
  v_add_f32 v249, v5, v249
  v_add_f32 v250, v6, v250
  v_add_f32 v251, v7, v251
  v_add_f32 v252, v8, v252
  v_add_f32 v253, v9, v253
  v_add_f32 v254, v10, v254
  v_add_f32 v255, v11, v255
  v_cvt_pk_bf16_f32 v8, v248, v249
  v_cvt_pk_bf16_f32 v9, v250, v251
  v_cvt_pk_bf16_f32 v10, v252, v253
  v_cvt_pk_bf16_f32 v11, v254, v255
  v_mov_b32 v29, 1
  v_mov_b32 v28, 0
  ds_write_b128 v2, v[8:11] offset:8192
  ds_write_b32 v28, v29 offset:11424
  s_mov_b32 s65, 2
L_h3:
  buffer_load_dwordx4 v[136:139], v1, s[8:11], s72 offen offset:1024 nt
  buffer_load_dwordx4 v[140:143], v1, s[8:11], s72 offen offset:2048 nt
  buffer_load_dwordx4 v[144:147], v1, s[8:11], s72 offen offset:3072 nt
  s_xor_b32 s72, s49, 212992
  buffer_load_dwordx4 v[148:151], v1, s[8:11], s72 offen nt
  buffer_load_dwordx4 v[152:155], v1, s[8:11], s72 offen offset:1024 nt
  s_cmp_eq_u32 s65, 2
  s_cbranch_scc1 L_pass
  s_cmp_eq_u32 s65, 3
  s_cbranch_scc1 L_wq
  s_cmp_eq_u32 s65, 1
  s_cbranch_scc1 L_cntok
  v_mov_b32 v28, 0
  s_nop 9
L_cnt:
  buffer_load_dword v24, v28, s[88:91], 0 offen sc1
  s_waitcnt vmcnt(0)
  v_readfirstlane_b32 s51, v24
  s_nop 0
  s_cmp_ge_u32 s51, 256
  s_cbranch_scc1 L_cntok
  s_sub_u32 s55, s55, 1
  s_cmp_le_i32 s55, 0
  s_cbranch_scc1 L_cntok
  s_sleep 2
  s_branch L_cnt
  s_nop 9
L_cntok:
  s_nop 9
L_poll1:
  s_add_u32 s51, s54, 0
  buffer_load_dwordx4 v[4:7], v2, s[36:39], s51 offen sc1
  buffer_load_dwordx4 v[8:11], v2, s[36:39], s51 offen offset:1024 sc1
  s_add_u32 s51, s54, 16384
  buffer_load_dwordx4 v[12:15], v2, s[36:39], s51 offen sc1
  buffer_load_dwordx4 v[16:19], v2, s[36:39], s51 offen offset:1024 sc1
  s_add_u32 s51, s54, 32768
  buffer_load_dwordx4 v[20:23], v2, s[36:39], s51 offen sc1
  buffer_load_dwordx4 v[24:27], v2, s[36:39], s51 offen offset:1024 sc1
  s_add_u32 s51, s54, 49152
  buffer_load_dwordx4 v[248:251], v2, s[36:39], s51 offen sc1
  buffer_load_dwordx4 v[252:255], v2, s[36:39], s51 offen offset:1024 sc1
  s_waitcnt vmcnt(0)
  v_max_u32 v30, v4, v5
  v_max3_u32 v30, v30, v6, v7
  v_max3_u32 v30, v30, v8, v9
  v_max3_u32 v30, v30, v10, v11
  v_max3_u32 v30, v30, v12, v13
  v_max3_u32 v30, v30, v14, v15
  v_max3_u32 v30, v30, v16, v17
  v_max3_u32 v30, v30, v18, v19
  v_max3_u32 v30, v30, v20, v21
  v_max3_u32 v30, v30, v22, v23
  v_max3_u32 v30, v30, v24, v25
  v_max3_u32 v30, v30, v26, v27
  v_max3_u32 v30, v30, v248, v249
  v_max3_u32 v30, v30, v250, v251
  v_max3_u32 v30, v30, v252, v253
  v_max3_u32 v30, v30, v254, v255
  v_cmp_eq_u32 vcc, -1, v30
  s_nop 0
  s_cbranch_vccz L_pdone1
  s_sub_u32 s55, s55, 1
  s_cmp_le_i32 s55, 0
  s_cbranch_scc1 L_pdone1
  s_sleep 1
  s_branch L_poll1
  s_nop 9
L_pdone1:
  v_add_f32 v4, v4, v12
  v_add_f32 v248, v20, v248
  v_add_f32 v5, v5, v13
  v_add_f32 v249, v21, v249
  v_add_f32 v6, v6, v14
  v_add_f32 v250, v22, v250
  v_add_f32 v7, v7, v15
  v_add_f32 v251, v23, v251
  v_add_f32 v8, v8, v16
  v_add_f32 v252, v24, v252
  v_add_f32 v9, v9, v17
  v_add_f32 v253, v25, v253
  v_add_f32 v10, v10, v18
  v_add_f32 v254, v26, v254
  v_add_f32 v11, v11, v19
  v_add_f32 v255, v27, v255
  v_add_f32 v248, v4, v248
  v_add_f32 v249, v5, v249
  v_add_f32 v250, v6, v250
  v_add_f32 v251, v7, v251
  v_add_f32 v252, v8, v252
  v_add_f32 v253, v9, v253
  v_add_f32 v254, v10, v254
  v_add_f32 v255, v11, v255
  v_cvt_pk_bf16_f32 v8, v248, v249
  v_cvt_pk_bf16_f32 v9, v250, v251
  v_cvt_pk_bf16_f32 v10, v252, v253
  v_cvt_pk_bf16_f32 v11, v254, v255
  v_mov_b32 v29, 1
  v_mov_b32 v28, 0
  ds_write_b128 v2, v[8:11] offset:8192
  ds_write_b32 v28, v29 offset:11424
  s_branch L_pass
  s_nop 9
L_wq:
  v_mov_b32 v29, 0
  s_nop 9
L_qf:
  ds_read_b32 v28, v29 offset:11424
  s_waitcnt lgkmcnt(0)
  v_readfirstlane_b32 s51, v28
  s_nop 0
  s_cmp_lg_u32 s51, 0
  s_cbranch_scc1 L_qfok
  s_sub_u32 s55, s55, 1
  s_cmp_le_i32 s55, 0
  s_cbranch_scc1 L_qfok
  s_sleep 1
  s_branch L_qf
  s_nop 9
L_qfok:
  ds_read_b128 v[8:11], v2 offset:8192
  s_waitcnt lgkmcnt(0)
  s_nop 9
L_pass:
  v_mov_b32 v4, 0xff7fffff
  v_mov_b32 v5, 0
  v_bfe_i32 v7, v0, 3, 1
  v_not_b32 v6, v7
  v_mov_b32 v12, 0
  v_mov_b32 v13, 0
  v_mov_b32 v14, 0
  v_mov_b32 v15, 0
  v_mov_b32 v16, 0
  v_mov_b32 v17, 0
  v_mov_b32 v18, 0
  v_mov_b32 v19, 0
  s_mov_b64 s[86:87], 0
  s_cmp_lg_u32 s48, 0
  s_cbranch_scc1 L_pass2
  s_cmp_lg_u32 s5, 0
  s_cbranch_scc1 L_pgen1
  s_mov_b32 s51, 0x00800080
  v_and_b32 v20, 0x7fff7fff, v8
  v_and_b32 v21, 0x7fff7fff, v9
  v_and_b32 v22, 0x7fff7fff, v10
  v_and_b32 v23, 0x7fff7fff, v11
  v_pk_sub_u16 v24, v20, s51
  v_pk_sub_u16 v25, v21, s51
  v_pk_sub_u16 v26, v22, s51
  v_pk_sub_u16 v27, v23, s51
  v_pk_max_u16 v20, v20, v21
  v_pk_max_u16 v22, v22, v23
  v_pk_max_u16 v20, v20, v22
  v_pk_max_u16 v24, v24, v25
  v_pk_max_u16 v26, v26, v27
  v_pk_max_u16 v24, v24, v26
  s_sub_u32 s51, 0x7f7f7f7f, s42
  s_mov_b32 s52, 0xff80ff80
  v_pk_sub_u16 v20, v20, s51 clamp
  v_pk_sub_u16 v24, v24, s52 clamp
  v_or_b32 v20, v20, v24
  v_cmp_ne_u32 vcc, 0, v20
  s_nop 0
  s_cbranch_vccnz L_pgen1
  s_bitcmp1_b32 s2, 0
  s_cbranch_scc1 L_skt5
  s_bitcmp1_b32 s2, 0
  s_cselect_b32 s51, 0xff800000, 0
  v_mfma_f32_16x16x32_bf16 v[32:35], a[0:3], v[8:11], 0
  v_mfma_f32_16x16x32_bf16 v[36:39], a[4:7], v[8:11], 0
  v_mfma_f32_16x16x32_bf16 v[40:43], a[8:11], v[8:11], 0
  v_mfma_f32_16x16x32_bf16 v[44:47], a[12:15], v[8:11], 0
  v_mfma_f32_16x16x32_bf16 v[48:51], a[28:31], v[8:11], 0
  v_mfma_f32_16x16x32_bf16 v[52:55], a[44:47], v[8:11], 0
  v_mfma_f32_16x16x32_bf16 v[56:59], a[48:51], v[8:11], 0
  v_mfma_f32_16x16x32_bf16 v[60:63], a[52:55], v[8:11], 0
  s_nop 0
  v_mov_b32_dpp v24, v32 quad_perm:[0,1,2,3] row_mask:0xf bank_mask:0x1
  v_mov_b32_dpp v26, v34 row_ror:8 row_mask:0xf bank_mask:0x1
  s_nop 0
  v_mov_b32_dpp v24, v36 row_ror:4 row_mask:0xf bank_mask:0x2
  v_mov_b32_dpp v25, v48 quad_perm:[0,1,2,3] row_mask:0xf bank_mask:0x1
  v_mov_b32_dpp v27, v50 row_ror:8 row_mask:0xf bank_mask:0x1
  v_mov_b32_dpp v26, v38 row_ror:12 row_mask:0xf bank_mask:0x2
  v_mov_b32_dpp v25, v52 row_ror:4 row_mask:0xf bank_mask:0x2
  v_mov_b32_dpp v27, v54 row_ror:12 row_mask:0xf bank_mask:0x2
  v_mov_b32_dpp v24, v40 row_ror:8 row_mask:0xf bank_mask:0x4
  v_mov_b32_dpp v25, v56 row_ror:8 row_mask:0xf bank_mask:0x4
  v_mov_b32_dpp v26, v42 quad_perm:[0,1,2,3] row_mask:0xf bank_mask:0x4
  v_mov_b32_dpp v27, v58 quad_perm:[0,1,2,3] row_mask:0xf bank_mask:0x4
  v_mov_b32_dpp v24, v44 row_ror:12 row_mask:0xf bank_mask:0x8
  v_mov_b32_dpp v25, v60 row_ror:12 row_mask:0xf bank_mask:0x8
  v_mov_b32_dpp v26, v46 row_ror:4 row_mask:0xf bank_mask:0x8
  v_mov_b32_dpp v27, v62 row_ror:4 row_mask:0xf bank_mask:0x8
  v_add_f32_dpp v24, v33, v24 row_ror:12 row_mask:0xf bank_mask:0x1
  v_add_f32_dpp v25, v49, v25 row_ror:12 row_mask:0xf bank_mask:0x1
  v_add_f32_dpp v26, v35, v26 row_ror:4 row_mask:0xf bank_mask:0x1
  v_add_f32_dpp v27, v51, v27 row_ror:4 row_mask:0xf bank_mask:0x1
  v_add_f32_dpp v24, v37, v24 quad_perm:[0,1,2,3] row_mask:0xf bank_mask:0x2
  v_add_f32_dpp v25, v53, v25 quad_perm:[0,1,2,3] row_mask:0xf bank_mask:0x2
  v_add_f32_dpp v26, v39, v26 row_ror:8 row_mask:0xf bank_mask:0x2
  v_add_f32_dpp v27, v55, v27 row_ror:8 row_mask:0xf bank_mask:0x2
  v_add_f32_dpp v24, v41, v24 row_ror:4 row_mask:0xf bank_mask:0x4
  v_add_f32_dpp v25, v57, v25 row_ror:4 row_mask:0xf bank_mask:0x4
  v_add_f32_dpp v26, v43, v26 row_ror:12 row_mask:0xf bank_mask:0x4
  v_add_f32_dpp v27, v59, v27 row_ror:12 row_mask:0xf bank_mask:0x4
  v_add_f32_dpp v24, v45, v24 row_ror:8 row_mask:0xf bank_mask:0x8
  v_add_f32_dpp v25, v61, v25 row_ror:8 row_mask:0xf bank_mask:0x8
  v_add_f32_dpp v26, v47, v26 quad_perm:[0,1,2,3] row_mask:0xf bank_mask:0x8
  v_add_f32_dpp v27, v63, v27 quad_perm:[0,1,2,3] row_mask:0xf bank_mask:0x8
  v_add_f32 v24, v24, v26
  v_add_f32 v25, v25, v27
  v_cvt_pk_bf16_f32 v32, v24, v25
  v_lshlrev_b32 v24, 16, v32
  v_and_b32 v25, 0xffff0000, v32
  v_pk_mul_f32 v[24:25], v[24:25], s[56:57] op_sel_hi:[1,0]
  v_cvt_pk_bf16_f32 v32, v24, v25
  v_lshlrev_b32 v24, 16, v32
  v_and_b32 v25, 0xffff0000, v32
  v_add_f32 v24, s51, v24
  v_add_f32 v25, s51, v25
  v_pk_add_f32 v[26:27], v[24:25], v[4:5] op_sel_hi:[1,0] neg_lo:[0,1] neg_hi:[0,1]
  v_pk_mul_f32 v[26:27], v[26:27], s[56:57] op_sel:[0,1] op_sel_hi:[1,1]
  v_max_f32 v20, v26, v27
  v_cmp_lt_f32 vcc, 0, v20
  s_getpc_b64 s[74:75]
  s_cbranch_vccnz L_remax
  v_exp_f32 v26, v26
  v_exp_f32 v27, v27
  v_cvt_pk_bf16_f32 v20, v26, 0
  v_add_f32 v32, v26, v27
  v_cvt_pk_bf16_f32 v21, v26, 0
  v_cvt_pk_bf16_f32 v23, v27, 0
  v_cvt_pk_bf16_f32 v22, v27, 0
  v_cvt_pk_bf16_f32 v24, 0, v26
  v_cvt_pk_bf16_f32 v25, 0, v27
  v_add_f32 v5, v5, v32
  v_mov_b32_dpp v20, v24 row_ror:4 row_mask:0xf bank_mask:0xa
  v_mov_b32_dpp v21, v24 row_ror:4 row_mask:0xf bank_mask:0x5
  v_mov_b32_dpp v23, v25 row_ror:4 row_mask:0xf bank_mask:0xa
  v_mov_b32_dpp v22, v25 row_ror:4 row_mask:0xf bank_mask:0x5
  v_and_b32_dpp v32, v20, v6 quad_perm:[0,1,2,3] row_mask:0xf bank_mask:0xf
  v_and_b32_dpp v33, v20, v7 row_ror:8 row_mask:0xf bank_mask:0xf
  v_and_b32_dpp v34, v21, v6 row_ror:12 row_mask:0xf bank_mask:0xf
  v_and_b32_dpp v35, v21, v7 row_ror:4 row_mask:0xf bank_mask:0xf
  v_mfma_f32_16x16x16_bf16 v[12:15], v[32:33], a[80:81], v[12:15]
  v_and_b32_dpp v36, v20, v6 row_ror:8 row_mask:0xf bank_mask:0xf
  v_and_b32_dpp v37, v20, v7 quad_perm:[0,1,2,3] row_mask:0xf bank_mask:0xf
  v_mfma_f32_16x16x16_bf16 v[16:19], v[32:33], a[82:83], v[16:19]
  v_and_b32_dpp v38, v21, v6 row_ror:4 row_mask:0xf bank_mask:0xf
  v_and_b32_dpp v39, v21, v7 row_ror:12 row_mask:0xf bank_mask:0xf
  v_mfma_f32_16x16x16_bf16 v[12:15], v[34:35], a[96:97], v[12:15]
  v_and_b32_dpp v40, v23, v6 quad_perm:[0,1,2,3] row_mask:0xf bank_mask:0xf
  v_and_b32_dpp v41, v23, v7 row_ror:8 row_mask:0xf bank_mask:0xf
  v_mfma_f32_16x16x16_bf16 v[16:19], v[34:35], a[98:99], v[16:19]
  v_and_b32_dpp v42, v22, v6 row_ror:12 row_mask:0xf bank_mask:0xf
  v_and_b32_dpp v43, v22, v7 row_ror:4 row_mask:0xf bank_mask:0xf
  v_mfma_f32_16x16x16_bf16 v[12:15], v[36:37], a[100:101], v[12:15]
  v_and_b32_dpp v44, v23, v6 row_ror:8 row_mask:0xf bank_mask:0xf
  v_and_b32_dpp v45, v23, v7 quad_perm:[0,1,2,3] row_mask:0xf bank_mask:0xf
  v_mfma_f32_16x16x16_bf16 v[16:19], v[36:37], a[102:103], v[16:19]
  v_and_b32_dpp v46, v22, v6 row_ror:4 row_mask:0xf bank_mask:0xf
  v_and_b32_dpp v47, v22, v7 row_ror:12 row_mask:0xf bank_mask:0xf
  v_mfma_f32_16x16x16_bf16 v[12:15], v[38:39], a[104:105], v[12:15]
  v_mfma_f32_16x16x16_bf16 v[16:19], v[38:39], a[106:107], v[16:19]
  v_mfma_f32_16x16x16_bf16 v[12:15], v[40:41], a[120:121], v[12:15]
  v_mfma_f32_16x16x16_bf16 v[16:19], v[40:41], a[122:123], v[16:19]
  v_mfma_f32_16x16x16_bf16 v[12:15], v[42:43], a[124:125], v[12:15]
  v_mfma_f32_16x16x16_bf16 v[16:19], v[42:43], a[126:127], v[16:19]
  v_mfma_f32_16x16x16_bf16 v[12:15], v[44:45], a[128:129], v[12:15]
  v_mfma_f32_16x16x16_bf16 v[16:19], v[44:45], a[130:131], v[16:19]
  v_mfma_f32_16x16x16_bf16 v[12:15], v[46:47], a[132:133], v[12:15]
  v_mfma_f32_16x16x16_bf16 v[16:19], v[46:47], a[134:135], v[16:19]
L_skt5:
  buffer_load_dwordx4 a[0:3], v1, s[8:11], s72 offen offset:2048 nt
  buffer_load_dwordx4 a[4:7], v1, s[8:11], s72 offen offset:3072 nt
  s_bitcmp1_b32 s2, 0
  s_cbranch_scc1 L_skt6
  s_bitcmp1_b32 s2, 0
  s_cselect_b32 s51, 0xff800000, 0
  v_mfma_f32_16x16x32_bf16 v[32:35], a[148:151], v[8:11], 0
  v_mfma_f32_16x16x32_bf16 v[36:39], a[164:167], v[8:11], 0
  v_mfma_f32_16x16x32_bf16 v[40:43], a[168:171], v[8:11], 0
  v_mfma_f32_16x16x32_bf16 v[44:47], a[172:175], v[8:11], 0
  v_mfma_f32_16x16x32_bf16 v[48:51], a[188:191], v[8:11], 0
  v_mfma_f32_16x16x32_bf16 v[52:55], a[192:195], v[8:11], 0
  v_mfma_f32_16x16x32_bf16 v[56:59], a[196:199], v[8:11], 0
  v_mfma_f32_16x16x32_bf16 v[60:63], a[200:203], v[8:11], 0
  s_nop 0
  v_mov_b32_dpp v24, v32 quad_perm:[0,1,2,3] row_mask:0xf bank_mask:0x1
  v_mov_b32_dpp v26, v34 row_ror:8 row_mask:0xf bank_mask:0x1
  s_nop 0
  v_mov_b32_dpp v24, v36 row_ror:4 row_mask:0xf bank_mask:0x2
  v_mov_b32_dpp v25, v48 quad_perm:[0,1,2,3] row_mask:0xf bank_mask:0x1
  v_mov_b32_dpp v27, v50 row_ror:8 row_mask:0xf bank_mask:0x1
  v_mov_b32_dpp v26, v38 row_ror:12 row_mask:0xf bank_mask:0x2
  v_mov_b32_dpp v25, v52 row_ror:4 row_mask:0xf bank_mask:0x2
  v_mov_b32_dpp v27, v54 row_ror:12 row_mask:0xf bank_mask:0x2
  v_mov_b32_dpp v24, v40 row_ror:8 row_mask:0xf bank_mask:0x4
  v_mov_b32_dpp v25, v56 row_ror:8 row_mask:0xf bank_mask:0x4
  v_mov_b32_dpp v26, v42 quad_perm:[0,1,2,3] row_mask:0xf bank_mask:0x4
  v_mov_b32_dpp v27, v58 quad_perm:[0,1,2,3] row_mask:0xf bank_mask:0x4
  v_mov_b32_dpp v24, v44 row_ror:12 row_mask:0xf bank_mask:0x8
  v_mov_b32_dpp v25, v60 row_ror:12 row_mask:0xf bank_mask:0x8
  v_mov_b32_dpp v26, v46 row_ror:4 row_mask:0xf bank_mask:0x8
  v_mov_b32_dpp v27, v62 row_ror:4 row_mask:0xf bank_mask:0x8
  v_add_f32_dpp v24, v33, v24 row_ror:12 row_mask:0xf bank_mask:0x1
  v_add_f32_dpp v25, v49, v25 row_ror:12 row_mask:0xf bank_mask:0x1
  v_add_f32_dpp v26, v35, v26 row_ror:4 row_mask:0xf bank_mask:0x1
  v_add_f32_dpp v27, v51, v27 row_ror:4 row_mask:0xf bank_mask:0x1
  v_add_f32_dpp v24, v37, v24 quad_perm:[0,1,2,3] row_mask:0xf bank_mask:0x2
  v_add_f32_dpp v25, v53, v25 quad_perm:[0,1,2,3] row_mask:0xf bank_mask:0x2
  v_add_f32_dpp v26, v39, v26 row_ror:8 row_mask:0xf bank_mask:0x2
  v_add_f32_dpp v27, v55, v27 row_ror:8 row_mask:0xf bank_mask:0x2
  v_add_f32_dpp v24, v41, v24 row_ror:4 row_mask:0xf bank_mask:0x4
  v_add_f32_dpp v25, v57, v25 row_ror:4 row_mask:0xf bank_mask:0x4
  v_add_f32_dpp v26, v43, v26 row_ror:12 row_mask:0xf bank_mask:0x4
  v_add_f32_dpp v27, v59, v27 row_ror:12 row_mask:0xf bank_mask:0x4
  v_add_f32_dpp v24, v45, v24 row_ror:8 row_mask:0xf bank_mask:0x8
  v_add_f32_dpp v25, v61, v25 row_ror:8 row_mask:0xf bank_mask:0x8
  v_add_f32_dpp v26, v47, v26 quad_perm:[0,1,2,3] row_mask:0xf bank_mask:0x8
  v_add_f32_dpp v27, v63, v27 quad_perm:[0,1,2,3] row_mask:0xf bank_mask:0x8
  v_add_f32 v24, v24, v26
  v_add_f32 v25, v25, v27
  v_cvt_pk_bf16_f32 v32, v24, v25
  v_lshlrev_b32 v24, 16, v32
  v_and_b32 v25, 0xffff0000, v32
  v_pk_mul_f32 v[24:25], v[24:25], s[56:57] op_sel_hi:[1,0]
  v_cvt_pk_bf16_f32 v32, v24, v25
  v_lshlrev_b32 v24, 16, v32
  v_and_b32 v25, 0xffff0000, v32
  v_add_f32 v24, s51, v24
  v_add_f32 v25, s51, v25
  v_pk_add_f32 v[26:27], v[24:25], v[4:5] op_sel_hi:[1,0] neg_lo:[0,1] neg_hi:[0,1]
  v_pk_mul_f32 v[26:27], v[26:27], s[56:57] op_sel:[0,1] op_sel_hi:[1,1]
  v_max_f32 v20, v26, v27
  v_cmp_lt_f32 vcc, 0, v20
  s_getpc_b64 s[74:75]
  s_cbranch_vccnz L_remax
  v_exp_f32 v26, v26
  v_exp_f32 v27, v27
  v_cvt_pk_bf16_f32 v20, v26, 0
  v_add_f32 v32, v26, v27
  v_cvt_pk_bf16_f32 v21, v26, 0
  v_cvt_pk_bf16_f32 v23, v27, 0
  v_cvt_pk_bf16_f32 v22, v27, 0
  v_cvt_pk_bf16_f32 v24, 0, v26
  v_cvt_pk_bf16_f32 v25, 0, v27
  v_add_f32 v5, v5, v32
  v_mov_b32_dpp v20, v24 row_ror:4 row_mask:0xf bank_mask:0xa
  v_mov_b32_dpp v21, v24 row_ror:4 row_mask:0xf bank_mask:0x5
  v_mov_b32_dpp v23, v25 row_ror:4 row_mask:0xf bank_mask:0xa
  v_mov_b32_dpp v22, v25 row_ror:4 row_mask:0xf bank_mask:0x5
  v_and_b32_dpp v32, v20, v6 quad_perm:[0,1,2,3] row_mask:0xf bank_mask:0xf
  v_and_b32_dpp v33, v20, v7 row_ror:8 row_mask:0xf bank_mask:0xf
  v_and_b32_dpp v34, v21, v6 row_ror:12 row_mask:0xf bank_mask:0xf
  v_and_b32_dpp v35, v21, v7 row_ror:4 row_mask:0xf bank_mask:0xf
  v_mfma_f32_16x16x16_bf16 v[12:15], v[32:33], a[216:217], v[12:15]
  v_and_b32_dpp v36, v20, v6 row_ror:8 row_mask:0xf bank_mask:0xf
  v_and_b32_dpp v37, v20, v7 quad_perm:[0,1,2,3] row_mask:0xf bank_mask:0xf
  v_mfma_f32_16x16x16_bf16 v[16:19], v[32:33], a[218:219], v[16:19]
  v_and_b32_dpp v38, v21, v6 row_ror:4 row_mask:0xf bank_mask:0xf
  v_and_b32_dpp v39, v21, v7 row_ror:12 row_mask:0xf bank_mask:0xf
  v_mfma_f32_16x16x16_bf16 v[12:15], v[34:35], a[232:233], v[12:15]
  v_and_b32_dpp v40, v23, v6 quad_perm:[0,1,2,3] row_mask:0xf bank_mask:0xf
  v_and_b32_dpp v41, v23, v7 row_ror:8 row_mask:0xf bank_mask:0xf
  v_mfma_f32_16x16x16_bf16 v[16:19], v[34:35], a[234:235], v[16:19]
  v_and_b32_dpp v42, v22, v6 row_ror:12 row_mask:0xf bank_mask:0xf
  v_and_b32_dpp v43, v22, v7 row_ror:4 row_mask:0xf bank_mask:0xf
  v_mfma_f32_16x16x16_bf16 v[12:15], v[36:37], a[236:237], v[12:15]
  v_and_b32_dpp v44, v23, v6 row_ror:8 row_mask:0xf bank_mask:0xf
  v_and_b32_dpp v45, v23, v7 quad_perm:[0,1,2,3] row_mask:0xf bank_mask:0xf
  v_mfma_f32_16x16x16_bf16 v[16:19], v[36:37], a[238:239], v[16:19]
  v_and_b32_dpp v46, v22, v6 row_ror:4 row_mask:0xf bank_mask:0xf
  v_and_b32_dpp v47, v22, v7 row_ror:12 row_mask:0xf bank_mask:0xf
  v_mfma_f32_16x16x16_bf16 v[12:15], v[38:39], a[240:241], v[12:15]
  v_mfma_f32_16x16x16_bf16 v[16:19], v[38:39], a[242:243], v[16:19]
  v_mfma_f32_16x16x16_bf16 v[12:15], v[40:41], v[184:185], v[12:15]
  v_mfma_f32_16x16x16_bf16 v[16:19], v[40:41], v[186:187], v[16:19]
  v_mfma_f32_16x16x16_bf16 v[12:15], v[42:43], v[188:189], v[12:15]
  v_mfma_f32_16x16x16_bf16 v[16:19], v[42:43], v[190:191], v[16:19]
  v_mfma_f32_16x16x16_bf16 v[12:15], v[44:45], v[192:193], v[12:15]
  v_mfma_f32_16x16x16_bf16 v[16:19], v[44:45], v[194:195], v[16:19]
  v_mfma_f32_16x16x16_bf16 v[12:15], v[46:47], v[196:197], v[12:15]
  v_mfma_f32_16x16x16_bf16 v[16:19], v[46:47], v[198:199], v[16:19]
L_skt6:
  s_xor_b32 s72, s49, 196608
  buffer_load_dwordx4 a[8:11], v2, s[12:15], s72 offen nt
  buffer_load_dwordx4 a[12:15], v2, s[12:15], s72 offen offset:1024 nt
  buffer_load_dwordx4 a[28:31], v2, s[12:15], s72 offen offset:2048 nt
  s_mov_b32 s65, 0x05010400
  s_mov_b32 s66, 0x07030602
  s_lshl_b32 s69, s3, 11
  v_add_u32 v20, s69, v2
  ds_write_b128 v20, v[8:11]
  v_bfe_u32 v20, v31, 12, 4
  v_bfe_u32 v21, v31, 9, 3
  v_lshlrev_b32 v20, 6, v20
  v_lshl_add_u32 v20, v21, 1, v20
  v_add_u32 v20, s69, v20
  ds_read_u16 v24, v20 offset:0
  ds_read_u16 v25, v20 offset:16
  ds_read_u16 v26, v20 offset:32
  ds_read_u16 v27, v20 offset:48
  v_mov_b64 v[28:29], 0
  v_mov_b32 v30, 0
  v_mov_b32 v23, v31
  v_mov_b32 v31, 0
  ds_write_b128 v3, v[28:31]
  ds_write_b128 v3, v[28:31] offset:1024
  ds_write_b128 v3, v[28:31] offset:2048
  v_mov_b32 v31, v23
  v_bfe_u32 v21, v31, 6, 3
  v_and_b32 v20, 15, v31
  v_lshlrev_b32 v21, 10, v21
  v_lshl_add_u32 v21, v20, 6, v21
  v_bfe_u32 v20, v31, 4, 2
  v_lshl_add_u32 v21, v20, 2, v21
  v_add_u32 v21, s61, v21
  v_and_b32 v22, 0xffff0000, v31
  s_bfm_b64 s[76:77], s50, 0
  s_mov_b32 s40, s0
  s_mov_b32 s69, 0x7fff7fff
  s_waitcnt lgkmcnt(3)
  v_lshlrev_b32 v24, 16, v24
  v_lshlrev_b32 v25, 16, v25
  v_lshlrev_b32 v26, 16, v26
  v_lshlrev_b32 v27, 16, v27
  v_mul_f32 v24, v24, v22
  v_mul_f32 v25, v25, v22
  v_mul_f32 v26, v26, v22
  v_mul_f32 v27, v27, v22
  s_mov_b64 exec, s[76:77]
  ds_add_f32 v21, v24 offset:0
  ds_add_f32 v21, v25 offset:16
  ds_add_f32 v21, v26 offset:32
  ds_add_f32 v21, v27 offset:48
  s_mov_b64 exec, -1
  ds_read_b64 v[24:25], v3
  v_and_b32 v20, 0x7fff7fff, v8
  v_and_b32 v21, 0x7fff7fff, v9
  v_and_b32 v22, 0x7fff7fff, v10
  v_and_b32 v23, 0x7fff7fff, v11
  v_pk_min_u16 v20, v20, 1 op_sel_hi:[1,0]
  v_pk_min_u16 v21, v21, 1 op_sel_hi:[1,0]
  v_pk_min_u16 v22, v22, 1 op_sel_hi:[1,0]
  v_pk_min_u16 v23, v23, 1 op_sel_hi:[1,0]
  v_pk_mul_lo_u16 v20, v20, s42
  v_pk_mul_lo_u16 v21, v21, s42
  v_pk_mul_lo_u16 v22, v22, s42
  v_pk_mul_lo_u16 v23, v23, s42
  v_pk_add_u16 v8, v8, v20
  v_pk_add_u16 v9, v9, v21
  v_pk_add_u16 v10, v10, v22
  v_pk_add_u16 v11, v11, v23
  v_accvgpr_read_b32 v29, a18
  v_and_b32 v28, s64, v29
  v_alignbit_b32 v29, v29, v29, 4
  v_and_b32 v29, s64, v29
  v_accvgpr_read_b32 v49, a16
  v_perm_b32 v48, v28, v49, s65
  v_perm_b32 v49, v28, v49, s66
  v_accvgpr_read_b32 v51, a17
  v_perm_b32 v50, v29, v51, s65
  v_perm_b32 v51, v29, v51, s66
  v_accvgpr_read_b32 v29, a19
  v_and_b32 v28, s64, v29
  v_mfma_f32_16x16x32_bf16 v[32:35], v[48:51], v[8:11], 0
  v_alignbit_b32 v29, v29, v29, 4
  v_and_b32 v29, s64, v29
  v_accvgpr_read_b32 v53, a20
  v_perm_b32 v52, v28, v53, s65
  v_perm_b32 v53, v28, v53, s66
  v_accvgpr_read_b32 v55, a21
  v_perm_b32 v54, v29, v55, s65
  v_perm_b32 v55, v29, v55, s66
  v_accvgpr_read_b32 v29, a24
  v_and_b32 v28, s64, v29
  v_mfma_f32_16x16x32_bf16 v[36:39], v[52:55], v[8:11], 0
  v_alignbit_b32 v29, v29, v29, 4
  v_and_b32 v29, s64, v29
  v_accvgpr_read_b32 v57, a22
  v_perm_b32 v56, v28, v57, s65
  v_perm_b32 v57, v28, v57, s66
  v_accvgpr_read_b32 v59, a23
  v_perm_b32 v58, v29, v59, s65
  v_perm_b32 v59, v29, v59, s66
  v_accvgpr_read_b32 v29, a25
  v_and_b32 v28, s64, v29
  v_mfma_f32_16x16x32_bf16 v[40:43], v[56:59], v[8:11], 0
  v_alignbit_b32 v29, v29, v29, 4
  v_and_b32 v29, s64, v29
  v_accvgpr_read_b32 v61, a26
  v_perm_b32 v60, v28, v61, s65
  v_perm_b32 v61, v28, v61, s66
  v_accvgpr_read_b32 v63, a27
  v_perm_b32 v62, v29, v63, s65
  v_perm_b32 v63, v29, v63, s66
  s_waitcnt lgkmcnt(0)
  ds_read_b128 v[52:55], v3 offset:6144
  v_mfma_f32_16x16x32_bf16 v[44:47], v[60:63], v[8:11], 0
  ds_read_b128 v[56:59], v3 offset:7168
  ds_read_b128 v[60:63], v3 offset:8192
  buffer_load_dwordx4 a[44:47], v2, s[12:15], s72 offen offset:3072 nt
  v_add_f32_dpp v24, v32, v24 quad_perm:[0,1,2,3] row_mask:0xf bank_mask:0x1
  v_mov_b32_dpp v26, v34 row_ror:8 row_mask:0xf bank_mask:0x1
  s_xor_b32 s72, s49, 212992
  v_add_f32_dpp v24, v36, v24 row_ror:4 row_mask:0xf bank_mask:0x2
  v_mov_b32_dpp v26, v38 row_ror:12 row_mask:0xf bank_mask:0x2
  buffer_load_dwordx4 a[48:51], v2, s[12:15], s72 offen nt
  v_add_f32_dpp v24, v40, v24 row_ror:8 row_mask:0xf bank_mask:0x4
  v_mov_b32_dpp v26, v42 quad_perm:[0,1,2,3] row_mask:0xf bank_mask:0x4
  s_nop 0
  v_add_f32_dpp v24, v44, v24 row_ror:12 row_mask:0xf bank_mask:0x8
  v_mov_b32_dpp v26, v46 row_ror:4 row_mask:0xf bank_mask:0x8
  s_nop 0
  v_add_f32_dpp v24, v33, v24 row_ror:12 row_mask:0xf bank_mask:0x1
  v_add_f32_dpp v26, v35, v26 row_ror:4 row_mask:0xf bank_mask:0x1
  s_nop 0
  v_add_f32_dpp v24, v37, v24 quad_perm:[0,1,2,3] row_mask:0xf bank_mask:0x2
  v_add_f32_dpp v26, v39, v26 row_ror:8 row_mask:0xf bank_mask:0x2
  s_nop 0
  v_add_f32_dpp v24, v41, v24 row_ror:4 row_mask:0xf bank_mask:0x4
  v_add_f32_dpp v26, v43, v26 row_ror:12 row_mask:0xf bank_mask:0x4
  s_nop 0
  v_add_f32_dpp v24, v45, v24 row_ror:8 row_mask:0xf bank_mask:0x8
  v_add_f32_dpp v26, v47, v26 quad_perm:[0,1,2,3] row_mask:0xf bank_mask:0x8
  v_add_f32 v24, v24, v26
  s_waitcnt lgkmcnt(0)
  v_and_b32 v28, s64, v54
  v_alignbit_b32 v29, v54, v54, 4
  v_and_b32 v29, s64, v29
  v_perm_b32 v48, v28, v52, s65
  v_perm_b32 v49, v28, v52, s66
  v_perm_b32 v50, v29, v53, s65
  v_perm_b32 v51, v29, v53, s66
  v_and_b32 v28, s64, v55
  v_alignbit_b32 v29, v55, v55, 4
  v_mfma_f32_16x16x32_bf16 v[32:35], v[48:51], v[8:11], 0
  v_and_b32 v29, s64, v29
  v_perm_b32 v52, v28, v56, s65
  v_perm_b32 v53, v28, v56, s66
  v_perm_b32 v54, v29, v57, s65
  v_perm_b32 v55, v29, v57, s66
  v_and_b32 v28, s64, v60
  v_alignbit_b32 v29, v60, v60, 4
  v_mfma_f32_16x16x32_bf16 v[36:39], v[52:55], v[8:11], 0
  v_and_b32 v29, s64, v29
  v_perm_b32 v56, v28, v58, s65
  v_perm_b32 v57, v28, v58, s66
  v_perm_b32 v58, v29, v59, s65
  v_perm_b32 v59, v29, v59, s66
  v_and_b32 v28, s64, v61
  v_alignbit_b32 v29, v61, v61, 4
  v_mfma_f32_16x16x32_bf16 v[40:43], v[56:59], v[8:11], 0
  v_and_b32 v29, s64, v29
  v_perm_b32 v60, v28, v62, s65
  v_perm_b32 v61, v28, v62, s66
  v_perm_b32 v62, v29, v63, s65
  v_perm_b32 v63, v29, v63, s66
  v_add_f32_dpp v25, v32, v25 quad_perm:[0,1,2,3] row_mask:0xf bank_mask:0x1
  v_accvgpr_read_b32 v29, a34
  v_mfma_f32_16x16x32_bf16 v[44:47], v[60:63], v[8:11], 0
  v_mov_b32_dpp v27, v34 row_ror:8 row_mask:0xf bank_mask:0x1
  v_and_b32 v28, s64, v29
  v_add_f32_dpp v25, v36, v25 row_ror:4 row_mask:0xf bank_mask:0x2
  v_alignbit_b32 v29, v29, v29, 4
  v_mov_b32_dpp v27, v38 row_ror:12 row_mask:0xf bank_mask:0x2
  v_and_b32 v29, s64, v29
  v_add_f32_dpp v25, v40, v25 row_ror:8 row_mask:0xf bank_mask:0x4
  v_accvgpr_read_b32 v49, a32
  v_mov_b32_dpp v27, v42 quad_perm:[0,1,2,3] row_mask:0xf bank_mask:0x4
  v_perm_b32 v48, v28, v49, s65
  v_add_f32_dpp v25, v44, v25 row_ror:12 row_mask:0xf bank_mask:0x8
  v_perm_b32 v49, v28, v49, s66
  v_mov_b32_dpp v27, v46 row_ror:4 row_mask:0xf bank_mask:0x8
  v_accvgpr_read_b32 v53, a33
  v_add_f32_dpp v25, v33, v25 row_ror:12 row_mask:0xf bank_mask:0x1
  v_perm_b32 v52, v29, v53, s65
  v_add_f32_dpp v27, v35, v27 row_ror:4 row_mask:0xf bank_mask:0x1
  v_perm_b32 v53, v29, v53, s66
  v_add_f32_dpp v25, v37, v25 quad_perm:[0,1,2,3] row_mask:0xf bank_mask:0x2
  v_accvgpr_read_b32 v29, a35
  v_add_f32_dpp v27, v39, v27 row_ror:8 row_mask:0xf bank_mask:0x2
  v_and_b32 v28, s64, v29
  v_add_f32_dpp v25, v41, v25 row_ror:4 row_mask:0xf bank_mask:0x4
  v_alignbit_b32 v29, v29, v29, 4
  v_add_f32_dpp v27, v43, v27 row_ror:12 row_mask:0xf bank_mask:0x4
  v_and_b32 v29, s64, v29
  v_add_f32_dpp v25, v45, v25 row_ror:8 row_mask:0xf bank_mask:0x8
  v_accvgpr_read_b32 v51, a36
  v_add_f32_dpp v27, v47, v27 quad_perm:[0,1,2,3] row_mask:0xf bank_mask:0x8
  v_perm_b32 v50, v28, v51, s65
  v_perm_b32 v51, v28, v51, s66
  v_add_f32 v25, v25, v27
  v_accvgpr_read_b32 v55, a37
  v_cvt_pk_bf16_f32 v32, v24, v25
  v_perm_b32 v54, v29, v55, s65
  v_lshlrev_b32 v24, 16, v32
  v_perm_b32 v55, v29, v55, s66
  v_and_b32 v25, 0xffff0000, v32
  v_accvgpr_read_b32 v29, a40
  v_pk_mul_f32 v[24:25], v[24:25], s[56:57] op_sel_hi:[1,0]
  v_and_b32 v28, s64, v29
  v_cvt_pk_bf16_f32 v32, v24, v25
  v_lshlrev_b32 v24, 16, v32
  v_alignbit_b32 v29, v29, v29, 4
  v_and_b32 v25, 0xffff0000, v32
  ds_write_b64 v3, v[24:25]
  v_and_b32 v29, s64, v29
  v_pk_add_f32 v[26:27], v[24:25], v[4:5] op_sel_hi:[1,0] neg_lo:[0,1] neg_hi:[0,1]
  v_pk_mul_f32 v[26:27], v[26:27], s[56:57] op_sel:[0,1] op_sel_hi:[1,1]
  v_accvgpr_read_b32 v57, a38
  v_max_f32 v20, v26, v27
  v_perm_b32 v56, v28, v57, s65
  v_perm_b32 v57, v28, v57, s66
  v_cmp_lt_f32 vcc, 0, v20
  s_getpc_b64 s[74:75]
  s_cbranch_vccnz L_remax
  v_accvgpr_read_b32 v61, a39
  v_exp_f32 v26, v26
  v_exp_f32 v27, v27
  v_perm_b32 v60, v29, v61, s65
  v_pk_mul_f32 v[24:25], v[26:27], s[40:41] op_sel:[0,1] op_sel_hi:[1,1]
  v_perm_b32 v61, v29, v61, s66
  v_add_f32 v32, v26, v27
  v_accvgpr_read_b32 v29, a41
  v_cvt_pk_bf16_f32 v20, v24, 0
  v_and_b32 v28, s64, v29
  v_cvt_pk_bf16_f32 v21, v24, 0
  v_alignbit_b32 v29, v29, v29, 4
  v_cvt_pk_bf16_f32 v23, v25, 0
  v_and_b32 v29, s64, v29
  v_cvt_pk_bf16_f32 v22, v25, 0
  v_cvt_pk_bf16_f32 v24, 0, v24
  v_accvgpr_read_b32 v59, a42
  v_cvt_pk_bf16_f32 v25, 0, v25
  v_perm_b32 v58, v28, v59, s65
  v_add_f32 v5, v5, v32
  v_perm_b32 v59, v28, v59, s66
  v_mov_b32_dpp v20, v24 row_ror:4 row_mask:0xf bank_mask:0xa
  v_accvgpr_read_b32 v63, a43
  v_mov_b32_dpp v21, v24 row_ror:4 row_mask:0xf bank_mask:0x5
  v_perm_b32 v62, v29, v63, s65
  v_mov_b32_dpp v23, v25 row_ror:4 row_mask:0xf bank_mask:0xa
  v_perm_b32 v63, v29, v63, s66
  v_mov_b32_dpp v22, v25 row_ror:4 row_mask:0xf bank_mask:0x5
  ds_read_b64 v[24:25], v3 offset:8
  buffer_load_dwordx4 a[52:55], v2, s[12:15], s72 offen offset:1024 nt
  v_and_b32_dpp v32, v20, v6 quad_perm:[0,1,2,3] row_mask:0xf bank_mask:0xf
  v_and_b32_dpp v33, v20, v7 row_ror:8 row_mask:0xf bank_mask:0xf
  v_and_b32_dpp v34, v21, v6 row_ror:12 row_mask:0xf bank_mask:0xf
  v_and_b32_dpp v35, v21, v7 row_ror:4 row_mask:0xf bank_mask:0xf
  v_and_b32_dpp v36, v20, v6 row_ror:8 row_mask:0xf bank_mask:0xf
  v_and_b32_dpp v37, v20, v7 quad_perm:[0,1,2,3] row_mask:0xf bank_mask:0xf
  v_mfma_f32_16x16x32_bf16 v[12:15], v[32:35], v[48:51], v[12:15]
  v_and_b32_dpp v38, v21, v6 row_ror:4 row_mask:0xf bank_mask:0xf
  v_and_b32_dpp v39, v21, v7 row_ror:12 row_mask:0xf bank_mask:0xf
  v_mfma_f32_16x16x32_bf16 v[16:19], v[32:35], v[52:55], v[16:19]
  v_and_b32_dpp v40, v23, v6 quad_perm:[0,1,2,3] row_mask:0xf bank_mask:0xf
  v_and_b32_dpp v41, v23, v7 row_ror:8 row_mask:0xf bank_mask:0xf
  v_mfma_f32_16x16x32_bf16 v[12:15], v[36:39], v[56:59], v[12:15]
  v_and_b32_dpp v42, v22, v6 row_ror:12 row_mask:0xf bank_mask:0xf
  v_and_b32_dpp v43, v22, v7 row_ror:4 row_mask:0xf bank_mask:0xf
  v_mfma_f32_16x16x32_bf16 v[16:19], v[36:39], v[60:63], v[16:19]
  v_and_b32_dpp v44, v23, v6 row_ror:8 row_mask:0xf bank_mask:0xf
  v_and_b32_dpp v45, v23, v7 quad_perm:[0,1,2,3] row_mask:0xf bank_mask:0xf
  v_and_b32_dpp v46, v22, v6 row_ror:4 row_mask:0xf bank_mask:0xf
  v_and_b32_dpp v47, v22, v7 row_ror:12 row_mask:0xf bank_mask:0xf
  v_accvgpr_read_b32 v29, a58
  v_and_b32 v28, s64, v29
  v_alignbit_b32 v29, v29, v29, 4
  v_and_b32 v29, s64, v29
  v_accvgpr_read_b32 v49, a56
  v_perm_b32 v48, v28, v49, s65
  v_perm_b32 v49, v28, v49, s66
  v_accvgpr_read_b32 v53, a57
  v_perm_b32 v52, v29, v53, s65
  v_perm_b32 v53, v29, v53, s66
  v_accvgpr_read_b32 v29, a59
  v_and_b32 v28, s64, v29
  v_alignbit_b32 v29, v29, v29, 4
  v_and_b32 v29, s64, v29
  v_accvgpr_read_b32 v51, a60
  v_perm_b32 v50, v28, v51, s65
  v_perm_b32 v51, v28, v51, s66
  v_accvgpr_read_b32 v55, a61
  v_perm_b32 v54, v29, v55, s65
  v_mfma_f32_16x16x32_bf16 v[12:15], v[40:43], v[48:51], v[12:15]
  v_perm_b32 v55, v29, v55, s66
  v_accvgpr_read_b32 v29, a64
  v_and_b32 v28, s64, v29
  v_mfma_f32_16x16x32_bf16 v[16:19], v[40:43], v[52:55], v[16:19]
  v_alignbit_b32 v29, v29, v29, 4
  v_and_b32 v29, s64, v29
  v_accvgpr_read_b32 v57, a62
  v_perm_b32 v56, v28, v57, s65
  v_perm_b32 v57, v28, v57, s66
  v_accvgpr_read_b32 v61, a63
  v_perm_b32 v60, v29, v61, s65
  v_perm_b32 v61, v29, v61, s66
  v_accvgpr_read_b32 v29, a65
  v_and_b32 v28, s64, v29
  v_alignbit_b32 v29, v29, v29, 4
  v_and_b32 v29, s64, v29
  v_accvgpr_read_b32 v59, a66
  v_perm_b32 v58, v28, v59, s65
  v_perm_b32 v59, v28, v59, s66
  v_accvgpr_read_b32 v63, a67
  v_perm_b32 v62, v29, v63, s65
  v_mfma_f32_16x16x32_bf16 v[12:15], v[44:47], v[56:59], v[12:15]
  v_perm_b32 v63, v29, v63, s66
  buffer_load_dwordx4 a[80:83], v2, s[12:15], s72 offen offset:2048 nt
  buffer_load_dwordx4 a[96:99], v2, s[12:15], s72 offen offset:3072 nt
  v_mfma_f32_16x16x32_bf16 v[16:19], v[44:47], v[60:63], v[16:19]
  v_accvgpr_read_b32 v29, a70
  v_and_b32 v28, s64, v29
  v_alignbit_b32 v29, v29, v29, 4
  v_and_b32 v29, s64, v29
  v_accvgpr_read_b32 v49, a68
  v_perm_b32 v48, v28, v49, s65
  v_perm_b32 v49, v28, v49, s66
  v_accvgpr_read_b32 v51, a69
  v_perm_b32 v50, v29, v51, s65
  v_perm_b32 v51, v29, v51, s66
  v_accvgpr_read_b32 v29, a71
  v_and_b32 v28, s64, v29
  v_mfma_f32_16x16x32_bf16 v[32:35], v[48:51], v[8:11], 0
  v_alignbit_b32 v29, v29, v29, 4
  v_and_b32 v29, s64, v29
  v_accvgpr_read_b32 v53, a72
  v_perm_b32 v52, v28, v53, s65
  v_perm_b32 v53, v28, v53, s66
  v_accvgpr_read_b32 v55, a73
  v_perm_b32 v54, v29, v55, s65
  v_perm_b32 v55, v29, v55, s66
  v_accvgpr_read_b32 v29, a76
  v_and_b32 v28, s64, v29
  v_mfma_f32_16x16x32_bf16 v[36:39], v[52:55], v[8:11], 0
  v_alignbit_b32 v29, v29, v29, 4
  v_and_b32 v29, s64, v29
  v_accvgpr_read_b32 v57, a74
  v_perm_b32 v56, v28, v57, s65
  v_perm_b32 v57, v28, v57, s66
  v_accvgpr_read_b32 v59, a75
  v_perm_b32 v58, v29, v59, s65
  v_perm_b32 v59, v29, v59, s66
  v_accvgpr_read_b32 v29, a77
  v_and_b32 v28, s64, v29
  v_mfma_f32_16x16x32_bf16 v[40:43], v[56:59], v[8:11], 0
  v_alignbit_b32 v29, v29, v29, 4
  v_and_b32 v29, s64, v29
  v_accvgpr_read_b32 v61, a78
  v_perm_b32 v60, v28, v61, s65
  v_perm_b32 v61, v28, v61, s66
  v_accvgpr_read_b32 v63, a79
  v_perm_b32 v62, v29, v63, s65
  v_perm_b32 v63, v29, v63, s66
  s_waitcnt lgkmcnt(0)
  ds_read_b128 v[52:55], v3 offset:9216
  v_mfma_f32_16x16x32_bf16 v[44:47], v[60:63], v[8:11], 0
  ds_read_b128 v[56:59], v3 offset:10240
  ds_read_b128 v[60:63], v3 offset:11264
  s_xor_b32 s72, s49, 229376
  buffer_load_dwordx4 a[100:103], v1, s[8:11], s72 offen nt
  v_add_f32_dpp v24, v32, v24 quad_perm:[0,1,2,3] row_mask:0xf bank_mask:0x1
  v_mov_b32_dpp v26, v34 row_ror:8 row_mask:0xf bank_mask:0x1
  s_waitcnt vmcnt(32)
  v_add_f32_dpp v24, v36, v24 row_ror:4 row_mask:0xf bank_mask:0x2
  v_mov_b32_dpp v26, v38 row_ror:12 row_mask:0xf bank_mask:0x2
  buffer_load_dwordx4 a[104:107], v1, s[8:11], s72 offen offset:1024 nt
  v_add_f32_dpp v24, v40, v24 row_ror:8 row_mask:0xf bank_mask:0x4
  v_mov_b32_dpp v26, v42 quad_perm:[0,1,2,3] row_mask:0xf bank_mask:0x4
  s_nop 0
  v_add_f32_dpp v24, v44, v24 row_ror:12 row_mask:0xf bank_mask:0x8
  v_mov_b32_dpp v26, v46 row_ror:4 row_mask:0xf bank_mask:0x8
  s_nop 0
  v_add_f32_dpp v24, v33, v24 row_ror:12 row_mask:0xf bank_mask:0x1
  v_add_f32_dpp v26, v35, v26 row_ror:4 row_mask:0xf bank_mask:0x1
  s_nop 0
  v_add_f32_dpp v24, v37, v24 quad_perm:[0,1,2,3] row_mask:0xf bank_mask:0x2
  v_add_f32_dpp v26, v39, v26 row_ror:8 row_mask:0xf bank_mask:0x2
  s_nop 0
  v_add_f32_dpp v24, v41, v24 row_ror:4 row_mask:0xf bank_mask:0x4
  v_add_f32_dpp v26, v43, v26 row_ror:12 row_mask:0xf bank_mask:0x4
  s_nop 0
  v_add_f32_dpp v24, v45, v24 row_ror:8 row_mask:0xf bank_mask:0x8
  v_add_f32_dpp v26, v47, v26 quad_perm:[0,1,2,3] row_mask:0xf bank_mask:0x8
  v_add_f32 v24, v24, v26
  s_waitcnt lgkmcnt(0)
  v_and_b32 v28, s64, v54
  v_alignbit_b32 v29, v54, v54, 4
  v_and_b32 v29, s64, v29
  v_perm_b32 v48, v28, v52, s65
  v_perm_b32 v49, v28, v52, s66
  v_perm_b32 v50, v29, v53, s65
  v_perm_b32 v51, v29, v53, s66
  v_and_b32 v28, s64, v55
  v_alignbit_b32 v29, v55, v55, 4
  v_mfma_f32_16x16x32_bf16 v[32:35], v[48:51], v[8:11], 0
  v_and_b32 v29, s64, v29
  v_perm_b32 v52, v28, v56, s65
  v_perm_b32 v53, v28, v56, s66
  v_perm_b32 v54, v29, v57, s65
  v_perm_b32 v55, v29, v57, s66
  v_and_b32 v28, s64, v60
  v_alignbit_b32 v29, v60, v60, 4
  v_mfma_f32_16x16x32_bf16 v[36:39], v[52:55], v[8:11], 0
  v_and_b32 v29, s64, v29
  v_perm_b32 v56, v28, v58, s65
  v_perm_b32 v57, v28, v58, s66
  v_perm_b32 v58, v29, v59, s65
  v_perm_b32 v59, v29, v59, s66
  v_and_b32 v28, s64, v61
  v_alignbit_b32 v29, v61, v61, 4
  v_mfma_f32_16x16x32_bf16 v[40:43], v[56:59], v[8:11], 0
  v_and_b32 v29, s64, v29
  v_perm_b32 v60, v28, v62, s65
  v_perm_b32 v61, v28, v62, s66
  v_perm_b32 v62, v29, v63, s65
  v_perm_b32 v63, v29, v63, s66
  v_add_f32_dpp v25, v32, v25 quad_perm:[0,1,2,3] row_mask:0xf bank_mask:0x1
  v_accvgpr_read_b32 v29, a86
  v_mfma_f32_16x16x32_bf16 v[44:47], v[60:63], v[8:11], 0
  v_mov_b32_dpp v27, v34 row_ror:8 row_mask:0xf bank_mask:0x1
  v_and_b32 v28, s64, v29
  v_add_f32_dpp v25, v36, v25 row_ror:4 row_mask:0xf bank_mask:0x2
  v_alignbit_b32 v29, v29, v29, 4
  v_mov_b32_dpp v27, v38 row_ror:12 row_mask:0xf bank_mask:0x2
  v_and_b32 v29, s64, v29
  v_add_f32_dpp v25, v40, v25 row_ror:8 row_mask:0xf bank_mask:0x4
  v_accvgpr_read_b32 v49, a84
  v_mov_b32_dpp v27, v42 quad_perm:[0,1,2,3] row_mask:0xf bank_mask:0x4
  v_perm_b32 v48, v28, v49, s65
  v_add_f32_dpp v25, v44, v25 row_ror:12 row_mask:0xf bank_mask:0x8
  v_perm_b32 v49, v28, v49, s66
  v_mov_b32_dpp v27, v46 row_ror:4 row_mask:0xf bank_mask:0x8
  v_accvgpr_read_b32 v53, a85
  v_add_f32_dpp v25, v33, v25 row_ror:12 row_mask:0xf bank_mask:0x1
  v_perm_b32 v52, v29, v53, s65
  v_add_f32_dpp v27, v35, v27 row_ror:4 row_mask:0xf bank_mask:0x1
  v_perm_b32 v53, v29, v53, s66
  v_add_f32_dpp v25, v37, v25 quad_perm:[0,1,2,3] row_mask:0xf bank_mask:0x2
  v_accvgpr_read_b32 v29, a87
  v_add_f32_dpp v27, v39, v27 row_ror:8 row_mask:0xf bank_mask:0x2
  v_and_b32 v28, s64, v29
  v_add_f32_dpp v25, v41, v25 row_ror:4 row_mask:0xf bank_mask:0x4
  v_alignbit_b32 v29, v29, v29, 4
  v_add_f32_dpp v27, v43, v27 row_ror:12 row_mask:0xf bank_mask:0x4
  v_and_b32 v29, s64, v29
  v_add_f32_dpp v25, v45, v25 row_ror:8 row_mask:0xf bank_mask:0x8
  v_accvgpr_read_b32 v51, a88
  v_add_f32_dpp v27, v47, v27 quad_perm:[0,1,2,3] row_mask:0xf bank_mask:0x8
  v_perm_b32 v50, v28, v51, s65
  v_perm_b32 v51, v28, v51, s66
  v_add_f32 v25, v25, v27
  v_accvgpr_read_b32 v55, a89
  v_cvt_pk_bf16_f32 v32, v24, v25
  v_perm_b32 v54, v29, v55, s65
  v_lshlrev_b32 v24, 16, v32
  v_perm_b32 v55, v29, v55, s66
  v_and_b32 v25, 0xffff0000, v32
  v_accvgpr_read_b32 v29, a92
  v_pk_mul_f32 v[24:25], v[24:25], s[56:57] op_sel_hi:[1,0]
  v_and_b32 v28, s64, v29
  v_cvt_pk_bf16_f32 v32, v24, v25
  v_lshlrev_b32 v24, 16, v32
  v_alignbit_b32 v29, v29, v29, 4
  v_and_b32 v25, 0xffff0000, v32
  ds_write_b64 v3, v[24:25] offset:8
  v_and_b32 v29, s64, v29
  v_pk_add_f32 v[26:27], v[24:25], v[4:5] op_sel_hi:[1,0] neg_lo:[0,1] neg_hi:[0,1]
  v_pk_mul_f32 v[26:27], v[26:27], s[56:57] op_sel:[0,1] op_sel_hi:[1,1]
  v_accvgpr_read_b32 v57, a90
  v_max_f32 v20, v26, v27
  v_perm_b32 v56, v28, v57, s65
  v_perm_b32 v57, v28, v57, s66
  v_cmp_lt_f32 vcc, 0, v20
  s_getpc_b64 s[74:75]
  s_cbranch_vccnz L_remax
  v_accvgpr_read_b32 v61, a91
  v_exp_f32 v26, v26
  v_exp_f32 v27, v27
  v_perm_b32 v60, v29, v61, s65
  v_pk_mul_f32 v[24:25], v[26:27], s[40:41] op_sel:[0,1] op_sel_hi:[1,1]
  v_perm_b32 v61, v29, v61, s66
  v_add_f32 v32, v26, v27
  v_accvgpr_read_b32 v29, a93
  v_cvt_pk_bf16_f32 v20, v24, 0
  v_and_b32 v28, s64, v29
  v_cvt_pk_bf16_f32 v21, v24, 0
  v_alignbit_b32 v29, v29, v29, 4
  v_cvt_pk_bf16_f32 v23, v25, 0
  v_and_b32 v29, s64, v29
  v_cvt_pk_bf16_f32 v22, v25, 0
  v_cvt_pk_bf16_f32 v24, 0, v24
  v_accvgpr_read_b32 v59, a94
  v_cvt_pk_bf16_f32 v25, 0, v25
  v_perm_b32 v58, v28, v59, s65
  v_add_f32 v5, v5, v32
  v_perm_b32 v59, v28, v59, s66
  v_mov_b32_dpp v20, v24 row_ror:4 row_mask:0xf bank_mask:0xa
  v_accvgpr_read_b32 v63, a95
  v_mov_b32_dpp v21, v24 row_ror:4 row_mask:0xf bank_mask:0x5
  v_perm_b32 v62, v29, v63, s65
  v_mov_b32_dpp v23, v25 row_ror:4 row_mask:0xf bank_mask:0xa
  v_perm_b32 v63, v29, v63, s66
  v_mov_b32_dpp v22, v25 row_ror:4 row_mask:0xf bank_mask:0x5
  ds_read_b64 v[24:25], v3 offset:1024
  s_waitcnt vmcnt(32)
  buffer_load_dwordx4 a[120:123], v1, s[8:11], s72 offen offset:2048 nt
  v_and_b32_dpp v32, v20, v6 quad_perm:[0,1,2,3] row_mask:0xf bank_mask:0xf
  v_and_b32_dpp v33, v20, v7 row_ror:8 row_mask:0xf bank_mask:0xf
  v_and_b32_dpp v34, v21, v6 row_ror:12 row_mask:0xf bank_mask:0xf
  v_and_b32_dpp v35, v21, v7 row_ror:4 row_mask:0xf bank_mask:0xf
  v_and_b32_dpp v36, v20, v6 row_ror:8 row_mask:0xf bank_mask:0xf
  v_and_b32_dpp v37, v20, v7 quad_perm:[0,1,2,3] row_mask:0xf bank_mask:0xf
  v_mfma_f32_16x16x32_bf16 v[12:15], v[32:35], v[48:51], v[12:15]
  v_and_b32_dpp v38, v21, v6 row_ror:4 row_mask:0xf bank_mask:0xf
  v_and_b32_dpp v39, v21, v7 row_ror:12 row_mask:0xf bank_mask:0xf
  v_mfma_f32_16x16x32_bf16 v[16:19], v[32:35], v[52:55], v[16:19]
  v_and_b32_dpp v40, v23, v6 quad_perm:[0,1,2,3] row_mask:0xf bank_mask:0xf
  v_and_b32_dpp v41, v23, v7 row_ror:8 row_mask:0xf bank_mask:0xf
  v_mfma_f32_16x16x32_bf16 v[12:15], v[36:39], v[56:59], v[12:15]
  v_and_b32_dpp v42, v22, v6 row_ror:12 row_mask:0xf bank_mask:0xf
  v_and_b32_dpp v43, v22, v7 row_ror:4 row_mask:0xf bank_mask:0xf
  v_mfma_f32_16x16x32_bf16 v[16:19], v[36:39], v[60:63], v[16:19]
  v_and_b32_dpp v44, v23, v6 row_ror:8 row_mask:0xf bank_mask:0xf
  v_and_b32_dpp v45, v23, v7 quad_perm:[0,1,2,3] row_mask:0xf bank_mask:0xf
  v_and_b32_dpp v46, v22, v6 row_ror:4 row_mask:0xf bank_mask:0xf
  v_and_b32_dpp v47, v22, v7 row_ror:12 row_mask:0xf bank_mask:0xf
  v_accvgpr_read_b32 v29, a110
  v_and_b32 v28, s64, v29
  v_alignbit_b32 v29, v29, v29, 4
  v_and_b32 v29, s64, v29
  v_accvgpr_read_b32 v49, a108
  v_perm_b32 v48, v28, v49, s65
  v_perm_b32 v49, v28, v49, s66
  v_accvgpr_read_b32 v53, a109
  v_perm_b32 v52, v29, v53, s65
  v_perm_b32 v53, v29, v53, s66
  v_accvgpr_read_b32 v29, a111
  v_and_b32 v28, s64, v29
  v_alignbit_b32 v29, v29, v29, 4
  v_and_b32 v29, s64, v29
  v_accvgpr_read_b32 v51, a112
  v_perm_b32 v50, v28, v51, s65
  v_perm_b32 v51, v28, v51, s66
  v_accvgpr_read_b32 v55, a113
  v_perm_b32 v54, v29, v55, s65
  v_mfma_f32_16x16x32_bf16 v[12:15], v[40:43], v[48:51], v[12:15]
  v_perm_b32 v55, v29, v55, s66
  v_accvgpr_read_b32 v29, a116
  v_and_b32 v28, s64, v29
  v_mfma_f32_16x16x32_bf16 v[16:19], v[40:43], v[52:55], v[16:19]
  v_alignbit_b32 v29, v29, v29, 4
  v_and_b32 v29, s64, v29
  v_accvgpr_read_b32 v57, a114
  v_perm_b32 v56, v28, v57, s65
  v_perm_b32 v57, v28, v57, s66
  v_accvgpr_read_b32 v61, a115
  v_perm_b32 v60, v29, v61, s65
  v_perm_b32 v61, v29, v61, s66
  v_accvgpr_read_b32 v29, a117
  v_and_b32 v28, s64, v29
  v_alignbit_b32 v29, v29, v29, 4
  v_and_b32 v29, s64, v29
  v_accvgpr_read_b32 v59, a118
  v_perm_b32 v58, v28, v59, s65
  v_perm_b32 v59, v28, v59, s66
  v_accvgpr_read_b32 v63, a119
  v_perm_b32 v62, v29, v63, s65
  v_mfma_f32_16x16x32_bf16 v[12:15], v[44:47], v[56:59], v[12:15]
  v_perm_b32 v63, v29, v63, s66
  s_waitcnt vmcnt(32)
  buffer_load_dwordx4 a[124:127], v1, s[8:11], s72 offen offset:3072 nt
  v_mfma_f32_16x16x32_bf16 v[16:19], v[44:47], v[60:63], v[16:19]
  v_accvgpr_read_b32 v29, a138
  v_and_b32 v28, s64, v29
  v_alignbit_b32 v29, v29, v29, 4
  v_and_b32 v29, s64, v29
  v_accvgpr_read_b32 v49, a136
  v_perm_b32 v48, v28, v49, s65
  v_perm_b32 v49, v28, v49, s66
  v_accvgpr_read_b32 v51, a137
  v_perm_b32 v50, v29, v51, s65
  v_perm_b32 v51, v29, v51, s66
  v_accvgpr_read_b32 v29, a139
  v_and_b32 v28, s64, v29
  v_mfma_f32_16x16x32_bf16 v[32:35], v[48:51], v[8:11], 0
  v_alignbit_b32 v29, v29, v29, 4
  v_and_b32 v29, s64, v29
  v_accvgpr_read_b32 v53, a140
  v_perm_b32 v52, v28, v53, s65
  v_perm_b32 v53, v28, v53, s66
  v_accvgpr_read_b32 v55, a141
  v_perm_b32 v54, v29, v55, s65
  v_perm_b32 v55, v29, v55, s66
  v_accvgpr_read_b32 v29, a144
  v_and_b32 v28, s64, v29
  v_mfma_f32_16x16x32_bf16 v[36:39], v[52:55], v[8:11], 0
  v_alignbit_b32 v29, v29, v29, 4
  v_and_b32 v29, s64, v29
  v_accvgpr_read_b32 v57, a142
  v_perm_b32 v56, v28, v57, s65
  v_perm_b32 v57, v28, v57, s66
  v_accvgpr_read_b32 v59, a143
  v_perm_b32 v58, v29, v59, s65
  v_perm_b32 v59, v29, v59, s66
  v_accvgpr_read_b32 v29, a145
  v_and_b32 v28, s64, v29
  v_mfma_f32_16x16x32_bf16 v[40:43], v[56:59], v[8:11], 0
  v_alignbit_b32 v29, v29, v29, 4
  v_and_b32 v29, s64, v29
  v_accvgpr_read_b32 v61, a146
  v_perm_b32 v60, v28, v61, s65
  v_perm_b32 v61, v28, v61, s66
  v_accvgpr_read_b32 v63, a147
  v_perm_b32 v62, v29, v63, s65
  v_perm_b32 v63, v29, v63, s66
  s_waitcnt lgkmcnt(0)
  ds_read_b128 v[52:55], v3 offset:12288
  v_mfma_f32_16x16x32_bf16 v[44:47], v[60:63], v[8:11], 0
  ds_read_b128 v[56:59], v3 offset:13312
  ds_read_b128 v[60:63], v3 offset:14336
  s_waitcnt vmcnt(32)
  s_xor_b32 s72, s49, 245760
  buffer_load_dwordx4 a[128:131], v1, s[8:11], s72 offen nt
  v_add_f32_dpp v24, v32, v24 quad_perm:[0,1,2,3] row_mask:0xf bank_mask:0x1
  v_mov_b32_dpp v26, v34 row_ror:8 row_mask:0xf bank_mask:0x1
  s_waitcnt vmcnt(32)
  v_add_f32_dpp v24, v36, v24 row_ror:4 row_mask:0xf bank_mask:0x2
  v_mov_b32_dpp v26, v38 row_ror:12 row_mask:0xf bank_mask:0x2
  buffer_load_dwordx4 a[132:135], v1, s[8:11], s72 offen offset:1024 nt
  v_add_f32_dpp v24, v40, v24 row_ror:8 row_mask:0xf bank_mask:0x4
  v_mov_b32_dpp v26, v42 quad_perm:[0,1,2,3] row_mask:0xf bank_mask:0x4
  s_nop 0
  v_add_f32_dpp v24, v44, v24 row_ror:12 row_mask:0xf bank_mask:0x8
  v_mov_b32_dpp v26, v46 row_ror:4 row_mask:0xf bank_mask:0x8
  s_nop 0
  v_add_f32_dpp v24, v33, v24 row_ror:12 row_mask:0xf bank_mask:0x1
  v_add_f32_dpp v26, v35, v26 row_ror:4 row_mask:0xf bank_mask:0x1
  s_nop 0
  v_add_f32_dpp v24, v37, v24 quad_perm:[0,1,2,3] row_mask:0xf bank_mask:0x2
  v_add_f32_dpp v26, v39, v26 row_ror:8 row_mask:0xf bank_mask:0x2
  s_nop 0
  v_add_f32_dpp v24, v41, v24 row_ror:4 row_mask:0xf bank_mask:0x4
  v_add_f32_dpp v26, v43, v26 row_ror:12 row_mask:0xf bank_mask:0x4
  s_nop 0
  v_add_f32_dpp v24, v45, v24 row_ror:8 row_mask:0xf bank_mask:0x8
  v_add_f32_dpp v26, v47, v26 quad_perm:[0,1,2,3] row_mask:0xf bank_mask:0x8
  v_add_f32 v24, v24, v26
  s_waitcnt lgkmcnt(0)
  v_and_b32 v28, s64, v54
  v_alignbit_b32 v29, v54, v54, 4
  v_and_b32 v29, s64, v29
  v_perm_b32 v48, v28, v52, s65
  v_perm_b32 v49, v28, v52, s66
  v_perm_b32 v50, v29, v53, s65
  v_perm_b32 v51, v29, v53, s66
  v_and_b32 v28, s64, v55
  v_alignbit_b32 v29, v55, v55, 4
  v_mfma_f32_16x16x32_bf16 v[32:35], v[48:51], v[8:11], 0
  v_and_b32 v29, s64, v29
  v_perm_b32 v52, v28, v56, s65
  v_perm_b32 v53, v28, v56, s66
  v_perm_b32 v54, v29, v57, s65
  v_perm_b32 v55, v29, v57, s66
  v_and_b32 v28, s64, v60
  v_alignbit_b32 v29, v60, v60, 4
  v_mfma_f32_16x16x32_bf16 v[36:39], v[52:55], v[8:11], 0
  v_and_b32 v29, s64, v29
  v_perm_b32 v56, v28, v58, s65
  v_perm_b32 v57, v28, v58, s66
  v_perm_b32 v58, v29, v59, s65
  v_perm_b32 v59, v29, v59, s66
  v_and_b32 v28, s64, v61
  v_alignbit_b32 v29, v61, v61, 4
  v_mfma_f32_16x16x32_bf16 v[40:43], v[56:59], v[8:11], 0
  v_and_b32 v29, s64, v29
  v_perm_b32 v60, v28, v62, s65
  v_perm_b32 v61, v28, v62, s66
  v_perm_b32 v62, v29, v63, s65
  v_perm_b32 v63, v29, v63, s66
  v_add_f32_dpp v25, v32, v25 quad_perm:[0,1,2,3] row_mask:0xf bank_mask:0x1
  v_accvgpr_read_b32 v29, a154
  v_mfma_f32_16x16x32_bf16 v[44:47], v[60:63], v[8:11], 0
  v_mov_b32_dpp v27, v34 row_ror:8 row_mask:0xf bank_mask:0x1
  v_and_b32 v28, s64, v29
  v_add_f32_dpp v25, v36, v25 row_ror:4 row_mask:0xf bank_mask:0x2
  v_alignbit_b32 v29, v29, v29, 4
  v_mov_b32_dpp v27, v38 row_ror:12 row_mask:0xf bank_mask:0x2
  v_and_b32 v29, s64, v29
  v_add_f32_dpp v25, v40, v25 row_ror:8 row_mask:0xf bank_mask:0x4
  v_accvgpr_read_b32 v49, a152
  v_mov_b32_dpp v27, v42 quad_perm:[0,1,2,3] row_mask:0xf bank_mask:0x4
  v_perm_b32 v48, v28, v49, s65
  v_add_f32_dpp v25, v44, v25 row_ror:12 row_mask:0xf bank_mask:0x8
  v_perm_b32 v49, v28, v49, s66
  v_mov_b32_dpp v27, v46 row_ror:4 row_mask:0xf bank_mask:0x8
  v_accvgpr_read_b32 v53, a153
  v_add_f32_dpp v25, v33, v25 row_ror:12 row_mask:0xf bank_mask:0x1
  v_perm_b32 v52, v29, v53, s65
  v_add_f32_dpp v27, v35, v27 row_ror:4 row_mask:0xf bank_mask:0x1
  v_perm_b32 v53, v29, v53, s66
  v_add_f32_dpp v25, v37, v25 quad_perm:[0,1,2,3] row_mask:0xf bank_mask:0x2
  v_accvgpr_read_b32 v29, a155
  v_add_f32_dpp v27, v39, v27 row_ror:8 row_mask:0xf bank_mask:0x2
  v_and_b32 v28, s64, v29
  v_add_f32_dpp v25, v41, v25 row_ror:4 row_mask:0xf bank_mask:0x4
  v_alignbit_b32 v29, v29, v29, 4
  v_add_f32_dpp v27, v43, v27 row_ror:12 row_mask:0xf bank_mask:0x4
  v_and_b32 v29, s64, v29
  v_add_f32_dpp v25, v45, v25 row_ror:8 row_mask:0xf bank_mask:0x8
  v_accvgpr_read_b32 v51, a156
  v_add_f32_dpp v27, v47, v27 quad_perm:[0,1,2,3] row_mask:0xf bank_mask:0x8
  v_perm_b32 v50, v28, v51, s65
  v_perm_b32 v51, v28, v51, s66
  v_add_f32 v25, v25, v27
  v_accvgpr_read_b32 v55, a157
  v_cvt_pk_bf16_f32 v32, v24, v25
  v_perm_b32 v54, v29, v55, s65
  v_lshlrev_b32 v24, 16, v32
  v_perm_b32 v55, v29, v55, s66
  v_and_b32 v25, 0xffff0000, v32
  v_accvgpr_read_b32 v29, a160
  v_pk_mul_f32 v[24:25], v[24:25], s[56:57] op_sel_hi:[1,0]
  v_and_b32 v28, s64, v29
  v_cvt_pk_bf16_f32 v32, v24, v25
  v_lshlrev_b32 v24, 16, v32
  v_alignbit_b32 v29, v29, v29, 4
  v_and_b32 v25, 0xffff0000, v32
  ds_write_b64 v3, v[24:25] offset:1024
  v_and_b32 v29, s64, v29
  v_pk_add_f32 v[26:27], v[24:25], v[4:5] op_sel_hi:[1,0] neg_lo:[0,1] neg_hi:[0,1]
  v_pk_mul_f32 v[26:27], v[26:27], s[56:57] op_sel:[0,1] op_sel_hi:[1,1]
  v_accvgpr_read_b32 v57, a158
  v_max_f32 v20, v26, v27
  v_perm_b32 v56, v28, v57, s65
  v_perm_b32 v57, v28, v57, s66
  v_cmp_lt_f32 vcc, 0, v20
  s_getpc_b64 s[74:75]
  s_cbranch_vccnz L_remax
  v_accvgpr_read_b32 v61, a159
  v_exp_f32 v26, v26
  v_exp_f32 v27, v27
  v_perm_b32 v60, v29, v61, s65
  v_pk_mul_f32 v[24:25], v[26:27], s[40:41] op_sel:[0,1] op_sel_hi:[1,1]
  v_perm_b32 v61, v29, v61, s66
  v_add_f32 v32, v26, v27
  v_accvgpr_read_b32 v29, a161
  v_cvt_pk_bf16_f32 v20, v24, 0
  v_and_b32 v28, s64, v29
  v_cvt_pk_bf16_f32 v21, v24, 0
  v_alignbit_b32 v29, v29, v29, 4
  v_cvt_pk_bf16_f32 v23, v25, 0
  v_and_b32 v29, s64, v29
  v_cvt_pk_bf16_f32 v22, v25, 0
  v_cvt_pk_bf16_f32 v24, 0, v24
  v_accvgpr_read_b32 v59, a162
  v_cvt_pk_bf16_f32 v25, 0, v25
  v_perm_b32 v58, v28, v59, s65
  v_add_f32 v5, v5, v32
  v_perm_b32 v59, v28, v59, s66
  v_mov_b32_dpp v20, v24 row_ror:4 row_mask:0xf bank_mask:0xa
  v_accvgpr_read_b32 v63, a163
  v_mov_b32_dpp v21, v24 row_ror:4 row_mask:0xf bank_mask:0x5
  v_perm_b32 v62, v29, v63, s65
  v_mov_b32_dpp v23, v25 row_ror:4 row_mask:0xf bank_mask:0xa
  v_perm_b32 v63, v29, v63, s66
  v_mov_b32_dpp v22, v25 row_ror:4 row_mask:0xf bank_mask:0x5
  ds_read_b64 v[24:25], v3 offset:1032
  s_waitcnt vmcnt(32)
  buffer_load_dwordx4 a[148:151], v1, s[8:11], s72 offen offset:2048 nt
  s_waitcnt vmcnt(32)
  buffer_load_dwordx4 a[164:167], v1, s[8:11], s72 offen offset:3072 nt
  v_and_b32_dpp v32, v20, v6 quad_perm:[0,1,2,3] row_mask:0xf bank_mask:0xf
  v_and_b32_dpp v33, v20, v7 row_ror:8 row_mask:0xf bank_mask:0xf
  v_and_b32_dpp v34, v21, v6 row_ror:12 row_mask:0xf bank_mask:0xf
  v_and_b32_dpp v35, v21, v7 row_ror:4 row_mask:0xf bank_mask:0xf
  v_and_b32_dpp v36, v20, v6 row_ror:8 row_mask:0xf bank_mask:0xf
  v_and_b32_dpp v37, v20, v7 quad_perm:[0,1,2,3] row_mask:0xf bank_mask:0xf
  v_mfma_f32_16x16x32_bf16 v[12:15], v[32:35], v[48:51], v[12:15]
  v_and_b32_dpp v38, v21, v6 row_ror:4 row_mask:0xf bank_mask:0xf
  v_and_b32_dpp v39, v21, v7 row_ror:12 row_mask:0xf bank_mask:0xf
  v_mfma_f32_16x16x32_bf16 v[16:19], v[32:35], v[52:55], v[16:19]
  v_and_b32_dpp v40, v23, v6 quad_perm:[0,1,2,3] row_mask:0xf bank_mask:0xf
  v_and_b32_dpp v41, v23, v7 row_ror:8 row_mask:0xf bank_mask:0xf
  v_mfma_f32_16x16x32_bf16 v[12:15], v[36:39], v[56:59], v[12:15]
  v_and_b32_dpp v42, v22, v6 row_ror:12 row_mask:0xf bank_mask:0xf
  v_and_b32_dpp v43, v22, v7 row_ror:4 row_mask:0xf bank_mask:0xf
  v_mfma_f32_16x16x32_bf16 v[16:19], v[36:39], v[60:63], v[16:19]
  v_and_b32_dpp v44, v23, v6 row_ror:8 row_mask:0xf bank_mask:0xf
  v_and_b32_dpp v45, v23, v7 quad_perm:[0,1,2,3] row_mask:0xf bank_mask:0xf
  v_and_b32_dpp v46, v22, v6 row_ror:4 row_mask:0xf bank_mask:0xf
  v_and_b32_dpp v47, v22, v7 row_ror:12 row_mask:0xf bank_mask:0xf
  v_accvgpr_read_b32 v29, a178
  v_and_b32 v28, s64, v29
  v_alignbit_b32 v29, v29, v29, 4
  v_and_b32 v29, s64, v29
  v_accvgpr_read_b32 v49, a176
  v_perm_b32 v48, v28, v49, s65
  v_perm_b32 v49, v28, v49, s66
  v_accvgpr_read_b32 v53, a177
  v_perm_b32 v52, v29, v53, s65
  v_perm_b32 v53, v29, v53, s66
  v_accvgpr_read_b32 v29, a179
  v_and_b32 v28, s64, v29
  v_alignbit_b32 v29, v29, v29, 4
  v_and_b32 v29, s64, v29
  v_accvgpr_read_b32 v51, a180
  v_perm_b32 v50, v28, v51, s65
  v_perm_b32 v51, v28, v51, s66
  v_accvgpr_read_b32 v55, a181
  v_perm_b32 v54, v29, v55, s65
  v_mfma_f32_16x16x32_bf16 v[12:15], v[40:43], v[48:51], v[12:15]
  v_perm_b32 v55, v29, v55, s66
  v_accvgpr_read_b32 v29, a184
  v_and_b32 v28, s64, v29
  v_mfma_f32_16x16x32_bf16 v[16:19], v[40:43], v[52:55], v[16:19]
  v_alignbit_b32 v29, v29, v29, 4
  v_and_b32 v29, s64, v29
  v_accvgpr_read_b32 v57, a182
  v_perm_b32 v56, v28, v57, s65
  v_perm_b32 v57, v28, v57, s66
  v_accvgpr_read_b32 v61, a183
  v_perm_b32 v60, v29, v61, s65
  v_perm_b32 v61, v29, v61, s66
  v_accvgpr_read_b32 v29, a185
  v_and_b32 v28, s64, v29
  v_alignbit_b32 v29, v29, v29, 4
  v_and_b32 v29, s64, v29
  v_accvgpr_read_b32 v59, a186
  v_perm_b32 v58, v28, v59, s65
  v_perm_b32 v59, v28, v59, s66
  v_accvgpr_read_b32 v63, a187
  v_perm_b32 v62, v29, v63, s65
  v_mfma_f32_16x16x32_bf16 v[12:15], v[44:47], v[56:59], v[12:15]
  v_perm_b32 v63, v29, v63, s66
  s_waitcnt vmcnt(32)
  s_xor_b32 s72, s49, 229376
  v_mfma_f32_16x16x32_bf16 v[16:19], v[44:47], v[60:63], v[16:19]
  buffer_load_dwordx4 a[168:171], v2, s[12:15], s72 offen nt
  v_accvgpr_read_b32 v29, a206
  v_and_b32 v28, s64, v29
  v_alignbit_b32 v29, v29, v29, 4
  v_and_b32 v29, s64, v29
  v_accvgpr_read_b32 v49, a204
  v_perm_b32 v48, v28, v49, s65
  v_perm_b32 v49, v28, v49, s66
  v_accvgpr_read_b32 v51, a205
  v_perm_b32 v50, v29, v51, s65
  v_perm_b32 v51, v29, v51, s66
  v_accvgpr_read_b32 v29, a207
  v_and_b32 v28, s64, v29
  v_mfma_f32_16x16x32_bf16 v[32:35], v[48:51], v[8:11], 0
  v_alignbit_b32 v29, v29, v29, 4
  v_and_b32 v29, s64, v29
  v_accvgpr_read_b32 v53, a208
  v_perm_b32 v52, v28, v53, s65
  v_perm_b32 v53, v28, v53, s66
  v_accvgpr_read_b32 v55, a209
  v_perm_b32 v54, v29, v55, s65
  v_perm_b32 v55, v29, v55, s66
  v_accvgpr_read_b32 v29, a212
  v_and_b32 v28, s64, v29
  v_mfma_f32_16x16x32_bf16 v[36:39], v[52:55], v[8:11], 0
  v_alignbit_b32 v29, v29, v29, 4
  v_and_b32 v29, s64, v29
  v_accvgpr_read_b32 v57, a210
  v_perm_b32 v56, v28, v57, s65
  v_perm_b32 v57, v28, v57, s66
  v_accvgpr_read_b32 v59, a211
  v_perm_b32 v58, v29, v59, s65
  v_perm_b32 v59, v29, v59, s66
  v_accvgpr_read_b32 v29, a213
  v_and_b32 v28, s64, v29
  v_mfma_f32_16x16x32_bf16 v[40:43], v[56:59], v[8:11], 0
  v_alignbit_b32 v29, v29, v29, 4
  v_and_b32 v29, s64, v29
  v_accvgpr_read_b32 v61, a214
  v_perm_b32 v60, v28, v61, s65
  v_perm_b32 v61, v28, v61, s66
  v_accvgpr_read_b32 v63, a215
  v_perm_b32 v62, v29, v63, s65
  v_perm_b32 v63, v29, v63, s66
  s_waitcnt lgkmcnt(0)
  ds_read_b128 v[52:55], v3 offset:15360
  v_mfma_f32_16x16x32_bf16 v[44:47], v[60:63], v[8:11], 0
  ds_read_b128 v[56:59], v3 offset:16384
  ds_read_b128 v[60:63], v3 offset:17408
  s_waitcnt vmcnt(32)
  buffer_load_dwordx4 a[172:175], v2, s[12:15], s72 offen offset:1024 nt
  v_add_f32_dpp v24, v32, v24 quad_perm:[0,1,2,3] row_mask:0xf bank_mask:0x1
  v_mov_b32_dpp v26, v34 row_ror:8 row_mask:0xf bank_mask:0x1
  s_waitcnt vmcnt(32)
  v_add_f32_dpp v24, v36, v24 row_ror:4 row_mask:0xf bank_mask:0x2
  v_mov_b32_dpp v26, v38 row_ror:12 row_mask:0xf bank_mask:0x2
  buffer_load_dwordx4 a[188:191], v2, s[12:15], s72 offen offset:2048 nt
  v_add_f32_dpp v24, v40, v24 row_ror:8 row_mask:0xf bank_mask:0x4
  v_mov_b32_dpp v26, v42 quad_perm:[0,1,2,3] row_mask:0xf bank_mask:0x4
  s_nop 0
  v_add_f32_dpp v24, v44, v24 row_ror:12 row_mask:0xf bank_mask:0x8
  v_mov_b32_dpp v26, v46 row_ror:4 row_mask:0xf bank_mask:0x8
  s_nop 0
  v_add_f32_dpp v24, v33, v24 row_ror:12 row_mask:0xf bank_mask:0x1
  v_add_f32_dpp v26, v35, v26 row_ror:4 row_mask:0xf bank_mask:0x1
  s_nop 0
  v_add_f32_dpp v24, v37, v24 quad_perm:[0,1,2,3] row_mask:0xf bank_mask:0x2
  v_add_f32_dpp v26, v39, v26 row_ror:8 row_mask:0xf bank_mask:0x2
  s_nop 0
  v_add_f32_dpp v24, v41, v24 row_ror:4 row_mask:0xf bank_mask:0x4
  v_add_f32_dpp v26, v43, v26 row_ror:12 row_mask:0xf bank_mask:0x4
  s_nop 0
  v_add_f32_dpp v24, v45, v24 row_ror:8 row_mask:0xf bank_mask:0x8
  v_add_f32_dpp v26, v47, v26 quad_perm:[0,1,2,3] row_mask:0xf bank_mask:0x8
  v_add_f32 v24, v24, v26
  s_waitcnt lgkmcnt(0)
  v_and_b32 v28, s64, v54
  v_alignbit_b32 v29, v54, v54, 4
  v_and_b32 v29, s64, v29
  v_perm_b32 v48, v28, v52, s65
  v_perm_b32 v49, v28, v52, s66
  v_perm_b32 v50, v29, v53, s65
  v_perm_b32 v51, v29, v53, s66
  v_and_b32 v28, s64, v55
  v_alignbit_b32 v29, v55, v55, 4
  v_mfma_f32_16x16x32_bf16 v[32:35], v[48:51], v[8:11], 0
  v_and_b32 v29, s64, v29
  v_perm_b32 v52, v28, v56, s65
  v_perm_b32 v53, v28, v56, s66
  v_perm_b32 v54, v29, v57, s65
  v_perm_b32 v55, v29, v57, s66
  v_and_b32 v28, s64, v60
  v_alignbit_b32 v29, v60, v60, 4
  v_mfma_f32_16x16x32_bf16 v[36:39], v[52:55], v[8:11], 0
  v_and_b32 v29, s64, v29
  v_perm_b32 v56, v28, v58, s65
  v_perm_b32 v57, v28, v58, s66
  v_perm_b32 v58, v29, v59, s65
  v_perm_b32 v59, v29, v59, s66
  v_and_b32 v28, s64, v61
  v_alignbit_b32 v29, v61, v61, 4
  v_mfma_f32_16x16x32_bf16 v[40:43], v[56:59], v[8:11], 0
  v_and_b32 v29, s64, v29
  v_perm_b32 v60, v28, v62, s65
  v_perm_b32 v61, v28, v62, s66
  v_perm_b32 v62, v29, v63, s65
  v_perm_b32 v63, v29, v63, s66
  v_add_f32_dpp v25, v32, v25 quad_perm:[0,1,2,3] row_mask:0xf bank_mask:0x1
  v_accvgpr_read_b32 v29, a222
  v_mfma_f32_16x16x32_bf16 v[44:47], v[60:63], v[8:11], 0
  v_mov_b32_dpp v27, v34 row_ror:8 row_mask:0xf bank_mask:0x1
  v_and_b32 v28, s64, v29
  v_add_f32_dpp v25, v36, v25 row_ror:4 row_mask:0xf bank_mask:0x2
  v_alignbit_b32 v29, v29, v29, 4
  v_mov_b32_dpp v27, v38 row_ror:12 row_mask:0xf bank_mask:0x2
  v_and_b32 v29, s64, v29
  v_add_f32_dpp v25, v40, v25 row_ror:8 row_mask:0xf bank_mask:0x4
  v_accvgpr_read_b32 v49, a220
  v_mov_b32_dpp v27, v42 quad_perm:[0,1,2,3] row_mask:0xf bank_mask:0x4
  v_perm_b32 v48, v28, v49, s65
  v_add_f32_dpp v25, v44, v25 row_ror:12 row_mask:0xf bank_mask:0x8
  v_perm_b32 v49, v28, v49, s66
  v_mov_b32_dpp v27, v46 row_ror:4 row_mask:0xf bank_mask:0x8
  v_accvgpr_read_b32 v53, a221
  v_add_f32_dpp v25, v33, v25 row_ror:12 row_mask:0xf bank_mask:0x1
  v_perm_b32 v52, v29, v53, s65
  v_add_f32_dpp v27, v35, v27 row_ror:4 row_mask:0xf bank_mask:0x1
  v_perm_b32 v53, v29, v53, s66
  v_add_f32_dpp v25, v37, v25 quad_perm:[0,1,2,3] row_mask:0xf bank_mask:0x2
  v_accvgpr_read_b32 v29, a223
  v_add_f32_dpp v27, v39, v27 row_ror:8 row_mask:0xf bank_mask:0x2
  v_and_b32 v28, s64, v29
  v_add_f32_dpp v25, v41, v25 row_ror:4 row_mask:0xf bank_mask:0x4
  v_alignbit_b32 v29, v29, v29, 4
  v_add_f32_dpp v27, v43, v27 row_ror:12 row_mask:0xf bank_mask:0x4
  v_and_b32 v29, s64, v29
  v_add_f32_dpp v25, v45, v25 row_ror:8 row_mask:0xf bank_mask:0x8
  v_accvgpr_read_b32 v51, a224
  v_add_f32_dpp v27, v47, v27 quad_perm:[0,1,2,3] row_mask:0xf bank_mask:0x8
  v_perm_b32 v50, v28, v51, s65
  v_perm_b32 v51, v28, v51, s66
  v_add_f32 v25, v25, v27
  v_accvgpr_read_b32 v55, a225
  v_cvt_pk_bf16_f32 v32, v24, v25
  v_perm_b32 v54, v29, v55, s65
  v_lshlrev_b32 v24, 16, v32
  v_perm_b32 v55, v29, v55, s66
  v_and_b32 v25, 0xffff0000, v32
  v_accvgpr_read_b32 v29, a228
  v_pk_mul_f32 v[24:25], v[24:25], s[56:57] op_sel_hi:[1,0]
  v_and_b32 v28, s64, v29
  v_cvt_pk_bf16_f32 v32, v24, v25
  v_lshlrev_b32 v24, 16, v32
  v_alignbit_b32 v29, v29, v29, 4
  v_and_b32 v25, 0xffff0000, v32
  ds_write_b64 v3, v[24:25] offset:1032
  v_and_b32 v29, s64, v29
  v_pk_add_f32 v[26:27], v[24:25], v[4:5] op_sel_hi:[1,0] neg_lo:[0,1] neg_hi:[0,1]
  v_pk_mul_f32 v[26:27], v[26:27], s[56:57] op_sel:[0,1] op_sel_hi:[1,1]
  v_accvgpr_read_b32 v57, a226
  v_max_f32 v20, v26, v27
  v_perm_b32 v56, v28, v57, s65
  v_perm_b32 v57, v28, v57, s66
  v_cmp_lt_f32 vcc, 0, v20
  s_getpc_b64 s[74:75]
  s_cbranch_vccnz L_remax
  v_accvgpr_read_b32 v61, a227
  v_exp_f32 v26, v26
  v_exp_f32 v27, v27
  v_perm_b32 v60, v29, v61, s65
  v_pk_mul_f32 v[24:25], v[26:27], s[40:41] op_sel:[0,1] op_sel_hi:[1,1]
  v_perm_b32 v61, v29, v61, s66
  v_add_f32 v32, v26, v27
  v_accvgpr_read_b32 v29, a229
  v_cvt_pk_bf16_f32 v20, v24, 0
  v_and_b32 v28, s64, v29
  v_cvt_pk_bf16_f32 v21, v24, 0
  v_alignbit_b32 v29, v29, v29, 4
  v_cvt_pk_bf16_f32 v23, v25, 0
  v_and_b32 v29, s64, v29
  v_cvt_pk_bf16_f32 v22, v25, 0
  v_cvt_pk_bf16_f32 v24, 0, v24
  v_accvgpr_read_b32 v59, a230
  v_cvt_pk_bf16_f32 v25, 0, v25
  v_perm_b32 v58, v28, v59, s65
  v_add_f32 v5, v5, v32
  v_perm_b32 v59, v28, v59, s66
  v_mov_b32_dpp v20, v24 row_ror:4 row_mask:0xf bank_mask:0xa
  v_accvgpr_read_b32 v63, a231
  v_mov_b32_dpp v21, v24 row_ror:4 row_mask:0xf bank_mask:0x5
  v_perm_b32 v62, v29, v63, s65
  v_mov_b32_dpp v23, v25 row_ror:4 row_mask:0xf bank_mask:0xa
  v_perm_b32 v63, v29, v63, s66
  v_mov_b32_dpp v22, v25 row_ror:4 row_mask:0xf bank_mask:0x5
  ds_read_b64 v[24:25], v3 offset:2048
  s_waitcnt vmcnt(32)
  buffer_load_dwordx4 a[192:195], v2, s[12:15], s72 offen offset:3072 nt
  v_and_b32_dpp v32, v20, v6 quad_perm:[0,1,2,3] row_mask:0xf bank_mask:0xf
  v_and_b32_dpp v33, v20, v7 row_ror:8 row_mask:0xf bank_mask:0xf
  v_and_b32_dpp v34, v21, v6 row_ror:12 row_mask:0xf bank_mask:0xf
  v_and_b32_dpp v35, v21, v7 row_ror:4 row_mask:0xf bank_mask:0xf
  v_and_b32_dpp v36, v20, v6 row_ror:8 row_mask:0xf bank_mask:0xf
  v_and_b32_dpp v37, v20, v7 quad_perm:[0,1,2,3] row_mask:0xf bank_mask:0xf
  v_mfma_f32_16x16x32_bf16 v[12:15], v[32:35], v[48:51], v[12:15]
  v_and_b32_dpp v38, v21, v6 row_ror:4 row_mask:0xf bank_mask:0xf
  v_and_b32_dpp v39, v21, v7 row_ror:12 row_mask:0xf bank_mask:0xf
  v_mfma_f32_16x16x32_bf16 v[16:19], v[32:35], v[52:55], v[16:19]
  v_and_b32_dpp v40, v23, v6 quad_perm:[0,1,2,3] row_mask:0xf bank_mask:0xf
  v_and_b32_dpp v41, v23, v7 row_ror:8 row_mask:0xf bank_mask:0xf
  v_mfma_f32_16x16x32_bf16 v[12:15], v[36:39], v[56:59], v[12:15]
  v_and_b32_dpp v42, v22, v6 row_ror:12 row_mask:0xf bank_mask:0xf
  v_and_b32_dpp v43, v22, v7 row_ror:4 row_mask:0xf bank_mask:0xf
  v_mfma_f32_16x16x32_bf16 v[16:19], v[36:39], v[60:63], v[16:19]
  v_and_b32_dpp v44, v23, v6 row_ror:8 row_mask:0xf bank_mask:0xf
  v_and_b32_dpp v45, v23, v7 quad_perm:[0,1,2,3] row_mask:0xf bank_mask:0xf
  v_and_b32_dpp v46, v22, v6 row_ror:4 row_mask:0xf bank_mask:0xf
  v_and_b32_dpp v47, v22, v7 row_ror:12 row_mask:0xf bank_mask:0xf
  v_accvgpr_read_b32 v29, a246
  v_and_b32 v28, s64, v29
  v_alignbit_b32 v29, v29, v29, 4
  v_and_b32 v29, s64, v29
  v_accvgpr_read_b32 v49, a244
  v_perm_b32 v48, v28, v49, s65
  v_perm_b32 v49, v28, v49, s66
  v_accvgpr_read_b32 v53, a245
  v_perm_b32 v52, v29, v53, s65
  v_perm_b32 v53, v29, v53, s66
  v_accvgpr_read_b32 v29, a247
  v_and_b32 v28, s64, v29
  v_alignbit_b32 v29, v29, v29, 4
  v_and_b32 v29, s64, v29
  v_accvgpr_read_b32 v51, a248
  v_perm_b32 v50, v28, v51, s65
  v_perm_b32 v51, v28, v51, s66
  v_accvgpr_read_b32 v55, a249
  v_perm_b32 v54, v29, v55, s65
  v_mfma_f32_16x16x32_bf16 v[12:15], v[40:43], v[48:51], v[12:15]
  v_perm_b32 v55, v29, v55, s66
  v_accvgpr_read_b32 v29, a252
  v_and_b32 v28, s64, v29
  v_mfma_f32_16x16x32_bf16 v[16:19], v[40:43], v[52:55], v[16:19]
  v_alignbit_b32 v29, v29, v29, 4
  v_and_b32 v29, s64, v29
  v_accvgpr_read_b32 v57, a250
  v_perm_b32 v56, v28, v57, s65
  v_perm_b32 v57, v28, v57, s66
  v_accvgpr_read_b32 v61, a251
  v_perm_b32 v60, v29, v61, s65
  v_perm_b32 v61, v29, v61, s66
  v_accvgpr_read_b32 v29, a253
  v_and_b32 v28, s64, v29
  v_alignbit_b32 v29, v29, v29, 4
  v_and_b32 v29, s64, v29
  v_accvgpr_read_b32 v59, a254
  v_perm_b32 v58, v28, v59, s65
  v_perm_b32 v59, v28, v59, s66
  v_accvgpr_read_b32 v63, a255
  v_perm_b32 v62, v29, v63, s65
  v_mfma_f32_16x16x32_bf16 v[12:15], v[44:47], v[56:59], v[12:15]
  v_perm_b32 v63, v29, v63, s66
  s_waitcnt vmcnt(32)
  s_xor_b32 s72, s49, 245760
  v_mfma_f32_16x16x32_bf16 v[16:19], v[44:47], v[60:63], v[16:19]
  buffer_load_dwordx4 a[196:199], v2, s[12:15], s72 offen nt
  v_and_b32 v28, s64, v218
  v_alignbit_b32 v29, v218, v218, 4
  v_and_b32 v29, s64, v29
  v_perm_b32 v48, v28, v216, s65
  v_perm_b32 v49, v28, v216, s66
  v_perm_b32 v50, v29, v217, s65
  v_perm_b32 v51, v29, v217, s66
  v_and_b32 v28, s64, v219
  v_alignbit_b32 v29, v219, v219, 4
  v_mfma_f32_16x16x32_bf16 v[32:35], v[48:51], v[8:11], 0
  v_and_b32 v29, s64, v29
  v_perm_b32 v52, v28, v220, s65
  v_perm_b32 v53, v28, v220, s66
  v_perm_b32 v54, v29, v221, s65
  v_perm_b32 v55, v29, v221, s66
  v_and_b32 v28, s64, v224
  v_alignbit_b32 v29, v224, v224, 4
  v_mfma_f32_16x16x32_bf16 v[36:39], v[52:55], v[8:11], 0
  v_and_b32 v29, s64, v29
  v_perm_b32 v56, v28, v222, s65
  v_perm_b32 v57, v28, v222, s66
  v_perm_b32 v58, v29, v223, s65
  v_perm_b32 v59, v29, v223, s66
  v_and_b32 v28, s64, v225
  v_alignbit_b32 v29, v225, v225, 4
  v_mfma_f32_16x16x32_bf16 v[40:43], v[56:59], v[8:11], 0
  v_and_b32 v29, s64, v29
  v_perm_b32 v60, v28, v226, s65
  v_perm_b32 v61, v28, v226, s66
  v_perm_b32 v62, v29, v227, s65
  v_perm_b32 v63, v29, v227, s66
  s_waitcnt lgkmcnt(0)
  ds_read_b128 v[52:55], v3 offset:18432
  v_mfma_f32_16x16x32_bf16 v[44:47], v[60:63], v[8:11], 0
  ds_read_b128 v[56:59], v3 offset:19456
  ds_read_b128 v[60:63], v3 offset:20480
  s_waitcnt vmcnt(32)
  buffer_load_dwordx4 a[200:203], v2, s[12:15], s72 offen offset:1024 nt
  v_add_f32_dpp v24, v32, v24 quad_perm:[0,1,2,3] row_mask:0xf bank_mask:0x1
  v_mov_b32_dpp v26, v34 row_ror:8 row_mask:0xf bank_mask:0x1
  s_waitcnt vmcnt(32)
  v_add_f32_dpp v24, v36, v24 row_ror:4 row_mask:0xf bank_mask:0x2
  v_mov_b32_dpp v26, v38 row_ror:12 row_mask:0xf bank_mask:0x2
  buffer_load_dwordx4 a[216:219], v2, s[12:15], s72 offen offset:2048 nt
  v_add_f32_dpp v24, v40, v24 row_ror:8 row_mask:0xf bank_mask:0x4
  v_mov_b32_dpp v26, v42 quad_perm:[0,1,2,3] row_mask:0xf bank_mask:0x4
  s_waitcnt vmcnt(32)
  v_add_f32_dpp v24, v44, v24 row_ror:12 row_mask:0xf bank_mask:0x8
  v_mov_b32_dpp v26, v46 row_ror:4 row_mask:0xf bank_mask:0x8
  buffer_load_dwordx4 a[232:235], v2, s[12:15], s72 offen offset:3072 nt
  v_add_f32_dpp v24, v33, v24 row_ror:12 row_mask:0xf bank_mask:0x1
  v_add_f32_dpp v26, v35, v26 row_ror:4 row_mask:0xf bank_mask:0x1
  s_nop 0
  v_add_f32_dpp v24, v37, v24 quad_perm:[0,1,2,3] row_mask:0xf bank_mask:0x2
  v_add_f32_dpp v26, v39, v26 row_ror:8 row_mask:0xf bank_mask:0x2
  s_nop 0
  v_add_f32_dpp v24, v41, v24 row_ror:4 row_mask:0xf bank_mask:0x4
  v_add_f32_dpp v26, v43, v26 row_ror:12 row_mask:0xf bank_mask:0x4
  s_nop 0
  v_add_f32_dpp v24, v45, v24 row_ror:8 row_mask:0xf bank_mask:0x8
  v_add_f32_dpp v26, v47, v26 quad_perm:[0,1,2,3] row_mask:0xf bank_mask:0x8
  v_add_f32 v24, v24, v26
  s_waitcnt lgkmcnt(0)
  v_and_b32 v28, s64, v54
  v_alignbit_b32 v29, v54, v54, 4
  v_and_b32 v29, s64, v29
  v_perm_b32 v48, v28, v52, s65
  v_perm_b32 v49, v28, v52, s66
  v_perm_b32 v50, v29, v53, s65
  v_perm_b32 v51, v29, v53, s66
  v_and_b32 v28, s64, v55
  v_alignbit_b32 v29, v55, v55, 4
  v_mfma_f32_16x16x32_bf16 v[32:35], v[48:51], v[8:11], 0
  v_and_b32 v29, s64, v29
  v_perm_b32 v52, v28, v56, s65
  v_perm_b32 v53, v28, v56, s66
  v_perm_b32 v54, v29, v57, s65
  v_perm_b32 v55, v29, v57, s66
  v_and_b32 v28, s64, v60
  v_alignbit_b32 v29, v60, v60, 4
  v_mfma_f32_16x16x32_bf16 v[36:39], v[52:55], v[8:11], 0
  v_and_b32 v29, s64, v29
  v_perm_b32 v56, v28, v58, s65
  v_perm_b32 v57, v28, v58, s66
  v_perm_b32 v58, v29, v59, s65
  v_perm_b32 v59, v29, v59, s66
  v_and_b32 v28, s64, v61
  v_alignbit_b32 v29, v61, v61, 4
  v_mfma_f32_16x16x32_bf16 v[40:43], v[56:59], v[8:11], 0
  v_and_b32 v29, s64, v29
  v_perm_b32 v60, v28, v62, s65
  v_perm_b32 v61, v28, v62, s66
  v_perm_b32 v62, v29, v63, s65
  v_perm_b32 v63, v29, v63, s66
  v_add_f32_dpp v25, v32, v25 quad_perm:[0,1,2,3] row_mask:0xf bank_mask:0x1
  v_and_b32 v28, s64, v66
  v_mfma_f32_16x16x32_bf16 v[44:47], v[60:63], v[8:11], 0
  v_mov_b32_dpp v27, v34 row_ror:8 row_mask:0xf bank_mask:0x1
  v_alignbit_b32 v29, v66, v66, 4
  v_add_f32_dpp v25, v36, v25 row_ror:4 row_mask:0xf bank_mask:0x2
  v_and_b32 v29, s64, v29
  v_mov_b32_dpp v27, v38 row_ror:12 row_mask:0xf bank_mask:0x2
  v_perm_b32 v48, v28, v64, s65
  v_add_f32_dpp v25, v40, v25 row_ror:8 row_mask:0xf bank_mask:0x4
  v_perm_b32 v49, v28, v64, s66
  v_mov_b32_dpp v27, v42 quad_perm:[0,1,2,3] row_mask:0xf bank_mask:0x4
  v_perm_b32 v52, v29, v65, s65
  v_add_f32_dpp v25, v44, v25 row_ror:12 row_mask:0xf bank_mask:0x8
  v_perm_b32 v53, v29, v65, s66
  v_mov_b32_dpp v27, v46 row_ror:4 row_mask:0xf bank_mask:0x8
  v_and_b32 v28, s64, v67
  v_add_f32_dpp v25, v33, v25 row_ror:12 row_mask:0xf bank_mask:0x1
  v_alignbit_b32 v29, v67, v67, 4
  v_add_f32_dpp v27, v35, v27 row_ror:4 row_mask:0xf bank_mask:0x1
  v_and_b32 v29, s64, v29
  v_add_f32_dpp v25, v37, v25 quad_perm:[0,1,2,3] row_mask:0xf bank_mask:0x2
  v_perm_b32 v50, v28, v68, s65
  v_add_f32_dpp v27, v39, v27 row_ror:8 row_mask:0xf bank_mask:0x2
  v_perm_b32 v51, v28, v68, s66
  v_add_f32_dpp v25, v41, v25 row_ror:4 row_mask:0xf bank_mask:0x4
  v_perm_b32 v54, v29, v69, s65
  v_add_f32_dpp v27, v43, v27 row_ror:12 row_mask:0xf bank_mask:0x4
  v_perm_b32 v55, v29, v69, s66
  v_add_f32_dpp v25, v45, v25 row_ror:8 row_mask:0xf bank_mask:0x8
  v_and_b32 v28, s64, v72
  v_add_f32_dpp v27, v47, v27 quad_perm:[0,1,2,3] row_mask:0xf bank_mask:0x8
  v_alignbit_b32 v29, v72, v72, 4
  v_and_b32 v29, s64, v29
  v_add_f32 v25, v25, v27
  v_cvt_pk_bf16_f32 v32, v24, v25
  v_perm_b32 v56, v28, v70, s65
  v_lshlrev_b32 v24, 16, v32
  v_and_b32 v25, 0xffff0000, v32
  v_perm_b32 v57, v28, v70, s66
  v_pk_mul_f32 v[24:25], v[24:25], s[56:57] op_sel_hi:[1,0]
  v_cvt_pk_bf16_f32 v32, v24, v25
  v_lshlrev_b32 v24, 16, v32
  v_perm_b32 v60, v29, v71, s65
  v_and_b32 v25, 0xffff0000, v32
  ds_write_b64 v3, v[24:25] offset:2048
  v_pk_add_f32 v[26:27], v[24:25], v[4:5] op_sel_hi:[1,0] neg_lo:[0,1] neg_hi:[0,1]
  v_pk_mul_f32 v[26:27], v[26:27], s[56:57] op_sel:[0,1] op_sel_hi:[1,1]
  v_perm_b32 v61, v29, v71, s66
  v_max_f32 v20, v26, v27
  v_and_b32 v28, s64, v73
  v_cmp_lt_f32 vcc, 0, v20
  s_getpc_b64 s[74:75]
  s_cbranch_vccnz L_remax
  v_exp_f32 v26, v26
  v_exp_f32 v27, v27
  v_alignbit_b32 v29, v73, v73, 4
  v_pk_mul_f32 v[24:25], v[26:27], s[40:41] op_sel:[0,1] op_sel_hi:[1,1]
  v_add_f32 v32, v26, v27
  v_and_b32 v29, s64, v29
  v_cvt_pk_bf16_f32 v20, v24, 0
  v_cvt_pk_bf16_f32 v21, v24, 0
  v_perm_b32 v58, v28, v74, s65
  v_cvt_pk_bf16_f32 v23, v25, 0
  v_cvt_pk_bf16_f32 v22, v25, 0
  v_cvt_pk_bf16_f32 v24, 0, v24
  v_perm_b32 v59, v28, v74, s66
  v_cvt_pk_bf16_f32 v25, 0, v25
  v_add_f32 v5, v5, v32
  v_perm_b32 v62, v29, v75, s65
  v_mov_b32_dpp v20, v24 row_ror:4 row_mask:0xf bank_mask:0xa
  v_mov_b32_dpp v21, v24 row_ror:4 row_mask:0xf bank_mask:0x5
  v_perm_b32 v63, v29, v75, s66
  v_mov_b32_dpp v23, v25 row_ror:4 row_mask:0xf bank_mask:0xa
  v_mov_b32_dpp v22, v25 row_ror:4 row_mask:0xf bank_mask:0x5
  s_waitcnt vmcnt(32)
  s_xor_b32 s72, s49, 262144
  buffer_load_dwordx4 v[156:159], v1, s[8:11], s72 offen nt
  v_and_b32_dpp v32, v20, v6 quad_perm:[0,1,2,3] row_mask:0xf bank_mask:0xf
  v_and_b32_dpp v33, v20, v7 row_ror:8 row_mask:0xf bank_mask:0xf
  v_and_b32_dpp v34, v21, v6 row_ror:12 row_mask:0xf bank_mask:0xf
  v_and_b32_dpp v35, v21, v7 row_ror:4 row_mask:0xf bank_mask:0xf
  v_and_b32_dpp v36, v20, v6 row_ror:8 row_mask:0xf bank_mask:0xf
  v_and_b32_dpp v37, v20, v7 quad_perm:[0,1,2,3] row_mask:0xf bank_mask:0xf
  v_mfma_f32_16x16x32_bf16 v[12:15], v[32:35], v[48:51], v[12:15]
  v_and_b32_dpp v38, v21, v6 row_ror:4 row_mask:0xf bank_mask:0xf
  v_and_b32_dpp v39, v21, v7 row_ror:12 row_mask:0xf bank_mask:0xf
  v_mfma_f32_16x16x32_bf16 v[16:19], v[32:35], v[52:55], v[16:19]
  v_and_b32_dpp v40, v23, v6 quad_perm:[0,1,2,3] row_mask:0xf bank_mask:0xf
  v_and_b32_dpp v41, v23, v7 row_ror:8 row_mask:0xf bank_mask:0xf
  v_mfma_f32_16x16x32_bf16 v[12:15], v[36:39], v[56:59], v[12:15]
  v_and_b32_dpp v42, v22, v6 row_ror:12 row_mask:0xf bank_mask:0xf
  v_and_b32_dpp v43, v22, v7 row_ror:4 row_mask:0xf bank_mask:0xf
  v_mfma_f32_16x16x32_bf16 v[16:19], v[36:39], v[60:63], v[16:19]
  v_and_b32_dpp v44, v23, v6 row_ror:8 row_mask:0xf bank_mask:0xf
  v_and_b32_dpp v45, v23, v7 quad_perm:[0,1,2,3] row_mask:0xf bank_mask:0xf
  v_and_b32_dpp v46, v22, v6 row_ror:4 row_mask:0xf bank_mask:0xf
  v_and_b32_dpp v47, v22, v7 row_ror:12 row_mask:0xf bank_mask:0xf
  v_and_b32 v28, s64, v94
  v_alignbit_b32 v29, v94, v94, 4
  v_and_b32 v29, s64, v29
  v_perm_b32 v48, v28, v92, s65
  v_perm_b32 v49, v28, v92, s66
  v_perm_b32 v52, v29, v93, s65
  v_perm_b32 v53, v29, v93, s66
  v_and_b32 v28, s64, v95
  v_alignbit_b32 v29, v95, v95, 4
  v_and_b32 v29, s64, v29
  v_perm_b32 v50, v28, v96, s65
  v_perm_b32 v51, v28, v96, s66
  v_perm_b32 v54, v29, v97, s65
  v_perm_b32 v55, v29, v97, s66
  v_mfma_f32_16x16x32_bf16 v[12:15], v[40:43], v[48:51], v[12:15]
  v_and_b32 v28, s64, v100
  v_alignbit_b32 v29, v100, v100, 4
  v_mfma_f32_16x16x32_bf16 v[16:19], v[40:43], v[52:55], v[16:19]
  v_and_b32 v29, s64, v29
  v_perm_b32 v56, v28, v98, s65
  v_perm_b32 v57, v28, v98, s66
  v_perm_b32 v60, v29, v99, s65
  v_perm_b32 v61, v29, v99, s66
  v_and_b32 v28, s64, v101
  v_alignbit_b32 v29, v101, v101, 4
  v_and_b32 v29, s64, v29
  v_perm_b32 v58, v28, v102, s65
  v_perm_b32 v59, v28, v102, s66
  v_perm_b32 v62, v29, v103, s65
  v_perm_b32 v63, v29, v103, s66
  v_mfma_f32_16x16x32_bf16 v[12:15], v[44:47], v[56:59], v[12:15]
  s_waitcnt vmcnt(32)
  buffer_load_dwordx4 v[160:163], v1, s[8:11], s72 offen offset:1024 nt
  v_mfma_f32_16x16x32_bf16 v[16:19], v[44:47], v[60:63], v[16:19]
  v_and_b32 v20, 0x7fff7fff, v8
  v_and_b32 v21, 0x7fff7fff, v9
  v_and_b32 v22, 0x7fff7fff, v10
  v_and_b32 v23, 0x7fff7fff, v11
  v_pk_min_u16 v20, v20, 1 op_sel_hi:[1,0]
  v_pk_min_u16 v21, v21, 1 op_sel_hi:[1,0]
  v_pk_min_u16 v22, v22, 1 op_sel_hi:[1,0]
  v_pk_min_u16 v23, v23, 1 op_sel_hi:[1,0]
  v_pk_mul_lo_u16 v20, v20, s42
  v_pk_mul_lo_u16 v21, v21, s42
  v_pk_mul_lo_u16 v22, v22, s42
  v_pk_mul_lo_u16 v23, v23, s42
  v_pk_sub_u16 v8, v8, v20
  v_pk_sub_u16 v9, v9, v21
  v_pk_sub_u16 v10, v10, v22
  v_pk_sub_u16 v11, v11, v23
  v_bfe_u32 v21, v31, 6, 3
  v_and_b32 v20, 15, v31
  v_mfma_f32_16x16x32_bf16 v[32:35], v[228:231], v[8:11], 0
  v_lshlrev_b32 v21, 10, v21
  v_lshl_add_u32 v21, v20, 6, v21
  v_mfma_f32_16x16x32_bf16 v[36:39], v[232:235], v[8:11], 0
  v_bfe_u32 v20, v31, 4, 2
  v_lshl_add_u32 v21, v20, 2, v21
  v_mfma_f32_16x16x32_bf16 v[40:43], v[236:239], v[8:11], 0
  v_add_u32 v21, s61, v21
  ds_read_b32 v24, v21
  ds_read_b32 v25, v21 offset:16
  ds_read_b32 v26, v21 offset:32
  ds_read_b32 v27, v21 offset:48
  v_mfma_f32_16x16x32_bf16 v[44:47], v[240:243], v[8:11], 0
  s_lshl_b32 s51, s3, 11
  v_add_u32 v20, s51, v2
  v_mfma_f32_16x16x32_bf16 v[48:51], v[244:247], v[8:11], 0
  s_waitcnt vmcnt(32)
  buffer_load_dwordx4 v[164:167], v1, s[8:11], s72 offen offset:2048 nt
  v_mfma_f32_16x16x32_bf16 v[52:55], v[76:79], v[8:11], 0
  s_waitcnt vmcnt(32)
  v_mfma_f32_16x16x32_bf16 v[56:59], v[80:83], v[8:11], 0
  v_mfma_f32_16x16x32_bf16 v[60:63], v[84:87], v[8:11], 0
  s_waitcnt lgkmcnt(0)
  ds_write_b128 v20, v[24:27]
  v_mov_b32_dpp v24, v32 quad_perm:[0,1,2,3] row_mask:0xf bank_mask:0x1
  v_mov_b32_dpp v25, v48 quad_perm:[0,1,2,3] row_mask:0xf bank_mask:0x1
  v_mov_b32_dpp v26, v34 row_ror:8 row_mask:0xf bank_mask:0x1
  v_mov_b32_dpp v27, v50 row_ror:8 row_mask:0xf bank_mask:0x1
  v_mov_b32_dpp v24, v36 row_ror:4 row_mask:0xf bank_mask:0x2
  v_mov_b32_dpp v25, v52 row_ror:4 row_mask:0xf bank_mask:0x2
  v_mov_b32_dpp v26, v38 row_ror:12 row_mask:0xf bank_mask:0x2
  v_mov_b32_dpp v27, v54 row_ror:12 row_mask:0xf bank_mask:0x2
  v_mov_b32_dpp v24, v40 row_ror:8 row_mask:0xf bank_mask:0x4
  v_mov_b32_dpp v25, v56 row_ror:8 row_mask:0xf bank_mask:0x4
  v_mov_b32_dpp v26, v42 quad_perm:[0,1,2,3] row_mask:0xf bank_mask:0x4
  v_mov_b32_dpp v27, v58 quad_perm:[0,1,2,3] row_mask:0xf bank_mask:0x4
  v_mov_b32_dpp v24, v44 row_ror:12 row_mask:0xf bank_mask:0x8
  v_mov_b32_dpp v25, v60 row_ror:12 row_mask:0xf bank_mask:0x8
  v_mov_b32_dpp v26, v46 row_ror:4 row_mask:0xf bank_mask:0x8
  v_mov_b32_dpp v27, v62 row_ror:4 row_mask:0xf bank_mask:0x8
  v_add_f32_dpp v24, v33, v24 row_ror:12 row_mask:0xf bank_mask:0x1
  v_add_f32_dpp v25, v49, v25 row_ror:12 row_mask:0xf bank_mask:0x1
  v_add_f32_dpp v26, v35, v26 row_ror:4 row_mask:0xf bank_mask:0x1
  v_add_f32_dpp v27, v51, v27 row_ror:4 row_mask:0xf bank_mask:0x1
  v_add_f32_dpp v24, v37, v24 quad_perm:[0,1,2,3] row_mask:0xf bank_mask:0x2
  v_add_f32_dpp v25, v53, v25 quad_perm:[0,1,2,3] row_mask:0xf bank_mask:0x2
  v_add_f32_dpp v26, v39, v26 row_ror:8 row_mask:0xf bank_mask:0x2
  v_add_f32_dpp v27, v55, v27 row_ror:8 row_mask:0xf bank_mask:0x2
  v_add_f32_dpp v24, v41, v24 row_ror:4 row_mask:0xf bank_mask:0x4
  v_add_f32_dpp v25, v57, v25 row_ror:4 row_mask:0xf bank_mask:0x4
  v_add_f32_dpp v26, v43, v26 row_ror:12 row_mask:0xf bank_mask:0x4
  v_add_f32_dpp v27, v59, v27 row_ror:12 row_mask:0xf bank_mask:0x4
  v_add_f32_dpp v24, v45, v24 row_ror:8 row_mask:0xf bank_mask:0x8
  v_add_f32_dpp v25, v61, v25 row_ror:8 row_mask:0xf bank_mask:0x8
  v_add_f32_dpp v26, v47, v26 quad_perm:[0,1,2,3] row_mask:0xf bank_mask:0x8
  v_add_f32_dpp v27, v63, v27 quad_perm:[0,1,2,3] row_mask:0xf bank_mask:0x8
  v_add_f32 v24, v24, v26
  v_add_f32 v25, v25, v27
  v_cvt_pk_bf16_f32 v32, v24, v25
  v_lshlrev_b32 v24, 16, v32
  v_and_b32 v25, 0xffff0000, v32
  v_pk_mul_f32 v[24:25], v[24:25], s[56:57] op_sel_hi:[1,0]
  v_cvt_pk_bf16_f32 v32, v24, v25
  v_lshlrev_b32 v24, 16, v32
  v_and_b32 v25, 0xffff0000, v32
  v_pk_add_f32 v[26:27], v[24:25], v[4:5] op_sel_hi:[1,0] neg_lo:[0,1] neg_hi:[0,1]
  v_pk_mul_f32 v[26:27], v[26:27], s[56:57] op_sel:[0,1] op_sel_hi:[1,1]
  v_max_f32 v20, v26, v27
  v_cmp_lt_f32 vcc, 0, v20
  s_getpc_b64 s[74:75]
  s_cbranch_vccnz L_remax
  v_exp_f32 v26, v26
  v_exp_f32 v27, v27
  v_cvt_pk_bf16_f32 v20, v26, 0
  v_add_f32 v32, v26, v27
  v_cvt_pk_bf16_f32 v21, v26, 0
  v_cvt_pk_bf16_f32 v23, v27, 0
  v_cvt_pk_bf16_f32 v22, v27, 0
  v_cvt_pk_bf16_f32 v24, 0, v26
  v_cvt_pk_bf16_f32 v25, 0, v27
  v_add_f32 v5, v5, v32
  v_mov_b32_dpp v20, v24 row_ror:4 row_mask:0xf bank_mask:0xa
  v_mov_b32_dpp v21, v24 row_ror:4 row_mask:0xf bank_mask:0x5
  v_mov_b32_dpp v23, v25 row_ror:4 row_mask:0xf bank_mask:0xa
  v_mov_b32_dpp v22, v25 row_ror:4 row_mask:0xf bank_mask:0x5
  v_and_b32_dpp v32, v20, v6 quad_perm:[0,1,2,3] row_mask:0xf bank_mask:0xf
  v_and_b32_dpp v33, v20, v7 row_ror:8 row_mask:0xf bank_mask:0xf
  v_and_b32_dpp v34, v21, v6 row_ror:12 row_mask:0xf bank_mask:0xf
  v_and_b32_dpp v35, v21, v7 row_ror:4 row_mask:0xf bank_mask:0xf
  v_mfma_f32_16x16x16_bf16 v[12:15], v[32:33], v[88:89], v[12:15]
  v_and_b32_dpp v36, v20, v6 row_ror:8 row_mask:0xf bank_mask:0xf
  v_and_b32_dpp v37, v20, v7 quad_perm:[0,1,2,3] row_mask:0xf bank_mask:0xf
  v_mfma_f32_16x16x16_bf16 v[16:19], v[32:33], v[90:91], v[16:19]
  v_and_b32_dpp v38, v21, v6 row_ror:4 row_mask:0xf bank_mask:0xf
  v_and_b32_dpp v39, v21, v7 row_ror:12 row_mask:0xf bank_mask:0xf
  v_mfma_f32_16x16x16_bf16 v[12:15], v[34:35], v[104:105], v[12:15]
  v_and_b32_dpp v40, v23, v6 quad_perm:[0,1,2,3] row_mask:0xf bank_mask:0xf
  v_and_b32_dpp v41, v23, v7 row_ror:8 row_mask:0xf bank_mask:0xf
  v_mfma_f32_16x16x16_bf16 v[16:19], v[34:35], v[106:107], v[16:19]
  v_and_b32_dpp v42, v22, v6 row_ror:12 row_mask:0xf bank_mask:0xf
  v_and_b32_dpp v43, v22, v7 row_ror:4 row_mask:0xf bank_mask:0xf
  v_mfma_f32_16x16x16_bf16 v[12:15], v[36:37], v[108:109], v[12:15]
  v_and_b32_dpp v44, v23, v6 row_ror:8 row_mask:0xf bank_mask:0xf
  v_and_b32_dpp v45, v23, v7 quad_perm:[0,1,2,3] row_mask:0xf bank_mask:0xf
  v_mfma_f32_16x16x16_bf16 v[16:19], v[36:37], v[110:111], v[16:19]
  v_and_b32_dpp v46, v22, v6 row_ror:4 row_mask:0xf bank_mask:0xf
  v_and_b32_dpp v47, v22, v7 row_ror:12 row_mask:0xf bank_mask:0xf
  v_mfma_f32_16x16x16_bf16 v[12:15], v[38:39], v[112:113], v[12:15]
  buffer_load_dwordx4 v[168:171], v1, s[8:11], s72 offen offset:3072 nt
  s_waitcnt vmcnt(32)
  v_mfma_f32_16x16x16_bf16 v[16:19], v[38:39], v[114:115], v[16:19]
  s_xor_b32 s72, s49, 278528
  buffer_load_dwordx4 v[172:175], v1, s[8:11], s72 offen nt
  v_mfma_f32_16x16x16_bf16 v[12:15], v[40:41], v[116:117], v[12:15]
  s_waitcnt vmcnt(29)
  buffer_load_dwordx4 v[176:179], v1, s[8:11], s72 offen offset:1024 nt
  v_mfma_f32_16x16x16_bf16 v[16:19], v[40:41], v[118:119], v[16:19]
  s_waitcnt vmcnt(26)
  v_mfma_f32_16x16x16_bf16 v[12:15], v[42:43], v[120:121], v[12:15]
  v_mfma_f32_16x16x16_bf16 v[16:19], v[42:43], v[122:123], v[16:19]
  v_mfma_f32_16x16x16_bf16 v[12:15], v[44:45], v[124:125], v[12:15]
  v_mfma_f32_16x16x16_bf16 v[16:19], v[44:45], v[126:127], v[16:19]
  v_mfma_f32_16x16x16_bf16 v[12:15], v[46:47], v[128:129], v[12:15]
  v_mfma_f32_16x16x16_bf16 v[16:19], v[46:47], v[130:131], v[16:19]
  v_mfma_f32_16x16x32_bf16 v[32:35], v[132:135], v[8:11], 0
  s_waitcnt vmcnt(22)
  v_mfma_f32_16x16x32_bf16 v[36:39], v[136:139], v[8:11], 0
  v_mfma_f32_16x16x32_bf16 v[40:43], v[140:143], v[8:11], 0
  v_mfma_f32_16x16x32_bf16 v[44:47], v[144:147], v[8:11], 0
  v_mfma_f32_16x16x32_bf16 v[48:51], v[148:151], v[8:11], 0
  v_mfma_f32_16x16x32_bf16 v[52:55], v[152:155], v[8:11], 0
  v_mfma_f32_16x16x32_bf16 v[56:59], a[0:3], v[8:11], 0
  buffer_load_dwordx4 v[180:183], v1, s[8:11], s72 offen offset:2048 nt
  v_mov_b32_dpp v24, v32 quad_perm:[0,1,2,3] row_mask:0xf bank_mask:0x1
  v_mfma_f32_16x16x32_bf16 v[60:63], a[4:7], v[8:11], 0
  v_mov_b32_dpp v26, v34 row_ror:8 row_mask:0xf bank_mask:0x1
  v_mov_b32_dpp v24, v36 row_ror:4 row_mask:0xf bank_mask:0x2
  s_waitcnt vmcnt(19)
  v_mov_b32_dpp v25, v48 quad_perm:[0,1,2,3] row_mask:0xf bank_mask:0x1
  v_mov_b32_dpp v27, v50 row_ror:8 row_mask:0xf bank_mask:0x1
  v_mov_b32_dpp v26, v38 row_ror:12 row_mask:0xf bank_mask:0x2
  v_mov_b32_dpp v25, v52 row_ror:4 row_mask:0xf bank_mask:0x2
  v_mov_b32_dpp v27, v54 row_ror:12 row_mask:0xf bank_mask:0x2
  v_mov_b32_dpp v24, v40 row_ror:8 row_mask:0xf bank_mask:0x4
  v_mov_b32_dpp v25, v56 row_ror:8 row_mask:0xf bank_mask:0x4
  v_mov_b32_dpp v26, v42 quad_perm:[0,1,2,3] row_mask:0xf bank_mask:0x4
  v_mov_b32_dpp v27, v58 quad_perm:[0,1,2,3] row_mask:0xf bank_mask:0x4
  v_mov_b32_dpp v24, v44 row_ror:12 row_mask:0xf bank_mask:0x8
  v_mov_b32_dpp v25, v60 row_ror:12 row_mask:0xf bank_mask:0x8
  v_mov_b32_dpp v26, v46 row_ror:4 row_mask:0xf bank_mask:0x8
  v_mov_b32_dpp v27, v62 row_ror:4 row_mask:0xf bank_mask:0x8
  v_add_f32_dpp v24, v33, v24 row_ror:12 row_mask:0xf bank_mask:0x1
  v_add_f32_dpp v25, v49, v25 row_ror:12 row_mask:0xf bank_mask:0x1
  v_add_f32_dpp v26, v35, v26 row_ror:4 row_mask:0xf bank_mask:0x1
  v_add_f32_dpp v27, v51, v27 row_ror:4 row_mask:0xf bank_mask:0x1
  v_add_f32_dpp v24, v37, v24 quad_perm:[0,1,2,3] row_mask:0xf bank_mask:0x2
  v_add_f32_dpp v25, v53, v25 quad_perm:[0,1,2,3] row_mask:0xf bank_mask:0x2
  v_add_f32_dpp v26, v39, v26 row_ror:8 row_mask:0xf bank_mask:0x2
  v_add_f32_dpp v27, v55, v27 row_ror:8 row_mask:0xf bank_mask:0x2
  v_add_f32_dpp v24, v41, v24 row_ror:4 row_mask:0xf bank_mask:0x4
  v_add_f32_dpp v25, v57, v25 row_ror:4 row_mask:0xf bank_mask:0x4
  v_add_f32_dpp v26, v43, v26 row_ror:12 row_mask:0xf bank_mask:0x4
  v_add_f32_dpp v27, v59, v27 row_ror:12 row_mask:0xf bank_mask:0x4
  v_add_f32_dpp v24, v45, v24 row_ror:8 row_mask:0xf bank_mask:0x8
  v_add_f32_dpp v25, v61, v25 row_ror:8 row_mask:0xf bank_mask:0x8
  v_add_f32_dpp v26, v47, v26 quad_perm:[0,1,2,3] row_mask:0xf bank_mask:0x8
  v_add_f32_dpp v27, v63, v27 quad_perm:[0,1,2,3] row_mask:0xf bank_mask:0x8
  v_add_f32 v24, v24, v26
  v_add_f32 v25, v25, v27
  v_cvt_pk_bf16_f32 v32, v24, v25
  v_lshlrev_b32 v24, 16, v32
  v_and_b32 v25, 0xffff0000, v32
  v_pk_mul_f32 v[24:25], v[24:25], s[56:57] op_sel_hi:[1,0]
  v_cvt_pk_bf16_f32 v32, v24, v25
  v_lshlrev_b32 v24, 16, v32
  v_and_b32 v25, 0xffff0000, v32
  v_pk_add_f32 v[26:27], v[24:25], v[4:5] op_sel_hi:[1,0] neg_lo:[0,1] neg_hi:[0,1]
  v_pk_mul_f32 v[26:27], v[26:27], s[56:57] op_sel:[0,1] op_sel_hi:[1,1]
  v_max_f32 v20, v26, v27
  v_cmp_lt_f32 vcc, 0, v20
  s_getpc_b64 s[74:75]
  s_cbranch_vccnz L_remax
  v_exp_f32 v26, v26
  v_exp_f32 v27, v27
  v_cvt_pk_bf16_f32 v20, v26, 0
  v_add_f32 v32, v26, v27
  v_cvt_pk_bf16_f32 v21, v26, 0
  v_cvt_pk_bf16_f32 v23, v27, 0
  v_cvt_pk_bf16_f32 v22, v27, 0
  v_cvt_pk_bf16_f32 v24, 0, v26
  v_cvt_pk_bf16_f32 v25, 0, v27
  v_add_f32 v5, v5, v32
  v_mov_b32_dpp v20, v24 row_ror:4 row_mask:0xf bank_mask:0xa
  v_mov_b32_dpp v21, v24 row_ror:4 row_mask:0xf bank_mask:0x5
  v_mov_b32_dpp v23, v25 row_ror:4 row_mask:0xf bank_mask:0xa
  v_mov_b32_dpp v22, v25 row_ror:4 row_mask:0xf bank_mask:0x5
  v_and_b32_dpp v32, v20, v6 quad_perm:[0,1,2,3] row_mask:0xf bank_mask:0xf
  v_and_b32_dpp v33, v20, v7 row_ror:8 row_mask:0xf bank_mask:0xf
  v_and_b32_dpp v34, v21, v6 row_ror:12 row_mask:0xf bank_mask:0xf
  v_and_b32_dpp v35, v21, v7 row_ror:4 row_mask:0xf bank_mask:0xf
  v_mfma_f32_16x16x16_bf16 v[12:15], v[32:33], a[8:9], v[12:15]
  v_and_b32_dpp v36, v20, v6 row_ror:8 row_mask:0xf bank_mask:0xf
  v_and_b32_dpp v37, v20, v7 quad_perm:[0,1,2,3] row_mask:0xf bank_mask:0xf
  v_mfma_f32_16x16x16_bf16 v[16:19], v[32:33], a[10:11], v[16:19]
  v_and_b32_dpp v38, v21, v6 row_ror:4 row_mask:0xf bank_mask:0xf
  v_and_b32_dpp v39, v21, v7 row_ror:12 row_mask:0xf bank_mask:0xf
  v_mfma_f32_16x16x16_bf16 v[12:15], v[34:35], a[12:13], v[12:15]
  v_and_b32_dpp v40, v23, v6 quad_perm:[0,1,2,3] row_mask:0xf bank_mask:0xf
  v_and_b32_dpp v41, v23, v7 row_ror:8 row_mask:0xf bank_mask:0xf
  v_mfma_f32_16x16x16_bf16 v[16:19], v[34:35], a[14:15], v[16:19]
  v_and_b32_dpp v42, v22, v6 row_ror:12 row_mask:0xf bank_mask:0xf
  v_and_b32_dpp v43, v22, v7 row_ror:4 row_mask:0xf bank_mask:0xf
  v_mfma_f32_16x16x16_bf16 v[12:15], v[36:37], a[28:29], v[12:15]
  v_and_b32_dpp v44, v23, v6 row_ror:8 row_mask:0xf bank_mask:0xf
  v_and_b32_dpp v45, v23, v7 quad_perm:[0,1,2,3] row_mask:0xf bank_mask:0xf
  v_mfma_f32_16x16x16_bf16 v[16:19], v[36:37], a[30:31], v[16:19]
  v_and_b32_dpp v46, v22, v6 row_ror:4 row_mask:0xf bank_mask:0xf
  v_and_b32_dpp v47, v22, v7 row_ror:12 row_mask:0xf bank_mask:0xf
  v_mfma_f32_16x16x16_bf16 v[12:15], v[38:39], a[44:45], v[12:15]
  buffer_load_dwordx4 v[200:203], v1, s[8:11], s72 offen offset:3072 nt
  s_waitcnt vmcnt(16)
  v_mfma_f32_16x16x16_bf16 v[16:19], v[38:39], a[46:47], v[16:19]
  s_waitcnt vmcnt(12)
  v_mfma_f32_16x16x16_bf16 v[12:15], v[40:41], a[48:49], v[12:15]
  v_mfma_f32_16x16x16_bf16 v[16:19], v[40:41], a[50:51], v[16:19]
  v_mfma_f32_16x16x16_bf16 v[12:15], v[42:43], a[52:53], v[12:15]
  v_mfma_f32_16x16x16_bf16 v[16:19], v[42:43], a[54:55], v[16:19]
  v_mfma_f32_16x16x16_bf16 v[12:15], v[44:45], a[80:81], v[12:15]
  v_mfma_f32_16x16x16_bf16 v[16:19], v[44:45], a[82:83], v[16:19]
  v_mfma_f32_16x16x16_bf16 v[12:15], v[46:47], a[96:97], v[12:15]
  v_mfma_f32_16x16x16_bf16 v[16:19], v[46:47], a[98:99], v[16:19]
  s_xor_b32 s72, s49, 262144
  buffer_load_dwordx4 v[204:207], v2, s[12:15], s72 offen nt
  v_mfma_f32_16x16x32_bf16 v[32:35], a[100:103], v[8:11], 0
  buffer_load_dwordx4 v[208:211], v2, s[12:15], s72 offen offset:1024 nt
  v_mfma_f32_16x16x32_bf16 v[36:39], a[104:107], v[8:11], 0
  s_waitcnt vmcnt(10)
  v_mfma_f32_16x16x32_bf16 v[40:43], a[120:123], v[8:11], 0
  v_mfma_f32_16x16x32_bf16 v[44:47], a[124:127], v[8:11], 0
  v_mfma_f32_16x16x32_bf16 v[48:51], a[128:131], v[8:11], 0
  v_mfma_f32_16x16x32_bf16 v[52:55], a[132:135], v[8:11], 0
  s_nop 0
  v_mov_b32_dpp v24, v32 quad_perm:[0,1,2,3] row_mask:0xf bank_mask:0x1
  v_mfma_f32_16x16x32_bf16 v[56:59], a[148:151], v[8:11], 0
  v_mov_b32_dpp v26, v34 row_ror:8 row_mask:0xf bank_mask:0x1
  v_mov_b32_dpp v24, v36 row_ror:4 row_mask:0xf bank_mask:0x2
  v_mfma_f32_16x16x32_bf16 v[60:63], a[164:167], v[8:11], 0
  v_mov_b32_dpp v26, v38 row_ror:12 row_mask:0xf bank_mask:0x2
  v_mov_b32_dpp v25, v48 quad_perm:[0,1,2,3] row_mask:0xf bank_mask:0x1
  v_mov_b32_dpp v27, v50 row_ror:8 row_mask:0xf bank_mask:0x1
  v_mov_b32_dpp v24, v40 row_ror:8 row_mask:0xf bank_mask:0x4
  v_mov_b32_dpp v25, v52 row_ror:4 row_mask:0xf bank_mask:0x2
  v_mov_b32_dpp v27, v54 row_ror:12 row_mask:0xf bank_mask:0x2
  v_mov_b32_dpp v26, v42 quad_perm:[0,1,2,3] row_mask:0xf bank_mask:0x4
  v_mov_b32_dpp v25, v56 row_ror:8 row_mask:0xf bank_mask:0x4
  v_mov_b32_dpp v27, v58 quad_perm:[0,1,2,3] row_mask:0xf bank_mask:0x4
  v_mov_b32_dpp v24, v44 row_ror:12 row_mask:0xf bank_mask:0x8
  v_mov_b32_dpp v25, v60 row_ror:12 row_mask:0xf bank_mask:0x8
  v_mov_b32_dpp v26, v46 row_ror:4 row_mask:0xf bank_mask:0x8
  v_mov_b32_dpp v27, v62 row_ror:4 row_mask:0xf bank_mask:0x8
  v_add_f32_dpp v24, v33, v24 row_ror:12 row_mask:0xf bank_mask:0x1
  v_add_f32_dpp v25, v49, v25 row_ror:12 row_mask:0xf bank_mask:0x1
  v_add_f32_dpp v26, v35, v26 row_ror:4 row_mask:0xf bank_mask:0x1
  v_add_f32_dpp v27, v51, v27 row_ror:4 row_mask:0xf bank_mask:0x1
  v_add_f32_dpp v24, v37, v24 quad_perm:[0,1,2,3] row_mask:0xf bank_mask:0x2
  v_add_f32_dpp v25, v53, v25 quad_perm:[0,1,2,3] row_mask:0xf bank_mask:0x2
  v_add_f32_dpp v26, v39, v26 row_ror:8 row_mask:0xf bank_mask:0x2
  v_add_f32_dpp v27, v55, v27 row_ror:8 row_mask:0xf bank_mask:0x2
  v_add_f32_dpp v24, v41, v24 row_ror:4 row_mask:0xf bank_mask:0x4
  v_add_f32_dpp v25, v57, v25 row_ror:4 row_mask:0xf bank_mask:0x4
  v_add_f32_dpp v26, v43, v26 row_ror:12 row_mask:0xf bank_mask:0x4
  v_add_f32_dpp v27, v59, v27 row_ror:12 row_mask:0xf bank_mask:0x4
  v_add_f32_dpp v24, v45, v24 row_ror:8 row_mask:0xf bank_mask:0x8
  v_add_f32_dpp v25, v61, v25 row_ror:8 row_mask:0xf bank_mask:0x8
  v_add_f32_dpp v26, v47, v26 quad_perm:[0,1,2,3] row_mask:0xf bank_mask:0x8
  v_add_f32_dpp v27, v63, v27 quad_perm:[0,1,2,3] row_mask:0xf bank_mask:0x8
  v_add_f32 v24, v24, v26
  v_add_f32 v25, v25, v27
  v_cvt_pk_bf16_f32 v32, v24, v25
  v_lshlrev_b32 v24, 16, v32
  v_and_b32 v25, 0xffff0000, v32
  v_pk_mul_f32 v[24:25], v[24:25], s[56:57] op_sel_hi:[1,0]
  v_cvt_pk_bf16_f32 v32, v24, v25
  v_lshlrev_b32 v24, 16, v32
  v_and_b32 v25, 0xffff0000, v32
  v_pk_add_f32 v[26:27], v[24:25], v[4:5] op_sel_hi:[1,0] neg_lo:[0,1] neg_hi:[0,1]
  v_pk_mul_f32 v[26:27], v[26:27], s[56:57] op_sel:[0,1] op_sel_hi:[1,1]
  v_max_f32 v20, v26, v27
  v_cmp_lt_f32 vcc, 0, v20
  s_getpc_b64 s[74:75]
  s_cbranch_vccnz L_remax
  v_exp_f32 v26, v26
  v_exp_f32 v27, v27
  v_cvt_pk_bf16_f32 v20, v26, 0
  v_add_f32 v32, v26, v27
  v_cvt_pk_bf16_f32 v21, v26, 0
  v_cvt_pk_bf16_f32 v23, v27, 0
  v_cvt_pk_bf16_f32 v22, v27, 0
  v_cvt_pk_bf16_f32 v24, 0, v26
  v_cvt_pk_bf16_f32 v25, 0, v27
  v_add_f32 v5, v5, v32
  v_mov_b32_dpp v20, v24 row_ror:4 row_mask:0xf bank_mask:0xa
  v_mov_b32_dpp v21, v24 row_ror:4 row_mask:0xf bank_mask:0x5
  v_mov_b32_dpp v23, v25 row_ror:4 row_mask:0xf bank_mask:0xa
  v_mov_b32_dpp v22, v25 row_ror:4 row_mask:0xf bank_mask:0x5
  v_and_b32_dpp v32, v20, v6 quad_perm:[0,1,2,3] row_mask:0xf bank_mask:0xf
  v_and_b32_dpp v33, v20, v7 row_ror:8 row_mask:0xf bank_mask:0xf
  v_and_b32_dpp v34, v21, v6 row_ror:12 row_mask:0xf bank_mask:0xf
  v_and_b32_dpp v35, v21, v7 row_ror:4 row_mask:0xf bank_mask:0xf
  v_mfma_f32_16x16x16_bf16 v[12:15], v[32:33], a[168:169], v[12:15]
  v_and_b32_dpp v36, v20, v6 row_ror:8 row_mask:0xf bank_mask:0xf
  v_and_b32_dpp v37, v20, v7 quad_perm:[0,1,2,3] row_mask:0xf bank_mask:0xf
  v_mfma_f32_16x16x16_bf16 v[16:19], v[32:33], a[170:171], v[16:19]
  v_and_b32_dpp v38, v21, v6 row_ror:4 row_mask:0xf bank_mask:0xf
  v_and_b32_dpp v39, v21, v7 row_ror:12 row_mask:0xf bank_mask:0xf
  v_mfma_f32_16x16x16_bf16 v[12:15], v[34:35], a[172:173], v[12:15]
  v_and_b32_dpp v40, v23, v6 quad_perm:[0,1,2,3] row_mask:0xf bank_mask:0xf
  v_and_b32_dpp v41, v23, v7 row_ror:8 row_mask:0xf bank_mask:0xf
  v_mfma_f32_16x16x16_bf16 v[16:19], v[34:35], a[174:175], v[16:19]
  v_and_b32_dpp v42, v22, v6 row_ror:12 row_mask:0xf bank_mask:0xf
  v_and_b32_dpp v43, v22, v7 row_ror:4 row_mask:0xf bank_mask:0xf
  v_mfma_f32_16x16x16_bf16 v[12:15], v[36:37], a[188:189], v[12:15]
  v_and_b32_dpp v44, v23, v6 row_ror:8 row_mask:0xf bank_mask:0xf
  v_and_b32_dpp v45, v23, v7 quad_perm:[0,1,2,3] row_mask:0xf bank_mask:0xf
  v_mfma_f32_16x16x16_bf16 v[16:19], v[36:37], a[190:191], v[16:19]
  v_and_b32_dpp v46, v22, v6 row_ror:4 row_mask:0xf bank_mask:0xf
  v_and_b32_dpp v47, v22, v7 row_ror:12 row_mask:0xf bank_mask:0xf
  v_mfma_f32_16x16x16_bf16 v[12:15], v[38:39], a[192:193], v[12:15]
  buffer_load_dwordx4 v[212:215], v2, s[12:15], s72 offen offset:2048 nt
  buffer_load_dwordx4 v[248:251], v2, s[12:15], s72 offen offset:3072 nt
  v_mfma_f32_16x16x16_bf16 v[16:19], v[38:39], a[194:195], v[16:19]
  s_xor_b32 s72, s49, 278528
  buffer_load_dwordx4 v[252:255], v2, s[12:15], s72 offen nt
  v_mfma_f32_16x16x16_bf16 v[12:15], v[40:41], a[196:197], v[12:15]
  buffer_load_dwordx4 v[184:187], v2, s[12:15], s72 offen offset:1024 nt
  buffer_load_dwordx4 v[188:191], v2, s[12:15], s72 offen offset:2048 nt
  v_mfma_f32_16x16x16_bf16 v[16:19], v[40:41], a[198:199], v[16:19]
  buffer_load_dwordx4 v[192:195], v2, s[12:15], s72 offen offset:3072 nt
  s_waitcnt vmcnt(12)
  v_mfma_f32_16x16x16_bf16 v[12:15], v[42:43], a[200:201], v[12:15]
  v_mov_b64 v[48:49], v[156:157]
  v_mov_b64 v[50:51], v[158:159]
  v_mfma_f32_16x16x16_bf16 v[16:19], v[42:43], a[202:203], v[16:19]
  v_mov_b64 v[52:53], v[160:161]
  v_mov_b64 v[54:55], v[162:163]
  v_mfma_f32_16x16x16_bf16 v[12:15], v[44:45], a[216:217], v[12:15]
  v_mov_b64 v[56:57], v[164:165]
  v_mov_b64 v[58:59], v[166:167]
  v_mfma_f32_16x16x16_bf16 v[16:19], v[44:45], a[218:219], v[16:19]
  v_mov_b64 v[60:61], v[168:169]
  v_mov_b64 v[62:63], v[170:171]
  v_mfma_f32_16x16x16_bf16 v[12:15], v[46:47], a[232:233], v[12:15]
  s_mov_b32 s70, 10
  s_mov_b32 s71, s42
  v_mfma_f32_16x16x16_bf16 v[16:19], v[46:47], a[234:235], v[16:19]
  v_mfma_f32_16x16x32_bf16 v[32:35], v[156:159], v[8:11], 0
  v_mfma_f32_16x16x32_bf16 v[36:39], v[160:163], v[8:11], 0
  v_mfma_f32_16x16x32_bf16 v[40:43], v[164:167], v[8:11], 0
  v_mfma_f32_16x16x32_bf16 v[44:47], v[168:171], v[8:11], 0
  s_nop 4
  v_mov_b32_dpp v24, v32 quad_perm:[0,1,2,3] row_mask:0xf bank_mask:0x1
  v_mov_b32_dpp v26, v34 row_ror:8 row_mask:0xf bank_mask:0x1
  s_nop 0
  v_mov_b32_dpp v24, v36 row_ror:4 row_mask:0xf bank_mask:0x2
  v_mov_b32_dpp v26, v38 row_ror:12 row_mask:0xf bank_mask:0x2
  s_nop 0
  v_mov_b32_dpp v24, v40 row_ror:8 row_mask:0xf bank_mask:0x4
  v_mov_b32_dpp v26, v42 quad_perm:[0,1,2,3] row_mask:0xf bank_mask:0x4
  s_nop 0
  v_mov_b32_dpp v24, v44 row_ror:12 row_mask:0xf bank_mask:0x8
  v_mov_b32_dpp v26, v46 row_ror:4 row_mask:0xf bank_mask:0x8
  s_nop 0
  v_add_f32_dpp v24, v33, v24 row_ror:12 row_mask:0xf bank_mask:0x1
  v_add_f32_dpp v26, v35, v26 row_ror:4 row_mask:0xf bank_mask:0x1
  s_nop 0
  v_add_f32_dpp v24, v37, v24 quad_perm:[0,1,2,3] row_mask:0xf bank_mask:0x2
  v_add_f32_dpp v26, v39, v26 row_ror:8 row_mask:0xf bank_mask:0x2
  s_nop 0
  v_add_f32_dpp v24, v41, v24 row_ror:4 row_mask:0xf bank_mask:0x4
  v_add_f32_dpp v26, v43, v26 row_ror:12 row_mask:0xf bank_mask:0x4
  s_nop 0
  v_add_f32_dpp v24, v45, v24 row_ror:8 row_mask:0xf bank_mask:0x8
  v_add_f32_dpp v26, v47, v26 quad_perm:[0,1,2,3] row_mask:0xf bank_mask:0x8
  s_call_b64 s[74:75], L_enc
  s_nop 1
  v_accvgpr_write_b32 a236, v32
  v_accvgpr_write_b32 a237, v33
  v_accvgpr_write_b32 a238, v34
  v_accvgpr_write_b32 a239, v35
  v_accvgpr_write_b32 a240, v36
  v_accvgpr_write_b32 a241, v37
  v_accvgpr_write_b32 a242, v38
  v_accvgpr_write_b32 a243, v39
  v_accvgpr_write_b32 a0, v40
  v_accvgpr_write_b32 a1, v41
  v_accvgpr_write_b32 a2, v42
  v_accvgpr_write_b32 a3, v43
  s_xor_b32 s72, s49, 294912
  buffer_load_dwordx4 v[196:199], v1, s[8:11], s72 offen nt
  buffer_load_dwordx4 v[228:231], v1, s[8:11], s72 offen offset:1024 nt
  buffer_load_dwordx4 v[232:235], v1, s[8:11], s72 offen offset:2048 nt
  buffer_load_dwordx4 v[236:239], v1, s[8:11], s72 offen offset:3072 nt
  s_xor_b32 s72, s49, 311296
  buffer_load_dwordx4 v[240:243], v1, s[8:11], s72 offen nt
  s_waitcnt vmcnt(13)
  v_mfma_f32_16x16x32_bf16 v[32:35], v[172:175], v[8:11], 0
  v_mov_b64 v[48:49], v[172:173]
  v_mov_b64 v[50:51], v[174:175]
  v_mfma_f32_16x16x32_bf16 v[36:39], v[176:179], v[8:11], 0
  v_mov_b64 v[52:53], v[176:177]
  v_mov_b64 v[54:55], v[178:179]
  v_mfma_f32_16x16x32_bf16 v[40:43], v[180:183], v[8:11], 0
  v_mov_b64 v[56:57], v[180:181]
  v_mov_b64 v[58:59], v[182:183]
  v_mfma_f32_16x16x32_bf16 v[44:47], v[200:203], v[8:11], 0
  v_mov_b64 v[60:61], v[200:201]
  v_mov_b64 v[62:63], v[202:203]
  v_mov_b32_dpp v25, v32 quad_perm:[0,1,2,3] row_mask:0xf bank_mask:0x1
  v_mov_b32_dpp v27, v34 row_ror:8 row_mask:0xf bank_mask:0x1
  s_mov_b32 s70, 11
  v_mov_b32_dpp v25, v36 row_ror:4 row_mask:0xf bank_mask:0x2
  v_mov_b32_dpp v27, v38 row_ror:12 row_mask:0xf bank_mask:0x2
  s_mov_b32 s71, s42
  v_mov_b32_dpp v25, v40 row_ror:8 row_mask:0xf bank_mask:0x4
  v_mov_b32_dpp v27, v42 quad_perm:[0,1,2,3] row_mask:0xf bank_mask:0x4
  s_nop 0
  v_mov_b32_dpp v25, v44 row_ror:12 row_mask:0xf bank_mask:0x8
  v_mov_b32_dpp v27, v46 row_ror:4 row_mask:0xf bank_mask:0x8
  s_nop 0
  v_add_f32_dpp v25, v33, v25 row_ror:12 row_mask:0xf bank_mask:0x1
  v_add_f32_dpp v27, v35, v27 row_ror:4 row_mask:0xf bank_mask:0x1
  s_nop 0
  v_add_f32_dpp v25, v37, v25 quad_perm:[0,1,2,3] row_mask:0xf bank_mask:0x2
  v_add_f32_dpp v27, v39, v27 row_ror:8 row_mask:0xf bank_mask:0x2
  s_nop 0
  v_add_f32_dpp v25, v41, v25 row_ror:4 row_mask:0xf bank_mask:0x4
  v_add_f32_dpp v27, v43, v27 row_ror:12 row_mask:0xf bank_mask:0x4
  s_nop 0
  v_add_f32_dpp v25, v45, v25 row_ror:8 row_mask:0xf bank_mask:0x8
  v_add_f32_dpp v27, v47, v27 quad_perm:[0,1,2,3] row_mask:0xf bank_mask:0x8
  s_call_b64 s[74:75], L_enc
  s_nop 1
  ds_write_b128 v3, v[32:35] offset:21504
  ds_write_b128 v3, v[36:39] offset:22528
  ds_write_b128 v3, v[40:43] offset:23552
  buffer_load_dwordx4 v[244:247], v1, s[8:11], s72 offen offset:1024 nt
  buffer_load_dwordx4 v[76:79], v1, s[8:11], s72 offen offset:2048 nt
  buffer_load_dwordx4 v[80:83], v1, s[8:11], s72 offen offset:3072 nt
  s_xor_b32 s72, s49, 294912
  buffer_load_dwordx4 v[84:87], v2, s[12:15], s72 offen nt
  s_waitcnt vmcnt(13)
  v_add_f32 v24, v24, v26
  v_add_f32 v25, v25, v27
  v_cvt_pk_bf16_f32 v32, v24, v25
  v_lshlrev_b32 v24, 16, v32
  v_and_b32 v25, 0xffff0000, v32
  v_pk_mul_f32 v[24:25], v[24:25], s[56:57] op_sel_hi:[1,0]
  v_cvt_pk_bf16_f32 v32, v24, v25
  v_lshlrev_b32 v24, 16, v32
  v_and_b32 v25, 0xffff0000, v32
  v_pk_add_f32 v[26:27], v[24:25], v[4:5] op_sel_hi:[1,0] neg_lo:[0,1] neg_hi:[0,1]
  v_pk_mul_f32 v[26:27], v[26:27], s[56:57] op_sel:[0,1] op_sel_hi:[1,1]
  v_max_f32 v20, v26, v27
  v_cmp_lt_f32 vcc, 0, v20
  s_getpc_b64 s[74:75]
  s_cbranch_vccnz L_remax
  v_exp_f32 v26, v26
  v_exp_f32 v27, v27
  v_cvt_pk_bf16_f32 v20, v26, 0
  v_add_f32 v32, v26, v27
  v_cvt_pk_bf16_f32 v21, v26, 0
  v_cvt_pk_bf16_f32 v23, v27, 0
  v_cvt_pk_bf16_f32 v22, v27, 0
  v_cvt_pk_bf16_f32 v24, 0, v26
  v_cvt_pk_bf16_f32 v25, 0, v27
  v_add_f32 v5, v5, v32
  v_mov_b32_dpp v20, v24 row_ror:4 row_mask:0xf bank_mask:0xa
  v_mov_b32_dpp v21, v24 row_ror:4 row_mask:0xf bank_mask:0x5
  v_mov_b32_dpp v23, v25 row_ror:4 row_mask:0xf bank_mask:0xa
  v_mov_b32_dpp v22, v25 row_ror:4 row_mask:0xf bank_mask:0x5
  v_and_b32_dpp v32, v20, v6 quad_perm:[0,1,2,3] row_mask:0xf bank_mask:0xf
  v_and_b32_dpp v33, v20, v7 row_ror:8 row_mask:0xf bank_mask:0xf
  v_and_b32_dpp v34, v21, v6 row_ror:12 row_mask:0xf bank_mask:0xf
  v_and_b32_dpp v35, v21, v7 row_ror:4 row_mask:0xf bank_mask:0xf
  v_mfma_f32_16x16x16_bf16 v[12:15], v[32:33], v[204:205], v[12:15]
  v_and_b32_dpp v36, v20, v6 row_ror:8 row_mask:0xf bank_mask:0xf
  v_and_b32_dpp v37, v20, v7 quad_perm:[0,1,2,3] row_mask:0xf bank_mask:0xf
  v_mfma_f32_16x16x16_bf16 v[16:19], v[32:33], v[206:207], v[16:19]
  v_and_b32_dpp v38, v21, v6 row_ror:4 row_mask:0xf bank_mask:0xf
  v_and_b32_dpp v39, v21, v7 row_ror:12 row_mask:0xf bank_mask:0xf
  v_mfma_f32_16x16x16_bf16 v[12:15], v[34:35], v[208:209], v[12:15]
  v_mov_b64 v[48:49], v[204:205]
  v_mov_b64 v[50:51], v[206:207]
  v_mfma_f32_16x16x16_bf16 v[16:19], v[34:35], v[210:211], v[16:19]
  v_mov_b64 v[52:53], v[208:209]
  v_mov_b64 v[54:55], v[210:211]
  v_mfma_f32_16x16x16_bf16 v[12:15], v[36:37], v[212:213], v[12:15]
  v_mov_b64 v[56:57], v[212:213]
  v_mov_b64 v[58:59], v[214:215]
  v_mfma_f32_16x16x16_bf16 v[16:19], v[36:37], v[214:215], v[16:19]
  v_mov_b64 v[60:61], v[248:249]
  v_mov_b64 v[62:63], v[250:251]
  v_mfma_f32_16x16x16_bf16 v[12:15], v[38:39], v[248:249], v[12:15]
  s_mov_b32 s70, 266
  s_mov_b32 s71, s43
  v_mfma_f32_16x16x16_bf16 v[16:19], v[38:39], v[250:251], v[16:19]
  s_call_b64 s[74:75], L_enc
  s_nop 1
  v_accvgpr_write_b32 a4, v32
  v_accvgpr_write_b32 a5, v33
  v_accvgpr_write_b32 a6, v34
  v_accvgpr_write_b32 a7, v35
  v_accvgpr_write_b32 a8, v36
  v_accvgpr_write_b32 a9, v37
  v_accvgpr_write_b32 a10, v38
  v_accvgpr_write_b32 a11, v39
  v_mov_b64 v[88:89], v[40:41]
  v_mov_b64 v[90:91], v[42:43]
  buffer_load_dwordx4 v[104:107], v2, s[12:15], s72 offen offset:1024 nt
  buffer_load_dwordx4 v[108:111], v2, s[12:15], s72 offen offset:2048 nt
  buffer_load_dwordx4 v[112:115], v2, s[12:15], s72 offen offset:3072 nt
  s_xor_b32 s72, s49, 311296
  buffer_load_dwordx4 v[116:119], v2, s[12:15], s72 offen nt
  s_waitcnt vmcnt(13)
  v_and_b32_dpp v40, v23, v6 quad_perm:[0,1,2,3] row_mask:0xf bank_mask:0xf
  v_and_b32_dpp v41, v23, v7 row_ror:8 row_mask:0xf bank_mask:0xf
  v_and_b32_dpp v42, v22, v6 row_ror:12 row_mask:0xf bank_mask:0xf
  v_and_b32_dpp v43, v22, v7 row_ror:4 row_mask:0xf bank_mask:0xf
  v_mfma_f32_16x16x16_bf16 v[12:15], v[40:41], v[252:253], v[12:15]
  v_and_b32_dpp v44, v23, v6 row_ror:8 row_mask:0xf bank_mask:0xf
  v_and_b32_dpp v45, v23, v7 quad_perm:[0,1,2,3] row_mask:0xf bank_mask:0xf
  v_mfma_f32_16x16x16_bf16 v[16:19], v[40:41], v[254:255], v[16:19]
  v_and_b32_dpp v46, v22, v6 row_ror:4 row_mask:0xf bank_mask:0xf
  v_and_b32_dpp v47, v22, v7 row_ror:12 row_mask:0xf bank_mask:0xf
  v_mfma_f32_16x16x16_bf16 v[12:15], v[42:43], v[184:185], v[12:15]
  v_mov_b64 v[48:49], v[252:253]
  v_mov_b64 v[50:51], v[254:255]
  v_mfma_f32_16x16x16_bf16 v[16:19], v[42:43], v[186:187], v[16:19]
  v_mov_b64 v[52:53], v[184:185]
  v_mov_b64 v[54:55], v[186:187]
  v_mfma_f32_16x16x16_bf16 v[12:15], v[44:45], v[188:189], v[12:15]
  v_mov_b64 v[56:57], v[188:189]
  v_mov_b64 v[58:59], v[190:191]
  v_mfma_f32_16x16x16_bf16 v[16:19], v[44:45], v[190:191], v[16:19]
  v_mov_b64 v[60:61], v[192:193]
  v_mov_b64 v[62:63], v[194:195]
  v_mfma_f32_16x16x16_bf16 v[12:15], v[46:47], v[192:193], v[12:15]
  s_mov_b32 s70, 267
  s_mov_b32 s71, s43
  v_mfma_f32_16x16x16_bf16 v[16:19], v[46:47], v[194:195], v[16:19]
  s_call_b64 s[74:75], L_enc
  s_nop 1
  v_mov_b64 v[120:121], v[32:33]
  v_mov_b64 v[122:123], v[34:35]
  v_mov_b64 v[124:125], v[36:37]
  v_mov_b64 v[126:127], v[38:39]
  v_mov_b64 v[128:129], v[40:41]
  v_mov_b64 v[130:131], v[42:43]
  buffer_load_dwordx4 v[132:135], v2, s[12:15], s72 offen offset:1024 nt
  buffer_load_dwordx4 v[136:139], v2, s[12:15], s72 offen offset:2048 nt
  buffer_load_dwordx4 v[140:143], v2, s[12:15], s72 offen offset:3072 nt
  s_xor_b32 s72, s49, 327680
  buffer_load_dwordx4 v[144:147], v1, s[8:11], s72 offen nt
  s_waitcnt vmcnt(13)
  v_mfma_f32_16x16x32_bf16 v[32:35], v[196:199], v[8:11], 0
  v_mov_b64 v[48:49], v[196:197]
  v_mov_b64 v[50:51], v[198:199]
  v_mfma_f32_16x16x32_bf16 v[36:39], v[228:231], v[8:11], 0
  v_mov_b64 v[52:53], v[228:229]
  v_mov_b64 v[54:55], v[230:231]
  v_mfma_f32_16x16x32_bf16 v[40:43], v[232:235], v[8:11], 0
  v_mov_b64 v[56:57], v[232:233]
  v_mov_b64 v[58:59], v[234:235]
  v_mfma_f32_16x16x32_bf16 v[44:47], v[236:239], v[8:11], 0
  v_mov_b64 v[60:61], v[236:237]
  v_mov_b64 v[62:63], v[238:239]
  v_mov_b32_dpp v24, v32 quad_perm:[0,1,2,3] row_mask:0xf bank_mask:0x1
  v_mov_b32_dpp v26, v34 row_ror:8 row_mask:0xf bank_mask:0x1
  s_mov_b32 s70, 12
  v_mov_b32_dpp v24, v36 row_ror:4 row_mask:0xf bank_mask:0x2
  v_mov_b32_dpp v26, v38 row_ror:12 row_mask:0xf bank_mask:0x2
  s_mov_b32 s71, s42
  v_mov_b32_dpp v24, v40 row_ror:8 row_mask:0xf bank_mask:0x4
  v_mov_b32_dpp v26, v42 quad_perm:[0,1,2,3] row_mask:0xf bank_mask:0x4
  s_nop 0
  v_mov_b32_dpp v24, v44 row_ror:12 row_mask:0xf bank_mask:0x8
  v_mov_b32_dpp v26, v46 row_ror:4 row_mask:0xf bank_mask:0x8
  s_nop 0
  v_add_f32_dpp v24, v33, v24 row_ror:12 row_mask:0xf bank_mask:0x1
  v_add_f32_dpp v26, v35, v26 row_ror:4 row_mask:0xf bank_mask:0x1
  s_nop 0
  v_add_f32_dpp v24, v37, v24 quad_perm:[0,1,2,3] row_mask:0xf bank_mask:0x2
  v_add_f32_dpp v26, v39, v26 row_ror:8 row_mask:0xf bank_mask:0x2
  s_nop 0
  v_add_f32_dpp v24, v41, v24 row_ror:4 row_mask:0xf bank_mask:0x4
  v_add_f32_dpp v26, v43, v26 row_ror:12 row_mask:0xf bank_mask:0x4
  s_nop 0
  v_add_f32_dpp v24, v45, v24 row_ror:8 row_mask:0xf bank_mask:0x8
  v_add_f32_dpp v26, v47, v26 quad_perm:[0,1,2,3] row_mask:0xf bank_mask:0x8
  s_call_b64 s[74:75], L_enc
  s_nop 1
  v_mov_b64 v[148:149], v[32:33]
  v_mov_b64 v[150:151], v[34:35]
  v_mov_b64 v[152:153], v[36:37]
  v_mov_b64 v[154:155], v[38:39]
  v_mov_b64 v[156:157], v[40:41]
  v_mov_b64 v[158:159], v[42:43]
  buffer_load_dwordx4 v[160:163], v1, s[8:11], s72 offen offset:1024 nt
  buffer_load_dwordx4 v[164:167], v1, s[8:11], s72 offen offset:2048 nt
  buffer_load_dwordx4 v[168:171], v1, s[8:11], s72 offen offset:3072 nt
  s_xor_b32 s72, s49, 344064
  buffer_load_dwordx4 v[172:175], v1, s[8:11], s72 offen nt
  s_waitcnt vmcnt(13)
  v_mfma_f32_16x16x32_bf16 v[32:35], v[240:243], v[8:11], 0
  v_mov_b64 v[48:49], v[240:241]
  v_mov_b64 v[50:51], v[242:243]
  v_mfma_f32_16x16x32_bf16 v[36:39], v[244:247], v[8:11], 0
  v_mov_b64 v[52:53], v[244:245]
  v_mov_b64 v[54:55], v[246:247]
  v_mfma_f32_16x16x32_bf16 v[40:43], v[76:79], v[8:11], 0
  v_mov_b64 v[56:57], v[76:77]
  v_mov_b64 v[58:59], v[78:79]
  v_mfma_f32_16x16x32_bf16 v[44:47], v[80:83], v[8:11], 0
  v_mov_b64 v[60:61], v[80:81]
  v_mov_b64 v[62:63], v[82:83]
  v_mov_b32_dpp v25, v32 quad_perm:[0,1,2,3] row_mask:0xf bank_mask:0x1
  v_mov_b32_dpp v27, v34 row_ror:8 row_mask:0xf bank_mask:0x1
  s_mov_b32 s70, 13
  v_mov_b32_dpp v25, v36 row_ror:4 row_mask:0xf bank_mask:0x2
  v_mov_b32_dpp v27, v38 row_ror:12 row_mask:0xf bank_mask:0x2
  s_mov_b32 s71, s42
  v_mov_b32_dpp v25, v40 row_ror:8 row_mask:0xf bank_mask:0x4
  v_mov_b32_dpp v27, v42 quad_perm:[0,1,2,3] row_mask:0xf bank_mask:0x4
  s_nop 0
  v_mov_b32_dpp v25, v44 row_ror:12 row_mask:0xf bank_mask:0x8
  v_mov_b32_dpp v27, v46 row_ror:4 row_mask:0xf bank_mask:0x8
  s_nop 0
  v_add_f32_dpp v25, v33, v25 row_ror:12 row_mask:0xf bank_mask:0x1
  v_add_f32_dpp v27, v35, v27 row_ror:4 row_mask:0xf bank_mask:0x1
  s_nop 0
  v_add_f32_dpp v25, v37, v25 quad_perm:[0,1,2,3] row_mask:0xf bank_mask:0x2
  v_add_f32_dpp v27, v39, v27 row_ror:8 row_mask:0xf bank_mask:0x2
  s_nop 0
  v_add_f32_dpp v25, v41, v25 row_ror:4 row_mask:0xf bank_mask:0x4
  v_add_f32_dpp v27, v43, v27 row_ror:12 row_mask:0xf bank_mask:0x4
  s_nop 0
  v_add_f32_dpp v25, v45, v25 row_ror:8 row_mask:0xf bank_mask:0x8
  v_add_f32_dpp v27, v47, v27 quad_perm:[0,1,2,3] row_mask:0xf bank_mask:0x8
  s_call_b64 s[74:75], L_enc
  s_nop 1
  ds_write_b128 v3, v[32:35] offset:24576
  ds_write_b128 v3, v[36:39] offset:25600
  ds_write_b128 v3, v[40:43] offset:26624
  buffer_load_dwordx4 v[176:179], v1, s[8:11], s72 offen offset:1024 nt
  buffer_load_dwordx4 v[180:183], v1, s[8:11], s72 offen offset:2048 nt
  buffer_load_dwordx4 v[200:203], v1, s[8:11], s72 offen offset:3072 nt
  s_xor_b32 s72, s49, 327680
  buffer_load_dwordx4 v[204:207], v2, s[12:15], s72 offen nt
  s_waitcnt vmcnt(13)
  v_add_f32 v24, v24, v26
  v_add_f32 v25, v25, v27
  v_cvt_pk_bf16_f32 v32, v24, v25
  v_lshlrev_b32 v24, 16, v32
  v_and_b32 v25, 0xffff0000, v32
  v_pk_mul_f32 v[24:25], v[24:25], s[56:57] op_sel_hi:[1,0]
  v_cvt_pk_bf16_f32 v32, v24, v25
  v_lshlrev_b32 v24, 16, v32
  v_and_b32 v25, 0xffff0000, v32
  v_pk_add_f32 v[26:27], v[24:25], v[4:5] op_sel_hi:[1,0] neg_lo:[0,1] neg_hi:[0,1]
  v_pk_mul_f32 v[26:27], v[26:27], s[56:57] op_sel:[0,1] op_sel_hi:[1,1]
  v_max_f32 v20, v26, v27
  v_cmp_lt_f32 vcc, 0, v20
  s_getpc_b64 s[74:75]
  s_cbranch_vccnz L_remax
  v_exp_f32 v26, v26
  v_exp_f32 v27, v27
  v_cvt_pk_bf16_f32 v20, v26, 0
  v_add_f32 v32, v26, v27
  v_cvt_pk_bf16_f32 v21, v26, 0
  v_cvt_pk_bf16_f32 v23, v27, 0
  v_cvt_pk_bf16_f32 v22, v27, 0
  v_cvt_pk_bf16_f32 v24, 0, v26
  v_cvt_pk_bf16_f32 v25, 0, v27
  v_add_f32 v5, v5, v32
  v_mov_b32_dpp v20, v24 row_ror:4 row_mask:0xf bank_mask:0xa
  v_mov_b32_dpp v21, v24 row_ror:4 row_mask:0xf bank_mask:0x5
  v_mov_b32_dpp v23, v25 row_ror:4 row_mask:0xf bank_mask:0xa
  v_mov_b32_dpp v22, v25 row_ror:4 row_mask:0xf bank_mask:0x5
  v_and_b32_dpp v32, v20, v6 quad_perm:[0,1,2,3] row_mask:0xf bank_mask:0xf
  v_and_b32_dpp v33, v20, v7 row_ror:8 row_mask:0xf bank_mask:0xf
  v_and_b32_dpp v34, v21, v6 row_ror:12 row_mask:0xf bank_mask:0xf
  v_and_b32_dpp v35, v21, v7 row_ror:4 row_mask:0xf bank_mask:0xf
  v_mfma_f32_16x16x16_bf16 v[12:15], v[32:33], v[84:85], v[12:15]
  v_and_b32_dpp v36, v20, v6 row_ror:8 row_mask:0xf bank_mask:0xf
  v_and_b32_dpp v37, v20, v7 quad_perm:[0,1,2,3] row_mask:0xf bank_mask:0xf
  v_mfma_f32_16x16x16_bf16 v[16:19], v[32:33], v[86:87], v[16:19]
  v_and_b32_dpp v38, v21, v6 row_ror:4 row_mask:0xf bank_mask:0xf
  v_and_b32_dpp v39, v21, v7 row_ror:12 row_mask:0xf bank_mask:0xf
  v_mfma_f32_16x16x16_bf16 v[12:15], v[34:35], v[104:105], v[12:15]
  v_mov_b64 v[48:49], v[84:85]
  v_mov_b64 v[50:51], v[86:87]
  v_mfma_f32_16x16x16_bf16 v[16:19], v[34:35], v[106:107], v[16:19]
  v_mov_b64 v[52:53], v[104:105]
  v_mov_b64 v[54:55], v[106:107]
  v_mfma_f32_16x16x16_bf16 v[12:15], v[36:37], v[108:109], v[12:15]
  v_mov_b64 v[56:57], v[108:109]
  v_mov_b64 v[58:59], v[110:111]
  v_mfma_f32_16x16x16_bf16 v[16:19], v[36:37], v[110:111], v[16:19]
  v_mov_b64 v[60:61], v[112:113]
  v_mov_b64 v[62:63], v[114:115]
  v_mfma_f32_16x16x16_bf16 v[12:15], v[38:39], v[112:113], v[12:15]
  s_mov_b32 s70, 268
  s_mov_b32 s71, s43
  v_mfma_f32_16x16x16_bf16 v[16:19], v[38:39], v[114:115], v[16:19]
  s_call_b64 s[74:75], L_enc
  s_nop 1
  v_mov_b64 v[208:209], v[32:33]
  v_mov_b64 v[210:211], v[34:35]
  v_mov_b64 v[212:213], v[36:37]
  v_mov_b64 v[214:215], v[38:39]
  v_mov_b64 v[248:249], v[40:41]
  v_mov_b64 v[250:251], v[42:43]
  buffer_load_dwordx4 v[252:255], v2, s[12:15], s72 offen offset:1024 nt
  buffer_load_dwordx4 v[184:187], v2, s[12:15], s72 offen offset:2048 nt
  buffer_load_dwordx4 v[188:191], v2, s[12:15], s72 offen offset:3072 nt
  s_xor_b32 s72, s49, 344064
  buffer_load_dwordx4 v[192:195], v2, s[12:15], s72 offen nt
  s_waitcnt vmcnt(13)
  v_and_b32_dpp v40, v23, v6 quad_perm:[0,1,2,3] row_mask:0xf bank_mask:0xf
  v_and_b32_dpp v41, v23, v7 row_ror:8 row_mask:0xf bank_mask:0xf
  v_and_b32_dpp v42, v22, v6 row_ror:12 row_mask:0xf bank_mask:0xf
  v_and_b32_dpp v43, v22, v7 row_ror:4 row_mask:0xf bank_mask:0xf
  v_mfma_f32_16x16x16_bf16 v[12:15], v[40:41], v[116:117], v[12:15]
  v_and_b32_dpp v44, v23, v6 row_ror:8 row_mask:0xf bank_mask:0xf
  v_and_b32_dpp v45, v23, v7 quad_perm:[0,1,2,3] row_mask:0xf bank_mask:0xf
  v_mfma_f32_16x16x16_bf16 v[16:19], v[40:41], v[118:119], v[16:19]
  v_and_b32_dpp v46, v22, v6 row_ror:4 row_mask:0xf bank_mask:0xf
  v_and_b32_dpp v47, v22, v7 row_ror:12 row_mask:0xf bank_mask:0xf
  v_mfma_f32_16x16x16_bf16 v[12:15], v[42:43], v[132:133], v[12:15]
  v_mov_b64 v[48:49], v[116:117]
  v_mov_b64 v[50:51], v[118:119]
  v_mfma_f32_16x16x16_bf16 v[16:19], v[42:43], v[134:135], v[16:19]
  v_mov_b64 v[52:53], v[132:133]
  v_mov_b64 v[54:55], v[134:135]
  v_mfma_f32_16x16x16_bf16 v[12:15], v[44:45], v[136:137], v[12:15]
  v_mov_b64 v[56:57], v[136:137]
  v_mov_b64 v[58:59], v[138:139]
  v_mfma_f32_16x16x16_bf16 v[16:19], v[44:45], v[138:139], v[16:19]
  v_mov_b64 v[60:61], v[140:141]
  v_mov_b64 v[62:63], v[142:143]
  v_mfma_f32_16x16x16_bf16 v[12:15], v[46:47], v[140:141], v[12:15]
  s_mov_b32 s70, 269
  s_mov_b32 s71, s43
  v_mfma_f32_16x16x16_bf16 v[16:19], v[46:47], v[142:143], v[16:19]
  s_call_b64 s[74:75], L_enc
  s_nop 1
  v_mov_b64 v[196:197], v[32:33]
  v_mov_b64 v[198:199], v[34:35]
  v_mov_b64 v[228:229], v[36:37]
  v_mov_b64 v[230:231], v[38:39]
  v_mov_b64 v[232:233], v[40:41]
  v_mov_b64 v[234:235], v[42:43]
  buffer_load_dwordx4 v[236:239], v2, s[12:15], s72 offen offset:1024 nt
  buffer_load_dwordx4 v[240:243], v2, s[12:15], s72 offen offset:2048 nt
  buffer_load_dwordx4 v[244:247], v2, s[12:15], s72 offen offset:3072 nt
  s_xor_b32 s72, s49, 360448
  buffer_load_dwordx4 v[76:79], v1, s[8:11], s72 offen nt
  s_waitcnt vmcnt(13)
  v_mfma_f32_16x16x32_bf16 v[32:35], v[144:147], v[8:11], 0
  v_mov_b64 v[48:49], v[144:145]
  v_mov_b64 v[50:51], v[146:147]
  v_mfma_f32_16x16x32_bf16 v[36:39], v[160:163], v[8:11], 0
  v_mov_b64 v[52:53], v[160:161]
  v_mov_b64 v[54:55], v[162:163]
  v_mfma_f32_16x16x32_bf16 v[40:43], v[164:167], v[8:11], 0
  v_mov_b64 v[56:57], v[164:165]
  v_mov_b64 v[58:59], v[166:167]
  v_mfma_f32_16x16x32_bf16 v[44:47], v[168:171], v[8:11], 0
  v_mov_b64 v[60:61], v[168:169]
  v_mov_b64 v[62:63], v[170:171]
  v_mov_b32_dpp v24, v32 quad_perm:[0,1,2,3] row_mask:0xf bank_mask:0x1
  v_mov_b32_dpp v26, v34 row_ror:8 row_mask:0xf bank_mask:0x1
  s_mov_b32 s70, 14
  v_mov_b32_dpp v24, v36 row_ror:4 row_mask:0xf bank_mask:0x2
  v_mov_b32_dpp v26, v38 row_ror:12 row_mask:0xf bank_mask:0x2
  s_mov_b32 s71, s42
  v_mov_b32_dpp v24, v40 row_ror:8 row_mask:0xf bank_mask:0x4
  v_mov_b32_dpp v26, v42 quad_perm:[0,1,2,3] row_mask:0xf bank_mask:0x4
  s_nop 0
  v_mov_b32_dpp v24, v44 row_ror:12 row_mask:0xf bank_mask:0x8
  v_mov_b32_dpp v26, v46 row_ror:4 row_mask:0xf bank_mask:0x8
  s_nop 0
  v_add_f32_dpp v24, v33, v24 row_ror:12 row_mask:0xf bank_mask:0x1
  v_add_f32_dpp v26, v35, v26 row_ror:4 row_mask:0xf bank_mask:0x1
  s_nop 0
  v_add_f32_dpp v24, v37, v24 quad_perm:[0,1,2,3] row_mask:0xf bank_mask:0x2
  v_add_f32_dpp v26, v39, v26 row_ror:8 row_mask:0xf bank_mask:0x2
  s_nop 0
  v_add_f32_dpp v24, v41, v24 row_ror:4 row_mask:0xf bank_mask:0x4
  v_add_f32_dpp v26, v43, v26 row_ror:12 row_mask:0xf bank_mask:0x4
  s_nop 0
  v_add_f32_dpp v24, v45, v24 row_ror:8 row_mask:0xf bank_mask:0x8
  v_add_f32_dpp v26, v47, v26 quad_perm:[0,1,2,3] row_mask:0xf bank_mask:0x8
  s_call_b64 s[74:75], L_enc
  s_nop 1
  v_mov_b64 v[80:81], v[32:33]
  v_mov_b64 v[82:83], v[34:35]
  v_mov_b64 v[84:85], v[36:37]
  v_mov_b64 v[86:87], v[38:39]
  v_mov_b64 v[104:105], v[40:41]
  v_mov_b64 v[106:107], v[42:43]
  buffer_load_dwordx4 v[108:111], v1, s[8:11], s72 offen offset:1024 nt
  buffer_load_dwordx4 v[112:115], v1, s[8:11], s72 offen offset:2048 nt
  buffer_load_dwordx4 v[116:119], v1, s[8:11], s72 offen offset:3072 nt
  s_xor_b32 s72, s49, 376832
  buffer_load_dwordx4 v[132:135], v1, s[8:11], s72 offen nt
  s_waitcnt vmcnt(13)
  v_mfma_f32_16x16x32_bf16 v[32:35], v[172:175], v[8:11], 0
  v_mov_b64 v[48:49], v[172:173]
  v_mov_b64 v[50:51], v[174:175]
  v_mfma_f32_16x16x32_bf16 v[36:39], v[176:179], v[8:11], 0
  v_mov_b64 v[52:53], v[176:177]
  v_mov_b64 v[54:55], v[178:179]
  v_mfma_f32_16x16x32_bf16 v[40:43], v[180:183], v[8:11], 0
  v_mov_b64 v[56:57], v[180:181]
  v_mov_b64 v[58:59], v[182:183]
  v_mfma_f32_16x16x32_bf16 v[44:47], v[200:203], v[8:11], 0
  v_mov_b64 v[60:61], v[200:201]
  v_mov_b64 v[62:63], v[202:203]
  v_mov_b32_dpp v25, v32 quad_perm:[0,1,2,3] row_mask:0xf bank_mask:0x1
  v_mov_b32_dpp v27, v34 row_ror:8 row_mask:0xf bank_mask:0x1
  s_mov_b32 s70, 15
  v_mov_b32_dpp v25, v36 row_ror:4 row_mask:0xf bank_mask:0x2
  v_mov_b32_dpp v27, v38 row_ror:12 row_mask:0xf bank_mask:0x2
  s_mov_b32 s71, s42
  v_mov_b32_dpp v25, v40 row_ror:8 row_mask:0xf bank_mask:0x4
  v_mov_b32_dpp v27, v42 quad_perm:[0,1,2,3] row_mask:0xf bank_mask:0x4
  s_nop 0
  v_mov_b32_dpp v25, v44 row_ror:12 row_mask:0xf bank_mask:0x8
  v_mov_b32_dpp v27, v46 row_ror:4 row_mask:0xf bank_mask:0x8
  s_nop 0
  v_add_f32_dpp v25, v33, v25 row_ror:12 row_mask:0xf bank_mask:0x1
  v_add_f32_dpp v27, v35, v27 row_ror:4 row_mask:0xf bank_mask:0x1
  s_nop 0
  v_add_f32_dpp v25, v37, v25 quad_perm:[0,1,2,3] row_mask:0xf bank_mask:0x2
  v_add_f32_dpp v27, v39, v27 row_ror:8 row_mask:0xf bank_mask:0x2
  s_nop 0
  v_add_f32_dpp v25, v41, v25 row_ror:4 row_mask:0xf bank_mask:0x4
  v_add_f32_dpp v27, v43, v27 row_ror:12 row_mask:0xf bank_mask:0x4
  s_nop 0
  v_add_f32_dpp v25, v45, v25 row_ror:8 row_mask:0xf bank_mask:0x8
  v_add_f32_dpp v27, v47, v27 quad_perm:[0,1,2,3] row_mask:0xf bank_mask:0x8
  s_call_b64 s[74:75], L_enc
  s_nop 1
  ds_write_b128 v3, v[32:35] offset:27648
  ds_write_b128 v3, v[36:39] offset:28672
  ds_write_b128 v3, v[40:43] offset:29696
  buffer_load_dwordx4 v[136:139], v1, s[8:11], s72 offen offset:1024 nt
  buffer_load_dwordx4 v[140:143], v1, s[8:11], s72 offen offset:2048 nt
  buffer_load_dwordx4 v[144:147], v1, s[8:11], s72 offen offset:3072 nt
  s_xor_b32 s72, s49, 360448
  buffer_load_dwordx4 v[160:163], v2, s[12:15], s72 offen nt
  s_waitcnt vmcnt(13)
  v_add_f32 v24, v24, v26
  v_add_f32 v25, v25, v27
  v_cvt_pk_bf16_f32 v32, v24, v25
  v_lshlrev_b32 v24, 16, v32
  v_and_b32 v25, 0xffff0000, v32
  v_pk_mul_f32 v[24:25], v[24:25], s[56:57] op_sel_hi:[1,0]
  v_cvt_pk_bf16_f32 v32, v24, v25
  v_lshlrev_b32 v24, 16, v32
  v_and_b32 v25, 0xffff0000, v32
  v_pk_add_f32 v[26:27], v[24:25], v[4:5] op_sel_hi:[1,0] neg_lo:[0,1] neg_hi:[0,1]
  v_pk_mul_f32 v[26:27], v[26:27], s[56:57] op_sel:[0,1] op_sel_hi:[1,1]
  v_max_f32 v20, v26, v27
  v_cmp_lt_f32 vcc, 0, v20
  s_getpc_b64 s[74:75]
  s_cbranch_vccnz L_remax
  v_exp_f32 v26, v26
  v_exp_f32 v27, v27
  v_cvt_pk_bf16_f32 v20, v26, 0
  v_add_f32 v32, v26, v27
  v_cvt_pk_bf16_f32 v21, v26, 0
  v_cvt_pk_bf16_f32 v23, v27, 0
  v_cvt_pk_bf16_f32 v22, v27, 0
  v_cvt_pk_bf16_f32 v24, 0, v26
  v_cvt_pk_bf16_f32 v25, 0, v27
  v_add_f32 v5, v5, v32
  v_mov_b32_dpp v20, v24 row_ror:4 row_mask:0xf bank_mask:0xa
  v_mov_b32_dpp v21, v24 row_ror:4 row_mask:0xf bank_mask:0x5
  v_mov_b32_dpp v23, v25 row_ror:4 row_mask:0xf bank_mask:0xa
  v_mov_b32_dpp v22, v25 row_ror:4 row_mask:0xf bank_mask:0x5
  v_and_b32_dpp v32, v20, v6 quad_perm:[0,1,2,3] row_mask:0xf bank_mask:0xf
  v_and_b32_dpp v33, v20, v7 row_ror:8 row_mask:0xf bank_mask:0xf
  v_and_b32_dpp v34, v21, v6 row_ror:12 row_mask:0xf bank_mask:0xf
  v_and_b32_dpp v35, v21, v7 row_ror:4 row_mask:0xf bank_mask:0xf
  v_mfma_f32_16x16x16_bf16 v[12:15], v[32:33], v[204:205], v[12:15]
  v_and_b32_dpp v36, v20, v6 row_ror:8 row_mask:0xf bank_mask:0xf
  v_and_b32_dpp v37, v20, v7 quad_perm:[0,1,2,3] row_mask:0xf bank_mask:0xf
  v_mfma_f32_16x16x16_bf16 v[16:19], v[32:33], v[206:207], v[16:19]
  v_and_b32_dpp v38, v21, v6 row_ror:4 row_mask:0xf bank_mask:0xf
  v_and_b32_dpp v39, v21, v7 row_ror:12 row_mask:0xf bank_mask:0xf
  v_mfma_f32_16x16x16_bf16 v[12:15], v[34:35], v[252:253], v[12:15]
  v_mov_b64 v[48:49], v[204:205]
  v_mov_b64 v[50:51], v[206:207]
  v_mfma_f32_16x16x16_bf16 v[16:19], v[34:35], v[254:255], v[16:19]
  v_mov_b64 v[52:53], v[252:253]
  v_mov_b64 v[54:55], v[254:255]
  v_mfma_f32_16x16x16_bf16 v[12:15], v[36:37], v[184:185], v[12:15]
  v_mov_b64 v[56:57], v[184:185]
  v_mov_b64 v[58:59], v[186:187]
  v_mfma_f32_16x16x16_bf16 v[16:19], v[36:37], v[186:187], v[16:19]
  v_mov_b64 v[60:61], v[188:189]
  v_mov_b64 v[62:63], v[190:191]
  v_mfma_f32_16x16x16_bf16 v[12:15], v[38:39], v[188:189], v[12:15]
  s_mov_b32 s70, 270
  s_mov_b32 s71, s43
  v_mfma_f32_16x16x16_bf16 v[16:19], v[38:39], v[190:191], v[16:19]
  s_call_b64 s[74:75], L_enc
  s_nop 1
  v_mov_b64 v[164:165], v[32:33]
  v_mov_b64 v[166:167], v[34:35]
  v_mov_b64 v[168:169], v[36:37]
  v_mov_b64 v[170:171], v[38:39]
  v_mov_b64 v[172:173], v[40:41]
  v_mov_b64 v[174:175], v[42:43]
  buffer_load_dwordx4 v[176:179], v2, s[12:15], s72 offen offset:1024 nt
  buffer_load_dwordx4 v[180:183], v2, s[12:15], s72 offen offset:2048 nt
  buffer_load_dwordx4 v[200:203], v2, s[12:15], s72 offen offset:3072 nt
  s_xor_b32 s72, s49, 376832
  buffer_load_dwordx4 v[204:207], v2, s[12:15], s72 offen nt
  s_waitcnt vmcnt(13)
  v_and_b32_dpp v40, v23, v6 quad_perm:[0,1,2,3] row_mask:0xf bank_mask:0xf
  v_and_b32_dpp v41, v23, v7 row_ror:8 row_mask:0xf bank_mask:0xf
  v_and_b32_dpp v42, v22, v6 row_ror:12 row_mask:0xf bank_mask:0xf
  v_and_b32_dpp v43, v22, v7 row_ror:4 row_mask:0xf bank_mask:0xf
  v_mfma_f32_16x16x16_bf16 v[12:15], v[40:41], v[192:193], v[12:15]
  v_and_b32_dpp v44, v23, v6 row_ror:8 row_mask:0xf bank_mask:0xf
  v_and_b32_dpp v45, v23, v7 quad_perm:[0,1,2,3] row_mask:0xf bank_mask:0xf
  v_mfma_f32_16x16x16_bf16 v[16:19], v[40:41], v[194:195], v[16:19]
  v_and_b32_dpp v46, v22, v6 row_ror:4 row_mask:0xf bank_mask:0xf
  v_and_b32_dpp v47, v22, v7 row_ror:12 row_mask:0xf bank_mask:0xf
  v_mfma_f32_16x16x16_bf16 v[12:15], v[42:43], v[236:237], v[12:15]
  v_mov_b64 v[48:49], v[192:193]
  v_mov_b64 v[50:51], v[194:195]
  v_mfma_f32_16x16x16_bf16 v[16:19], v[42:43], v[238:239], v[16:19]
  v_mov_b64 v[52:53], v[236:237]
  v_mov_b64 v[54:55], v[238:239]
  v_mfma_f32_16x16x16_bf16 v[12:15], v[44:45], v[240:241], v[12:15]
  v_mov_b64 v[56:57], v[240:241]
  v_mov_b64 v[58:59], v[242:243]
  v_mfma_f32_16x16x16_bf16 v[16:19], v[44:45], v[242:243], v[16:19]
  v_mov_b64 v[60:61], v[244:245]
  v_mov_b64 v[62:63], v[246:247]
  v_mfma_f32_16x16x16_bf16 v[12:15], v[46:47], v[244:245], v[12:15]
  s_mov_b32 s70, 271
  s_mov_b32 s71, s43
  v_mfma_f32_16x16x16_bf16 v[16:19], v[46:47], v[246:247], v[16:19]
  s_call_b64 s[74:75], L_enc
  s_nop 1
  v_mov_b64 v[252:253], v[32:33]
  v_mov_b64 v[254:255], v[34:35]
  v_mov_b64 v[184:185], v[36:37]
  v_mov_b64 v[186:187], v[38:39]
  v_mov_b64 v[188:189], v[40:41]
  v_mov_b64 v[190:191], v[42:43]
  buffer_load_dwordx4 v[192:195], v2, s[12:15], s72 offen offset:1024 nt
  buffer_load_dwordx4 v[236:239], v2, s[12:15], s72 offen offset:2048 nt
  buffer_load_dwordx4 v[240:243], v2, s[12:15], s72 offen offset:3072 nt
  s_xor_b32 s72, s49, 393216
  buffer_load_dwordx4 v[244:247], v1, s[8:11], s72 offen nt
  s_getpc_b64 s[88:89]
L_tc2:
  s_add_u32 s88, s88, L_pass2-L_tc2
  s_addc_u32 s89, s89, 0
  s_and_b32 s89, s89, 0xffff
  s_mov_b32 s90, L_end-L_pass2
  s_mov_b32 s91, 0x00020000
  s_lshr_b32 s92, s2, 3
  s_lshl_b32 s92, s92, 2
  s_add_u32 s92, s92, s3
  s_and_b32 s92, s92, 15
  s_lshl_b32 s92, s92, 12
  v_lshlrev_b32 v20, 2, v2
  s_mov_b32 m0, 11520
  s_nop 0
  buffer_load_dword v20, s[88:91], s92 offen lds
  s_waitcnt vmcnt(14)
  v_mfma_f32_16x16x32_bf16 v[32:35], v[76:79], v[8:11], 0
  v_mov_b64 v[48:49], v[76:77]
  v_mov_b64 v[50:51], v[78:79]
  v_mfma_f32_16x16x32_bf16 v[36:39], v[108:111], v[8:11], 0
  v_mov_b64 v[52:53], v[108:109]
  v_mov_b64 v[54:55], v[110:111]
  v_mfma_f32_16x16x32_bf16 v[40:43], v[112:115], v[8:11], 0
  v_mov_b64 v[56:57], v[112:113]
  v_mov_b64 v[58:59], v[114:115]
  v_mfma_f32_16x16x32_bf16 v[44:47], v[116:119], v[8:11], 0
  v_mov_b64 v[60:61], v[116:117]
  v_mov_b64 v[62:63], v[118:119]
  v_mov_b32_dpp v24, v32 quad_perm:[0,1,2,3] row_mask:0xf bank_mask:0x1
  v_mov_b32_dpp v26, v34 row_ror:8 row_mask:0xf bank_mask:0x1
  s_mov_b32 s70, 16
  v_mov_b32_dpp v24, v36 row_ror:4 row_mask:0xf bank_mask:0x2
  v_mov_b32_dpp v26, v38 row_ror:12 row_mask:0xf bank_mask:0x2
  s_mov_b32 s71, s42
  v_mov_b32_dpp v24, v40 row_ror:8 row_mask:0xf bank_mask:0x4
  v_mov_b32_dpp v26, v42 quad_perm:[0,1,2,3] row_mask:0xf bank_mask:0x4
  s_nop 0
  v_mov_b32_dpp v24, v44 row_ror:12 row_mask:0xf bank_mask:0x8
  v_mov_b32_dpp v26, v46 row_ror:4 row_mask:0xf bank_mask:0x8
  s_nop 0
  v_add_f32_dpp v24, v33, v24 row_ror:12 row_mask:0xf bank_mask:0x1
  v_add_f32_dpp v26, v35, v26 row_ror:4 row_mask:0xf bank_mask:0x1
  s_nop 0
  v_add_f32_dpp v24, v37, v24 quad_perm:[0,1,2,3] row_mask:0xf bank_mask:0x2
  v_add_f32_dpp v26, v39, v26 row_ror:8 row_mask:0xf bank_mask:0x2
  s_nop 0
  v_add_f32_dpp v24, v41, v24 row_ror:4 row_mask:0xf bank_mask:0x4
  v_add_f32_dpp v26, v43, v26 row_ror:12 row_mask:0xf bank_mask:0x4
  s_nop 0
  v_add_f32_dpp v24, v45, v24 row_ror:8 row_mask:0xf bank_mask:0x8
  v_add_f32_dpp v26, v47, v26 quad_perm:[0,1,2,3] row_mask:0xf bank_mask:0x8
  s_call_b64 s[74:75], L_enc
  s_nop 1
  v_mov_b64 v[76:77], v[32:33]
  v_mov_b64 v[78:79], v[34:35]
  v_mov_b64 v[108:109], v[36:37]
  v_mov_b64 v[110:111], v[38:39]
  v_mov_b64 v[112:113], v[40:41]
  v_mov_b64 v[114:115], v[42:43]
  buffer_load_dwordx4 v[116:119], v1, s[8:11], s72 offen offset:1024 nt
  s_add_u32 m0, s61, 28672
  s_mov_b32 s70, 17
  buffer_load_dwordx4 v1, s[8:11], s72 offen offset:2048 nt lds
  s_add_u32 m0, s61, 28672
  s_mov_b32 s71, s42
  buffer_load_dwordx4 v1, s[8:11], s72 offen offset:3072 nt lds
  s_xor_b32 s72, s49, 409600
  s_add_u32 m0, s61, 32768
  s_nop 0
  buffer_load_dwordx4 v1, s[8:11], s72 offen nt lds
  s_waitcnt vmcnt(14)
  v_mfma_f32_16x16x32_bf16 v[32:35], v[132:135], v[8:11], 0
  v_mov_b64 v[48:49], v[132:133]
  v_mov_b64 v[50:51], v[134:135]
  v_mfma_f32_16x16x32_bf16 v[36:39], v[136:139], v[8:11], 0
  v_mov_b64 v[52:53], v[136:137]
  v_mov_b64 v[54:55], v[138:139]
  v_mfma_f32_16x16x32_bf16 v[40:43], v[140:143], v[8:11], 0
  v_mov_b64 v[56:57], v[140:141]
  v_mov_b64 v[58:59], v[142:143]
  v_mfma_f32_16x16x32_bf16 v[44:47], v[144:147], v[8:11], 0
  v_mov_b64 v[60:61], v[144:145]
  v_mov_b64 v[62:63], v[146:147]
  v_mov_b32_dpp v25, v32 quad_perm:[0,1,2,3] row_mask:0xf bank_mask:0x1
  v_mov_b32_dpp v27, v34 row_ror:8 row_mask:0xf bank_mask:0x1
  s_nop 0
  v_mov_b32_dpp v25, v36 row_ror:4 row_mask:0xf bank_mask:0x2
  v_mov_b32_dpp v27, v38 row_ror:12 row_mask:0xf bank_mask:0x2
  s_nop 0
  v_mov_b32_dpp v25, v40 row_ror:8 row_mask:0xf bank_mask:0x4
  v_mov_b32_dpp v27, v42 quad_perm:[0,1,2,3] row_mask:0xf bank_mask:0x4
  s_nop 0
  v_mov_b32_dpp v25, v44 row_ror:12 row_mask:0xf bank_mask:0x8
  v_mov_b32_dpp v27, v46 row_ror:4 row_mask:0xf bank_mask:0x8
  s_nop 0
  v_add_f32_dpp v25, v33, v25 row_ror:12 row_mask:0xf bank_mask:0x1
  v_add_f32_dpp v27, v35, v27 row_ror:4 row_mask:0xf bank_mask:0x1
  s_nop 0
  v_add_f32_dpp v25, v37, v25 quad_perm:[0,1,2,3] row_mask:0xf bank_mask:0x2
  v_add_f32_dpp v27, v39, v27 row_ror:8 row_mask:0xf bank_mask:0x2
  s_nop 0
  v_add_f32_dpp v25, v41, v25 row_ror:4 row_mask:0xf bank_mask:0x4
  v_add_f32_dpp v27, v43, v27 row_ror:12 row_mask:0xf bank_mask:0x4
  s_nop 0
  v_add_f32_dpp v25, v45, v25 row_ror:8 row_mask:0xf bank_mask:0x8
  v_add_f32_dpp v27, v47, v27 quad_perm:[0,1,2,3] row_mask:0xf bank_mask:0x8
  s_call_b64 s[74:75], L_enc
  s_nop 1
  ds_write_b128 v3, v[32:35] offset:33792
  ds_write_b128 v3, v[36:39] offset:34816
  ds_write_b128 v3, v[40:43] offset:35840
  buffer_load_dwordx4 v[132:135], v1, s[8:11], s72 offen offset:1024 nt
  buffer_load_dwordx4 v[136:139], v1, s[8:11], s72 offen offset:2048 nt
  buffer_load_dwordx4 v[140:143], v1, s[8:11], s72 offen offset:3072 nt
  s_xor_b32 s72, s49, 393216
  buffer_load_dwordx4 v[144:147], v2, s[12:15], s72 offen nt
  s_waitcnt vmcnt(14)
  v_add_f32 v24, v24, v26
  v_add_f32 v25, v25, v27
  v_cvt_pk_bf16_f32 v32, v24, v25
  v_lshlrev_b32 v24, 16, v32
  v_and_b32 v25, 0xffff0000, v32
  v_pk_mul_f32 v[24:25], v[24:25], s[56:57] op_sel_hi:[1,0]
  v_cvt_pk_bf16_f32 v32, v24, v25
  v_lshlrev_b32 v24, 16, v32
  v_and_b32 v25, 0xffff0000, v32
  v_pk_add_f32 v[26:27], v[24:25], v[4:5] op_sel_hi:[1,0] neg_lo:[0,1] neg_hi:[0,1]
  v_pk_mul_f32 v[26:27], v[26:27], s[56:57] op_sel:[0,1] op_sel_hi:[1,1]
  v_max_f32 v20, v26, v27
  v_cmp_lt_f32 vcc, 0, v20
  s_getpc_b64 s[74:75]
  s_cbranch_vccnz L_remax
  v_exp_f32 v26, v26
  v_exp_f32 v27, v27
  v_cvt_pk_bf16_f32 v20, v26, 0
  v_add_f32 v32, v26, v27
  v_cvt_pk_bf16_f32 v21, v26, 0
  v_cvt_pk_bf16_f32 v23, v27, 0
  v_cvt_pk_bf16_f32 v22, v27, 0
  v_cvt_pk_bf16_f32 v24, 0, v26
  v_cvt_pk_bf16_f32 v25, 0, v27
  v_add_f32 v5, v5, v32
  v_mov_b32_dpp v20, v24 row_ror:4 row_mask:0xf bank_mask:0xa
  v_mov_b32_dpp v21, v24 row_ror:4 row_mask:0xf bank_mask:0x5
  v_mov_b32_dpp v23, v25 row_ror:4 row_mask:0xf bank_mask:0xa
  v_mov_b32_dpp v22, v25 row_ror:4 row_mask:0xf bank_mask:0x5
  v_and_b32_dpp v32, v20, v6 quad_perm:[0,1,2,3] row_mask:0xf bank_mask:0xf
  v_and_b32_dpp v33, v20, v7 row_ror:8 row_mask:0xf bank_mask:0xf
  v_and_b32_dpp v34, v21, v6 row_ror:12 row_mask:0xf bank_mask:0xf
  v_and_b32_dpp v35, v21, v7 row_ror:4 row_mask:0xf bank_mask:0xf
  v_mfma_f32_16x16x16_bf16 v[12:15], v[32:33], v[160:161], v[12:15]
  v_and_b32_dpp v36, v20, v6 row_ror:8 row_mask:0xf bank_mask:0xf
  v_and_b32_dpp v37, v20, v7 quad_perm:[0,1,2,3] row_mask:0xf bank_mask:0xf
  v_mfma_f32_16x16x16_bf16 v[16:19], v[32:33], v[162:163], v[16:19]
  v_and_b32_dpp v38, v21, v6 row_ror:4 row_mask:0xf bank_mask:0xf
  v_and_b32_dpp v39, v21, v7 row_ror:12 row_mask:0xf bank_mask:0xf
  v_mfma_f32_16x16x16_bf16 v[12:15], v[34:35], v[176:177], v[12:15]
  v_mov_b64 v[48:49], v[160:161]
  v_mov_b64 v[50:51], v[162:163]
  v_mfma_f32_16x16x16_bf16 v[16:19], v[34:35], v[178:179], v[16:19]
  v_mov_b64 v[52:53], v[176:177]
  v_mov_b64 v[54:55], v[178:179]
  v_mfma_f32_16x16x16_bf16 v[12:15], v[36:37], v[180:181], v[12:15]
  v_mov_b64 v[56:57], v[180:181]
  v_mov_b64 v[58:59], v[182:183]
  v_mfma_f32_16x16x16_bf16 v[16:19], v[36:37], v[182:183], v[16:19]
  v_mov_b64 v[60:61], v[200:201]
  v_mov_b64 v[62:63], v[202:203]
  v_mfma_f32_16x16x16_bf16 v[12:15], v[38:39], v[200:201], v[12:15]
  s_mov_b32 s70, 272
  s_mov_b32 s71, s43
  v_mfma_f32_16x16x16_bf16 v[16:19], v[38:39], v[202:203], v[16:19]
  s_call_b64 s[74:75], L_enc
  s_nop 1
  v_mov_b64 v[160:161], v[32:33]
  v_mov_b64 v[162:163], v[34:35]
  v_mov_b64 v[176:177], v[36:37]
  v_mov_b64 v[178:179], v[38:39]
  v_mov_b64 v[180:181], v[40:41]
  v_mov_b64 v[182:183], v[42:43]
  buffer_load_dwordx4 v[200:203], v2, s[12:15], s72 offen offset:1024 nt
  s_add_u32 m0, s61, 34816
  v_and_b32_dpp v40, v23, v6 quad_perm:[0,1,2,3] row_mask:0xf bank_mask:0xf
  buffer_load_dwordx4 v2, s[12:15], s72 offen offset:2048 nt lds
  buffer_load_dwordx4 a[12:15], v2, s[12:15], s72 offen offset:3072 nt
  s_xor_b32 s72, s49, 409600
  buffer_load_dwordx4 a[28:31], v2, s[12:15], s72 offen nt
  s_waitcnt vmcnt(14)
  v_and_b32_dpp v41, v23, v7 row_ror:8 row_mask:0xf bank_mask:0xf
  v_and_b32_dpp v42, v22, v6 row_ror:12 row_mask:0xf bank_mask:0xf
  v_and_b32_dpp v43, v22, v7 row_ror:4 row_mask:0xf bank_mask:0xf
  v_mfma_f32_16x16x16_bf16 v[12:15], v[40:41], v[204:205], v[12:15]
  v_and_b32_dpp v44, v23, v6 row_ror:8 row_mask:0xf bank_mask:0xf
  v_and_b32_dpp v45, v23, v7 quad_perm:[0,1,2,3] row_mask:0xf bank_mask:0xf
  v_mfma_f32_16x16x16_bf16 v[16:19], v[40:41], v[206:207], v[16:19]
  v_and_b32_dpp v46, v22, v6 row_ror:4 row_mask:0xf bank_mask:0xf
  v_and_b32_dpp v47, v22, v7 row_ror:12 row_mask:0xf bank_mask:0xf
  v_mfma_f32_16x16x16_bf16 v[12:15], v[42:43], v[192:193], v[12:15]
  v_mov_b64 v[48:49], v[204:205]
  v_mov_b64 v[50:51], v[206:207]
  v_mfma_f32_16x16x16_bf16 v[16:19], v[42:43], v[194:195], v[16:19]
  v_mov_b64 v[52:53], v[192:193]
  v_mov_b64 v[54:55], v[194:195]
  v_mfma_f32_16x16x16_bf16 v[12:15], v[44:45], v[236:237], v[12:15]
  v_mov_b64 v[56:57], v[236:237]
  v_mov_b64 v[58:59], v[238:239]
  v_mfma_f32_16x16x16_bf16 v[16:19], v[44:45], v[238:239], v[16:19]
  v_mov_b64 v[60:61], v[240:241]
  v_mov_b64 v[62:63], v[242:243]
  v_mfma_f32_16x16x16_bf16 v[12:15], v[46:47], v[240:241], v[12:15]
  s_mov_b32 s70, 273
  s_mov_b32 s71, s43
  v_mfma_f32_16x16x16_bf16 v[16:19], v[46:47], v[242:243], v[16:19]
  s_call_b64 s[74:75], L_enc
  s_nop 1
  v_mov_b64 v[204:205], v[32:33]
  v_mov_b64 v[206:207], v[34:35]
  v_mov_b64 v[192:193], v[36:37]
  v_mov_b64 v[194:195], v[38:39]
  v_mov_b64 v[236:237], v[40:41]
  v_mov_b64 v[238:239], v[42:43]
  buffer_load_dwordx4 v[240:243], v2, s[12:15], s72 offen offset:1024 nt
  buffer_load_dwordx4 a[44:47], v2, s[12:15], s72 offen offset:2048 nt
  buffer_load_dwordx4 a[48:51], v2, s[12:15], s72 offen offset:3072 nt
  s_xor_b32 s72, s49, 425984
  buffer_load_dwordx4 a[52:55], v1, s[8:11], s72 offen nt
  s_waitcnt vmcnt(13)
  ds_read_b128 v[56:59], v3 offset:30720
  ds_read_b128 v[60:63], v3 offset:31744
  v_mfma_f32_16x16x32_bf16 v[32:35], v[244:247], v[8:11], 0
  v_mov_b64 v[48:49], v[244:245]
  v_mov_b64 v[50:51], v[246:247]
  v_mfma_f32_16x16x32_bf16 v[36:39], v[116:119], v[8:11], 0
  v_mov_b64 v[52:53], v[116:117]
  v_mov_b64 v[54:55], v[118:119]
  s_mov_b32 s70, 18
  s_mov_b32 s71, s42
  s_nop 0
  v_mov_b32_dpp v24, v32 quad_perm:[0,1,2,3] row_mask:0xf bank_mask:0x1
  v_mov_b32_dpp v26, v34 row_ror:8 row_mask:0xf bank_mask:0x1
  s_nop 0
  v_mov_b32_dpp v24, v36 row_ror:4 row_mask:0xf bank_mask:0x2
  v_mov_b32_dpp v26, v38 row_ror:12 row_mask:0xf bank_mask:0x2
  s_waitcnt lgkmcnt(0)
  v_mfma_f32_16x16x32_bf16 v[40:43], v[56:59], v[8:11], 0
  v_mfma_f32_16x16x32_bf16 v[44:47], v[60:63], v[8:11], 0
  s_nop 6
  v_mov_b32_dpp v24, v40 row_ror:8 row_mask:0xf bank_mask:0x4
  v_mov_b32_dpp v26, v42 quad_perm:[0,1,2,3] row_mask:0xf bank_mask:0x4
  s_nop 0
  v_mov_b32_dpp v24, v44 row_ror:12 row_mask:0xf bank_mask:0x8
  v_mov_b32_dpp v26, v46 row_ror:4 row_mask:0xf bank_mask:0x8
  s_nop 0
  v_add_f32_dpp v24, v33, v24 row_ror:12 row_mask:0xf bank_mask:0x1
  v_add_f32_dpp v26, v35, v26 row_ror:4 row_mask:0xf bank_mask:0x1
  s_nop 0
  v_add_f32_dpp v24, v37, v24 quad_perm:[0,1,2,3] row_mask:0xf bank_mask:0x2
  v_add_f32_dpp v26, v39, v26 row_ror:8 row_mask:0xf bank_mask:0x2
  s_nop 0
  v_add_f32_dpp v24, v41, v24 row_ror:4 row_mask:0xf bank_mask:0x4
  v_add_f32_dpp v26, v43, v26 row_ror:12 row_mask:0xf bank_mask:0x4
  s_nop 0
  v_add_f32_dpp v24, v45, v24 row_ror:8 row_mask:0xf bank_mask:0x8
  v_add_f32_dpp v26, v47, v26 quad_perm:[0,1,2,3] row_mask:0xf bank_mask:0x8
  s_call_b64 s[74:75], L_enc
  s_nop 1
  v_mov_b64 v[244:245], v[32:33]
  v_mov_b64 v[246:247], v[34:35]
  v_mov_b64 v[116:117], v[36:37]
  v_mov_b64 v[118:119], v[38:39]
  v_accvgpr_write_b32 a80, v40
  v_accvgpr_write_b32 a81, v41
  v_accvgpr_write_b32 a82, v42
  v_accvgpr_write_b32 a83, v43
  s_add_u32 m0, s61, 29696
  s_mov_b32 s70, 19
  buffer_load_dwordx4 v1, s[8:11], s72 offen offset:1024 nt lds
  s_add_u32 m0, s61, 29696
  s_mov_b32 s71, s42
  buffer_load_dwordx4 v1, s[8:11], s72 offen offset:2048 nt lds
  buffer_load_dwordx4 a[96:99], v1, s[8:11], s72 offen offset:3072 nt
  s_xor_b32 s72, s49, 442368
  buffer_load_dwordx4 a[100:103], v1, s[8:11], s72 offen nt
  s_waitcnt vmcnt(13)
  ds_read_b128 v[48:51], v3 offset:32768
  v_mfma_f32_16x16x32_bf16 v[36:39], v[132:135], v[8:11], 0
  v_mov_b64 v[52:53], v[132:133]
  v_mov_b64 v[54:55], v[134:135]
  v_mfma_f32_16x16x32_bf16 v[40:43], v[136:139], v[8:11], 0
  v_mov_b64 v[56:57], v[136:137]
  v_mov_b64 v[58:59], v[138:139]
  v_mfma_f32_16x16x32_bf16 v[44:47], v[140:143], v[8:11], 0
  v_mov_b64 v[60:61], v[140:141]
  v_mov_b64 v[62:63], v[142:143]
  s_waitcnt lgkmcnt(0)
  v_mfma_f32_16x16x32_bf16 v[32:35], v[48:51], v[8:11], 0
  s_nop 7
  v_mov_b32_dpp v25, v32 quad_perm:[0,1,2,3] row_mask:0xf bank_mask:0x1
  v_mov_b32_dpp v27, v34 row_ror:8 row_mask:0xf bank_mask:0x1
  s_nop 0
  v_mov_b32_dpp v25, v36 row_ror:4 row_mask:0xf bank_mask:0x2
  v_mov_b32_dpp v27, v38 row_ror:12 row_mask:0xf bank_mask:0x2
  s_nop 0
  v_mov_b32_dpp v25, v40 row_ror:8 row_mask:0xf bank_mask:0x4
  v_mov_b32_dpp v27, v42 quad_perm:[0,1,2,3] row_mask:0xf bank_mask:0x4
  s_nop 0
  v_mov_b32_dpp v25, v44 row_ror:12 row_mask:0xf bank_mask:0x8
  v_mov_b32_dpp v27, v46 row_ror:4 row_mask:0xf bank_mask:0x8
  s_nop 0
  v_add_f32_dpp v25, v33, v25 row_ror:12 row_mask:0xf bank_mask:0x1
  v_add_f32_dpp v27, v35, v27 row_ror:4 row_mask:0xf bank_mask:0x1
  s_nop 0
  v_add_f32_dpp v25, v37, v25 quad_perm:[0,1,2,3] row_mask:0xf bank_mask:0x2
  v_add_f32_dpp v27, v39, v27 row_ror:8 row_mask:0xf bank_mask:0x2
  s_nop 0
  v_add_f32_dpp v25, v41, v25 row_ror:4 row_mask:0xf bank_mask:0x4
  v_add_f32_dpp v27, v43, v27 row_ror:12 row_mask:0xf bank_mask:0x4
  s_nop 0
  v_add_f32_dpp v25, v45, v25 row_ror:8 row_mask:0xf bank_mask:0x8
  v_add_f32_dpp v27, v47, v27 quad_perm:[0,1,2,3] row_mask:0xf bank_mask:0x8
  s_call_b64 s[74:75], L_enc
  s_nop 1
  ds_write_b128 v3, v[32:35] offset:32768
  v_accvgpr_write_b32 a104, v36
  v_accvgpr_write_b32 a105, v37
  v_accvgpr_write_b32 a106, v38
  v_accvgpr_write_b32 a107, v39
  v_accvgpr_write_b32 a120, v40
  v_accvgpr_write_b32 a121, v41
  v_accvgpr_write_b32 a122, v42
  v_accvgpr_write_b32 a123, v43
  buffer_load_dwordx4 v[132:135], v1, s[8:11], s72 offen offset:1024 nt
  buffer_load_dwordx4 v[136:139], v1, s[8:11], s72 offen offset:2048 nt
  buffer_load_dwordx4 v[140:143], v1, s[8:11], s72 offen offset:3072 nt
  s_xor_b32 s72, s49, 425984
  buffer_load_dwordx4 a[124:127], v2, s[12:15], s72 offen nt
  s_waitcnt vmcnt(13)
  ds_read_b128 v[56:59], v3 offset:36864
  v_add_f32 v24, v24, v26
  v_add_f32 v25, v25, v27
  v_cvt_pk_bf16_f32 v32, v24, v25
  v_lshlrev_b32 v24, 16, v32
  v_and_b32 v25, 0xffff0000, v32
  v_pk_mul_f32 v[24:25], v[24:25], s[56:57] op_sel_hi:[1,0]
  v_cvt_pk_bf16_f32 v32, v24, v25
  v_lshlrev_b32 v24, 16, v32
  v_and_b32 v25, 0xffff0000, v32
  v_pk_add_f32 v[26:27], v[24:25], v[4:5] op_sel_hi:[1,0] neg_lo:[0,1] neg_hi:[0,1]
  v_pk_mul_f32 v[26:27], v[26:27], s[56:57] op_sel:[0,1] op_sel_hi:[1,1]
  v_max_f32 v20, v26, v27
  v_cmp_lt_f32 vcc, 0, v20
  s_getpc_b64 s[74:75]
  s_cbranch_vccnz L_remax
  v_exp_f32 v26, v26
  v_exp_f32 v27, v27
  v_cvt_pk_bf16_f32 v20, v26, 0
  v_add_f32 v32, v26, v27
  v_cvt_pk_bf16_f32 v21, v26, 0
  v_cvt_pk_bf16_f32 v23, v27, 0
  v_cvt_pk_bf16_f32 v22, v27, 0
  v_cvt_pk_bf16_f32 v24, 0, v26
  v_cvt_pk_bf16_f32 v25, 0, v27
  v_add_f32 v5, v5, v32
  v_mov_b32_dpp v20, v24 row_ror:4 row_mask:0xf bank_mask:0xa
  v_mov_b32_dpp v21, v24 row_ror:4 row_mask:0xf bank_mask:0x5
  v_mov_b32_dpp v23, v25 row_ror:4 row_mask:0xf bank_mask:0xa
  v_mov_b32_dpp v22, v25 row_ror:4 row_mask:0xf bank_mask:0x5
  v_and_b32_dpp v32, v20, v6 quad_perm:[0,1,2,3] row_mask:0xf bank_mask:0xf
  v_and_b32_dpp v33, v20, v7 row_ror:8 row_mask:0xf bank_mask:0xf
  v_and_b32_dpp v34, v21, v6 row_ror:12 row_mask:0xf bank_mask:0xf
  s_waitcnt lgkmcnt(0)
  v_mfma_f32_16x16x16_bf16 v[12:15], v[32:33], v[144:145], v[12:15]
  v_and_b32_dpp v35, v21, v7 row_ror:4 row_mask:0xf bank_mask:0xf
  v_and_b32_dpp v36, v20, v6 row_ror:8 row_mask:0xf bank_mask:0xf
  v_mfma_f32_16x16x16_bf16 v[16:19], v[32:33], v[146:147], v[16:19]
  v_and_b32_dpp v37, v20, v7 quad_perm:[0,1,2,3] row_mask:0xf bank_mask:0xf
  v_and_b32_dpp v38, v21, v6 row_ror:4 row_mask:0xf bank_mask:0xf
  v_mfma_f32_16x16x16_bf16 v[12:15], v[34:35], v[200:201], v[12:15]
  v_and_b32_dpp v39, v21, v7 row_ror:12 row_mask:0xf bank_mask:0xf
  v_mov_b64 v[48:49], v[144:145]
  v_mfma_f32_16x16x16_bf16 v[16:19], v[34:35], v[202:203], v[16:19]
  v_mov_b64 v[50:51], v[146:147]
  v_mov_b64 v[52:53], v[200:201]
  v_mfma_f32_16x16x16_bf16 v[12:15], v[36:37], v[56:57], v[12:15]
  v_mov_b64 v[54:55], v[202:203]
  v_accvgpr_read_b32 v60, a12
  v_mfma_f32_16x16x16_bf16 v[16:19], v[36:37], v[58:59], v[16:19]
  v_accvgpr_read_b32 v61, a13
  v_accvgpr_read_b32 v62, a14
  v_mfma_f32_16x16x16_bf16 v[12:15], v[38:39], a[12:13], v[12:15]
  v_accvgpr_read_b32 v63, a15
  s_mov_b32 s70, 274
  v_mfma_f32_16x16x16_bf16 v[16:19], v[38:39], a[14:15], v[16:19]
  s_mov_b32 s71, s43
  s_call_b64 s[74:75], L_enc
  s_nop 1
  v_mov_b64 v[144:145], v[32:33]
  v_mov_b64 v[146:147], v[34:35]
  v_mov_b64 v[200:201], v[36:37]
  v_mov_b64 v[202:203], v[38:39]
  v_accvgpr_write_b32 a128, v40
  v_accvgpr_write_b32 a129, v41
  v_accvgpr_write_b32 a130, v42
  v_accvgpr_write_b32 a131, v43
  s_add_u32 m0, s61, 35840
  v_and_b32_dpp v40, v23, v6 quad_perm:[0,1,2,3] row_mask:0xf bank_mask:0xf
  buffer_load_dwordx4 v2, s[12:15], s72 offen offset:1024 nt lds
  buffer_load_dwordx4 a[132:135], v2, s[12:15], s72 offen offset:2048 nt
  buffer_load_dwordx4 a[148:151], v2, s[12:15], s72 offen offset:3072 nt
  s_xor_b32 s72, s49, 442368
  buffer_load_dwordx4 a[164:167], v2, s[12:15], s72 offen nt
  s_waitcnt vmcnt(13)
  v_and_b32_dpp v41, v23, v7 row_ror:8 row_mask:0xf bank_mask:0xf
  v_and_b32_dpp v42, v22, v6 row_ror:12 row_mask:0xf bank_mask:0xf
  v_and_b32_dpp v43, v22, v7 row_ror:4 row_mask:0xf bank_mask:0xf
  v_mfma_f32_16x16x16_bf16 v[12:15], v[40:41], a[28:29], v[12:15]
  v_and_b32_dpp v44, v23, v6 row_ror:8 row_mask:0xf bank_mask:0xf
  v_and_b32_dpp v45, v23, v7 quad_perm:[0,1,2,3] row_mask:0xf bank_mask:0xf
  v_mfma_f32_16x16x16_bf16 v[16:19], v[40:41], a[30:31], v[16:19]
  v_and_b32_dpp v46, v22, v6 row_ror:4 row_mask:0xf bank_mask:0xf
  v_and_b32_dpp v47, v22, v7 row_ror:12 row_mask:0xf bank_mask:0xf
  v_mfma_f32_16x16x16_bf16 v[12:15], v[42:43], v[240:241], v[12:15]
  v_accvgpr_read_b32 v48, a28
  v_accvgpr_read_b32 v49, a29
  v_mfma_f32_16x16x16_bf16 v[16:19], v[42:43], v[242:243], v[16:19]
  v_accvgpr_read_b32 v50, a30
  v_accvgpr_read_b32 v51, a31
  v_mfma_f32_16x16x16_bf16 v[12:15], v[44:45], a[44:45], v[12:15]
  v_mov_b64 v[52:53], v[240:241]
  v_mov_b64 v[54:55], v[242:243]
  v_mfma_f32_16x16x16_bf16 v[16:19], v[44:45], a[46:47], v[16:19]
  v_accvgpr_read_b32 v56, a44
  v_accvgpr_read_b32 v57, a45
  v_mfma_f32_16x16x16_bf16 v[12:15], v[46:47], a[48:49], v[12:15]
  v_accvgpr_read_b32 v58, a46
  v_accvgpr_read_b32 v59, a47
  v_mfma_f32_16x16x16_bf16 v[16:19], v[46:47], a[50:51], v[16:19]
  v_accvgpr_read_b32 v60, a48
  v_accvgpr_read_b32 v61, a49
  v_accvgpr_read_b32 v62, a50
  v_accvgpr_read_b32 v63, a51
  s_mov_b32 s70, 275
  s_mov_b32 s71, s43
  s_call_b64 s[74:75], L_enc
  s_nop 1
  v_mov_b64 v[240:241], v[32:33]
  v_mov_b64 v[242:243], v[34:35]
  v_accvgpr_write_b32 a168, v36
  v_accvgpr_write_b32 a169, v37
  v_accvgpr_write_b32 a170, v38
  v_accvgpr_write_b32 a171, v39
  v_accvgpr_write_b32 a172, v40
  v_accvgpr_write_b32 a173, v41
  v_accvgpr_write_b32 a174, v42
  v_accvgpr_write_b32 a175, v43
  buffer_load_dwordx4 a[188:191], v2, s[12:15], s72 offen offset:1024 nt
  buffer_load_dwordx4 a[192:195], v2, s[12:15], s72 offen offset:2048 nt
  buffer_load_dwordx4 a[196:199], v2, s[12:15], s72 offen offset:3072 nt
  s_xor_b32 s72, s49, 458752
  s_add_u32 m0, s61, 0
  s_mov_b32 s70, 20
  buffer_load_dwordx4 v1, s[8:11], s72 offen nt lds
  s_waitcnt vmcnt(13)
  ds_read_b128 v[52:55], v3 offset:30720
  ds_read_b128 v[56:59], v3 offset:31744
  v_mfma_f32_16x16x32_bf16 v[32:35], a[52:55], v[8:11], 0
  v_accvgpr_read_b32 v48, a52
  v_accvgpr_read_b32 v49, a53
  v_mfma_f32_16x16x32_bf16 v[44:47], a[96:99], v[8:11], 0
  v_accvgpr_read_b32 v50, a54
  v_accvgpr_read_b32 v51, a55
  v_accvgpr_read_b32 v60, a96
  v_accvgpr_read_b32 v61, a97
  v_accvgpr_read_b32 v62, a98
  v_accvgpr_read_b32 v63, a99
  v_mov_b32_dpp v24, v32 quad_perm:[0,1,2,3] row_mask:0xf bank_mask:0x1
  v_mov_b32_dpp v26, v34 row_ror:8 row_mask:0xf bank_mask:0x1
  s_mov_b32 s71, s42
  s_waitcnt lgkmcnt(0)
  v_mfma_f32_16x16x32_bf16 v[36:39], v[52:55], v[8:11], 0
  v_mfma_f32_16x16x32_bf16 v[40:43], v[56:59], v[8:11], 0
  s_nop 6
  v_mov_b32_dpp v24, v36 row_ror:4 row_mask:0xf bank_mask:0x2
  v_mov_b32_dpp v26, v38 row_ror:12 row_mask:0xf bank_mask:0x2
  s_nop 0
  v_mov_b32_dpp v24, v40 row_ror:8 row_mask:0xf bank_mask:0x4
  v_mov_b32_dpp v26, v42 quad_perm:[0,1,2,3] row_mask:0xf bank_mask:0x4
  s_nop 0
  v_mov_b32_dpp v24, v44 row_ror:12 row_mask:0xf bank_mask:0x8
  v_mov_b32_dpp v26, v46 row_ror:4 row_mask:0xf bank_mask:0x8
  s_nop 0
  v_add_f32_dpp v24, v33, v24 row_ror:12 row_mask:0xf bank_mask:0x1
  v_add_f32_dpp v26, v35, v26 row_ror:4 row_mask:0xf bank_mask:0x1
  s_nop 0
  v_add_f32_dpp v24, v37, v24 quad_perm:[0,1,2,3] row_mask:0xf bank_mask:0x2
  v_add_f32_dpp v26, v39, v26 row_ror:8 row_mask:0xf bank_mask:0x2
  s_nop 0
  v_add_f32_dpp v24, v41, v24 row_ror:4 row_mask:0xf bank_mask:0x4
  v_add_f32_dpp v26, v43, v26 row_ror:12 row_mask:0xf bank_mask:0x4
  s_nop 0
  v_add_f32_dpp v24, v45, v24 row_ror:8 row_mask:0xf bank_mask:0x8
  v_add_f32_dpp v26, v47, v26 quad_perm:[0,1,2,3] row_mask:0xf bank_mask:0x8
  s_call_b64 s[74:75], L_enc
  s_nop 1
  v_accvgpr_write_b32 a200, v32
  v_accvgpr_write_b32 a201, v33
  v_accvgpr_write_b32 a202, v34
  v_accvgpr_write_b32 a203, v35
  v_accvgpr_write_b32 a216, v36
  v_accvgpr_write_b32 a217, v37
  v_accvgpr_write_b32 a218, v38
  v_accvgpr_write_b32 a219, v39
  v_accvgpr_write_b32 a232, v40
  v_accvgpr_write_b32 a233, v41
  v_accvgpr_write_b32 a234, v42
  v_accvgpr_write_b32 a235, v43
  s_add_u32 m0, s61, 0
  s_mov_b32 s70, 21
  buffer_load_dwordx4 v1, s[8:11], s72 offen offset:1024 nt lds
  s_add_u32 m0, s61, 0
  s_mov_b32 s71, s42
  buffer_load_dwordx4 v1, s[8:11], s72 offen offset:2048 nt lds
  s_add_u32 m0, s61, 0
  s_nop 0
  buffer_load_dwordx4 v1, s[8:11], s72 offen offset:3072 nt lds
  s_xor_b32 s72, s49, 475136
  s_add_u32 m0, s61, 4096
  s_nop 0
  buffer_load_dwordx4 v1, s[8:11], s72 offen nt lds
  s_waitcnt vmcnt(13)
  v_mfma_f32_16x16x32_bf16 v[32:35], a[100:103], v[8:11], 0
  v_accvgpr_read_b32 v48, a100
  v_accvgpr_read_b32 v49, a101
  v_mfma_f32_16x16x32_bf16 v[36:39], v[132:135], v[8:11], 0
  v_accvgpr_read_b32 v50, a102
  v_accvgpr_read_b32 v51, a103
  v_mfma_f32_16x16x32_bf16 v[40:43], v[136:139], v[8:11], 0
  v_mov_b64 v[52:53], v[132:133]
  v_mov_b64 v[54:55], v[134:135]
  v_mfma_f32_16x16x32_bf16 v[44:47], v[140:143], v[8:11], 0
  v_mov_b64 v[56:57], v[136:137]
  v_mov_b64 v[58:59], v[138:139]
  v_mov_b64 v[60:61], v[140:141]
  v_mov_b64 v[62:63], v[142:143]
  v_mov_b32_dpp v25, v32 quad_perm:[0,1,2,3] row_mask:0xf bank_mask:0x1
  v_mov_b32_dpp v27, v34 row_ror:8 row_mask:0xf bank_mask:0x1
  s_nop 0
  v_mov_b32_dpp v25, v36 row_ror:4 row_mask:0xf bank_mask:0x2
  v_mov_b32_dpp v27, v38 row_ror:12 row_mask:0xf bank_mask:0x2
  s_nop 0
  v_mov_b32_dpp v25, v40 row_ror:8 row_mask:0xf bank_mask:0x4
  v_mov_b32_dpp v27, v42 quad_perm:[0,1,2,3] row_mask:0xf bank_mask:0x4
  s_nop 0
  v_mov_b32_dpp v25, v44 row_ror:12 row_mask:0xf bank_mask:0x8
  v_mov_b32_dpp v27, v46 row_ror:4 row_mask:0xf bank_mask:0x8
  s_nop 0
  v_add_f32_dpp v25, v33, v25 row_ror:12 row_mask:0xf bank_mask:0x1
  v_add_f32_dpp v27, v35, v27 row_ror:4 row_mask:0xf bank_mask:0x1
  s_nop 0
  v_add_f32_dpp v25, v37, v25 quad_perm:[0,1,2,3] row_mask:0xf bank_mask:0x2
  v_add_f32_dpp v27, v39, v27 row_ror:8 row_mask:0xf bank_mask:0x2
  s_nop 0
  v_add_f32_dpp v25, v41, v25 row_ror:4 row_mask:0xf bank_mask:0x4
  v_add_f32_dpp v27, v43, v27 row_ror:12 row_mask:0xf bank_mask:0x4
  s_nop 0
  v_add_f32_dpp v25, v45, v25 row_ror:8 row_mask:0xf bank_mask:0x8
  v_add_f32_dpp v27, v47, v27 quad_perm:[0,1,2,3] row_mask:0xf bank_mask:0x8
  s_call_b64 s[74:75], L_enc
  s_nop 1
  ds_write_b128 v3, v[32:35] offset:30720
  v_mov_b64 v[132:133], v[36:37]
  v_mov_b64 v[134:135], v[38:39]
  v_mov_b64 v[136:137], v[40:41]
  v_mov_b64 v[138:139], v[42:43]
  s_add_u32 m0, s61, 4096
  v_add_f32 v24, v24, v26
  buffer_load_dwordx4 v1, s[8:11], s72 offen offset:1024 nt lds
  buffer_load_dwordx4 a[12:15], v1, s[8:11], s72 offen offset:2048 nt
  buffer_load_dwordx4 a[28:31], v1, s[8:11], s72 offen offset:3072 nt
  s_xor_b32 s72, s49, 458752
  buffer_load_dwordx4 a[44:47], v2, s[12:15], s72 offen nt
  s_waitcnt vmcnt(13)
  ds_read_b128 v[52:55], v3 offset:36864
  v_add_f32 v25, v25, v27
  v_cvt_pk_bf16_f32 v32, v24, v25
  v_lshlrev_b32 v24, 16, v32
  v_and_b32 v25, 0xffff0000, v32
  v_pk_mul_f32 v[24:25], v[24:25], s[56:57] op_sel_hi:[1,0]
  v_cvt_pk_bf16_f32 v32, v24, v25
  v_lshlrev_b32 v24, 16, v32
  v_and_b32 v25, 0xffff0000, v32
  v_pk_add_f32 v[26:27], v[24:25], v[4:5] op_sel_hi:[1,0] neg_lo:[0,1] neg_hi:[0,1]
  v_pk_mul_f32 v[26:27], v[26:27], s[56:57] op_sel:[0,1] op_sel_hi:[1,1]
  v_max_f32 v20, v26, v27
  v_cmp_lt_f32 vcc, 0, v20
  s_getpc_b64 s[74:75]
  s_cbranch_vccnz L_remax
  v_exp_f32 v26, v26
  v_exp_f32 v27, v27
  v_cvt_pk_bf16_f32 v20, v26, 0
  v_add_f32 v32, v26, v27
  v_cvt_pk_bf16_f32 v21, v26, 0
  v_cvt_pk_bf16_f32 v23, v27, 0
  v_cvt_pk_bf16_f32 v22, v27, 0
  v_cvt_pk_bf16_f32 v24, 0, v26
  v_cvt_pk_bf16_f32 v25, 0, v27
  v_add_f32 v5, v5, v32
  v_mov_b32_dpp v20, v24 row_ror:4 row_mask:0xf bank_mask:0xa
  v_mov_b32_dpp v21, v24 row_ror:4 row_mask:0xf bank_mask:0x5
  v_mov_b32_dpp v23, v25 row_ror:4 row_mask:0xf bank_mask:0xa
  v_mov_b32_dpp v22, v25 row_ror:4 row_mask:0xf bank_mask:0x5
  v_and_b32_dpp v32, v20, v6 quad_perm:[0,1,2,3] row_mask:0xf bank_mask:0xf
  v_and_b32_dpp v33, v20, v7 row_ror:8 row_mask:0xf bank_mask:0xf
  v_and_b32_dpp v34, v21, v6 row_ror:12 row_mask:0xf bank_mask:0xf
  v_and_b32_dpp v35, v21, v7 row_ror:4 row_mask:0xf bank_mask:0xf
  v_mfma_f32_16x16x16_bf16 v[12:15], v[32:33], a[124:125], v[12:15]
  s_waitcnt lgkmcnt(0)
  v_and_b32_dpp v36, v20, v6 row_ror:8 row_mask:0xf bank_mask:0xf
  v_mfma_f32_16x16x16_bf16 v[16:19], v[32:33], a[126:127], v[16:19]
  v_and_b32_dpp v37, v20, v7 quad_perm:[0,1,2,3] row_mask:0xf bank_mask:0xf
  v_and_b32_dpp v38, v21, v6 row_ror:4 row_mask:0xf bank_mask:0xf
  v_mfma_f32_16x16x16_bf16 v[12:15], v[34:35], v[52:53], v[12:15]
  v_and_b32_dpp v39, v21, v7 row_ror:12 row_mask:0xf bank_mask:0xf
  v_accvgpr_read_b32 v48, a124
  v_mfma_f32_16x16x16_bf16 v[16:19], v[34:35], v[54:55], v[16:19]
  v_accvgpr_read_b32 v49, a125
  v_accvgpr_read_b32 v50, a126
  v_mfma_f32_16x16x16_bf16 v[12:15], v[36:37], a[132:133], v[12:15]
  v_accvgpr_read_b32 v51, a127
  v_accvgpr_read_b32 v56, a132
  v_mfma_f32_16x16x16_bf16 v[16:19], v[36:37], a[134:135], v[16:19]
  v_accvgpr_read_b32 v57, a133
  v_accvgpr_read_b32 v58, a134
  v_mfma_f32_16x16x16_bf16 v[12:15], v[38:39], a[148:149], v[12:15]
  v_accvgpr_read_b32 v59, a135
  v_accvgpr_read_b32 v60, a148
  v_mfma_f32_16x16x16_bf16 v[16:19], v[38:39], a[150:151], v[16:19]
  v_accvgpr_read_b32 v61, a149
  v_accvgpr_read_b32 v62, a150
  v_accvgpr_read_b32 v63, a151
  s_mov_b32 s70, 276
  s_mov_b32 s71, s43
  s_call_b64 s[74:75], L_enc
  s_nop 1
  ds_write_b128 v3, v[36:39] offset:31744
  ds_write_b128 v3, v[40:43] offset:36864
  v_mov_b64 v[140:141], v[32:33]
  v_mov_b64 v[142:143], v[34:35]
  buffer_load_dwordx4 a[48:51], v2, s[12:15], s72 offen offset:1024 nt
  buffer_load_dwordx4 a[52:55], v2, s[12:15], s72 offen offset:2048 nt
  buffer_load_dwordx4 a[96:99], v2, s[12:15], s72 offen offset:3072 nt
  s_xor_b32 s72, s49, 475136
  buffer_load_dwordx4 a[100:103], v2, s[12:15], s72 offen nt
  s_waitcnt vmcnt(13)
  v_and_b32_dpp v40, v23, v6 quad_perm:[0,1,2,3] row_mask:0xf bank_mask:0xf
  v_and_b32_dpp v41, v23, v7 row_ror:8 row_mask:0xf bank_mask:0xf
  v_and_b32_dpp v42, v22, v6 row_ror:12 row_mask:0xf bank_mask:0xf
  v_and_b32_dpp v43, v22, v7 row_ror:4 row_mask:0xf bank_mask:0xf
  v_mfma_f32_16x16x16_bf16 v[12:15], v[40:41], a[164:165], v[12:15]
  v_and_b32_dpp v44, v23, v6 row_ror:8 row_mask:0xf bank_mask:0xf
  v_and_b32_dpp v45, v23, v7 quad_perm:[0,1,2,3] row_mask:0xf bank_mask:0xf
  v_mfma_f32_16x16x16_bf16 v[16:19], v[40:41], a[166:167], v[16:19]
  v_and_b32_dpp v46, v22, v6 row_ror:4 row_mask:0xf bank_mask:0xf
  v_and_b32_dpp v47, v22, v7 row_ror:12 row_mask:0xf bank_mask:0xf
  v_mfma_f32_16x16x16_bf16 v[12:15], v[42:43], a[188:189], v[12:15]
  buffer_load_dwordx4 a[124:127], v2, s[12:15], s72 offen offset:1024 nt
  buffer_load_dwordx4 a[132:135], v2, s[12:15], s72 offen offset:2048 nt
  v_mfma_f32_16x16x16_bf16 v[16:19], v[42:43], a[190:191], v[16:19]
  buffer_load_dwordx4 a[148:151], v2, s[12:15], s72 offen offset:3072 nt
  s_waitcnt vmcnt(12)
  v_mfma_f32_16x16x16_bf16 v[12:15], v[44:45], a[192:193], v[12:15]
  ds_read_b128 v[48:51], v3
  ds_read_b128 v[52:55], v3 offset:1024
  v_mfma_f32_16x16x16_bf16 v[16:19], v[44:45], a[194:195], v[16:19]
  ds_read_b128 v[56:59], v3 offset:2048
  ds_read_b128 v[60:63], v3 offset:3072
  v_mfma_f32_16x16x16_bf16 v[12:15], v[46:47], a[196:197], v[12:15]
  s_waitcnt vmcnt(8)
  s_waitcnt vmcnt(4)
  v_mfma_f32_16x16x16_bf16 v[16:19], v[46:47], a[198:199], v[16:19]
  s_waitcnt lgkmcnt(0)
  v_mfma_f32_16x16x32_bf16 v[32:35], v[48:51], v[8:11], 0
  ds_read_b128 v[48:51], v3 offset:4096
  s_waitcnt vmcnt(0)
  v_mfma_f32_16x16x32_bf16 v[36:39], v[52:55], v[8:11], 0
  ds_read_b128 v[52:55], v3 offset:5120
  v_mfma_f32_16x16x32_bf16 v[40:43], v[56:59], v[8:11], 0
  v_mfma_f32_16x16x32_bf16 v[44:47], v[60:63], v[8:11], 0
  s_nop 1
  v_mov_b32_dpp v24, v32 quad_perm:[0,1,2,3] row_mask:0xf bank_mask:0x1
  v_mov_b32_dpp v26, v34 row_ror:8 row_mask:0xf bank_mask:0x1
  s_nop 0
  v_mov_b32_dpp v24, v36 row_ror:4 row_mask:0xf bank_mask:0x2
  v_mov_b32_dpp v26, v38 row_ror:12 row_mask:0xf bank_mask:0x2
  s_nop 0
  v_mov_b32_dpp v24, v40 row_ror:8 row_mask:0xf bank_mask:0x4
  v_mov_b32_dpp v26, v42 quad_perm:[0,1,2,3] row_mask:0xf bank_mask:0x4
  s_nop 0
  v_mov_b32_dpp v24, v44 row_ror:12 row_mask:0xf bank_mask:0x8
  v_mov_b32_dpp v26, v46 row_ror:4 row_mask:0xf bank_mask:0x8
  s_nop 0
  v_add_f32_dpp v24, v33, v24 row_ror:12 row_mask:0xf bank_mask:0x1
  v_add_f32_dpp v26, v35, v26 row_ror:4 row_mask:0xf bank_mask:0x1
  s_nop 0
  v_add_f32_dpp v24, v37, v24 quad_perm:[0,1,2,3] row_mask:0xf bank_mask:0x2
  v_add_f32_dpp v26, v39, v26 row_ror:8 row_mask:0xf bank_mask:0x2
  s_nop 0
  v_add_f32_dpp v24, v41, v24 row_ror:4 row_mask:0xf bank_mask:0x4
  v_add_f32_dpp v26, v43, v26 row_ror:12 row_mask:0xf bank_mask:0x4
  v_mfma_f32_16x16x32_bf16 v[40:43], a[12:15], v[8:11], 0
  v_add_f32_dpp v24, v45, v24 row_ror:8 row_mask:0xf bank_mask:0x8
  v_add_f32_dpp v26, v47, v26 quad_perm:[0,1,2,3] row_mask:0xf bank_mask:0x8
  v_mfma_f32_16x16x32_bf16 v[44:47], a[28:31], v[8:11], 0
  s_waitcnt lgkmcnt(0)
  v_add_f32 v24, v24, v26
  v_mfma_f32_16x16x32_bf16 v[32:35], v[48:51], v[8:11], 0
  v_mfma_f32_16x16x32_bf16 v[36:39], v[52:55], v[8:11], 0
  s_nop 6
  v_mov_b32_dpp v25, v32 quad_perm:[0,1,2,3] row_mask:0xf bank_mask:0x1
  v_mov_b32_dpp v27, v34 row_ror:8 row_mask:0xf bank_mask:0x1
  s_nop 0
  v_mov_b32_dpp v25, v36 row_ror:4 row_mask:0xf bank_mask:0x2
  v_mov_b32_dpp v27, v38 row_ror:12 row_mask:0xf bank_mask:0x2
  s_nop 0
  v_mov_b32_dpp v25, v40 row_ror:8 row_mask:0xf bank_mask:0x4
  v_mov_b32_dpp v27, v42 quad_perm:[0,1,2,3] row_mask:0xf bank_mask:0x4
  s_nop 0
  v_mov_b32_dpp v25, v44 row_ror:12 row_mask:0xf bank_mask:0x8
  v_mov_b32_dpp v27, v46 row_ror:4 row_mask:0xf bank_mask:0x8
  s_nop 0
  v_add_f32_dpp v25, v33, v25 row_ror:12 row_mask:0xf bank_mask:0x1
  v_add_f32_dpp v27, v35, v27 row_ror:4 row_mask:0xf bank_mask:0x1
  s_nop 0
  v_add_f32_dpp v25, v37, v25 quad_perm:[0,1,2,3] row_mask:0xf bank_mask:0x2
  v_add_f32_dpp v27, v39, v27 row_ror:8 row_mask:0xf bank_mask:0x2
  s_nop 0
  v_add_f32_dpp v25, v41, v25 row_ror:4 row_mask:0xf bank_mask:0x4
  v_add_f32_dpp v27, v43, v27 row_ror:12 row_mask:0xf bank_mask:0x4
  s_nop 0
  v_add_f32_dpp v25, v45, v25 row_ror:8 row_mask:0xf bank_mask:0x8
  v_add_f32_dpp v27, v47, v27 quad_perm:[0,1,2,3] row_mask:0xf bank_mask:0x8
  v_add_f32 v25, v25, v27
  v_cvt_pk_bf16_f32 v32, v24, v25
  v_lshlrev_b32 v24, 16, v32
  v_and_b32 v25, 0xffff0000, v32
  v_pk_mul_f32 v[24:25], v[24:25], s[56:57] op_sel_hi:[1,0]
  v_cvt_pk_bf16_f32 v32, v24, v25
  v_lshlrev_b32 v24, 16, v32
  v_and_b32 v25, 0xffff0000, v32
  v_pk_add_f32 v[26:27], v[24:25], v[4:5] op_sel_hi:[1,0] neg_lo:[0,1] neg_hi:[0,1]
  v_pk_mul_f32 v[26:27], v[26:27], s[56:57] op_sel:[0,1] op_sel_hi:[1,1]
  v_max_f32 v20, v26, v27
  v_cmp_lt_f32 vcc, 0, v20
  s_getpc_b64 s[74:75]
  s_cbranch_vccnz L_remax
  v_exp_f32 v26, v26
  v_exp_f32 v27, v27
  v_cvt_pk_bf16_f32 v20, v26, 0
  v_add_f32 v32, v26, v27
  v_cvt_pk_bf16_f32 v21, v26, 0
  v_cvt_pk_bf16_f32 v23, v27, 0
  v_cvt_pk_bf16_f32 v22, v27, 0
  v_cvt_pk_bf16_f32 v24, 0, v26
  v_cvt_pk_bf16_f32 v25, 0, v27
  v_add_f32 v5, v5, v32
  v_mov_b32_dpp v20, v24 row_ror:4 row_mask:0xf bank_mask:0xa
  v_mov_b32_dpp v21, v24 row_ror:4 row_mask:0xf bank_mask:0x5
  v_mov_b32_dpp v23, v25 row_ror:4 row_mask:0xf bank_mask:0xa
  v_mov_b32_dpp v22, v25 row_ror:4 row_mask:0xf bank_mask:0x5
  v_and_b32_dpp v32, v20, v6 quad_perm:[0,1,2,3] row_mask:0xf bank_mask:0xf
  v_and_b32_dpp v33, v20, v7 row_ror:8 row_mask:0xf bank_mask:0xf
  v_and_b32_dpp v34, v21, v6 row_ror:12 row_mask:0xf bank_mask:0xf
  v_and_b32_dpp v35, v21, v7 row_ror:4 row_mask:0xf bank_mask:0xf
  v_mfma_f32_16x16x16_bf16 v[12:15], v[32:33], a[44:45], v[12:15]
  v_and_b32_dpp v36, v20, v6 row_ror:8 row_mask:0xf bank_mask:0xf
  v_and_b32_dpp v37, v20, v7 quad_perm:[0,1,2,3] row_mask:0xf bank_mask:0xf
  v_mfma_f32_16x16x16_bf16 v[16:19], v[32:33], a[46:47], v[16:19]
  v_and_b32_dpp v38, v21, v6 row_ror:4 row_mask:0xf bank_mask:0xf
  v_and_b32_dpp v39, v21, v7 row_ror:12 row_mask:0xf bank_mask:0xf
  v_mfma_f32_16x16x16_bf16 v[12:15], v[34:35], a[48:49], v[12:15]
  v_and_b32_dpp v40, v23, v6 quad_perm:[0,1,2,3] row_mask:0xf bank_mask:0xf
  v_and_b32_dpp v41, v23, v7 row_ror:8 row_mask:0xf bank_mask:0xf
  v_mfma_f32_16x16x16_bf16 v[16:19], v[34:35], a[50:51], v[16:19]
  v_and_b32_dpp v42, v22, v6 row_ror:12 row_mask:0xf bank_mask:0xf
  v_and_b32_dpp v43, v22, v7 row_ror:4 row_mask:0xf bank_mask:0xf
  v_mfma_f32_16x16x16_bf16 v[12:15], v[36:37], a[52:53], v[12:15]
  v_and_b32_dpp v44, v23, v6 row_ror:8 row_mask:0xf bank_mask:0xf
  v_and_b32_dpp v45, v23, v7 quad_perm:[0,1,2,3] row_mask:0xf bank_mask:0xf
  v_mfma_f32_16x16x16_bf16 v[16:19], v[36:37], a[54:55], v[16:19]
  v_and_b32_dpp v46, v22, v6 row_ror:4 row_mask:0xf bank_mask:0xf
  v_and_b32_dpp v47, v22, v7 row_ror:12 row_mask:0xf bank_mask:0xf
  v_mfma_f32_16x16x16_bf16 v[12:15], v[38:39], a[96:97], v[12:15]
  v_mfma_f32_16x16x16_bf16 v[16:19], v[38:39], a[98:99], v[16:19]
  v_mfma_f32_16x16x16_bf16 v[12:15], v[40:41], a[100:101], v[12:15]
  v_mfma_f32_16x16x16_bf16 v[16:19], v[40:41], a[102:103], v[16:19]
  v_mfma_f32_16x16x16_bf16 v[12:15], v[42:43], a[124:125], v[12:15]
  v_mfma_f32_16x16x16_bf16 v[16:19], v[42:43], a[126:127], v[16:19]
  v_mfma_f32_16x16x16_bf16 v[12:15], v[44:45], a[132:133], v[12:15]
  v_mfma_f32_16x16x16_bf16 v[16:19], v[44:45], a[134:135], v[16:19]
  v_mfma_f32_16x16x16_bf16 v[12:15], v[46:47], a[148:149], v[12:15]
  v_mfma_f32_16x16x16_bf16 v[16:19], v[46:47], a[150:151], v[16:19]
  s_branch L_vdel
  s_nop 9
L_enc:
  s_cmp_lg_u32 s5, 0
  s_cbranch_scc1 L_encret
  s_add_u32 s76, s71, 0x00800080
  s_sub_u32 s77, 0x10000, s76
L_enc2:
  v_and_b32 v32, s69, v48
  v_and_b32 v33, s69, v49
  v_and_b32 v34, s69, v50
  v_and_b32 v35, s69, v51
  v_pk_sub_u16 v28, v32, s76
  v_pk_sub_u16 v29, v33, s76
  v_pk_sub_u16 v30, v34, s76
  v_pk_max_u16 v28, v28, v29
  v_pk_sub_u16 v29, v35, s76
  v_pk_max_u16 v28, v28, v30
  v_pk_max_u16 v28, v28, v29
  v_pk_sub_u16 v28, v28, s77 clamp
  v_cmp_ne_u32 s[78:79], 0, v28
  v_and_b32 v36, s69, v52
  v_and_b32 v37, s69, v53
  v_and_b32 v38, s69, v54
  v_and_b32 v39, s69, v55
  v_pk_sub_u16 v28, v36, s76
  v_pk_sub_u16 v29, v37, s76
  v_pk_sub_u16 v30, v38, s76
  v_pk_max_u16 v28, v28, v29
  v_pk_sub_u16 v29, v39, s76
  v_pk_max_u16 v28, v28, v30
  v_pk_max_u16 v28, v28, v29
  v_pk_sub_u16 v28, v28, s77 clamp
  v_cmp_ne_u32 s[80:81], 0, v28
  v_and_b32 v40, s69, v56
  v_and_b32 v41, s69, v57
  v_and_b32 v42, s69, v58
  v_and_b32 v43, s69, v59
  v_pk_sub_u16 v28, v40, s76
  v_pk_sub_u16 v29, v41, s76
  v_pk_sub_u16 v30, v42, s76
  v_pk_max_u16 v28, v28, v29
  v_pk_sub_u16 v29, v43, s76
  v_pk_max_u16 v28, v28, v30
  v_pk_max_u16 v28, v28, v29
  v_pk_sub_u16 v28, v28, s77 clamp
  v_cmp_ne_u32 s[82:83], 0, v28
  v_and_b32 v44, s69, v60
  v_and_b32 v45, s69, v61
  v_and_b32 v46, s69, v62
  v_and_b32 v47, s69, v63
  v_pk_sub_u16 v28, v44, s76
  v_pk_sub_u16 v29, v45, s76
  v_pk_sub_u16 v30, v46, s76
  v_pk_max_u16 v28, v28, v29
  v_pk_sub_u16 v29, v47, s76
  v_pk_max_u16 v28, v28, v30
  v_pk_max_u16 v28, v28, v29
  v_pk_sub_u16 v28, v28, s77 clamp
  v_cmp_ne_u32 s[84:85], 0, v28
  s_or_b64 vcc, s[78:79], s[80:81]
  s_or_b64 s[86:87], s[82:83], s[84:85]
  s_or_b64 vcc, vcc, s[86:87]
  s_cbranch_scc1 L_encx
L_encB:
  v_pk_sub_u16 v32, v32, s71 clamp
  v_pk_sub_u16 v33, v33, s71 clamp
  v_pk_sub_u16 v34, v34, s71 clamp
  v_pk_sub_u16 v35, v35, s71 clamp
  v_bfi_b32 v32, s69, v32, v48
  v_bfi_b32 v33, s69, v33, v49
  v_bfi_b32 v34, s69, v34, v50
  v_bfi_b32 v35, s69, v35, v51
  v_perm_b32 v28, v33, v32, s68
  v_perm_b32 v29, v35, v34, s68
  v_perm_b32 v32, v33, v32, s67
  v_perm_b32 v33, v35, v34, s67
  v_or_b32 v30, v28, v29
  v_alignbit_b32 v29, v29, v29, 28
  v_pk_sub_u16 v36, v36, s71 clamp
  v_pk_sub_u16 v37, v37, s71 clamp
  v_pk_sub_u16 v38, v38, s71 clamp
  v_pk_sub_u16 v39, v39, s71 clamp
  v_bfi_b32 v34, s64, v28, v29
  v_bfi_b32 v36, s69, v36, v52
  v_bfi_b32 v37, s69, v37, v53
  v_bfi_b32 v38, s69, v38, v54
  v_bfi_b32 v39, s69, v39, v55
  v_perm_b32 v28, v37, v36, s68
  v_perm_b32 v29, v39, v38, s68
  v_perm_b32 v36, v37, v36, s67
  v_perm_b32 v37, v39, v38, s67
  v_or3_b32 v30, v30, v28, v29
  v_alignbit_b32 v29, v29, v29, 28
  v_pk_sub_u16 v40, v40, s71 clamp
  v_pk_sub_u16 v41, v41, s71 clamp
  v_pk_sub_u16 v42, v42, s71 clamp
  v_pk_sub_u16 v43, v43, s71 clamp
  v_bfi_b32 v35, s64, v28, v29
  v_bfi_b32 v40, s69, v40, v56
  v_bfi_b32 v41, s69, v41, v57
  v_bfi_b32 v42, s69, v42, v58
  v_bfi_b32 v43, s69, v43, v59
  v_perm_b32 v28, v41, v40, s68
  v_perm_b32 v29, v43, v42, s68
  v_perm_b32 v38, v41, v40, s67
  v_perm_b32 v39, v43, v42, s67
  v_or3_b32 v30, v30, v28, v29
  v_alignbit_b32 v29, v29, v29, 28
  v_pk_sub_u16 v44, v44, s71 clamp
  v_pk_sub_u16 v45, v45, s71 clamp
  v_pk_sub_u16 v46, v46, s71 clamp
  v_pk_sub_u16 v47, v47, s71 clamp
  v_bfi_b32 v40, s64, v28, v29
  v_bfi_b32 v44, s69, v44, v60
  v_bfi_b32 v45, s69, v45, v61
  v_bfi_b32 v46, s69, v46, v62
  v_bfi_b32 v47, s69, v47, v63
  v_perm_b32 v28, v45, v44, s68
  v_perm_b32 v29, v47, v46, s68
  v_perm_b32 v42, v45, v44, s67
  v_perm_b32 v43, v47, v46, s67
  v_or3_b32 v30, v30, v28, v29
  v_alignbit_b32 v29, v29, v29, 28
  v_bfi_b32 v41, s64, v28, v29
  v_and_b32 v30, 0x78787878, v30
  v_cmp_ne_u32 vcc, 0, v30
  s_nop 0
  s_cbranch_vccnz L_encxa
L_encret:
  s_setpc_b64 s[74:75]
L_encxa:
  s_mov_b64 s[78:79], vcc
  s_mov_b64 s[80:81], vcc
  s_mov_b64 s[82:83], vcc
  s_mov_b64 s[84:85], vcc
  s_bitset1_b32 s70, 9
L_encx:
L_encu:
  s_cmp_lg_u64 s[78:79], 0
  s_cbranch_scc1 L_ej0
  s_cmp_lg_u64 s[80:81], 0
  s_cbranch_scc1 L_ej1
  s_cmp_lg_u64 s[82:83], 0
  s_cbranch_scc1 L_ej2
  s_cmp_lg_u64 s[84:85], 0
  s_cbranch_scc1 L_ej3
  s_branch L_ence
L_ej0:
  s_mov_b32 s73, 0
  s_ff1_i32_b64 s51, s[78:79]
  s_bitset0_b64 s[78:79], s51
  s_branch L_eb
L_ej1:
  s_mov_b32 s73, 4
  s_ff1_i32_b64 s51, s[80:81]
  s_bitset0_b64 s[80:81], s51
  s_branch L_eb
L_ej2:
  s_mov_b32 s73, 8
  s_ff1_i32_b64 s51, s[82:83]
  s_bitset0_b64 s[82:83], s51
  s_branch L_eb
L_ej3:
  s_mov_b32 s73, 12
  s_ff1_i32_b64 s51, s[84:85]
  s_bitset0_b64 s[84:85], s51
L_eb:
  s_lshl_b64 exec, 1, s51
  s_set_gpr_idx_on s73, 0x1
  v_readfirstlane_b32 s92, v48
  v_readfirstlane_b32 s93, v49
  v_readfirstlane_b32 s94, v50
  v_readfirstlane_b32 s95, v51
  s_set_gpr_idx_off
  s_and_b32 s60, s51, 48
  s_bitcmp1_b32 s70, 8
  s_cbranch_scc1 L_epv
  s_and_b32 s63, s51, 12
  s_lshl_b32 s62, s60, 10
  s_or_b32 s63, s63, s62
  s_and_b32 s62, s51, 3
  s_branch L_epk
L_epv:
  s_lshr_b32 s63, s60, 2
  s_and_b32 s62, s51, 15
L_epk:
  s_lshl_b32 s62, s62, 12
  s_or_b32 s63, s63, s62
  s_lshr_b32 s62, s73, 2
  s_or_b32 s63, s63, s62
  s_and_b32 s62, s70, 31
  s_lshl4_add_u32 s63, s62, s63
  s_bitcmp1_b32 s70, 9
  s_cbranch_scc1 L_efull
  s_sub_u32 s77, 0x80008000, s76
  s_and_b32 s96, s92, s69
  s_and_b32 s97, s93, s69
  s_add_u32 s98, s96, s77
  s_add_u32 s99, s97, s77
  s_add_u32 s96, s96, s69
  s_add_u32 s97, s97, s69
  s_andn2_b64 s[100:101], s[96:97], s[98:99]
  s_and_b32 s100, s100, 0x80008000
  s_and_b32 s101, s101, 0x80008000
  s_lshr_b64 s[100:101], s[100:101], 15
  s_and_b32 s96, s94, s69
  s_and_b32 s97, s95, s69
  s_add_u32 s98, s96, s77
  s_add_u32 s99, s97, s77
  s_add_u32 s96, s96, s69
  s_add_u32 s97, s97, s69
  s_andn2_b64 s[86:87], s[96:97], s[98:99]
  s_and_b32 s86, s86, 0x80008000
  s_and_b32 s87, s87, 0x80008000
  s_lshr_b64 s[86:87], s[86:87], 11
  s_or_b64 s[86:87], s[86:87], s[100:101]
  s_lshl2_add_u32 s52, s87, s86
  s_lshr_b32 s60, s52, 15
  s_or_b32 s52, s52, s60
  s_and_b32 s52, s52, 0xff
  s_branch L_ence1
L_efull:
  s_and_b32 s77, s76, 0xffff
  s_mov_b32 s52, 0
  s_bfe_u32 s60, s95, 0xf0010
  s_cselect_b32 s62, s77, 0
  s_cselect_b32 s60, s60, 1
  s_sub_u32 s60, s60, s62
  s_cmp_ge_u32 s60, 1920
  s_addc_u32 s52, s52, s52
  s_bfe_u32 s60, s95, 0xf0000
  s_cselect_b32 s62, s77, 0
  s_cselect_b32 s60, s60, 1
  s_sub_u32 s60, s60, s62
  s_cmp_ge_u32 s60, 1920
  s_addc_u32 s52, s52, s52
  s_bfe_u32 s60, s94, 0xf0010
  s_cselect_b32 s62, s77, 0
  s_cselect_b32 s60, s60, 1
  s_sub_u32 s60, s60, s62
  s_cmp_ge_u32 s60, 1920
  s_addc_u32 s52, s52, s52
  s_bfe_u32 s60, s94, 0xf0000
  s_cselect_b32 s62, s77, 0
  s_cselect_b32 s60, s60, 1
  s_sub_u32 s60, s60, s62
  s_cmp_ge_u32 s60, 1920
  s_addc_u32 s52, s52, s52
  s_bfe_u32 s60, s93, 0xf0010
  s_cselect_b32 s62, s77, 0
  s_cselect_b32 s60, s60, 1
  s_sub_u32 s60, s60, s62
  s_cmp_ge_u32 s60, 1920
  s_addc_u32 s52, s52, s52
  s_bfe_u32 s60, s93, 0xf0000
  s_cselect_b32 s62, s77, 0
  s_cselect_b32 s60, s60, 1
  s_sub_u32 s60, s60, s62
  s_cmp_ge_u32 s60, 1920
  s_addc_u32 s52, s52, s52
  s_bfe_u32 s60, s92, 0xf0010
  s_cselect_b32 s62, s77, 0
  s_cselect_b32 s60, s60, 1
  s_sub_u32 s60, s60, s62
  s_cmp_ge_u32 s60, 1920
  s_addc_u32 s52, s52, s52
  s_bfe_u32 s60, s92, 0xf0000
  s_cselect_b32 s62, s77, 0
  s_cselect_b32 s60, s60, 1
  s_sub_u32 s60, s60, s62
  s_cmp_ge_u32 s60, 1920
  s_addc_u32 s52, s52, s52
L_ence1:
  s_ff1_i32_b32 s60, s52
  s_cmp_lt_i32 s60, 0
  s_cbranch_scc1 L_encu
  s_bitset0_b32 s52, s60
  s_lshr_b32 m0, s60, 1
  s_lshl_b32 s51, s60, 9
  s_movrels_b32 s62, s92
  s_or_b32 s51, s51, s63
  s_lshl_b32 s86, s62, 16
  s_andn2_b32 s62, s62, 0xffff
  s_bitcmp1_b32 s60, 0
  s_cselect_b32 s62, s62, s86
  s_cselect_b32 s86, 0, -1
  s_xor_b32 s86, s86, 0xffff
  s_or_b32 s62, s62, s51
  s_lshr_b32 s60, s60, 1
  s_add_u32 s60, s60, s73
  s_set_gpr_idx_on s60, 0xa
  v_and_b32 v48, s86, v48
  v_and_b32 v32, s86, v32
  s_set_gpr_idx_off
  s_add_u32 s60, s50, s0
  s_cmp_ge_u32 s60, 63
  s_cbranch_scc1 L_encfail
  s_sub_u32 s60, 63, s0
  s_bitcmp1_b32 s70, 8
  s_cselect_b32 m0, s60, s50
  s_cselect_b32 s60, 1, 0
  s_add_u32 s0, s0, s60
  s_xor_b32 s60, s60, 1
  s_add_u32 s50, s50, s60
  v_writelane_b32 v31, s62, m0
  s_cmp_lg_u32 s52, 0
  s_cbranch_scc1 L_ence1
  s_or_b64 s[86:87], s[78:79], s[80:81]
  s_or_b64 s[96:97], s[82:83], s[84:85]
  s_or_b64 s[86:87], s[86:87], s[96:97]
  s_cbranch_scc1 L_encu
L_ence:
  s_mov_b64 exec, -1
  s_bitcmp0_b32 s70, 9
  s_cbranch_scc1 L_encB
  s_bitset0_b32 s70, 9
  s_sub_u32 s77, 0x10000, s76
  s_branch L_enc2
L_encfail:
  s_mov_b64 exec, -1
  s_mov_b32 s5, 1
  s_setpc_b64 s[74:75]
  s_nop 9
L_pass2:
  v_mov_b32 v31, v3
  v_add_u32 v3, s61, v2
  s_mov_b32 s64, 0x87878787
  s_cmp_lg_u32 s5, 0
  s_cbranch_scc1 L_pgen
  s_mov_b32 s51, 0x00800080
  v_and_b32 v20, 0x7fff7fff, v8
  v_and_b32 v21, 0x7fff7fff, v9
  v_and_b32 v22, 0x7fff7fff, v10
  v_and_b32 v23, 0x7fff7fff, v11
  v_pk_sub_u16 v24, v20, s51
  v_pk_sub_u16 v25, v21, s51
  v_pk_sub_u16 v26, v22, s51
  v_pk_sub_u16 v27, v23, s51
  v_pk_max_u16 v20, v20, v21
  v_pk_max_u16 v22, v22, v23
  v_pk_max_u16 v20, v20, v22
  v_pk_max_u16 v24, v24, v25
  v_pk_max_u16 v26, v26, v27
  v_pk_max_u16 v24, v24, v26
  s_sub_u32 s51, 0x7f7f7f7f, s42
  s_mov_b32 s52, 0xff80ff80
  v_pk_sub_u16 v20, v20, s51 clamp
  v_pk_sub_u16 v24, v24, s52 clamp
  v_or_b32 v20, v20, v24
  v_cmp_ne_u32 vcc, 0, v20
  s_nop 0
  s_cbranch_vccnz L_pgen
  s_mov_b32 s65, 0x05010400
  s_mov_b32 s66, 0x07030602
  ds_read_b128 v[48:51], v3
  ds_read_b128 v[52:55], v3 offset:1024
  ds_read_b128 v[56:59], v3 offset:2048
  ds_read_b128 v[60:63], v3 offset:3072
  s_xor_b32 s72, s49, 163840
  s_waitcnt lgkmcnt(0)
  v_mfma_f32_16x16x32_bf16 v[32:35], v[48:51], v[8:11], 0
  ds_read_b128 v[48:51], v3 offset:4096
  v_mfma_f32_16x16x32_bf16 v[36:39], v[52:55], v[8:11], 0
  ds_read_b128 v[52:55], v3 offset:5120
  v_mfma_f32_16x16x32_bf16 v[40:43], v[56:59], v[8:11], 0
  v_mfma_f32_16x16x32_bf16 v[44:47], v[60:63], v[8:11], 0
  s_nop 2
  v_mov_b32_dpp v24, v32 quad_perm:[0,1,2,3] row_mask:0xf bank_mask:0x1
  v_mov_b32_dpp v26, v34 row_ror:8 row_mask:0xf bank_mask:0x1
  s_nop 0
  v_mov_b32_dpp v24, v36 row_ror:4 row_mask:0xf bank_mask:0x2
  v_mov_b32_dpp v26, v38 row_ror:12 row_mask:0xf bank_mask:0x2
  s_nop 0
  v_mov_b32_dpp v24, v40 row_ror:8 row_mask:0xf bank_mask:0x4
  v_mov_b32_dpp v26, v42 quad_perm:[0,1,2,3] row_mask:0xf bank_mask:0x4
  s_lshl_b32 s69, s3, 11
  v_mov_b32_dpp v24, v44 row_ror:12 row_mask:0xf bank_mask:0x8
  v_mov_b32_dpp v26, v46 row_ror:4 row_mask:0xf bank_mask:0x8
  s_nop 0
  v_add_f32_dpp v24, v33, v24 row_ror:12 row_mask:0xf bank_mask:0x1
  v_add_f32_dpp v26, v35, v26 row_ror:4 row_mask:0xf bank_mask:0x1
  s_nop 0
  v_add_f32_dpp v24, v37, v24 quad_perm:[0,1,2,3] row_mask:0xf bank_mask:0x2
  v_add_f32_dpp v26, v39, v26 row_ror:8 row_mask:0xf bank_mask:0x2
  s_nop 0
  v_add_f32_dpp v24, v41, v24 row_ror:4 row_mask:0xf bank_mask:0x4
  v_add_f32_dpp v26, v43, v26 row_ror:12 row_mask:0xf bank_mask:0x4
  v_mfma_f32_16x16x32_bf16 v[40:43], a[12:15], v[8:11], 0
  v_add_f32_dpp v24, v45, v24 row_ror:8 row_mask:0xf bank_mask:0x8
  v_add_f32_dpp v26, v47, v26 quad_perm:[0,1,2,3] row_mask:0xf bank_mask:0x8
  v_mfma_f32_16x16x32_bf16 v[44:47], a[28:31], v[8:11], 0
  s_waitcnt lgkmcnt(0)
  buffer_load_dwordx4 a[12:15], v1, s[8:11], s72 offen nt
  v_mfma_f32_16x16x32_bf16 v[32:35], v[48:51], v[8:11], 0
  v_add_f32 v24, v24, v26
  buffer_load_dwordx4 a[28:31], v1, s[8:11], s72 offen offset:1024 nt
  v_mfma_f32_16x16x32_bf16 v[36:39], v[52:55], v[8:11], 0
  v_mov_b64 v[28:29], 0
  v_mov_b32 v30, 0
  s_nop 2
  v_mov_b32_dpp v25, v32 quad_perm:[0,1,2,3] row_mask:0xf bank_mask:0x1
  v_mov_b32_dpp v27, v34 row_ror:8 row_mask:0xf bank_mask:0x1
  s_nop 0
  v_mov_b32_dpp v25, v36 row_ror:4 row_mask:0xf bank_mask:0x2
  v_mov_b32_dpp v27, v38 row_ror:12 row_mask:0xf bank_mask:0x2
  s_nop 0
  v_mov_b32_dpp v25, v40 row_ror:8 row_mask:0xf bank_mask:0x4
  v_mov_b32_dpp v27, v42 quad_perm:[0,1,2,3] row_mask:0xf bank_mask:0x4
  s_nop 0
  v_mov_b32_dpp v25, v44 row_ror:12 row_mask:0xf bank_mask:0x8
  v_mov_b32_dpp v27, v46 row_ror:4 row_mask:0xf bank_mask:0x8
  s_nop 0
  v_add_f32_dpp v25, v33, v25 row_ror:12 row_mask:0xf bank_mask:0x1
  v_add_f32_dpp v27, v35, v27 row_ror:4 row_mask:0xf bank_mask:0x1
  s_nop 0
  v_add_f32_dpp v25, v37, v25 quad_perm:[0,1,2,3] row_mask:0xf bank_mask:0x2
  v_add_f32_dpp v27, v39, v27 row_ror:8 row_mask:0xf bank_mask:0x2
  s_nop 0
  v_add_f32_dpp v25, v41, v25 row_ror:4 row_mask:0xf bank_mask:0x4
  v_add_f32_dpp v27, v43, v27 row_ror:12 row_mask:0xf bank_mask:0x4
  s_bfm_b64 s[76:77], s50, 0
  v_add_f32_dpp v25, v45, v25 row_ror:8 row_mask:0xf bank_mask:0x8
  v_add_f32_dpp v27, v47, v27 quad_perm:[0,1,2,3] row_mask:0xf bank_mask:0x8
  v_add_f32 v25, v25, v27
  v_cvt_pk_bf16_f32 v32, v24, v25
  v_lshlrev_b32 v24, 16, v32
  v_and_b32 v25, 0xffff0000, v32
  v_pk_mul_f32 v[24:25], v[24:25], s[56:57] op_sel_hi:[1,0]
  v_cvt_pk_bf16_f32 v32, v24, v25
  v_lshlrev_b32 v24, 16, v32
  v_and_b32 v25, 0xffff0000, v32
  v_pk_add_f32 v[26:27], v[24:25], v[4:5] op_sel_hi:[1,0] neg_lo:[0,1] neg_hi:[0,1]
  v_pk_mul_f32 v[26:27], v[26:27], s[56:57] op_sel:[0,1] op_sel_hi:[1,1]
  v_max_f32 v20, v26, v27
  v_cmp_lt_f32 vcc, 0, v20
  s_getpc_b64 s[74:75]
  s_cbranch_vccnz L_remax
  v_exp_f32 v26, v26
  v_exp_f32 v27, v27
  v_cvt_pk_bf16_f32 v20, v26, 0
  v_add_f32 v32, v26, v27
  v_cvt_pk_bf16_f32 v21, v26, 0
  v_cvt_pk_bf16_f32 v23, v27, 0
  v_cvt_pk_bf16_f32 v22, v27, 0
  v_cvt_pk_bf16_f32 v24, 0, v26
  v_cvt_pk_bf16_f32 v25, 0, v27
  v_add_f32 v5, v5, v32
  v_mov_b32_dpp v20, v24 row_ror:4 row_mask:0xf bank_mask:0xa
  v_mov_b32_dpp v21, v24 row_ror:4 row_mask:0xf bank_mask:0x5
  v_mov_b32_dpp v23, v25 row_ror:4 row_mask:0xf bank_mask:0xa
  v_mov_b32_dpp v22, v25 row_ror:4 row_mask:0xf bank_mask:0x5
  v_and_b32_dpp v32, v20, v6 quad_perm:[0,1,2,3] row_mask:0xf bank_mask:0xf
  v_and_b32_dpp v33, v20, v7 row_ror:8 row_mask:0xf bank_mask:0xf
  v_and_b32_dpp v34, v21, v6 row_ror:12 row_mask:0xf bank_mask:0xf
  v_and_b32_dpp v35, v21, v7 row_ror:4 row_mask:0xf bank_mask:0xf
  v_mfma_f32_16x16x16_bf16 v[12:15], v[32:33], a[44:45], v[12:15]
  v_and_b32_dpp v36, v20, v6 row_ror:8 row_mask:0xf bank_mask:0xf
  v_and_b32_dpp v37, v20, v7 quad_perm:[0,1,2,3] row_mask:0xf bank_mask:0xf
  v_mfma_f32_16x16x16_bf16 v[16:19], v[32:33], a[46:47], v[16:19]
  v_and_b32_dpp v38, v21, v6 row_ror:4 row_mask:0xf bank_mask:0xf
  v_and_b32_dpp v39, v21, v7 row_ror:12 row_mask:0xf bank_mask:0xf
  v_mfma_f32_16x16x16_bf16 v[12:15], v[34:35], a[48:49], v[12:15]
  v_and_b32_dpp v40, v23, v6 quad_perm:[0,1,2,3] row_mask:0xf bank_mask:0xf
  v_and_b32_dpp v41, v23, v7 row_ror:8 row_mask:0xf bank_mask:0xf
  v_mfma_f32_16x16x16_bf16 v[16:19], v[34:35], a[50:51], v[16:19]
  v_and_b32_dpp v42, v22, v6 row_ror:12 row_mask:0xf bank_mask:0xf
  v_and_b32_dpp v43, v22, v7 row_ror:4 row_mask:0xf bank_mask:0xf
  v_mfma_f32_16x16x16_bf16 v[12:15], v[36:37], a[52:53], v[12:15]
  v_and_b32_dpp v44, v23, v6 row_ror:8 row_mask:0xf bank_mask:0xf
  v_and_b32_dpp v45, v23, v7 quad_perm:[0,1,2,3] row_mask:0xf bank_mask:0xf
  v_mfma_f32_16x16x16_bf16 v[16:19], v[36:37], a[54:55], v[16:19]
  v_and_b32_dpp v46, v22, v6 row_ror:4 row_mask:0xf bank_mask:0xf
  v_and_b32_dpp v47, v22, v7 row_ror:12 row_mask:0xf bank_mask:0xf
  v_mfma_f32_16x16x16_bf16 v[12:15], v[38:39], a[96:97], v[12:15]
  buffer_load_dwordx4 a[44:47], v1, s[8:11], s72 offen offset:2048 nt
  buffer_load_dwordx4 a[48:51], v1, s[8:11], s72 offen offset:3072 nt
  v_mfma_f32_16x16x16_bf16 v[16:19], v[38:39], a[98:99], v[16:19]
  v_add_u32 v20, s69, v2
  ds_write_b128 v20, v[8:11]
  v_mfma_f32_16x16x16_bf16 v[12:15], v[40:41], a[100:101], v[12:15]
  v_bfe_u32 v20, v31, 12, 4
  v_bfe_u32 v21, v31, 9, 3
  v_mfma_f32_16x16x16_bf16 v[16:19], v[40:41], a[102:103], v[16:19]
  v_lshlrev_b32 v20, 6, v20
  v_lshl_add_u32 v20, v21, 1, v20
  v_mfma_f32_16x16x16_bf16 v[12:15], v[42:43], a[124:125], v[12:15]
  v_add_u32 v20, s69, v20
  ds_read_u16 v24, v20 offset:0
  v_mfma_f32_16x16x16_bf16 v[16:19], v[42:43], a[126:127], v[16:19]
  ds_read_u16 v25, v20 offset:16
  ds_read_u16 v26, v20 offset:32
  v_mfma_f32_16x16x16_bf16 v[12:15], v[44:45], a[132:133], v[12:15]
  ds_read_u16 v27, v20 offset:48
  v_mov_b32 v23, v31
  v_mfma_f32_16x16x16_bf16 v[16:19], v[44:45], a[134:135], v[16:19]
  v_mov_b32 v31, 0
  ds_write_b128 v3, v[28:31]
  v_mfma_f32_16x16x16_bf16 v[12:15], v[46:47], a[148:149], v[12:15]
  ds_write_b128 v3, v[28:31] offset:1024
  ds_write_b128 v3, v[28:31] offset:2048
  v_mfma_f32_16x16x16_bf16 v[16:19], v[46:47], a[150:151], v[16:19]
  ds_write_b128 v3, v[28:31] offset:3072
  ds_write_b128 v3, v[28:31] offset:4096
  ds_write_b128 v3, v[28:31] offset:5120
  v_mov_b32 v31, v23
  v_bfe_u32 v21, v31, 6, 3
  v_and_b32 v20, 15, v31
  v_lshlrev_b32 v21, 10, v21
  v_lshl_add_u32 v21, v20, 6, v21
  v_bfe_u32 v20, v31, 4, 2
  v_lshl_add_u32 v21, v20, 2, v21
  v_add_u32 v21, s61, v21
  v_and_b32 v22, 0xffff0000, v31
  s_mov_b32 s40, s0
  s_mov_b32 s69, 0x7fff7fff
  s_waitcnt lgkmcnt(6)
  v_lshlrev_b32 v24, 16, v24
  v_lshlrev_b32 v25, 16, v25
  v_lshlrev_b32 v26, 16, v26
  v_lshlrev_b32 v27, 16, v27
  v_mul_f32 v24, v24, v22
  v_mul_f32 v25, v25, v22
  v_mul_f32 v26, v26, v22
  v_mul_f32 v27, v27, v22
  s_mov_b64 exec, s[76:77]
  ds_add_f32 v21, v24 offset:0
  ds_add_f32 v21, v25 offset:16
  ds_add_f32 v21, v26 offset:32
  ds_add_f32 v21, v27 offset:48
  s_mov_b64 exec, -1
  ds_read_b64 v[24:25], v3
  v_and_b32 v20, 0x7fff7fff, v8
  v_and_b32 v21, 0x7fff7fff, v9
  v_and_b32 v22, 0x7fff7fff, v10
  v_and_b32 v23, 0x7fff7fff, v11
  v_pk_min_u16 v20, v20, 1 op_sel_hi:[1,0]
  v_pk_min_u16 v21, v21, 1 op_sel_hi:[1,0]
  v_pk_min_u16 v22, v22, 1 op_sel_hi:[1,0]
  v_pk_min_u16 v23, v23, 1 op_sel_hi:[1,0]
  v_pk_mul_lo_u16 v20, v20, s42
  v_pk_mul_lo_u16 v21, v21, s42
  v_pk_mul_lo_u16 v22, v22, s42
  v_pk_mul_lo_u16 v23, v23, s42
  v_pk_add_u16 v8, v8, v20
  v_pk_add_u16 v9, v9, v21
  v_pk_add_u16 v10, v10, v22
  v_pk_add_u16 v11, v11, v23
  v_accvgpr_read_b32 v29, a18
  v_and_b32 v28, s64, v29
  v_alignbit_b32 v29, v29, v29, 4
  v_and_b32 v29, s64, v29
  v_accvgpr_read_b32 v49, a16
  v_perm_b32 v48, v28, v49, s65
  v_perm_b32 v49, v28, v49, s66
  v_accvgpr_read_b32 v51, a17
  v_perm_b32 v50, v29, v51, s65
  v_perm_b32 v51, v29, v51, s66
  v_accvgpr_read_b32 v29, a19
  v_and_b32 v28, s64, v29
  v_mfma_f32_16x16x32_bf16 v[32:35], v[48:51], v[8:11], 0
  v_alignbit_b32 v29, v29, v29, 4
  v_and_b32 v29, s64, v29
  v_accvgpr_read_b32 v53, a20
  v_perm_b32 v52, v28, v53, s65
  v_perm_b32 v53, v28, v53, s66
  v_accvgpr_read_b32 v55, a21
  v_perm_b32 v54, v29, v55, s65
  v_perm_b32 v55, v29, v55, s66
  v_accvgpr_read_b32 v29, a24
  v_and_b32 v28, s64, v29
  v_mfma_f32_16x16x32_bf16 v[36:39], v[52:55], v[8:11], 0
  v_alignbit_b32 v29, v29, v29, 4
  v_and_b32 v29, s64, v29
  v_accvgpr_read_b32 v57, a22
  v_perm_b32 v56, v28, v57, s65
  v_perm_b32 v57, v28, v57, s66
  v_accvgpr_read_b32 v59, a23
  v_perm_b32 v58, v29, v59, s65
  v_perm_b32 v59, v29, v59, s66
  v_accvgpr_read_b32 v29, a25
  v_and_b32 v28, s64, v29
  v_mfma_f32_16x16x32_bf16 v[40:43], v[56:59], v[8:11], 0
  v_alignbit_b32 v29, v29, v29, 4
  v_and_b32 v29, s64, v29
  v_accvgpr_read_b32 v61, a26
  v_perm_b32 v60, v28, v61, s65
  v_perm_b32 v61, v28, v61, s66
  v_accvgpr_read_b32 v63, a27
  v_perm_b32 v62, v29, v63, s65
  v_perm_b32 v63, v29, v63, s66
  s_waitcnt lgkmcnt(0)
  s_nop 0
  v_mfma_f32_16x16x32_bf16 v[44:47], v[60:63], v[8:11], 0
  s_bitcmp1_b32 s2, 0
  s_cselect_b32 s10, 0, 0x8000000
  ds_read_b128 v[52:55], v3 offset:6144
  ds_read_b128 v[56:59], v3 offset:7168
  ds_read_b128 v[60:63], v3 offset:8192
  s_xor_b32 s72, s49, 491520
  buffer_load_dwordx4 a[52:55], v1, s[8:11], s72 offen nt
  buffer_load_dwordx4 a[96:99], v1, s[8:11], s72 offen offset:1024 nt
  v_add_f32_dpp v24, v32, v24 quad_perm:[0,1,2,3] row_mask:0xf bank_mask:0x1
  v_mov_b32_dpp v26, v34 row_ror:8 row_mask:0xf bank_mask:0x1
  buffer_load_dwordx4 a[100:103], v1, s[8:11], s72 offen offset:2048 nt
  v_add_f32_dpp v24, v36, v24 row_ror:4 row_mask:0xf bank_mask:0x2
  v_mov_b32_dpp v26, v38 row_ror:12 row_mask:0xf bank_mask:0x2
  s_nop 0
  v_add_f32_dpp v24, v40, v24 row_ror:8 row_mask:0xf bank_mask:0x4
  v_mov_b32_dpp v26, v42 quad_perm:[0,1,2,3] row_mask:0xf bank_mask:0x4
  s_nop 0
  v_add_f32_dpp v24, v44, v24 row_ror:12 row_mask:0xf bank_mask:0x8
  v_mov_b32_dpp v26, v46 row_ror:4 row_mask:0xf bank_mask:0x8
  s_nop 0
  v_add_f32_dpp v24, v33, v24 row_ror:12 row_mask:0xf bank_mask:0x1
  v_add_f32_dpp v26, v35, v26 row_ror:4 row_mask:0xf bank_mask:0x1
  s_nop 0
  v_add_f32_dpp v24, v37, v24 quad_perm:[0,1,2,3] row_mask:0xf bank_mask:0x2
  v_add_f32_dpp v26, v39, v26 row_ror:8 row_mask:0xf bank_mask:0x2
  s_nop 0
  v_add_f32_dpp v24, v41, v24 row_ror:4 row_mask:0xf bank_mask:0x4
  v_add_f32_dpp v26, v43, v26 row_ror:12 row_mask:0xf bank_mask:0x4
  s_nop 0
  v_add_f32_dpp v24, v45, v24 row_ror:8 row_mask:0xf bank_mask:0x8
  v_add_f32_dpp v26, v47, v26 quad_perm:[0,1,2,3] row_mask:0xf bank_mask:0x8
  v_add_f32 v24, v24, v26
  s_waitcnt lgkmcnt(0)
  v_and_b32 v28, s64, v54
  v_alignbit_b32 v29, v54, v54, 4
  v_and_b32 v29, s64, v29
  v_perm_b32 v48, v28, v52, s65
  v_perm_b32 v49, v28, v52, s66
  v_perm_b32 v50, v29, v53, s65
  v_perm_b32 v51, v29, v53, s66
  v_and_b32 v28, s64, v55
  v_alignbit_b32 v29, v55, v55, 4
  v_mfma_f32_16x16x32_bf16 v[32:35], v[48:51], v[8:11], 0
  v_and_b32 v29, s64, v29
  v_perm_b32 v52, v28, v56, s65
  v_perm_b32 v53, v28, v56, s66
  v_perm_b32 v54, v29, v57, s65
  v_perm_b32 v55, v29, v57, s66
  v_and_b32 v28, s64, v60
  v_alignbit_b32 v29, v60, v60, 4
  v_mfma_f32_16x16x32_bf16 v[36:39], v[52:55], v[8:11], 0
  v_and_b32 v29, s64, v29
  v_perm_b32 v56, v28, v58, s65
  v_perm_b32 v57, v28, v58, s66
  v_perm_b32 v58, v29, v59, s65
  v_perm_b32 v59, v29, v59, s66
  v_and_b32 v28, s64, v61
  v_alignbit_b32 v29, v61, v61, 4
  v_mfma_f32_16x16x32_bf16 v[40:43], v[56:59], v[8:11], 0
  v_and_b32 v29, s64, v29
  v_perm_b32 v60, v28, v62, s65
  v_perm_b32 v61, v28, v62, s66
  v_perm_b32 v62, v29, v63, s65
  v_perm_b32 v63, v29, v63, s66
  v_add_f32_dpp v25, v32, v25 quad_perm:[0,1,2,3] row_mask:0xf bank_mask:0x1
  v_accvgpr_read_b32 v29, a34
  v_mfma_f32_16x16x32_bf16 v[44:47], v[60:63], v[8:11], 0
  v_mov_b32_dpp v27, v34 row_ror:8 row_mask:0xf bank_mask:0x1
  v_and_b32 v28, s64, v29
  v_add_f32_dpp v25, v36, v25 row_ror:4 row_mask:0xf bank_mask:0x2
  v_alignbit_b32 v29, v29, v29, 4
  v_mov_b32_dpp v27, v38 row_ror:12 row_mask:0xf bank_mask:0x2
  v_and_b32 v29, s64, v29
  v_add_f32_dpp v25, v40, v25 row_ror:8 row_mask:0xf bank_mask:0x4
  v_accvgpr_read_b32 v49, a32
  v_mov_b32_dpp v27, v42 quad_perm:[0,1,2,3] row_mask:0xf bank_mask:0x4
  v_perm_b32 v48, v28, v49, s65
  v_add_f32_dpp v25, v44, v25 row_ror:12 row_mask:0xf bank_mask:0x8
  v_perm_b32 v49, v28, v49, s66
  v_mov_b32_dpp v27, v46 row_ror:4 row_mask:0xf bank_mask:0x8
  v_accvgpr_read_b32 v53, a33
  v_add_f32_dpp v25, v33, v25 row_ror:12 row_mask:0xf bank_mask:0x1
  v_perm_b32 v52, v29, v53, s65
  v_add_f32_dpp v27, v35, v27 row_ror:4 row_mask:0xf bank_mask:0x1
  v_perm_b32 v53, v29, v53, s66
  v_add_f32_dpp v25, v37, v25 quad_perm:[0,1,2,3] row_mask:0xf bank_mask:0x2
  v_accvgpr_read_b32 v29, a35
  v_add_f32_dpp v27, v39, v27 row_ror:8 row_mask:0xf bank_mask:0x2
  v_and_b32 v28, s64, v29
  v_add_f32_dpp v25, v41, v25 row_ror:4 row_mask:0xf bank_mask:0x4
  v_alignbit_b32 v29, v29, v29, 4
  v_add_f32_dpp v27, v43, v27 row_ror:12 row_mask:0xf bank_mask:0x4
  v_and_b32 v29, s64, v29
  v_add_f32_dpp v25, v45, v25 row_ror:8 row_mask:0xf bank_mask:0x8
  v_accvgpr_read_b32 v51, a36
  v_add_f32_dpp v27, v47, v27 quad_perm:[0,1,2,3] row_mask:0xf bank_mask:0x8
  v_perm_b32 v50, v28, v51, s65
  v_perm_b32 v51, v28, v51, s66
  v_add_f32 v25, v25, v27
  v_accvgpr_read_b32 v55, a37
  v_cvt_pk_bf16_f32 v32, v24, v25
  v_perm_b32 v54, v29, v55, s65
  v_lshlrev_b32 v24, 16, v32
  v_perm_b32 v55, v29, v55, s66
  v_and_b32 v25, 0xffff0000, v32
  v_accvgpr_read_b32 v29, a40
  v_pk_mul_f32 v[24:25], v[24:25], s[56:57] op_sel_hi:[1,0]
  v_and_b32 v28, s64, v29
  v_cvt_pk_bf16_f32 v32, v24, v25
  v_lshlrev_b32 v24, 16, v32
  v_alignbit_b32 v29, v29, v29, 4
  v_and_b32 v25, 0xffff0000, v32
  ds_write_b64 v3, v[24:25]
  v_and_b32 v29, s64, v29
  v_pk_add_f32 v[26:27], v[24:25], v[4:5] op_sel_hi:[1,0] neg_lo:[0,1] neg_hi:[0,1]
  v_pk_mul_f32 v[26:27], v[26:27], s[56:57] op_sel:[0,1] op_sel_hi:[1,1]
  v_accvgpr_read_b32 v57, a38
  v_max_f32 v20, v26, v27
  v_perm_b32 v56, v28, v57, s65
  v_perm_b32 v57, v28, v57, s66
  v_cmp_lt_f32 vcc, 0, v20
  s_getpc_b64 s[74:75]
  s_cbranch_vccnz L_remax
  v_accvgpr_read_b32 v61, a39
  v_exp_f32 v26, v26
  v_exp_f32 v27, v27
  v_perm_b32 v60, v29, v61, s65
  v_pk_mul_f32 v[24:25], v[26:27], s[40:41] op_sel:[0,1] op_sel_hi:[1,1]
  v_perm_b32 v61, v29, v61, s66
  v_add_f32 v32, v26, v27
  v_accvgpr_read_b32 v29, a41
  v_cvt_pk_bf16_f32 v20, v24, 0
  v_and_b32 v28, s64, v29
  v_cvt_pk_bf16_f32 v21, v24, 0
  v_alignbit_b32 v29, v29, v29, 4
  v_cvt_pk_bf16_f32 v23, v25, 0
  v_and_b32 v29, s64, v29
  v_cvt_pk_bf16_f32 v22, v25, 0
  v_cvt_pk_bf16_f32 v24, 0, v24
  v_accvgpr_read_b32 v59, a42
  v_cvt_pk_bf16_f32 v25, 0, v25
  v_perm_b32 v58, v28, v59, s65
  v_add_f32 v5, v5, v32
  v_perm_b32 v59, v28, v59, s66
  v_mov_b32_dpp v20, v24 row_ror:4 row_mask:0xf bank_mask:0xa
  v_accvgpr_read_b32 v63, a43
  v_mov_b32_dpp v21, v24 row_ror:4 row_mask:0xf bank_mask:0x5
  v_perm_b32 v62, v29, v63, s65
  v_mov_b32_dpp v23, v25 row_ror:4 row_mask:0xf bank_mask:0xa
  v_perm_b32 v63, v29, v63, s66
  v_mov_b32_dpp v22, v25 row_ror:4 row_mask:0xf bank_mask:0x5
  ds_read_b64 v[24:25], v3 offset:8
  buffer_load_dwordx4 a[124:127], v1, s[8:11], s72 offen offset:3072 nt
  s_mov_b32 s10, 0x8000000
  s_xor_b32 s72, s49, 180224
  buffer_load_dwordx4 a[132:135], v1, s[8:11], s72 offen nt
  v_and_b32_dpp v32, v20, v6 quad_perm:[0,1,2,3] row_mask:0xf bank_mask:0xf
  v_and_b32_dpp v33, v20, v7 row_ror:8 row_mask:0xf bank_mask:0xf
  v_and_b32_dpp v34, v21, v6 row_ror:12 row_mask:0xf bank_mask:0xf
  v_and_b32_dpp v35, v21, v7 row_ror:4 row_mask:0xf bank_mask:0xf
  v_and_b32_dpp v36, v20, v6 row_ror:8 row_mask:0xf bank_mask:0xf
  v_and_b32_dpp v37, v20, v7 quad_perm:[0,1,2,3] row_mask:0xf bank_mask:0xf
  v_mfma_f32_16x16x32_bf16 v[12:15], v[32:35], v[48:51], v[12:15]
  v_and_b32_dpp v38, v21, v6 row_ror:4 row_mask:0xf bank_mask:0xf
  v_and_b32_dpp v39, v21, v7 row_ror:12 row_mask:0xf bank_mask:0xf
  v_mfma_f32_16x16x32_bf16 v[16:19], v[32:35], v[52:55], v[16:19]
  v_and_b32_dpp v40, v23, v6 quad_perm:[0,1,2,3] row_mask:0xf bank_mask:0xf
  v_and_b32_dpp v41, v23, v7 row_ror:8 row_mask:0xf bank_mask:0xf
  v_mfma_f32_16x16x32_bf16 v[12:15], v[36:39], v[56:59], v[12:15]
  v_and_b32_dpp v42, v22, v6 row_ror:12 row_mask:0xf bank_mask:0xf
  v_and_b32_dpp v43, v22, v7 row_ror:4 row_mask:0xf bank_mask:0xf
  v_mfma_f32_16x16x32_bf16 v[16:19], v[36:39], v[60:63], v[16:19]
  v_and_b32_dpp v44, v23, v6 row_ror:8 row_mask:0xf bank_mask:0xf
  v_and_b32_dpp v45, v23, v7 quad_perm:[0,1,2,3] row_mask:0xf bank_mask:0xf
  v_and_b32_dpp v46, v22, v6 row_ror:4 row_mask:0xf bank_mask:0xf
  v_and_b32_dpp v47, v22, v7 row_ror:12 row_mask:0xf bank_mask:0xf
  v_accvgpr_read_b32 v29, a58
  v_and_b32 v28, s64, v29
  v_alignbit_b32 v29, v29, v29, 4
  v_and_b32 v29, s64, v29
  v_accvgpr_read_b32 v49, a56
  v_perm_b32 v48, v28, v49, s65
  v_perm_b32 v49, v28, v49, s66
  v_accvgpr_read_b32 v53, a57
  v_perm_b32 v52, v29, v53, s65
  v_perm_b32 v53, v29, v53, s66
  v_accvgpr_read_b32 v29, a59
  v_and_b32 v28, s64, v29
  v_alignbit_b32 v29, v29, v29, 4
  v_and_b32 v29, s64, v29
  v_accvgpr_read_b32 v51, a60
  v_perm_b32 v50, v28, v51, s65
  v_perm_b32 v51, v28, v51, s66
  v_accvgpr_read_b32 v55, a61
  v_perm_b32 v54, v29, v55, s65
  v_mfma_f32_16x16x32_bf16 v[12:15], v[40:43], v[48:51], v[12:15]
  v_perm_b32 v55, v29, v55, s66
  v_accvgpr_read_b32 v29, a64
  v_and_b32 v28, s64, v29
  v_mfma_f32_16x16x32_bf16 v[16:19], v[40:43], v[52:55], v[16:19]
  v_alignbit_b32 v29, v29, v29, 4
  v_and_b32 v29, s64, v29
  v_accvgpr_read_b32 v57, a62
  v_perm_b32 v56, v28, v57, s65
  v_perm_b32 v57, v28, v57, s66
  v_accvgpr_read_b32 v61, a63
  v_perm_b32 v60, v29, v61, s65
  v_perm_b32 v61, v29, v61, s66
  v_accvgpr_read_b32 v29, a65
  v_and_b32 v28, s64, v29
  v_alignbit_b32 v29, v29, v29, 4
  v_and_b32 v29, s64, v29
  v_accvgpr_read_b32 v59, a66
  v_perm_b32 v58, v28, v59, s65
  v_perm_b32 v59, v28, v59, s66
  v_accvgpr_read_b32 v63, a67
  v_perm_b32 v62, v29, v63, s65
  v_mfma_f32_16x16x32_bf16 v[12:15], v[44:47], v[56:59], v[12:15]
  v_perm_b32 v63, v29, v63, s66
  buffer_load_dwordx4 a[148:151], v1, s[8:11], s72 offen offset:1024 nt
  v_accvgpr_read_b32 v29, a70
  v_mfma_f32_16x16x32_bf16 v[16:19], v[44:47], v[60:63], v[16:19]
  v_and_b32 v28, s64, v29
  v_alignbit_b32 v29, v29, v29, 4
  v_and_b32 v29, s64, v29
  v_accvgpr_read_b32 v49, a68
  v_perm_b32 v48, v28, v49, s65
  v_perm_b32 v49, v28, v49, s66
  v_accvgpr_read_b32 v51, a69
  v_perm_b32 v50, v29, v51, s65
  v_perm_b32 v51, v29, v51, s66
  v_accvgpr_read_b32 v29, a71
  v_and_b32 v28, s64, v29
  v_mfma_f32_16x16x32_bf16 v[32:35], v[48:51], v[8:11], 0
  v_alignbit_b32 v29, v29, v29, 4
  v_and_b32 v29, s64, v29
  v_accvgpr_read_b32 v53, a72
  v_perm_b32 v52, v28, v53, s65
  v_perm_b32 v53, v28, v53, s66
  v_accvgpr_read_b32 v55, a73
  v_perm_b32 v54, v29, v55, s65
  v_perm_b32 v55, v29, v55, s66
  v_accvgpr_read_b32 v29, a76
  v_and_b32 v28, s64, v29
  v_mfma_f32_16x16x32_bf16 v[36:39], v[52:55], v[8:11], 0
  v_alignbit_b32 v29, v29, v29, 4
  v_and_b32 v29, s64, v29
  v_accvgpr_read_b32 v57, a74
  v_perm_b32 v56, v28, v57, s65
  v_perm_b32 v57, v28, v57, s66
  v_accvgpr_read_b32 v59, a75
  v_perm_b32 v58, v29, v59, s65
  v_perm_b32 v59, v29, v59, s66
  v_accvgpr_read_b32 v29, a77
  v_and_b32 v28, s64, v29
  v_mfma_f32_16x16x32_bf16 v[40:43], v[56:59], v[8:11], 0
  v_alignbit_b32 v29, v29, v29, 4
  v_and_b32 v29, s64, v29
  v_accvgpr_read_b32 v61, a78
  v_perm_b32 v60, v28, v61, s65
  v_perm_b32 v61, v28, v61, s66
  v_accvgpr_read_b32 v63, a79
  v_perm_b32 v62, v29, v63, s65
  v_perm_b32 v63, v29, v63, s66
  s_waitcnt lgkmcnt(0)
  ds_read_b128 v[52:55], v3 offset:9216
  v_mfma_f32_16x16x32_bf16 v[44:47], v[60:63], v[8:11], 0
  ds_read_b128 v[56:59], v3 offset:10240
  ds_read_b128 v[60:63], v3 offset:11264
  buffer_load_dwordx4 a[16:19], v1, s[8:11], s72 offen offset:2048 nt
  buffer_load_dwordx4 a[20:23], v1, s[8:11], s72 offen offset:3072 nt
  v_add_f32_dpp v24, v32, v24 quad_perm:[0,1,2,3] row_mask:0xf bank_mask:0x1
  v_mov_b32_dpp v26, v34 row_ror:8 row_mask:0xf bank_mask:0x1
  s_xor_b32 s72, s49, 163840
  v_add_f32_dpp v24, v36, v24 row_ror:4 row_mask:0xf bank_mask:0x2
  v_mov_b32_dpp v26, v38 row_ror:12 row_mask:0xf bank_mask:0x2
  buffer_load_dwordx4 a[24:27], v2, s[12:15], s72 offen nt
  v_add_f32_dpp v24, v40, v24 row_ror:8 row_mask:0xf bank_mask:0x4
  v_mov_b32_dpp v26, v42 quad_perm:[0,1,2,3] row_mask:0xf bank_mask:0x4
  s_nop 0
  v_add_f32_dpp v24, v44, v24 row_ror:12 row_mask:0xf bank_mask:0x8
  v_mov_b32_dpp v26, v46 row_ror:4 row_mask:0xf bank_mask:0x8
  s_nop 0
  v_add_f32_dpp v24, v33, v24 row_ror:12 row_mask:0xf bank_mask:0x1
  v_add_f32_dpp v26, v35, v26 row_ror:4 row_mask:0xf bank_mask:0x1
  s_nop 0
  v_add_f32_dpp v24, v37, v24 quad_perm:[0,1,2,3] row_mask:0xf bank_mask:0x2
  v_add_f32_dpp v26, v39, v26 row_ror:8 row_mask:0xf bank_mask:0x2
  s_nop 0
  v_add_f32_dpp v24, v41, v24 row_ror:4 row_mask:0xf bank_mask:0x4
  v_add_f32_dpp v26, v43, v26 row_ror:12 row_mask:0xf bank_mask:0x4
  s_nop 0
  v_add_f32_dpp v24, v45, v24 row_ror:8 row_mask:0xf bank_mask:0x8
  v_add_f32_dpp v26, v47, v26 quad_perm:[0,1,2,3] row_mask:0xf bank_mask:0x8
  v_add_f32 v24, v24, v26
  s_waitcnt lgkmcnt(0)
  v_and_b32 v28, s64, v54
  v_alignbit_b32 v29, v54, v54, 4
  v_and_b32 v29, s64, v29
  v_perm_b32 v48, v28, v52, s65
  v_perm_b32 v49, v28, v52, s66
  v_perm_b32 v50, v29, v53, s65
  v_perm_b32 v51, v29, v53, s66
  v_and_b32 v28, s64, v55
  v_alignbit_b32 v29, v55, v55, 4
  v_mfma_f32_16x16x32_bf16 v[32:35], v[48:51], v[8:11], 0
  v_and_b32 v29, s64, v29
  v_perm_b32 v52, v28, v56, s65
  v_perm_b32 v53, v28, v56, s66
  v_perm_b32 v54, v29, v57, s65
  v_perm_b32 v55, v29, v57, s66
  v_and_b32 v28, s64, v60
  v_alignbit_b32 v29, v60, v60, 4
  v_mfma_f32_16x16x32_bf16 v[36:39], v[52:55], v[8:11], 0
  v_and_b32 v29, s64, v29
  v_perm_b32 v56, v28, v58, s65
  v_perm_b32 v57, v28, v58, s66
  v_perm_b32 v58, v29, v59, s65
  v_perm_b32 v59, v29, v59, s66
  v_and_b32 v28, s64, v61
  v_alignbit_b32 v29, v61, v61, 4
  v_mfma_f32_16x16x32_bf16 v[40:43], v[56:59], v[8:11], 0
  v_and_b32 v29, s64, v29
  v_perm_b32 v60, v28, v62, s65
  v_perm_b32 v61, v28, v62, s66
  v_perm_b32 v62, v29, v63, s65
  v_perm_b32 v63, v29, v63, s66
  v_add_f32_dpp v25, v32, v25 quad_perm:[0,1,2,3] row_mask:0xf bank_mask:0x1
  v_accvgpr_read_b32 v29, a86
  v_mfma_f32_16x16x32_bf16 v[44:47], v[60:63], v[8:11], 0
  v_mov_b32_dpp v27, v34 row_ror:8 row_mask:0xf bank_mask:0x1
  v_and_b32 v28, s64, v29
  v_add_f32_dpp v25, v36, v25 row_ror:4 row_mask:0xf bank_mask:0x2
  v_alignbit_b32 v29, v29, v29, 4
  v_mov_b32_dpp v27, v38 row_ror:12 row_mask:0xf bank_mask:0x2
  v_and_b32 v29, s64, v29
  v_add_f32_dpp v25, v40, v25 row_ror:8 row_mask:0xf bank_mask:0x4
  v_accvgpr_read_b32 v49, a84
  v_mov_b32_dpp v27, v42 quad_perm:[0,1,2,3] row_mask:0xf bank_mask:0x4
  v_perm_b32 v48, v28, v49, s65
  v_add_f32_dpp v25, v44, v25 row_ror:12 row_mask:0xf bank_mask:0x8
  v_perm_b32 v49, v28, v49, s66
  v_mov_b32_dpp v27, v46 row_ror:4 row_mask:0xf bank_mask:0x8
  v_accvgpr_read_b32 v53, a85
  v_add_f32_dpp v25, v33, v25 row_ror:12 row_mask:0xf bank_mask:0x1
  v_perm_b32 v52, v29, v53, s65
  v_add_f32_dpp v27, v35, v27 row_ror:4 row_mask:0xf bank_mask:0x1
  v_perm_b32 v53, v29, v53, s66
  v_add_f32_dpp v25, v37, v25 quad_perm:[0,1,2,3] row_mask:0xf bank_mask:0x2
  v_accvgpr_read_b32 v29, a87
  v_add_f32_dpp v27, v39, v27 row_ror:8 row_mask:0xf bank_mask:0x2
  v_and_b32 v28, s64, v29
  v_add_f32_dpp v25, v41, v25 row_ror:4 row_mask:0xf bank_mask:0x4
  v_alignbit_b32 v29, v29, v29, 4
  v_add_f32_dpp v27, v43, v27 row_ror:12 row_mask:0xf bank_mask:0x4
  v_and_b32 v29, s64, v29
  v_add_f32_dpp v25, v45, v25 row_ror:8 row_mask:0xf bank_mask:0x8
  v_accvgpr_read_b32 v51, a88
  v_add_f32_dpp v27, v47, v27 quad_perm:[0,1,2,3] row_mask:0xf bank_mask:0x8
  v_perm_b32 v50, v28, v51, s65
  v_perm_b32 v51, v28, v51, s66
  v_add_f32 v25, v25, v27
  v_accvgpr_read_b32 v55, a89
  v_cvt_pk_bf16_f32 v32, v24, v25
  v_perm_b32 v54, v29, v55, s65
  v_lshlrev_b32 v24, 16, v32
  v_perm_b32 v55, v29, v55, s66
  v_and_b32 v25, 0xffff0000, v32
  v_accvgpr_read_b32 v29, a92
  v_pk_mul_f32 v[24:25], v[24:25], s[56:57] op_sel_hi:[1,0]
  v_and_b32 v28, s64, v29
  v_cvt_pk_bf16_f32 v32, v24, v25
  v_lshlrev_b32 v24, 16, v32
  v_alignbit_b32 v29, v29, v29, 4
  v_and_b32 v25, 0xffff0000, v32
  ds_write_b64 v3, v[24:25] offset:8
  v_and_b32 v29, s64, v29
  v_pk_add_f32 v[26:27], v[24:25], v[4:5] op_sel_hi:[1,0] neg_lo:[0,1] neg_hi:[0,1]
  v_pk_mul_f32 v[26:27], v[26:27], s[56:57] op_sel:[0,1] op_sel_hi:[1,1]
  v_accvgpr_read_b32 v57, a90
  v_max_f32 v20, v26, v27
  v_perm_b32 v56, v28, v57, s65
  v_perm_b32 v57, v28, v57, s66
  v_cmp_lt_f32 vcc, 0, v20
  s_getpc_b64 s[74:75]
  s_cbranch_vccnz L_remax
  v_accvgpr_read_b32 v61, a91
  v_exp_f32 v26, v26
  v_exp_f32 v27, v27
  v_perm_b32 v60, v29, v61, s65
  v_pk_mul_f32 v[24:25], v[26:27], s[40:41] op_sel:[0,1] op_sel_hi:[1,1]
  v_perm_b32 v61, v29, v61, s66
  v_add_f32 v32, v26, v27
  v_accvgpr_read_b32 v29, a93
  v_cvt_pk_bf16_f32 v20, v24, 0
  v_and_b32 v28, s64, v29
  v_cvt_pk_bf16_f32 v21, v24, 0
  v_alignbit_b32 v29, v29, v29, 4
  v_cvt_pk_bf16_f32 v23, v25, 0
  v_and_b32 v29, s64, v29
  v_cvt_pk_bf16_f32 v22, v25, 0
  v_cvt_pk_bf16_f32 v24, 0, v24
  v_accvgpr_read_b32 v59, a94
  v_cvt_pk_bf16_f32 v25, 0, v25
  v_perm_b32 v58, v28, v59, s65
  v_add_f32 v5, v5, v32
  v_perm_b32 v59, v28, v59, s66
  v_mov_b32_dpp v20, v24 row_ror:4 row_mask:0xf bank_mask:0xa
  v_accvgpr_read_b32 v63, a95
  v_mov_b32_dpp v21, v24 row_ror:4 row_mask:0xf bank_mask:0x5
  v_perm_b32 v62, v29, v63, s65
  v_mov_b32_dpp v23, v25 row_ror:4 row_mask:0xf bank_mask:0xa
  v_perm_b32 v63, v29, v63, s66
  v_mov_b32_dpp v22, v25 row_ror:4 row_mask:0xf bank_mask:0x5
  ds_read_b64 v[24:25], v3 offset:1024
  buffer_load_dwordx4 a[32:35], v2, s[12:15], s72 offen offset:1024 nt
  v_and_b32_dpp v32, v20, v6 quad_perm:[0,1,2,3] row_mask:0xf bank_mask:0xf
  v_and_b32_dpp v33, v20, v7 row_ror:8 row_mask:0xf bank_mask:0xf
  v_and_b32_dpp v34, v21, v6 row_ror:12 row_mask:0xf bank_mask:0xf
  v_and_b32_dpp v35, v21, v7 row_ror:4 row_mask:0xf bank_mask:0xf
  v_and_b32_dpp v36, v20, v6 row_ror:8 row_mask:0xf bank_mask:0xf
  v_and_b32_dpp v37, v20, v7 quad_perm:[0,1,2,3] row_mask:0xf bank_mask:0xf
  v_mfma_f32_16x16x32_bf16 v[12:15], v[32:35], v[48:51], v[12:15]
  v_and_b32_dpp v38, v21, v6 row_ror:4 row_mask:0xf bank_mask:0xf
  v_and_b32_dpp v39, v21, v7 row_ror:12 row_mask:0xf bank_mask:0xf
  v_mfma_f32_16x16x32_bf16 v[16:19], v[32:35], v[52:55], v[16:19]
  v_and_b32_dpp v40, v23, v6 quad_perm:[0,1,2,3] row_mask:0xf bank_mask:0xf
  v_and_b32_dpp v41, v23, v7 row_ror:8 row_mask:0xf bank_mask:0xf
  v_mfma_f32_16x16x32_bf16 v[12:15], v[36:39], v[56:59], v[12:15]
  v_and_b32_dpp v42, v22, v6 row_ror:12 row_mask:0xf bank_mask:0xf
  v_and_b32_dpp v43, v22, v7 row_ror:4 row_mask:0xf bank_mask:0xf
  v_mfma_f32_16x16x32_bf16 v[16:19], v[36:39], v[60:63], v[16:19]
  v_and_b32_dpp v44, v23, v6 row_ror:8 row_mask:0xf bank_mask:0xf
  v_and_b32_dpp v45, v23, v7 quad_perm:[0,1,2,3] row_mask:0xf bank_mask:0xf
  v_and_b32_dpp v46, v22, v6 row_ror:4 row_mask:0xf bank_mask:0xf
  v_and_b32_dpp v47, v22, v7 row_ror:12 row_mask:0xf bank_mask:0xf
  v_accvgpr_read_b32 v29, a110
  v_and_b32 v28, s64, v29
  v_alignbit_b32 v29, v29, v29, 4
  v_and_b32 v29, s64, v29
  v_accvgpr_read_b32 v49, a108
  v_perm_b32 v48, v28, v49, s65
  v_perm_b32 v49, v28, v49, s66
  v_accvgpr_read_b32 v53, a109
  v_perm_b32 v52, v29, v53, s65
  v_perm_b32 v53, v29, v53, s66
  v_accvgpr_read_b32 v29, a111
  v_and_b32 v28, s64, v29
  v_alignbit_b32 v29, v29, v29, 4
  v_and_b32 v29, s64, v29
  v_accvgpr_read_b32 v51, a112
  v_perm_b32 v50, v28, v51, s65
  v_perm_b32 v51, v28, v51, s66
  v_accvgpr_read_b32 v55, a113
  v_perm_b32 v54, v29, v55, s65
  v_mfma_f32_16x16x32_bf16 v[12:15], v[40:43], v[48:51], v[12:15]
  v_perm_b32 v55, v29, v55, s66
  v_accvgpr_read_b32 v29, a116
  v_and_b32 v28, s64, v29
  v_mfma_f32_16x16x32_bf16 v[16:19], v[40:43], v[52:55], v[16:19]
  v_alignbit_b32 v29, v29, v29, 4
  v_and_b32 v29, s64, v29
  v_accvgpr_read_b32 v57, a114
  v_perm_b32 v56, v28, v57, s65
  v_perm_b32 v57, v28, v57, s66
  v_accvgpr_read_b32 v61, a115
  v_perm_b32 v60, v29, v61, s65
  v_perm_b32 v61, v29, v61, s66
  v_accvgpr_read_b32 v29, a117
  v_and_b32 v28, s64, v29
  v_alignbit_b32 v29, v29, v29, 4
  v_and_b32 v29, s64, v29
  v_accvgpr_read_b32 v59, a118
  v_perm_b32 v58, v28, v59, s65
  v_perm_b32 v59, v28, v59, s66
  v_accvgpr_read_b32 v63, a119
  v_perm_b32 v62, v29, v63, s65
  v_mfma_f32_16x16x32_bf16 v[12:15], v[44:47], v[56:59], v[12:15]
  v_perm_b32 v63, v29, v63, s66
  buffer_load_dwordx4 a[36:39], v2, s[12:15], s72 offen offset:2048 nt
  buffer_load_dwordx4 a[40:43], v2, s[12:15], s72 offen offset:3072 nt
  v_mfma_f32_16x16x32_bf16 v[16:19], v[44:47], v[60:63], v[16:19]
  v_accvgpr_read_b32 v29, a138
  v_and_b32 v28, s64, v29
  v_alignbit_b32 v29, v29, v29, 4
  v_and_b32 v29, s64, v29
  v_accvgpr_read_b32 v49, a136
  v_perm_b32 v48, v28, v49, s65
  v_perm_b32 v49, v28, v49, s66
  v_accvgpr_read_b32 v51, a137
  v_perm_b32 v50, v29, v51, s65
  v_perm_b32 v51, v29, v51, s66
  v_accvgpr_read_b32 v29, a139
  v_and_b32 v28, s64, v29
  v_mfma_f32_16x16x32_bf16 v[32:35], v[48:51], v[8:11], 0
  v_alignbit_b32 v29, v29, v29, 4
  v_and_b32 v29, s64, v29
  v_accvgpr_read_b32 v53, a140
  v_perm_b32 v52, v28, v53, s65
  v_perm_b32 v53, v28, v53, s66
  v_accvgpr_read_b32 v55, a141
  v_perm_b32 v54, v29, v55, s65
  v_perm_b32 v55, v29, v55, s66
  v_accvgpr_read_b32 v29, a144
  v_and_b32 v28, s64, v29
  v_mfma_f32_16x16x32_bf16 v[36:39], v[52:55], v[8:11], 0
  v_alignbit_b32 v29, v29, v29, 4
  v_and_b32 v29, s64, v29
  v_accvgpr_read_b32 v57, a142
  v_perm_b32 v56, v28, v57, s65
  v_perm_b32 v57, v28, v57, s66
  v_accvgpr_read_b32 v59, a143
  v_perm_b32 v58, v29, v59, s65
  v_perm_b32 v59, v29, v59, s66
  v_accvgpr_read_b32 v29, a145
  v_and_b32 v28, s64, v29
  v_mfma_f32_16x16x32_bf16 v[40:43], v[56:59], v[8:11], 0
  v_alignbit_b32 v29, v29, v29, 4
  v_and_b32 v29, s64, v29
  v_accvgpr_read_b32 v61, a146
  v_perm_b32 v60, v28, v61, s65
  v_perm_b32 v61, v28, v61, s66
  v_accvgpr_read_b32 v63, a147
  v_perm_b32 v62, v29, v63, s65
  v_perm_b32 v63, v29, v63, s66
  s_waitcnt lgkmcnt(0)
  s_nop 0
  v_mfma_f32_16x16x32_bf16 v[44:47], v[60:63], v[8:11], 0
  s_bitcmp1_b32 s2, 0
  s_cselect_b32 s10, 0, 0x8000000
  ds_read_b128 v[52:55], v3 offset:12288
  ds_read_b128 v[56:59], v3 offset:13312
  ds_read_b128 v[60:63], v3 offset:14336
  s_xor_b32 s72, s49, 507904
  buffer_load_dwordx4 a[56:59], v1, s[8:11], s72 offen nt
  v_add_f32_dpp v24, v32, v24 quad_perm:[0,1,2,3] row_mask:0xf bank_mask:0x1
  v_mov_b32_dpp v26, v34 row_ror:8 row_mask:0xf bank_mask:0x1
  buffer_load_dwordx4 a[60:63], v1, s[8:11], s72 offen offset:1024 nt
  v_add_f32_dpp v24, v36, v24 row_ror:4 row_mask:0xf bank_mask:0x2
  v_mov_b32_dpp v26, v38 row_ror:12 row_mask:0xf bank_mask:0x2
  buffer_load_dwordx4 a[64:67], v1, s[8:11], s72 offen offset:2048 nt
  v_add_f32_dpp v24, v40, v24 row_ror:8 row_mask:0xf bank_mask:0x4
  v_mov_b32_dpp v26, v42 quad_perm:[0,1,2,3] row_mask:0xf bank_mask:0x4
  s_nop 0
  v_add_f32_dpp v24, v44, v24 row_ror:12 row_mask:0xf bank_mask:0x8
  v_mov_b32_dpp v26, v46 row_ror:4 row_mask:0xf bank_mask:0x8
  s_nop 0
  v_add_f32_dpp v24, v33, v24 row_ror:12 row_mask:0xf bank_mask:0x1
  v_add_f32_dpp v26, v35, v26 row_ror:4 row_mask:0xf bank_mask:0x1
  s_nop 0
  v_add_f32_dpp v24, v37, v24 quad_perm:[0,1,2,3] row_mask:0xf bank_mask:0x2
  v_add_f32_dpp v26, v39, v26 row_ror:8 row_mask:0xf bank_mask:0x2
  s_nop 0
  v_add_f32_dpp v24, v41, v24 row_ror:4 row_mask:0xf bank_mask:0x4
  v_add_f32_dpp v26, v43, v26 row_ror:12 row_mask:0xf bank_mask:0x4
  s_nop 0
  v_add_f32_dpp v24, v45, v24 row_ror:8 row_mask:0xf bank_mask:0x8
  v_add_f32_dpp v26, v47, v26 quad_perm:[0,1,2,3] row_mask:0xf bank_mask:0x8
  v_add_f32 v24, v24, v26
  s_waitcnt lgkmcnt(0)
  v_and_b32 v28, s64, v54
  v_alignbit_b32 v29, v54, v54, 4
  v_and_b32 v29, s64, v29
  v_perm_b32 v48, v28, v52, s65
  v_perm_b32 v49, v28, v52, s66
  v_perm_b32 v50, v29, v53, s65
  v_perm_b32 v51, v29, v53, s66
  v_and_b32 v28, s64, v55
  v_alignbit_b32 v29, v55, v55, 4
  v_mfma_f32_16x16x32_bf16 v[32:35], v[48:51], v[8:11], 0
  v_and_b32 v29, s64, v29
  v_perm_b32 v52, v28, v56, s65
  v_perm_b32 v53, v28, v56, s66
  v_perm_b32 v54, v29, v57, s65
  v_perm_b32 v55, v29, v57, s66
  v_and_b32 v28, s64, v60
  v_alignbit_b32 v29, v60, v60, 4
  v_mfma_f32_16x16x32_bf16 v[36:39], v[52:55], v[8:11], 0
  v_and_b32 v29, s64, v29
  v_perm_b32 v56, v28, v58, s65
  v_perm_b32 v57, v28, v58, s66
  v_perm_b32 v58, v29, v59, s65
  v_perm_b32 v59, v29, v59, s66
  v_and_b32 v28, s64, v61
  v_alignbit_b32 v29, v61, v61, 4
  v_mfma_f32_16x16x32_bf16 v[40:43], v[56:59], v[8:11], 0
  v_and_b32 v29, s64, v29
  v_perm_b32 v60, v28, v62, s65
  v_perm_b32 v61, v28, v62, s66
  v_perm_b32 v62, v29, v63, s65
  v_perm_b32 v63, v29, v63, s66
  v_add_f32_dpp v25, v32, v25 quad_perm:[0,1,2,3] row_mask:0xf bank_mask:0x1
  v_accvgpr_read_b32 v29, a154
  v_mfma_f32_16x16x32_bf16 v[44:47], v[60:63], v[8:11], 0
  v_mov_b32_dpp v27, v34 row_ror:8 row_mask:0xf bank_mask:0x1
  v_and_b32 v28, s64, v29
  v_add_f32_dpp v25, v36, v25 row_ror:4 row_mask:0xf bank_mask:0x2
  v_alignbit_b32 v29, v29, v29, 4
  v_mov_b32_dpp v27, v38 row_ror:12 row_mask:0xf bank_mask:0x2
  v_and_b32 v29, s64, v29
  v_add_f32_dpp v25, v40, v25 row_ror:8 row_mask:0xf bank_mask:0x4
  v_accvgpr_read_b32 v49, a152
  v_mov_b32_dpp v27, v42 quad_perm:[0,1,2,3] row_mask:0xf bank_mask:0x4
  v_perm_b32 v48, v28, v49, s65
  v_add_f32_dpp v25, v44, v25 row_ror:12 row_mask:0xf bank_mask:0x8
  v_perm_b32 v49, v28, v49, s66
  v_mov_b32_dpp v27, v46 row_ror:4 row_mask:0xf bank_mask:0x8
  v_accvgpr_read_b32 v53, a153
  v_add_f32_dpp v25, v33, v25 row_ror:12 row_mask:0xf bank_mask:0x1
  v_perm_b32 v52, v29, v53, s65
  v_add_f32_dpp v27, v35, v27 row_ror:4 row_mask:0xf bank_mask:0x1
  v_perm_b32 v53, v29, v53, s66
  v_add_f32_dpp v25, v37, v25 quad_perm:[0,1,2,3] row_mask:0xf bank_mask:0x2
  v_accvgpr_read_b32 v29, a155
  v_add_f32_dpp v27, v39, v27 row_ror:8 row_mask:0xf bank_mask:0x2
  v_and_b32 v28, s64, v29
  v_add_f32_dpp v25, v41, v25 row_ror:4 row_mask:0xf bank_mask:0x4
  v_alignbit_b32 v29, v29, v29, 4
  v_add_f32_dpp v27, v43, v27 row_ror:12 row_mask:0xf bank_mask:0x4
  v_and_b32 v29, s64, v29
  v_add_f32_dpp v25, v45, v25 row_ror:8 row_mask:0xf bank_mask:0x8
  v_accvgpr_read_b32 v51, a156
  v_add_f32_dpp v27, v47, v27 quad_perm:[0,1,2,3] row_mask:0xf bank_mask:0x8
  v_perm_b32 v50, v28, v51, s65
  v_perm_b32 v51, v28, v51, s66
  v_add_f32 v25, v25, v27
  v_accvgpr_read_b32 v55, a157
  v_cvt_pk_bf16_f32 v32, v24, v25
  v_perm_b32 v54, v29, v55, s65
  v_lshlrev_b32 v24, 16, v32
  v_perm_b32 v55, v29, v55, s66
  v_and_b32 v25, 0xffff0000, v32
  v_accvgpr_read_b32 v29, a160
  v_pk_mul_f32 v[24:25], v[24:25], s[56:57] op_sel_hi:[1,0]
  v_and_b32 v28, s64, v29
  v_cvt_pk_bf16_f32 v32, v24, v25
  v_lshlrev_b32 v24, 16, v32
  v_alignbit_b32 v29, v29, v29, 4
  v_and_b32 v25, 0xffff0000, v32
  ds_write_b64 v3, v[24:25] offset:1024
  v_and_b32 v29, s64, v29
  v_pk_add_f32 v[26:27], v[24:25], v[4:5] op_sel_hi:[1,0] neg_lo:[0,1] neg_hi:[0,1]
  v_pk_mul_f32 v[26:27], v[26:27], s[56:57] op_sel:[0,1] op_sel_hi:[1,1]
  v_accvgpr_read_b32 v57, a158
  v_max_f32 v20, v26, v27
  v_perm_b32 v56, v28, v57, s65
  v_perm_b32 v57, v28, v57, s66
  v_cmp_lt_f32 vcc, 0, v20
  s_getpc_b64 s[74:75]
  s_cbranch_vccnz L_remax
  v_accvgpr_read_b32 v61, a159
  v_exp_f32 v26, v26
  v_exp_f32 v27, v27
  v_perm_b32 v60, v29, v61, s65
  v_pk_mul_f32 v[24:25], v[26:27], s[40:41] op_sel:[0,1] op_sel_hi:[1,1]
  v_perm_b32 v61, v29, v61, s66
  v_add_f32 v32, v26, v27
  v_accvgpr_read_b32 v29, a161
  v_cvt_pk_bf16_f32 v20, v24, 0
  v_and_b32 v28, s64, v29
  v_cvt_pk_bf16_f32 v21, v24, 0
  v_alignbit_b32 v29, v29, v29, 4
  v_cvt_pk_bf16_f32 v23, v25, 0
  v_and_b32 v29, s64, v29
  v_cvt_pk_bf16_f32 v22, v25, 0
  v_cvt_pk_bf16_f32 v24, 0, v24
  v_accvgpr_read_b32 v59, a162
  v_cvt_pk_bf16_f32 v25, 0, v25
  v_perm_b32 v58, v28, v59, s65
  v_add_f32 v5, v5, v32
  v_perm_b32 v59, v28, v59, s66
  v_mov_b32_dpp v20, v24 row_ror:4 row_mask:0xf bank_mask:0xa
  v_accvgpr_read_b32 v63, a163
  v_mov_b32_dpp v21, v24 row_ror:4 row_mask:0xf bank_mask:0x5
  v_perm_b32 v62, v29, v63, s65
  v_mov_b32_dpp v23, v25 row_ror:4 row_mask:0xf bank_mask:0xa
  v_perm_b32 v63, v29, v63, s66
  v_mov_b32_dpp v22, v25 row_ror:4 row_mask:0xf bank_mask:0x5
  ds_read_b64 v[24:25], v3 offset:1032
  buffer_load_dwordx4 a[68:71], v1, s[8:11], s72 offen offset:3072 nt
  v_and_b32_dpp v32, v20, v6 quad_perm:[0,1,2,3] row_mask:0xf bank_mask:0xf
  v_and_b32_dpp v33, v20, v7 row_ror:8 row_mask:0xf bank_mask:0xf
  v_and_b32_dpp v34, v21, v6 row_ror:12 row_mask:0xf bank_mask:0xf
  v_and_b32_dpp v35, v21, v7 row_ror:4 row_mask:0xf bank_mask:0xf
  v_and_b32_dpp v36, v20, v6 row_ror:8 row_mask:0xf bank_mask:0xf
  v_and_b32_dpp v37, v20, v7 quad_perm:[0,1,2,3] row_mask:0xf bank_mask:0xf
  v_mfma_f32_16x16x32_bf16 v[12:15], v[32:35], v[48:51], v[12:15]
  v_and_b32_dpp v38, v21, v6 row_ror:4 row_mask:0xf bank_mask:0xf
  v_and_b32_dpp v39, v21, v7 row_ror:12 row_mask:0xf bank_mask:0xf
  v_mfma_f32_16x16x32_bf16 v[16:19], v[32:35], v[52:55], v[16:19]
  v_and_b32_dpp v40, v23, v6 quad_perm:[0,1,2,3] row_mask:0xf bank_mask:0xf
  v_and_b32_dpp v41, v23, v7 row_ror:8 row_mask:0xf bank_mask:0xf
  v_mfma_f32_16x16x32_bf16 v[12:15], v[36:39], v[56:59], v[12:15]
  v_and_b32_dpp v42, v22, v6 row_ror:12 row_mask:0xf bank_mask:0xf
  v_and_b32_dpp v43, v22, v7 row_ror:4 row_mask:0xf bank_mask:0xf
  v_mfma_f32_16x16x32_bf16 v[16:19], v[36:39], v[60:63], v[16:19]
  v_and_b32_dpp v44, v23, v6 row_ror:8 row_mask:0xf bank_mask:0xf
  v_and_b32_dpp v45, v23, v7 quad_perm:[0,1,2,3] row_mask:0xf bank_mask:0xf
  v_and_b32_dpp v46, v22, v6 row_ror:4 row_mask:0xf bank_mask:0xf
  v_and_b32_dpp v47, v22, v7 row_ror:12 row_mask:0xf bank_mask:0xf
  v_accvgpr_read_b32 v29, a178
  v_and_b32 v28, s64, v29
  v_alignbit_b32 v29, v29, v29, 4
  v_and_b32 v29, s64, v29
  v_accvgpr_read_b32 v49, a176
  v_perm_b32 v48, v28, v49, s65
  v_perm_b32 v49, v28, v49, s66
  v_accvgpr_read_b32 v53, a177
  v_perm_b32 v52, v29, v53, s65
  v_perm_b32 v53, v29, v53, s66
  v_accvgpr_read_b32 v29, a179
  v_and_b32 v28, s64, v29
  v_alignbit_b32 v29, v29, v29, 4
  v_and_b32 v29, s64, v29
  v_accvgpr_read_b32 v51, a180
  v_perm_b32 v50, v28, v51, s65
  v_perm_b32 v51, v28, v51, s66
  v_accvgpr_read_b32 v55, a181
  v_perm_b32 v54, v29, v55, s65
  v_mfma_f32_16x16x32_bf16 v[12:15], v[40:43], v[48:51], v[12:15]
  v_perm_b32 v55, v29, v55, s66
  v_accvgpr_read_b32 v29, a184
  v_and_b32 v28, s64, v29
  v_mfma_f32_16x16x32_bf16 v[16:19], v[40:43], v[52:55], v[16:19]
  v_alignbit_b32 v29, v29, v29, 4
  v_and_b32 v29, s64, v29
  v_accvgpr_read_b32 v57, a182
  v_perm_b32 v56, v28, v57, s65
  v_perm_b32 v57, v28, v57, s66
  v_accvgpr_read_b32 v61, a183
  v_perm_b32 v60, v29, v61, s65
  v_perm_b32 v61, v29, v61, s66
  v_accvgpr_read_b32 v29, a185
  v_and_b32 v28, s64, v29
  v_alignbit_b32 v29, v29, v29, 4
  v_and_b32 v29, s64, v29
  v_accvgpr_read_b32 v59, a186
  v_perm_b32 v58, v28, v59, s65
  v_perm_b32 v59, v28, v59, s66
  v_accvgpr_read_b32 v63, a187
  v_perm_b32 v62, v29, v63, s65
  v_mfma_f32_16x16x32_bf16 v[12:15], v[44:47], v[56:59], v[12:15]
  v_perm_b32 v63, v29, v63, s66
  s_xor_b32 s72, s49, 180224
  buffer_load_dwordx4 a[72:75], v2, s[12:15], s72 offen nt
  v_mfma_f32_16x16x32_bf16 v[16:19], v[44:47], v[60:63], v[16:19]
  buffer_load_dwordx4 a[76:79], v2, s[12:15], s72 offen offset:1024 nt
  v_accvgpr_read_b32 v29, a206
  v_and_b32 v28, s64, v29
  v_alignbit_b32 v29, v29, v29, 4
  v_and_b32 v29, s64, v29
  v_accvgpr_read_b32 v49, a204
  v_perm_b32 v48, v28, v49, s65
  v_perm_b32 v49, v28, v49, s66
  v_accvgpr_read_b32 v51, a205
  v_perm_b32 v50, v29, v51, s65
  v_perm_b32 v51, v29, v51, s66
  v_accvgpr_read_b32 v29, a207
  v_and_b32 v28, s64, v29
  v_mfma_f32_16x16x32_bf16 v[32:35], v[48:51], v[8:11], 0
  v_alignbit_b32 v29, v29, v29, 4
  v_and_b32 v29, s64, v29
  v_accvgpr_read_b32 v53, a208
  v_perm_b32 v52, v28, v53, s65
  v_perm_b32 v53, v28, v53, s66
  v_accvgpr_read_b32 v55, a209
  v_perm_b32 v54, v29, v55, s65
  v_perm_b32 v55, v29, v55, s66
  v_accvgpr_read_b32 v29, a212
  v_and_b32 v28, s64, v29
  v_mfma_f32_16x16x32_bf16 v[36:39], v[52:55], v[8:11], 0
  v_alignbit_b32 v29, v29, v29, 4
  v_and_b32 v29, s64, v29
  v_accvgpr_read_b32 v57, a210
  v_perm_b32 v56, v28, v57, s65
  v_perm_b32 v57, v28, v57, s66
  v_accvgpr_read_b32 v59, a211
  v_perm_b32 v58, v29, v59, s65
  v_perm_b32 v59, v29, v59, s66
  v_accvgpr_read_b32 v29, a213
  v_and_b32 v28, s64, v29
  v_mfma_f32_16x16x32_bf16 v[40:43], v[56:59], v[8:11], 0
  v_alignbit_b32 v29, v29, v29, 4
  v_and_b32 v29, s64, v29
  v_accvgpr_read_b32 v61, a214
  v_perm_b32 v60, v28, v61, s65
  v_perm_b32 v61, v28, v61, s66
  v_accvgpr_read_b32 v63, a215
  v_perm_b32 v62, v29, v63, s65
  v_perm_b32 v63, v29, v63, s66
  s_waitcnt lgkmcnt(0)
  ds_read_b128 v[52:55], v3 offset:15360
  v_mfma_f32_16x16x32_bf16 v[44:47], v[60:63], v[8:11], 0
  ds_read_b128 v[56:59], v3 offset:16384
  ds_read_b128 v[60:63], v3 offset:17408
  buffer_load_dwordx4 a[84:87], v2, s[12:15], s72 offen offset:2048 nt
  v_add_f32_dpp v24, v32, v24 quad_perm:[0,1,2,3] row_mask:0xf bank_mask:0x1
  v_mov_b32_dpp v26, v34 row_ror:8 row_mask:0xf bank_mask:0x1
  buffer_load_dwordx4 a[88:91], v2, s[12:15], s72 offen offset:3072 nt
  v_add_f32_dpp v24, v36, v24 row_ror:4 row_mask:0xf bank_mask:0x2
  v_mov_b32_dpp v26, v38 row_ror:12 row_mask:0xf bank_mask:0x2
  s_nop 0
  v_add_f32_dpp v24, v40, v24 row_ror:8 row_mask:0xf bank_mask:0x4
  v_mov_b32_dpp v26, v42 quad_perm:[0,1,2,3] row_mask:0xf bank_mask:0x4
  s_nop 0
  v_add_f32_dpp v24, v44, v24 row_ror:12 row_mask:0xf bank_mask:0x8
  v_mov_b32_dpp v26, v46 row_ror:4 row_mask:0xf bank_mask:0x8
  s_nop 0
  v_add_f32_dpp v24, v33, v24 row_ror:12 row_mask:0xf bank_mask:0x1
  v_add_f32_dpp v26, v35, v26 row_ror:4 row_mask:0xf bank_mask:0x1
  s_nop 0
  v_add_f32_dpp v24, v37, v24 quad_perm:[0,1,2,3] row_mask:0xf bank_mask:0x2
  v_add_f32_dpp v26, v39, v26 row_ror:8 row_mask:0xf bank_mask:0x2
  s_nop 0
  v_add_f32_dpp v24, v41, v24 row_ror:4 row_mask:0xf bank_mask:0x4
  v_add_f32_dpp v26, v43, v26 row_ror:12 row_mask:0xf bank_mask:0x4
  s_nop 0
  v_add_f32_dpp v24, v45, v24 row_ror:8 row_mask:0xf bank_mask:0x8
  v_add_f32_dpp v26, v47, v26 quad_perm:[0,1,2,3] row_mask:0xf bank_mask:0x8
  s_waitcnt lgkmcnt(0)
  v_and_b32 v28, s64, v54
  v_alignbit_b32 v29, v54, v54, 4
  v_and_b32 v29, s64, v29
  v_perm_b32 v48, v28, v52, s65
  v_perm_b32 v49, v28, v52, s66
  v_perm_b32 v50, v29, v53, s65
  v_perm_b32 v51, v29, v53, s66
  v_and_b32 v28, s64, v55
  v_alignbit_b32 v29, v55, v55, 4
  v_mfma_f32_16x16x32_bf16 v[32:35], v[48:51], v[8:11], 0
  v_and_b32 v29, s64, v29
  v_perm_b32 v52, v28, v56, s65
  v_perm_b32 v53, v28, v56, s66
  v_perm_b32 v54, v29, v57, s65
  v_perm_b32 v55, v29, v57, s66
  v_and_b32 v28, s64, v60
  v_alignbit_b32 v29, v60, v60, 4
  v_mfma_f32_16x16x32_bf16 v[36:39], v[52:55], v[8:11], 0
  v_and_b32 v29, s64, v29
  v_perm_b32 v56, v28, v58, s65
  v_perm_b32 v57, v28, v58, s66
  v_perm_b32 v58, v29, v59, s65
  v_perm_b32 v59, v29, v59, s66
  v_and_b32 v28, s64, v61
  v_alignbit_b32 v29, v61, v61, 4
  v_mfma_f32_16x16x32_bf16 v[40:43], v[56:59], v[8:11], 0
  v_and_b32 v29, s64, v29
  v_perm_b32 v60, v28, v62, s65
  v_perm_b32 v61, v28, v62, s66
  v_perm_b32 v62, v29, v63, s65
  v_perm_b32 v63, v29, v63, s66
  s_nop 1
  v_mfma_f32_16x16x32_bf16 v[44:47], v[60:63], v[8:11], 0
  s_bitcmp1_b32 s2, 0
  s_cselect_b32 s14, 0, 0x8000000
  s_xor_b32 s72, s49, 491520
  buffer_load_dwordx4 a[92:95], v2, s[12:15], s72 offen nt
  v_add_f32_dpp v25, v32, v25 quad_perm:[0,1,2,3] row_mask:0xf bank_mask:0x1
  v_accvgpr_read_b32 v29, a222
  v_mov_b32_dpp v27, v34 row_ror:8 row_mask:0xf bank_mask:0x1
  v_and_b32 v28, s64, v29
  v_add_f32_dpp v25, v36, v25 row_ror:4 row_mask:0xf bank_mask:0x2
  v_alignbit_b32 v29, v29, v29, 4
  v_mov_b32_dpp v27, v38 row_ror:12 row_mask:0xf bank_mask:0x2
  v_and_b32 v29, s64, v29
  v_add_f32_dpp v25, v40, v25 row_ror:8 row_mask:0xf bank_mask:0x4
  v_accvgpr_read_b32 v49, a220
  v_mov_b32_dpp v27, v42 quad_perm:[0,1,2,3] row_mask:0xf bank_mask:0x4
  v_perm_b32 v48, v28, v49, s65
  v_add_f32_dpp v25, v44, v25 row_ror:12 row_mask:0xf bank_mask:0x8
  v_perm_b32 v49, v28, v49, s66
  v_mov_b32_dpp v27, v46 row_ror:4 row_mask:0xf bank_mask:0x8
  v_accvgpr_read_b32 v53, a221
  v_add_f32_dpp v25, v33, v25 row_ror:12 row_mask:0xf bank_mask:0x1
  v_perm_b32 v52, v29, v53, s65
  v_add_f32_dpp v27, v35, v27 row_ror:4 row_mask:0xf bank_mask:0x1
  v_perm_b32 v53, v29, v53, s66
  v_add_f32_dpp v25, v37, v25 quad_perm:[0,1,2,3] row_mask:0xf bank_mask:0x2
  v_accvgpr_read_b32 v29, a223
  v_add_f32_dpp v27, v39, v27 row_ror:8 row_mask:0xf bank_mask:0x2
  v_and_b32 v28, s64, v29
  v_add_f32_dpp v25, v41, v25 row_ror:4 row_mask:0xf bank_mask:0x4
  v_alignbit_b32 v29, v29, v29, 4
  v_add_f32_dpp v27, v43, v27 row_ror:12 row_mask:0xf bank_mask:0x4
  v_and_b32 v29, s64, v29
  v_add_f32_dpp v25, v45, v25 row_ror:8 row_mask:0xf bank_mask:0x8
  v_accvgpr_read_b32 v51, a224
  v_add_f32_dpp v27, v47, v27 quad_perm:[0,1,2,3] row_mask:0xf bank_mask:0x8
  v_perm_b32 v50, v28, v51, s65
  v_add_f32 v24, v24, v26
  v_perm_b32 v51, v28, v51, s66
  v_add_f32 v25, v25, v27
  v_accvgpr_read_b32 v55, a225
  v_cvt_pk_bf16_f32 v32, v24, v25
  v_perm_b32 v54, v29, v55, s65
  v_lshlrev_b32 v24, 16, v32
  v_perm_b32 v55, v29, v55, s66
  v_and_b32 v25, 0xffff0000, v32
  v_accvgpr_read_b32 v29, a228
  v_pk_mul_f32 v[24:25], v[24:25], s[56:57] op_sel_hi:[1,0]
  v_and_b32 v28, s64, v29
  v_cvt_pk_bf16_f32 v32, v24, v25
  v_lshlrev_b32 v24, 16, v32
  v_alignbit_b32 v29, v29, v29, 4
  v_and_b32 v25, 0xffff0000, v32
  ds_write_b64 v3, v[24:25] offset:1032
  v_and_b32 v29, s64, v29
  v_pk_add_f32 v[26:27], v[24:25], v[4:5] op_sel_hi:[1,0] neg_lo:[0,1] neg_hi:[0,1]
  v_pk_mul_f32 v[26:27], v[26:27], s[56:57] op_sel:[0,1] op_sel_hi:[1,1]
  v_accvgpr_read_b32 v57, a226
  v_max_f32 v20, v26, v27
  v_perm_b32 v56, v28, v57, s65
  v_perm_b32 v57, v28, v57, s66
  v_cmp_lt_f32 vcc, 0, v20
  s_getpc_b64 s[74:75]
  s_cbranch_vccnz L_remax
  v_accvgpr_read_b32 v61, a227
  v_exp_f32 v26, v26
  v_exp_f32 v27, v27
  v_perm_b32 v60, v29, v61, s65
  v_pk_mul_f32 v[24:25], v[26:27], s[40:41] op_sel:[0,1] op_sel_hi:[1,1]
  v_perm_b32 v61, v29, v61, s66
  v_add_f32 v32, v26, v27
  v_accvgpr_read_b32 v29, a229
  v_cvt_pk_bf16_f32 v20, v24, 0
  v_and_b32 v28, s64, v29
  v_cvt_pk_bf16_f32 v21, v24, 0
  v_alignbit_b32 v29, v29, v29, 4
  v_cvt_pk_bf16_f32 v23, v25, 0
  v_and_b32 v29, s64, v29
  v_cvt_pk_bf16_f32 v22, v25, 0
  v_cvt_pk_bf16_f32 v24, 0, v24
  v_accvgpr_read_b32 v59, a230
  v_cvt_pk_bf16_f32 v25, 0, v25
  v_perm_b32 v58, v28, v59, s65
  v_add_f32 v5, v5, v32
  v_perm_b32 v59, v28, v59, s66
  v_mov_b32_dpp v20, v24 row_ror:4 row_mask:0xf bank_mask:0xa
  v_accvgpr_read_b32 v63, a231
  v_mov_b32_dpp v21, v24 row_ror:4 row_mask:0xf bank_mask:0x5
  v_perm_b32 v62, v29, v63, s65
  v_mov_b32_dpp v23, v25 row_ror:4 row_mask:0xf bank_mask:0xa
  v_perm_b32 v63, v29, v63, s66
  v_mov_b32_dpp v22, v25 row_ror:4 row_mask:0xf bank_mask:0x5
  ds_read_b64 v[24:25], v3 offset:2048
  buffer_load_dwordx4 a[108:111], v2, s[12:15], s72 offen offset:1024 nt
  v_and_b32_dpp v32, v20, v6 quad_perm:[0,1,2,3] row_mask:0xf bank_mask:0xf
  v_and_b32_dpp v33, v20, v7 row_ror:8 row_mask:0xf bank_mask:0xf
  v_and_b32_dpp v34, v21, v6 row_ror:12 row_mask:0xf bank_mask:0xf
  v_and_b32_dpp v35, v21, v7 row_ror:4 row_mask:0xf bank_mask:0xf
  v_and_b32_dpp v36, v20, v6 row_ror:8 row_mask:0xf bank_mask:0xf
  v_and_b32_dpp v37, v20, v7 quad_perm:[0,1,2,3] row_mask:0xf bank_mask:0xf
  v_mfma_f32_16x16x32_bf16 v[12:15], v[32:35], v[48:51], v[12:15]
  v_and_b32_dpp v38, v21, v6 row_ror:4 row_mask:0xf bank_mask:0xf
  v_and_b32_dpp v39, v21, v7 row_ror:12 row_mask:0xf bank_mask:0xf
  v_mfma_f32_16x16x32_bf16 v[16:19], v[32:35], v[52:55], v[16:19]
  v_and_b32_dpp v40, v23, v6 quad_perm:[0,1,2,3] row_mask:0xf bank_mask:0xf
  v_and_b32_dpp v41, v23, v7 row_ror:8 row_mask:0xf bank_mask:0xf
  v_mfma_f32_16x16x32_bf16 v[12:15], v[36:39], v[56:59], v[12:15]
  v_and_b32_dpp v42, v22, v6 row_ror:12 row_mask:0xf bank_mask:0xf
  v_and_b32_dpp v43, v22, v7 row_ror:4 row_mask:0xf bank_mask:0xf
  v_mfma_f32_16x16x32_bf16 v[16:19], v[36:39], v[60:63], v[16:19]
  v_and_b32_dpp v44, v23, v6 row_ror:8 row_mask:0xf bank_mask:0xf
  v_and_b32_dpp v45, v23, v7 quad_perm:[0,1,2,3] row_mask:0xf bank_mask:0xf
  v_and_b32_dpp v46, v22, v6 row_ror:4 row_mask:0xf bank_mask:0xf
  v_and_b32_dpp v47, v22, v7 row_ror:12 row_mask:0xf bank_mask:0xf
  v_accvgpr_read_b32 v29, a246
  v_and_b32 v28, s64, v29
  v_alignbit_b32 v29, v29, v29, 4
  v_and_b32 v29, s64, v29
  v_accvgpr_read_b32 v49, a244
  v_perm_b32 v48, v28, v49, s65
  v_perm_b32 v49, v28, v49, s66
  v_accvgpr_read_b32 v53, a245
  v_perm_b32 v52, v29, v53, s65
  v_perm_b32 v53, v29, v53, s66
  v_accvgpr_read_b32 v29, a247
  v_and_b32 v28, s64, v29
  v_alignbit_b32 v29, v29, v29, 4
  v_and_b32 v29, s64, v29
  v_accvgpr_read_b32 v51, a248
  v_perm_b32 v50, v28, v51, s65
  v_perm_b32 v51, v28, v51, s66
  v_accvgpr_read_b32 v55, a249
  v_perm_b32 v54, v29, v55, s65
  v_mfma_f32_16x16x32_bf16 v[12:15], v[40:43], v[48:51], v[12:15]
  v_perm_b32 v55, v29, v55, s66
  v_accvgpr_read_b32 v29, a252
  v_and_b32 v28, s64, v29
  v_mfma_f32_16x16x32_bf16 v[16:19], v[40:43], v[52:55], v[16:19]
  v_alignbit_b32 v29, v29, v29, 4
  v_and_b32 v29, s64, v29
  v_accvgpr_read_b32 v57, a250
  v_perm_b32 v56, v28, v57, s65
  v_perm_b32 v57, v28, v57, s66
  v_accvgpr_read_b32 v61, a251
  v_perm_b32 v60, v29, v61, s65
  v_perm_b32 v61, v29, v61, s66
  v_accvgpr_read_b32 v29, a253
  v_and_b32 v28, s64, v29
  v_alignbit_b32 v29, v29, v29, 4
  v_and_b32 v29, s64, v29
  v_accvgpr_read_b32 v59, a254
  v_perm_b32 v58, v28, v59, s65
  v_perm_b32 v59, v28, v59, s66
  v_accvgpr_read_b32 v63, a255
  v_perm_b32 v62, v29, v63, s65
  v_mfma_f32_16x16x32_bf16 v[12:15], v[44:47], v[56:59], v[12:15]
  v_perm_b32 v63, v29, v63, s66
  buffer_load_dwordx4 a[112:115], v2, s[12:15], s72 offen offset:2048 nt
  v_and_b32 v28, s64, v218
  v_mfma_f32_16x16x32_bf16 v[16:19], v[44:47], v[60:63], v[16:19]
  v_alignbit_b32 v29, v218, v218, 4
  v_and_b32 v29, s64, v29
  v_perm_b32 v48, v28, v216, s65
  v_perm_b32 v49, v28, v216, s66
  v_perm_b32 v50, v29, v217, s65
  v_perm_b32 v51, v29, v217, s66
  v_and_b32 v28, s64, v219
  v_alignbit_b32 v29, v219, v219, 4
  v_mfma_f32_16x16x32_bf16 v[32:35], v[48:51], v[8:11], 0
  v_and_b32 v29, s64, v29
  v_perm_b32 v52, v28, v220, s65
  v_perm_b32 v53, v28, v220, s66
  v_perm_b32 v54, v29, v221, s65
  v_perm_b32 v55, v29, v221, s66
  v_and_b32 v28, s64, v224
  v_alignbit_b32 v29, v224, v224, 4
  v_mfma_f32_16x16x32_bf16 v[36:39], v[52:55], v[8:11], 0
  v_and_b32 v29, s64, v29
  v_perm_b32 v56, v28, v222, s65
  v_perm_b32 v57, v28, v222, s66
  v_perm_b32 v58, v29, v223, s65
  v_perm_b32 v59, v29, v223, s66
  v_and_b32 v28, s64, v225
  v_alignbit_b32 v29, v225, v225, 4
  v_mfma_f32_16x16x32_bf16 v[40:43], v[56:59], v[8:11], 0
  v_and_b32 v29, s64, v29
  v_perm_b32 v60, v28, v226, s65
  v_perm_b32 v61, v28, v226, s66
  v_perm_b32 v62, v29, v227, s65
  v_perm_b32 v63, v29, v227, s66
  s_waitcnt lgkmcnt(0)
  ds_read_b128 v[52:55], v3 offset:18432
  v_mfma_f32_16x16x32_bf16 v[44:47], v[60:63], v[8:11], 0
  ds_read_b128 v[56:59], v3 offset:19456
  ds_read_b128 v[60:63], v3 offset:20480
  buffer_load_dwordx4 a[116:119], v2, s[12:15], s72 offen offset:3072 nt
  s_mov_b32 s10, 0x8000000
  s_xor_b32 s72, s49, 196608
  buffer_load_dwordx4 a[136:139], v1, s[8:11], s72 offen nt
  v_add_f32_dpp v24, v32, v24 quad_perm:[0,1,2,3] row_mask:0xf bank_mask:0x1
  v_mov_b32_dpp v26, v34 row_ror:8 row_mask:0xf bank_mask:0x1
  buffer_load_dwordx4 a[140:143], v1, s[8:11], s72 offen offset:1024 nt
  v_add_f32_dpp v24, v36, v24 row_ror:4 row_mask:0xf bank_mask:0x2
  v_mov_b32_dpp v26, v38 row_ror:12 row_mask:0xf bank_mask:0x2
  s_nop 0
  v_add_f32_dpp v24, v40, v24 row_ror:8 row_mask:0xf bank_mask:0x4
  v_mov_b32_dpp v26, v42 quad_perm:[0,1,2,3] row_mask:0xf bank_mask:0x4
  s_nop 0
  v_add_f32_dpp v24, v44, v24 row_ror:12 row_mask:0xf bank_mask:0x8
  v_mov_b32_dpp v26, v46 row_ror:4 row_mask:0xf bank_mask:0x8
  s_nop 0
  v_add_f32_dpp v24, v33, v24 row_ror:12 row_mask:0xf bank_mask:0x1
  v_add_f32_dpp v26, v35, v26 row_ror:4 row_mask:0xf bank_mask:0x1
  s_nop 0
  v_add_f32_dpp v24, v37, v24 quad_perm:[0,1,2,3] row_mask:0xf bank_mask:0x2
  v_add_f32_dpp v26, v39, v26 row_ror:8 row_mask:0xf bank_mask:0x2
  s_nop 0
  v_add_f32_dpp v24, v41, v24 row_ror:4 row_mask:0xf bank_mask:0x4
  v_add_f32_dpp v26, v43, v26 row_ror:12 row_mask:0xf bank_mask:0x4
  s_nop 0
  v_add_f32_dpp v24, v45, v24 row_ror:8 row_mask:0xf bank_mask:0x8
  v_add_f32_dpp v26, v47, v26 quad_perm:[0,1,2,3] row_mask:0xf bank_mask:0x8
  v_add_f32 v24, v24, v26
  s_waitcnt lgkmcnt(0)
  v_and_b32 v28, s64, v54
  v_alignbit_b32 v29, v54, v54, 4
  v_and_b32 v29, s64, v29
  v_perm_b32 v48, v28, v52, s65
  v_perm_b32 v49, v28, v52, s66
  v_perm_b32 v50, v29, v53, s65
  v_perm_b32 v51, v29, v53, s66
  v_and_b32 v28, s64, v55
  v_alignbit_b32 v29, v55, v55, 4
  v_mfma_f32_16x16x32_bf16 v[32:35], v[48:51], v[8:11], 0
  v_and_b32 v29, s64, v29
  v_perm_b32 v52, v28, v56, s65
  v_perm_b32 v53, v28, v56, s66
  v_perm_b32 v54, v29, v57, s65
  v_perm_b32 v55, v29, v57, s66
  v_and_b32 v28, s64, v60
  v_alignbit_b32 v29, v60, v60, 4
  v_mfma_f32_16x16x32_bf16 v[36:39], v[52:55], v[8:11], 0
  v_and_b32 v29, s64, v29
  v_perm_b32 v56, v28, v58, s65
  v_perm_b32 v57, v28, v58, s66
  v_perm_b32 v58, v29, v59, s65
  v_perm_b32 v59, v29, v59, s66
  v_and_b32 v28, s64, v61
  v_alignbit_b32 v29, v61, v61, 4
  v_mfma_f32_16x16x32_bf16 v[40:43], v[56:59], v[8:11], 0
  v_and_b32 v29, s64, v29
  v_perm_b32 v60, v28, v62, s65
  v_perm_b32 v61, v28, v62, s66
  v_perm_b32 v62, v29, v63, s65
  v_perm_b32 v63, v29, v63, s66
  v_add_f32_dpp v25, v32, v25 quad_perm:[0,1,2,3] row_mask:0xf bank_mask:0x1
  v_and_b32 v28, s64, v66
  v_mfma_f32_16x16x32_bf16 v[44:47], v[60:63], v[8:11], 0
  v_mov_b32_dpp v27, v34 row_ror:8 row_mask:0xf bank_mask:0x1
  v_alignbit_b32 v29, v66, v66, 4
  v_add_f32_dpp v25, v36, v25 row_ror:4 row_mask:0xf bank_mask:0x2
  v_and_b32 v29, s64, v29
  v_mov_b32_dpp v27, v38 row_ror:12 row_mask:0xf bank_mask:0x2
  v_perm_b32 v48, v28, v64, s65
  v_add_f32_dpp v25, v40, v25 row_ror:8 row_mask:0xf bank_mask:0x4
  v_perm_b32 v49, v28, v64, s66
  v_mov_b32_dpp v27, v42 quad_perm:[0,1,2,3] row_mask:0xf bank_mask:0x4
  v_perm_b32 v52, v29, v65, s65
  v_add_f32_dpp v25, v44, v25 row_ror:12 row_mask:0xf bank_mask:0x8
  v_perm_b32 v53, v29, v65, s66
  v_mov_b32_dpp v27, v46 row_ror:4 row_mask:0xf bank_mask:0x8
  v_and_b32 v28, s64, v67
  v_add_f32_dpp v25, v33, v25 row_ror:12 row_mask:0xf bank_mask:0x1
  v_alignbit_b32 v29, v67, v67, 4
  v_add_f32_dpp v27, v35, v27 row_ror:4 row_mask:0xf bank_mask:0x1
  v_and_b32 v29, s64, v29
  v_add_f32_dpp v25, v37, v25 quad_perm:[0,1,2,3] row_mask:0xf bank_mask:0x2
  v_perm_b32 v50, v28, v68, s65
  v_add_f32_dpp v27, v39, v27 row_ror:8 row_mask:0xf bank_mask:0x2
  v_perm_b32 v51, v28, v68, s66
  v_add_f32_dpp v25, v41, v25 row_ror:4 row_mask:0xf bank_mask:0x4
  v_perm_b32 v54, v29, v69, s65
  v_add_f32_dpp v27, v43, v27 row_ror:12 row_mask:0xf bank_mask:0x4
  v_perm_b32 v55, v29, v69, s66
  v_add_f32_dpp v25, v45, v25 row_ror:8 row_mask:0xf bank_mask:0x8
  v_and_b32 v28, s64, v72
  v_add_f32_dpp v27, v47, v27 quad_perm:[0,1,2,3] row_mask:0xf bank_mask:0x8
  v_alignbit_b32 v29, v72, v72, 4
  v_and_b32 v29, s64, v29
  v_add_f32 v25, v25, v27
  v_cvt_pk_bf16_f32 v32, v24, v25
  v_perm_b32 v56, v28, v70, s65
  v_lshlrev_b32 v24, 16, v32
  v_and_b32 v25, 0xffff0000, v32
  v_perm_b32 v57, v28, v70, s66
  v_pk_mul_f32 v[24:25], v[24:25], s[56:57] op_sel_hi:[1,0]
  v_cvt_pk_bf16_f32 v32, v24, v25
  v_lshlrev_b32 v24, 16, v32
  v_perm_b32 v60, v29, v71, s65
  v_and_b32 v25, 0xffff0000, v32
  ds_write_b64 v3, v[24:25] offset:2048
  v_pk_add_f32 v[26:27], v[24:25], v[4:5] op_sel_hi:[1,0] neg_lo:[0,1] neg_hi:[0,1]
  v_pk_mul_f32 v[26:27], v[26:27], s[56:57] op_sel:[0,1] op_sel_hi:[1,1]
  v_perm_b32 v61, v29, v71, s66
  v_max_f32 v20, v26, v27
  v_and_b32 v28, s64, v73
  v_cmp_lt_f32 vcc, 0, v20
  s_getpc_b64 s[74:75]
  s_cbranch_vccnz L_remax
  v_exp_f32 v26, v26
  v_exp_f32 v27, v27
  v_alignbit_b32 v29, v73, v73, 4
  v_pk_mul_f32 v[24:25], v[26:27], s[40:41] op_sel:[0,1] op_sel_hi:[1,1]
  v_add_f32 v32, v26, v27
  v_and_b32 v29, s64, v29
  v_cvt_pk_bf16_f32 v20, v24, 0
  v_cvt_pk_bf16_f32 v21, v24, 0
  v_perm_b32 v58, v28, v74, s65
  v_cvt_pk_bf16_f32 v23, v25, 0
  v_cvt_pk_bf16_f32 v22, v25, 0
  v_cvt_pk_bf16_f32 v24, 0, v24
  v_perm_b32 v59, v28, v74, s66
  v_cvt_pk_bf16_f32 v25, 0, v25
  v_add_f32 v5, v5, v32
  v_perm_b32 v62, v29, v75, s65
  v_mov_b32_dpp v20, v24 row_ror:4 row_mask:0xf bank_mask:0xa
  v_mov_b32_dpp v21, v24 row_ror:4 row_mask:0xf bank_mask:0x5
  v_perm_b32 v63, v29, v75, s66
  v_mov_b32_dpp v23, v25 row_ror:4 row_mask:0xf bank_mask:0xa
  v_mov_b32_dpp v22, v25 row_ror:4 row_mask:0xf bank_mask:0x5
  ds_read_b64 v[24:25], v3 offset:2056
  buffer_load_dwordx4 a[144:147], v1, s[8:11], s72 offen offset:2048 nt
  buffer_load_dwordx4 a[152:155], v1, s[8:11], s72 offen offset:3072 nt
  v_and_b32_dpp v32, v20, v6 quad_perm:[0,1,2,3] row_mask:0xf bank_mask:0xf
  v_and_b32_dpp v33, v20, v7 row_ror:8 row_mask:0xf bank_mask:0xf
  v_and_b32_dpp v34, v21, v6 row_ror:12 row_mask:0xf bank_mask:0xf
  v_and_b32_dpp v35, v21, v7 row_ror:4 row_mask:0xf bank_mask:0xf
  v_and_b32_dpp v36, v20, v6 row_ror:8 row_mask:0xf bank_mask:0xf
  v_and_b32_dpp v37, v20, v7 quad_perm:[0,1,2,3] row_mask:0xf bank_mask:0xf
  v_mfma_f32_16x16x32_bf16 v[12:15], v[32:35], v[48:51], v[12:15]
  v_and_b32_dpp v38, v21, v6 row_ror:4 row_mask:0xf bank_mask:0xf
  v_and_b32_dpp v39, v21, v7 row_ror:12 row_mask:0xf bank_mask:0xf
  v_mfma_f32_16x16x32_bf16 v[16:19], v[32:35], v[52:55], v[16:19]
  v_and_b32_dpp v40, v23, v6 quad_perm:[0,1,2,3] row_mask:0xf bank_mask:0xf
  v_and_b32_dpp v41, v23, v7 row_ror:8 row_mask:0xf bank_mask:0xf
  v_mfma_f32_16x16x32_bf16 v[12:15], v[36:39], v[56:59], v[12:15]
  v_and_b32_dpp v42, v22, v6 row_ror:12 row_mask:0xf bank_mask:0xf
  v_and_b32_dpp v43, v22, v7 row_ror:4 row_mask:0xf bank_mask:0xf
  v_mfma_f32_16x16x32_bf16 v[16:19], v[36:39], v[60:63], v[16:19]
  v_and_b32_dpp v44, v23, v6 row_ror:8 row_mask:0xf bank_mask:0xf
  v_and_b32_dpp v45, v23, v7 quad_perm:[0,1,2,3] row_mask:0xf bank_mask:0xf
  v_and_b32_dpp v46, v22, v6 row_ror:4 row_mask:0xf bank_mask:0xf
  v_and_b32_dpp v47, v22, v7 row_ror:12 row_mask:0xf bank_mask:0xf
  v_and_b32 v28, s64, v94
  v_alignbit_b32 v29, v94, v94, 4
  v_and_b32 v29, s64, v29
  v_perm_b32 v48, v28, v92, s65
  v_perm_b32 v49, v28, v92, s66
  v_perm_b32 v52, v29, v93, s65
  v_perm_b32 v53, v29, v93, s66
  v_and_b32 v28, s64, v95
  v_alignbit_b32 v29, v95, v95, 4
  v_and_b32 v29, s64, v29
  v_perm_b32 v50, v28, v96, s65
  v_perm_b32 v51, v28, v96, s66
  v_perm_b32 v54, v29, v97, s65
  v_perm_b32 v55, v29, v97, s66
  v_mfma_f32_16x16x32_bf16 v[12:15], v[40:43], v[48:51], v[12:15]
  v_and_b32 v28, s64, v100
  v_alignbit_b32 v29, v100, v100, 4
  v_mfma_f32_16x16x32_bf16 v[16:19], v[40:43], v[52:55], v[16:19]
  v_and_b32 v29, s64, v29
  v_perm_b32 v56, v28, v98, s65
  v_perm_b32 v57, v28, v98, s66
  v_perm_b32 v60, v29, v99, s65
  v_perm_b32 v61, v29, v99, s66
  v_and_b32 v28, s64, v101
  v_alignbit_b32 v29, v101, v101, 4
  v_and_b32 v29, s64, v29
  v_perm_b32 v58, v28, v102, s65
  v_perm_b32 v59, v28, v102, s66
  v_perm_b32 v62, v29, v103, s65
  v_perm_b32 v63, v29, v103, s66
  v_mfma_f32_16x16x32_bf16 v[12:15], v[44:47], v[56:59], v[12:15]
  s_xor_b32 s72, s49, 212992
  buffer_load_dwordx4 a[156:159], v1, s[8:11], s72 offen nt
  v_mfma_f32_16x16x32_bf16 v[16:19], v[44:47], v[60:63], v[16:19]
  v_accvgpr_read_b32 v29, a238
  v_and_b32 v28, s64, v29
  v_alignbit_b32 v29, v29, v29, 4
  v_and_b32 v29, s64, v29
  v_accvgpr_read_b32 v49, a236
  v_perm_b32 v48, v28, v49, s65
  v_perm_b32 v49, v28, v49, s66
  v_accvgpr_read_b32 v51, a237
  v_perm_b32 v50, v29, v51, s65
  v_perm_b32 v51, v29, v51, s66
  v_accvgpr_read_b32 v29, a239
  v_and_b32 v28, s64, v29
  v_mfma_f32_16x16x32_bf16 v[32:35], v[48:51], v[8:11], 0
  v_alignbit_b32 v29, v29, v29, 4
  v_and_b32 v29, s64, v29
  v_accvgpr_read_b32 v53, a240
  v_perm_b32 v52, v28, v53, s65
  v_perm_b32 v53, v28, v53, s66
  v_accvgpr_read_b32 v55, a241
  v_perm_b32 v54, v29, v55, s65
  v_perm_b32 v55, v29, v55, s66
  v_accvgpr_read_b32 v29, a0
  v_and_b32 v28, s64, v29
  v_mfma_f32_16x16x32_bf16 v[36:39], v[52:55], v[8:11], 0
  v_alignbit_b32 v29, v29, v29, 4
  v_and_b32 v29, s64, v29
  v_accvgpr_read_b32 v57, a242
  v_perm_b32 v56, v28, v57, s65
  v_perm_b32 v57, v28, v57, s66
  v_accvgpr_read_b32 v59, a243
  v_perm_b32 v58, v29, v59, s65
  v_perm_b32 v59, v29, v59, s66
  v_accvgpr_read_b32 v29, a1
  v_and_b32 v28, s64, v29
  v_mfma_f32_16x16x32_bf16 v[40:43], v[56:59], v[8:11], 0
  v_alignbit_b32 v29, v29, v29, 4
  v_and_b32 v29, s64, v29
  v_accvgpr_read_b32 v61, a2
  v_perm_b32 v60, v28, v61, s65
  v_perm_b32 v61, v28, v61, s66
  v_accvgpr_read_b32 v63, a3
  v_perm_b32 v62, v29, v63, s65
  v_perm_b32 v63, v29, v63, s66
  s_waitcnt lgkmcnt(0)
  ds_read_b128 v[52:55], v3 offset:21504
  v_mfma_f32_16x16x32_bf16 v[44:47], v[60:63], v[8:11], 0
  ds_read_b128 v[56:59], v3 offset:22528
  ds_read_b128 v[60:63], v3 offset:23552
  buffer_load_dwordx4 a[160:163], v1, s[8:11], s72 offen offset:1024 nt
  buffer_load_dwordx4 a[176:179], v1, s[8:11], s72 offen offset:2048 nt
  v_add_f32_dpp v24, v32, v24 quad_perm:[0,1,2,3] row_mask:0xf bank_mask:0x1
  v_mov_b32_dpp v26, v34 row_ror:8 row_mask:0xf bank_mask:0x1
  buffer_load_dwordx4 a[180:183], v1, s[8:11], s72 offen offset:3072 nt
  v_add_f32_dpp v24, v36, v24 row_ror:4 row_mask:0xf bank_mask:0x2
  v_mov_b32_dpp v26, v38 row_ror:12 row_mask:0xf bank_mask:0x2
  s_nop 0
  v_add_f32_dpp v24, v40, v24 row_ror:8 row_mask:0xf bank_mask:0x4
  v_mov_b32_dpp v26, v42 quad_perm:[0,1,2,3] row_mask:0xf bank_mask:0x4
  s_nop 0
  v_add_f32_dpp v24, v44, v24 row_ror:12 row_mask:0xf bank_mask:0x8
  v_mov_b32_dpp v26, v46 row_ror:4 row_mask:0xf bank_mask:0x8
  s_nop 0
  v_add_f32_dpp v24, v33, v24 row_ror:12 row_mask:0xf bank_mask:0x1
  v_add_f32_dpp v26, v35, v26 row_ror:4 row_mask:0xf bank_mask:0x1
  s_nop 0
  v_add_f32_dpp v24, v37, v24 quad_perm:[0,1,2,3] row_mask:0xf bank_mask:0x2
  v_add_f32_dpp v26, v39, v26 row_ror:8 row_mask:0xf bank_mask:0x2
  s_nop 0
  v_add_f32_dpp v24, v41, v24 row_ror:4 row_mask:0xf bank_mask:0x4
  v_add_f32_dpp v26, v43, v26 row_ror:12 row_mask:0xf bank_mask:0x4
  s_nop 0
  v_add_f32_dpp v24, v45, v24 row_ror:8 row_mask:0xf bank_mask:0x8
  v_add_f32_dpp v26, v47, v26 quad_perm:[0,1,2,3] row_mask:0xf bank_mask:0x8
  v_add_f32 v24, v24, v26
  s_waitcnt lgkmcnt(0)
  v_and_b32 v28, s64, v54
  v_alignbit_b32 v29, v54, v54, 4
  v_and_b32 v29, s64, v29
  v_perm_b32 v48, v28, v52, s65
  v_perm_b32 v49, v28, v52, s66
  v_perm_b32 v50, v29, v53, s65
  v_perm_b32 v51, v29, v53, s66
  v_and_b32 v28, s64, v55
  v_alignbit_b32 v29, v55, v55, 4
  v_mfma_f32_16x16x32_bf16 v[32:35], v[48:51], v[8:11], 0
  v_and_b32 v29, s64, v29
  v_perm_b32 v52, v28, v56, s65
  v_perm_b32 v53, v28, v56, s66
  v_perm_b32 v54, v29, v57, s65
  v_perm_b32 v55, v29, v57, s66
  v_and_b32 v28, s64, v60
  v_alignbit_b32 v29, v60, v60, 4
  v_mfma_f32_16x16x32_bf16 v[36:39], v[52:55], v[8:11], 0
  v_and_b32 v29, s64, v29
  v_perm_b32 v56, v28, v58, s65
  v_perm_b32 v57, v28, v58, s66
  v_perm_b32 v58, v29, v59, s65
  v_perm_b32 v59, v29, v59, s66
  v_and_b32 v28, s64, v61
  v_alignbit_b32 v29, v61, v61, 4
  v_mfma_f32_16x16x32_bf16 v[40:43], v[56:59], v[8:11], 0
  v_and_b32 v29, s64, v29
  v_perm_b32 v60, v28, v62, s65
  v_perm_b32 v61, v28, v62, s66
  v_perm_b32 v62, v29, v63, s65
  v_perm_b32 v63, v29, v63, s66
  v_add_f32_dpp v25, v32, v25 quad_perm:[0,1,2,3] row_mask:0xf bank_mask:0x1
  v_accvgpr_read_b32 v29, a6
  v_mfma_f32_16x16x32_bf16 v[44:47], v[60:63], v[8:11], 0
  v_mov_b32_dpp v27, v34 row_ror:8 row_mask:0xf bank_mask:0x1
  v_and_b32 v28, s64, v29
  v_add_f32_dpp v25, v36, v25 row_ror:4 row_mask:0xf bank_mask:0x2
  v_alignbit_b32 v29, v29, v29, 4
  v_mov_b32_dpp v27, v38 row_ror:12 row_mask:0xf bank_mask:0x2
  v_and_b32 v29, s64, v29
  v_add_f32_dpp v25, v40, v25 row_ror:8 row_mask:0xf bank_mask:0x4
  v_accvgpr_read_b32 v49, a4
  v_mov_b32_dpp v27, v42 quad_perm:[0,1,2,3] row_mask:0xf bank_mask:0x4
  v_perm_b32 v48, v28, v49, s65
  v_add_f32_dpp v25, v44, v25 row_ror:12 row_mask:0xf bank_mask:0x8
  v_perm_b32 v49, v28, v49, s66
  v_mov_b32_dpp v27, v46 row_ror:4 row_mask:0xf bank_mask:0x8
  v_accvgpr_read_b32 v53, a5
  v_add_f32_dpp v25, v33, v25 row_ror:12 row_mask:0xf bank_mask:0x1
  v_perm_b32 v52, v29, v53, s65
  v_add_f32_dpp v27, v35, v27 row_ror:4 row_mask:0xf bank_mask:0x1
  v_perm_b32 v53, v29, v53, s66
  v_add_f32_dpp v25, v37, v25 quad_perm:[0,1,2,3] row_mask:0xf bank_mask:0x2
  v_accvgpr_read_b32 v29, a7
  v_add_f32_dpp v27, v39, v27 row_ror:8 row_mask:0xf bank_mask:0x2
  v_and_b32 v28, s64, v29
  v_add_f32_dpp v25, v41, v25 row_ror:4 row_mask:0xf bank_mask:0x4
  v_alignbit_b32 v29, v29, v29, 4
  v_add_f32_dpp v27, v43, v27 row_ror:12 row_mask:0xf bank_mask:0x4
  v_and_b32 v29, s64, v29
  v_add_f32_dpp v25, v45, v25 row_ror:8 row_mask:0xf bank_mask:0x8
  v_accvgpr_read_b32 v51, a8
  v_add_f32_dpp v27, v47, v27 quad_perm:[0,1,2,3] row_mask:0xf bank_mask:0x8
  v_perm_b32 v50, v28, v51, s65
  v_perm_b32 v51, v28, v51, s66
  v_add_f32 v25, v25, v27
  v_accvgpr_read_b32 v55, a9
  v_cvt_pk_bf16_f32 v32, v24, v25
  v_perm_b32 v54, v29, v55, s65
  v_lshlrev_b32 v24, 16, v32
  v_and_b32 v25, 0xffff0000, v32
  v_perm_b32 v55, v29, v55, s66
  v_pk_mul_f32 v[24:25], v[24:25], s[56:57] op_sel_hi:[1,0]
  v_and_b32 v28, s64, v88
  v_cvt_pk_bf16_f32 v32, v24, v25
  v_lshlrev_b32 v24, 16, v32
  v_alignbit_b32 v29, v88, v88, 4
  v_and_b32 v25, 0xffff0000, v32
  ds_write_b64 v3, v[24:25] offset:2056
  v_and_b32 v29, s64, v29
  v_pk_add_f32 v[26:27], v[24:25], v[4:5] op_sel_hi:[1,0] neg_lo:[0,1] neg_hi:[0,1]
  v_pk_mul_f32 v[26:27], v[26:27], s[56:57] op_sel:[0,1] op_sel_hi:[1,1]
  v_accvgpr_read_b32 v57, a10
  v_max_f32 v20, v26, v27
  v_perm_b32 v56, v28, v57, s65
  v_cmp_lt_f32 vcc, 0, v20
  s_getpc_b64 s[74:75]
  s_cbranch_vccnz L_remax
  v_perm_b32 v57, v28, v57, s66
  v_exp_f32 v26, v26
  v_exp_f32 v27, v27
  v_accvgpr_read_b32 v61, a11
  v_pk_mul_f32 v[24:25], v[26:27], s[40:41] op_sel:[0,1] op_sel_hi:[1,1]
  v_perm_b32 v60, v29, v61, s65
  v_add_f32 v32, v26, v27
  v_perm_b32 v61, v29, v61, s66
  v_cvt_pk_bf16_f32 v20, v24, 0
  v_cvt_pk_bf16_f32 v21, v24, 0
  v_and_b32 v28, s64, v89
  v_cvt_pk_bf16_f32 v23, v25, 0
  v_alignbit_b32 v29, v89, v89, 4
  v_cvt_pk_bf16_f32 v22, v25, 0
  v_cvt_pk_bf16_f32 v24, 0, v24
  v_and_b32 v29, s64, v29
  v_cvt_pk_bf16_f32 v25, 0, v25
  v_perm_b32 v58, v28, v90, s65
  v_add_f32 v5, v5, v32
  v_perm_b32 v59, v28, v90, s66
  v_mov_b32_dpp v20, v24 row_ror:4 row_mask:0xf bank_mask:0xa
  v_mov_b32_dpp v21, v24 row_ror:4 row_mask:0xf bank_mask:0x5
  v_perm_b32 v62, v29, v91, s65
  v_mov_b32_dpp v23, v25 row_ror:4 row_mask:0xf bank_mask:0xa
  v_perm_b32 v63, v29, v91, s66
  v_mov_b32_dpp v22, v25 row_ror:4 row_mask:0xf bank_mask:0x5
  ds_read_b64 v[24:25], v3 offset:3072
  s_xor_b32 s72, s49, 507904
  buffer_load_dwordx4 a[184:187], v2, s[12:15], s72 offen nt
  buffer_load_dwordx4 a[204:207], v2, s[12:15], s72 offen offset:1024 nt
  v_and_b32_dpp v32, v20, v6 quad_perm:[0,1,2,3] row_mask:0xf bank_mask:0xf
  v_and_b32_dpp v33, v20, v7 row_ror:8 row_mask:0xf bank_mask:0xf
  v_and_b32_dpp v34, v21, v6 row_ror:12 row_mask:0xf bank_mask:0xf
  v_and_b32_dpp v35, v21, v7 row_ror:4 row_mask:0xf bank_mask:0xf
  v_and_b32_dpp v36, v20, v6 row_ror:8 row_mask:0xf bank_mask:0xf
  v_and_b32_dpp v37, v20, v7 quad_perm:[0,1,2,3] row_mask:0xf bank_mask:0xf
  v_mfma_f32_16x16x32_bf16 v[12:15], v[32:35], v[48:51], v[12:15]
  v_and_b32_dpp v38, v21, v6 row_ror:4 row_mask:0xf bank_mask:0xf
  v_and_b32_dpp v39, v21, v7 row_ror:12 row_mask:0xf bank_mask:0xf
  v_mfma_f32_16x16x32_bf16 v[16:19], v[32:35], v[52:55], v[16:19]
  v_and_b32_dpp v40, v23, v6 quad_perm:[0,1,2,3] row_mask:0xf bank_mask:0xf
  v_and_b32_dpp v41, v23, v7 row_ror:8 row_mask:0xf bank_mask:0xf
  v_mfma_f32_16x16x32_bf16 v[12:15], v[36:39], v[56:59], v[12:15]
  v_and_b32_dpp v42, v22, v6 row_ror:12 row_mask:0xf bank_mask:0xf
  v_and_b32_dpp v43, v22, v7 row_ror:4 row_mask:0xf bank_mask:0xf
  v_mfma_f32_16x16x32_bf16 v[16:19], v[36:39], v[60:63], v[16:19]
  v_and_b32_dpp v44, v23, v6 row_ror:8 row_mask:0xf bank_mask:0xf
  v_and_b32_dpp v45, v23, v7 quad_perm:[0,1,2,3] row_mask:0xf bank_mask:0xf
  v_and_b32_dpp v46, v22, v6 row_ror:4 row_mask:0xf bank_mask:0xf
  v_and_b32_dpp v47, v22, v7 row_ror:12 row_mask:0xf bank_mask:0xf
  v_and_b32 v28, s64, v122
  v_alignbit_b32 v29, v122, v122, 4
  v_and_b32 v29, s64, v29
  v_perm_b32 v48, v28, v120, s65
  v_perm_b32 v49, v28, v120, s66
  v_perm_b32 v52, v29, v121, s65
  v_perm_b32 v53, v29, v121, s66
  v_and_b32 v28, s64, v123
  v_alignbit_b32 v29, v123, v123, 4
  v_and_b32 v29, s64, v29
  v_perm_b32 v50, v28, v124, s65
  v_perm_b32 v51, v28, v124, s66
  v_perm_b32 v54, v29, v125, s65
  v_perm_b32 v55, v29, v125, s66
  v_mfma_f32_16x16x32_bf16 v[12:15], v[40:43], v[48:51], v[12:15]
  v_and_b32 v28, s64, v128
  v_alignbit_b32 v29, v128, v128, 4
  v_mfma_f32_16x16x32_bf16 v[16:19], v[40:43], v[52:55], v[16:19]
  v_and_b32 v29, s64, v29
  v_perm_b32 v56, v28, v126, s65
  v_perm_b32 v57, v28, v126, s66
  v_perm_b32 v60, v29, v127, s65
  v_perm_b32 v61, v29, v127, s66
  v_and_b32 v28, s64, v129
  v_alignbit_b32 v29, v129, v129, 4
  v_and_b32 v29, s64, v29
  v_perm_b32 v58, v28, v130, s65
  v_perm_b32 v59, v28, v130, s66
  v_perm_b32 v62, v29, v131, s65
  v_perm_b32 v63, v29, v131, s66
  v_mfma_f32_16x16x32_bf16 v[12:15], v[44:47], v[56:59], v[12:15]
  buffer_load_dwordx4 a[208:211], v2, s[12:15], s72 offen offset:2048 nt
  v_and_b32 v28, s64, v150
  v_mfma_f32_16x16x32_bf16 v[16:19], v[44:47], v[60:63], v[16:19]
  v_alignbit_b32 v29, v150, v150, 4
  v_and_b32 v29, s64, v29
  v_perm_b32 v48, v28, v148, s65
  v_perm_b32 v49, v28, v148, s66
  v_perm_b32 v50, v29, v149, s65
  v_perm_b32 v51, v29, v149, s66
  v_and_b32 v28, s64, v151
  v_alignbit_b32 v29, v151, v151, 4
  v_mfma_f32_16x16x32_bf16 v[32:35], v[48:51], v[8:11], 0
  v_and_b32 v29, s64, v29
  v_perm_b32 v52, v28, v152, s65
  v_perm_b32 v53, v28, v152, s66
  v_perm_b32 v54, v29, v153, s65
  v_perm_b32 v55, v29, v153, s66
  v_and_b32 v28, s64, v156
  v_alignbit_b32 v29, v156, v156, 4
  v_mfma_f32_16x16x32_bf16 v[36:39], v[52:55], v[8:11], 0
  v_and_b32 v29, s64, v29
  v_perm_b32 v56, v28, v154, s65
  v_perm_b32 v57, v28, v154, s66
  v_perm_b32 v58, v29, v155, s65
  v_perm_b32 v59, v29, v155, s66
  v_and_b32 v28, s64, v157
  v_alignbit_b32 v29, v157, v157, 4
  v_mfma_f32_16x16x32_bf16 v[40:43], v[56:59], v[8:11], 0
  v_and_b32 v29, s64, v29
  v_perm_b32 v60, v28, v158, s65
  v_perm_b32 v61, v28, v158, s66
  v_perm_b32 v62, v29, v159, s65
  v_perm_b32 v63, v29, v159, s66
  s_waitcnt lgkmcnt(0)
  ds_read_b128 v[52:55], v3 offset:24576
  v_mfma_f32_16x16x32_bf16 v[44:47], v[60:63], v[8:11], 0
  ds_read_b128 v[56:59], v3 offset:25600
  ds_read_b128 v[60:63], v3 offset:26624
  buffer_load_dwordx4 a[212:215], v2, s[12:15], s72 offen offset:3072 nt
  s_mov_b32 s14, 0x8000000
  s_xor_b32 s72, s49, 196608
  buffer_load_dwordx4 a[220:223], v2, s[12:15], s72 offen nt
  v_add_f32_dpp v24, v32, v24 quad_perm:[0,1,2,3] row_mask:0xf bank_mask:0x1
  v_mov_b32_dpp v26, v34 row_ror:8 row_mask:0xf bank_mask:0x1
  s_waitcnt vmcnt(40)
  v_add_f32_dpp v24, v36, v24 row_ror:4 row_mask:0xf bank_mask:0x2
  v_mov_b32_dpp v26, v38 row_ror:12 row_mask:0xf bank_mask:0x2
  buffer_load_dwordx4 a[224:227], v2, s[12:15], s72 offen offset:1024 nt
  v_add_f32_dpp v24, v40, v24 row_ror:8 row_mask:0xf bank_mask:0x4
  v_mov_b32_dpp v26, v42 quad_perm:[0,1,2,3] row_mask:0xf bank_mask:0x4
  s_nop 0
  v_add_f32_dpp v24, v44, v24 row_ror:12 row_mask:0xf bank_mask:0x8
  v_mov_b32_dpp v26, v46 row_ror:4 row_mask:0xf bank_mask:0x8
  s_nop 0
  v_add_f32_dpp v24, v33, v24 row_ror:12 row_mask:0xf bank_mask:0x1
  v_add_f32_dpp v26, v35, v26 row_ror:4 row_mask:0xf bank_mask:0x1
  s_nop 0
  v_add_f32_dpp v24, v37, v24 quad_perm:[0,1,2,3] row_mask:0xf bank_mask:0x2
  v_add_f32_dpp v26, v39, v26 row_ror:8 row_mask:0xf bank_mask:0x2
  s_nop 0
  v_add_f32_dpp v24, v41, v24 row_ror:4 row_mask:0xf bank_mask:0x4
  v_add_f32_dpp v26, v43, v26 row_ror:12 row_mask:0xf bank_mask:0x4
  s_nop 0
  v_add_f32_dpp v24, v45, v24 row_ror:8 row_mask:0xf bank_mask:0x8
  v_add_f32_dpp v26, v47, v26 quad_perm:[0,1,2,3] row_mask:0xf bank_mask:0x8
  v_add_f32 v24, v24, v26
  s_waitcnt lgkmcnt(0)
  v_and_b32 v28, s64, v54
  v_alignbit_b32 v29, v54, v54, 4
  v_and_b32 v29, s64, v29
  v_perm_b32 v48, v28, v52, s65
  v_perm_b32 v49, v28, v52, s66
  v_perm_b32 v50, v29, v53, s65
  v_perm_b32 v51, v29, v53, s66
  v_and_b32 v28, s64, v55
  v_alignbit_b32 v29, v55, v55, 4
  v_mfma_f32_16x16x32_bf16 v[32:35], v[48:51], v[8:11], 0
  v_and_b32 v29, s64, v29
  v_perm_b32 v52, v28, v56, s65
  v_perm_b32 v53, v28, v56, s66
  v_perm_b32 v54, v29, v57, s65
  v_perm_b32 v55, v29, v57, s66
  v_and_b32 v28, s64, v60
  v_alignbit_b32 v29, v60, v60, 4
  v_mfma_f32_16x16x32_bf16 v[36:39], v[52:55], v[8:11], 0
  v_and_b32 v29, s64, v29
  v_perm_b32 v56, v28, v58, s65
  v_perm_b32 v57, v28, v58, s66
  v_perm_b32 v58, v29, v59, s65
  v_perm_b32 v59, v29, v59, s66
  v_and_b32 v28, s64, v61
  v_alignbit_b32 v29, v61, v61, 4
  v_mfma_f32_16x16x32_bf16 v[40:43], v[56:59], v[8:11], 0
  v_and_b32 v29, s64, v29
  v_perm_b32 v60, v28, v62, s65
  v_perm_b32 v61, v28, v62, s66
  v_perm_b32 v62, v29, v63, s65
  v_perm_b32 v63, v29, v63, s66
  v_add_f32_dpp v25, v32, v25 quad_perm:[0,1,2,3] row_mask:0xf bank_mask:0x1
  v_and_b32 v28, s64, v210
  v_mfma_f32_16x16x32_bf16 v[44:47], v[60:63], v[8:11], 0
  v_mov_b32_dpp v27, v34 row_ror:8 row_mask:0xf bank_mask:0x1
  v_alignbit_b32 v29, v210, v210, 4
  v_add_f32_dpp v25, v36, v25 row_ror:4 row_mask:0xf bank_mask:0x2
  v_and_b32 v29, s64, v29
  v_mov_b32_dpp v27, v38 row_ror:12 row_mask:0xf bank_mask:0x2
  v_perm_b32 v48, v28, v208, s65
  v_add_f32_dpp v25, v40, v25 row_ror:8 row_mask:0xf bank_mask:0x4
  v_perm_b32 v49, v28, v208, s66
  v_mov_b32_dpp v27, v42 quad_perm:[0,1,2,3] row_mask:0xf bank_mask:0x4
  v_perm_b32 v52, v29, v209, s65
  v_add_f32_dpp v25, v44, v25 row_ror:12 row_mask:0xf bank_mask:0x8
  v_perm_b32 v53, v29, v209, s66
  v_mov_b32_dpp v27, v46 row_ror:4 row_mask:0xf bank_mask:0x8
  v_and_b32 v28, s64, v211
  v_add_f32_dpp v25, v33, v25 row_ror:12 row_mask:0xf bank_mask:0x1
  v_alignbit_b32 v29, v211, v211, 4
  v_add_f32_dpp v27, v35, v27 row_ror:4 row_mask:0xf bank_mask:0x1
  v_and_b32 v29, s64, v29
  v_add_f32_dpp v25, v37, v25 quad_perm:[0,1,2,3] row_mask:0xf bank_mask:0x2
  v_perm_b32 v50, v28, v212, s65
  v_add_f32_dpp v27, v39, v27 row_ror:8 row_mask:0xf bank_mask:0x2
  v_perm_b32 v51, v28, v212, s66
  v_add_f32_dpp v25, v41, v25 row_ror:4 row_mask:0xf bank_mask:0x4
  v_perm_b32 v54, v29, v213, s65
  v_add_f32_dpp v27, v43, v27 row_ror:12 row_mask:0xf bank_mask:0x4
  v_perm_b32 v55, v29, v213, s66
  v_add_f32_dpp v25, v45, v25 row_ror:8 row_mask:0xf bank_mask:0x8
  v_and_b32 v28, s64, v248
  v_add_f32_dpp v27, v47, v27 quad_perm:[0,1,2,3] row_mask:0xf bank_mask:0x8
  v_alignbit_b32 v29, v248, v248, 4
  v_and_b32 v29, s64, v29
  v_add_f32 v25, v25, v27
  v_cvt_pk_bf16_f32 v32, v24, v25
  v_perm_b32 v56, v28, v214, s65
  v_lshlrev_b32 v24, 16, v32
  v_and_b32 v25, 0xffff0000, v32
  v_perm_b32 v57, v28, v214, s66
  v_pk_mul_f32 v[24:25], v[24:25], s[56:57] op_sel_hi:[1,0]
  v_cvt_pk_bf16_f32 v32, v24, v25
  v_lshlrev_b32 v24, 16, v32
  v_perm_b32 v60, v29, v215, s65
  v_and_b32 v25, 0xffff0000, v32
  ds_write_b64 v3, v[24:25] offset:3072
  v_pk_add_f32 v[26:27], v[24:25], v[4:5] op_sel_hi:[1,0] neg_lo:[0,1] neg_hi:[0,1]
  v_pk_mul_f32 v[26:27], v[26:27], s[56:57] op_sel:[0,1] op_sel_hi:[1,1]
  v_perm_b32 v61, v29, v215, s66
  v_max_f32 v20, v26, v27
  v_and_b32 v28, s64, v249
  v_cmp_lt_f32 vcc, 0, v20
  s_getpc_b64 s[74:75]
  s_cbranch_vccnz L_remax
  v_exp_f32 v26, v26
  v_exp_f32 v27, v27
  v_alignbit_b32 v29, v249, v249, 4
  v_pk_mul_f32 v[24:25], v[26:27], s[40:41] op_sel:[0,1] op_sel_hi:[1,1]
  v_add_f32 v32, v26, v27
  v_and_b32 v29, s64, v29
  v_cvt_pk_bf16_f32 v20, v24, 0
  v_cvt_pk_bf16_f32 v21, v24, 0
  v_perm_b32 v58, v28, v250, s65
  v_cvt_pk_bf16_f32 v23, v25, 0
  v_cvt_pk_bf16_f32 v22, v25, 0
  v_cvt_pk_bf16_f32 v24, 0, v24
  v_perm_b32 v59, v28, v250, s66
  v_cvt_pk_bf16_f32 v25, 0, v25
  v_add_f32 v5, v5, v32
  v_perm_b32 v62, v29, v251, s65
  v_mov_b32_dpp v20, v24 row_ror:4 row_mask:0xf bank_mask:0xa
  v_mov_b32_dpp v21, v24 row_ror:4 row_mask:0xf bank_mask:0x5
  v_perm_b32 v63, v29, v251, s66
  v_mov_b32_dpp v23, v25 row_ror:4 row_mask:0xf bank_mask:0xa
  v_mov_b32_dpp v22, v25 row_ror:4 row_mask:0xf bank_mask:0x5
  s_waitcnt vmcnt(40)
  buffer_load_dwordx4 a[228:231], v2, s[12:15], s72 offen offset:2048 nt
  v_and_b32_dpp v32, v20, v6 quad_perm:[0,1,2,3] row_mask:0xf bank_mask:0xf
  v_and_b32_dpp v33, v20, v7 row_ror:8 row_mask:0xf bank_mask:0xf
  v_and_b32_dpp v34, v21, v6 row_ror:12 row_mask:0xf bank_mask:0xf
  v_and_b32_dpp v35, v21, v7 row_ror:4 row_mask:0xf bank_mask:0xf
  v_and_b32_dpp v36, v20, v6 row_ror:8 row_mask:0xf bank_mask:0xf
  v_and_b32_dpp v37, v20, v7 quad_perm:[0,1,2,3] row_mask:0xf bank_mask:0xf
  v_mfma_f32_16x16x32_bf16 v[12:15], v[32:35], v[48:51], v[12:15]
  v_and_b32_dpp v38, v21, v6 row_ror:4 row_mask:0xf bank_mask:0xf
  v_and_b32_dpp v39, v21, v7 row_ror:12 row_mask:0xf bank_mask:0xf
  v_mfma_f32_16x16x32_bf16 v[16:19], v[32:35], v[52:55], v[16:19]
  v_and_b32_dpp v40, v23, v6 quad_perm:[0,1,2,3] row_mask:0xf bank_mask:0xf
  v_and_b32_dpp v41, v23, v7 row_ror:8 row_mask:0xf bank_mask:0xf
  v_mfma_f32_16x16x32_bf16 v[12:15], v[36:39], v[56:59], v[12:15]
  v_and_b32_dpp v42, v22, v6 row_ror:12 row_mask:0xf bank_mask:0xf
  v_and_b32_dpp v43, v22, v7 row_ror:4 row_mask:0xf bank_mask:0xf
  v_mfma_f32_16x16x32_bf16 v[16:19], v[36:39], v[60:63], v[16:19]
  v_and_b32_dpp v44, v23, v6 row_ror:8 row_mask:0xf bank_mask:0xf
  v_and_b32_dpp v45, v23, v7 quad_perm:[0,1,2,3] row_mask:0xf bank_mask:0xf
  v_and_b32_dpp v46, v22, v6 row_ror:4 row_mask:0xf bank_mask:0xf
  v_and_b32_dpp v47, v22, v7 row_ror:12 row_mask:0xf bank_mask:0xf
  v_and_b32 v28, s64, v198
  v_alignbit_b32 v29, v198, v198, 4
  v_and_b32 v29, s64, v29
  v_perm_b32 v48, v28, v196, s65
  v_perm_b32 v49, v28, v196, s66
  v_perm_b32 v52, v29, v197, s65
  v_perm_b32 v53, v29, v197, s66
  v_and_b32 v28, s64, v199
  v_alignbit_b32 v29, v199, v199, 4
  v_and_b32 v29, s64, v29
  v_perm_b32 v50, v28, v228, s65
  v_perm_b32 v51, v28, v228, s66
  v_perm_b32 v54, v29, v229, s65
  v_perm_b32 v55, v29, v229, s66
  v_and_b32 v28, s64, v232
  v_alignbit_b32 v29, v232, v232, 4
  v_and_b32 v29, s64, v29
  v_perm_b32 v56, v28, v230, s65
  v_perm_b32 v57, v28, v230, s66
  v_perm_b32 v60, v29, v231, s65
  v_perm_b32 v61, v29, v231, s66
  v_and_b32 v28, s64, v233
  v_alignbit_b32 v29, v233, v233, 4
  v_and_b32 v29, s64, v29
  v_perm_b32 v58, v28, v234, s65
  v_perm_b32 v59, v28, v234, s66
  v_perm_b32 v62, v29, v235, s65
  v_perm_b32 v63, v29, v235, s66
  s_waitcnt vmcnt(40)
  buffer_load_dwordx4 a[244:247], v2, s[12:15], s72 offen offset:3072 nt
  s_waitcnt vmcnt(40)
  s_bitcmp1_b32 s2, 0
  s_cselect_b32 s10, 0, 0x8000000
  v_mfma_f32_16x16x32_bf16 v[12:15], v[40:43], v[48:51], v[12:15]
  ds_read_b64 v[24:25], v3 offset:3080
  s_xor_b32 s72, s49, 1015808
  v_mfma_f32_16x16x32_bf16 v[16:19], v[40:43], v[52:55], v[16:19]
  buffer_load_dwordx4 a[248:251], v1, s[8:11], s72 offen nt
  v_and_b32 v28, s64, v82
  v_mfma_f32_16x16x32_bf16 v[12:15], v[44:47], v[56:59], v[12:15]
  v_alignbit_b32 v29, v82, v82, 4
  v_and_b32 v29, s64, v29
  v_mfma_f32_16x16x32_bf16 v[16:19], v[44:47], v[60:63], v[16:19]
  v_perm_b32 v48, v28, v80, s65
  v_perm_b32 v49, v28, v80, s66
  v_perm_b32 v50, v29, v81, s65
  v_perm_b32 v51, v29, v81, s66
  v_and_b32 v28, s64, v83
  v_alignbit_b32 v29, v83, v83, 4
  v_mfma_f32_16x16x32_bf16 v[32:35], v[48:51], v[8:11], 0
  v_and_b32 v29, s64, v29
  v_perm_b32 v52, v28, v84, s65
  v_perm_b32 v53, v28, v84, s66
  v_perm_b32 v54, v29, v85, s65
  v_perm_b32 v55, v29, v85, s66
  v_and_b32 v28, s64, v104
  v_alignbit_b32 v29, v104, v104, 4
  v_mfma_f32_16x16x32_bf16 v[36:39], v[52:55], v[8:11], 0
  v_and_b32 v29, s64, v29
  v_perm_b32 v56, v28, v86, s65
  v_perm_b32 v57, v28, v86, s66
  v_perm_b32 v58, v29, v87, s65
  v_perm_b32 v59, v29, v87, s66
  v_and_b32 v28, s64, v105
  v_alignbit_b32 v29, v105, v105, 4
  v_mfma_f32_16x16x32_bf16 v[40:43], v[56:59], v[8:11], 0
  v_and_b32 v29, s64, v29
  v_perm_b32 v60, v28, v106, s65
  v_perm_b32 v61, v28, v106, s66
  v_perm_b32 v62, v29, v107, s65
  v_perm_b32 v63, v29, v107, s66
  s_waitcnt lgkmcnt(0)
  ds_read_b128 v[52:55], v3 offset:27648
  v_mfma_f32_16x16x32_bf16 v[44:47], v[60:63], v[8:11], 0
  ds_read_b128 v[56:59], v3 offset:28672
  ds_read_b128 v[60:63], v3 offset:29696
  s_waitcnt vmcnt(40)
  buffer_load_dwordx4 a[252:255], v1, s[8:11], s72 offen offset:1024 nt
  v_add_f32_dpp v24, v32, v24 quad_perm:[0,1,2,3] row_mask:0xf bank_mask:0x1
  v_mov_b32_dpp v26, v34 row_ror:8 row_mask:0xf bank_mask:0x1
  s_waitcnt vmcnt(40)
  v_add_f32_dpp v24, v36, v24 row_ror:4 row_mask:0xf bank_mask:0x2
  v_mov_b32_dpp v26, v38 row_ror:12 row_mask:0xf bank_mask:0x2
  buffer_load_dwordx4 a[236:239], v1, s[8:11], s72 offen offset:2048 nt
  v_add_f32_dpp v24, v40, v24 row_ror:8 row_mask:0xf bank_mask:0x4
  v_mov_b32_dpp v26, v42 quad_perm:[0,1,2,3] row_mask:0xf bank_mask:0x4
  s_waitcnt vmcnt(40)
  v_add_f32_dpp v24, v44, v24 row_ror:12 row_mask:0xf bank_mask:0x8
  v_mov_b32_dpp v26, v46 row_ror:4 row_mask:0xf bank_mask:0x8
  buffer_load_dwordx4 a[240:243], v1, s[8:11], s72 offen offset:3072 nt
  v_add_f32_dpp v24, v33, v24 row_ror:12 row_mask:0xf bank_mask:0x1
  v_add_f32_dpp v26, v35, v26 row_ror:4 row_mask:0xf bank_mask:0x1
  s_nop 0
  v_add_f32_dpp v24, v37, v24 quad_perm:[0,1,2,3] row_mask:0xf bank_mask:0x2
  v_add_f32_dpp v26, v39, v26 row_ror:8 row_mask:0xf bank_mask:0x2
  s_nop 0
  v_add_f32_dpp v24, v41, v24 row_ror:4 row_mask:0xf bank_mask:0x4
  v_add_f32_dpp v26, v43, v26 row_ror:12 row_mask:0xf bank_mask:0x4
  s_nop 0
  v_add_f32_dpp v24, v45, v24 row_ror:8 row_mask:0xf bank_mask:0x8
  v_add_f32_dpp v26, v47, v26 quad_perm:[0,1,2,3] row_mask:0xf bank_mask:0x8
  v_add_f32 v24, v24, v26
  s_waitcnt lgkmcnt(0)
  v_and_b32 v28, s64, v54
  v_alignbit_b32 v29, v54, v54, 4
  v_and_b32 v29, s64, v29
  v_perm_b32 v48, v28, v52, s65
  v_perm_b32 v49, v28, v52, s66
  v_perm_b32 v50, v29, v53, s65
  v_perm_b32 v51, v29, v53, s66
  v_and_b32 v28, s64, v55
  v_alignbit_b32 v29, v55, v55, 4
  v_mfma_f32_16x16x32_bf16 v[32:35], v[48:51], v[8:11], 0
  v_and_b32 v29, s64, v29
  v_perm_b32 v52, v28, v56, s65
  v_perm_b32 v53, v28, v56, s66
  v_perm_b32 v54, v29, v57, s65
  v_perm_b32 v55, v29, v57, s66
  v_and_b32 v28, s64, v60
  v_alignbit_b32 v29, v60, v60, 4
  v_mfma_f32_16x16x32_bf16 v[36:39], v[52:55], v[8:11], 0
  v_and_b32 v29, s64, v29
  v_perm_b32 v56, v28, v58, s65
  v_perm_b32 v57, v28, v58, s66
  v_perm_b32 v58, v29, v59, s65
  v_perm_b32 v59, v29, v59, s66
  v_and_b32 v28, s64, v61
  v_alignbit_b32 v29, v61, v61, 4
  v_mfma_f32_16x16x32_bf16 v[40:43], v[56:59], v[8:11], 0
  v_and_b32 v29, s64, v29
  v_perm_b32 v60, v28, v62, s65
  v_perm_b32 v61, v28, v62, s66
  v_perm_b32 v62, v29, v63, s65
  v_perm_b32 v63, v29, v63, s66
  v_add_f32_dpp v25, v32, v25 quad_perm:[0,1,2,3] row_mask:0xf bank_mask:0x1
  v_and_b32 v28, s64, v166
  v_mfma_f32_16x16x32_bf16 v[44:47], v[60:63], v[8:11], 0
  v_mov_b32_dpp v27, v34 row_ror:8 row_mask:0xf bank_mask:0x1
  v_alignbit_b32 v29, v166, v166, 4
  v_add_f32_dpp v25, v36, v25 row_ror:4 row_mask:0xf bank_mask:0x2
  v_and_b32 v29, s64, v29
  v_mov_b32_dpp v27, v38 row_ror:12 row_mask:0xf bank_mask:0x2
  v_perm_b32 v48, v28, v164, s65
  v_add_f32_dpp v25, v40, v25 row_ror:8 row_mask:0xf bank_mask:0x4
  v_perm_b32 v49, v28, v164, s66
  v_mov_b32_dpp v27, v42 quad_perm:[0,1,2,3] row_mask:0xf bank_mask:0x4
  v_perm_b32 v52, v29, v165, s65
  v_add_f32_dpp v25, v44, v25 row_ror:12 row_mask:0xf bank_mask:0x8
  v_perm_b32 v53, v29, v165, s66
  v_mov_b32_dpp v27, v46 row_ror:4 row_mask:0xf bank_mask:0x8
  v_and_b32 v28, s64, v167
  v_add_f32_dpp v25, v33, v25 row_ror:12 row_mask:0xf bank_mask:0x1
  v_alignbit_b32 v29, v167, v167, 4
  v_add_f32_dpp v27, v35, v27 row_ror:4 row_mask:0xf bank_mask:0x1
  v_and_b32 v29, s64, v29
  v_add_f32_dpp v25, v37, v25 quad_perm:[0,1,2,3] row_mask:0xf bank_mask:0x2
  v_perm_b32 v50, v28, v168, s65
  v_add_f32_dpp v27, v39, v27 row_ror:8 row_mask:0xf bank_mask:0x2
  v_perm_b32 v51, v28, v168, s66
  v_add_f32_dpp v25, v41, v25 row_ror:4 row_mask:0xf bank_mask:0x4
  v_perm_b32 v54, v29, v169, s65
  v_add_f32_dpp v27, v43, v27 row_ror:12 row_mask:0xf bank_mask:0x4
  v_perm_b32 v55, v29, v169, s66
  v_add_f32_dpp v25, v45, v25 row_ror:8 row_mask:0xf bank_mask:0x8
  v_and_b32 v28, s64, v172
  v_add_f32_dpp v27, v47, v27 quad_perm:[0,1,2,3] row_mask:0xf bank_mask:0x8
  v_alignbit_b32 v29, v172, v172, 4
  v_and_b32 v29, s64, v29
  v_add_f32 v25, v25, v27
  v_cvt_pk_bf16_f32 v32, v24, v25
  v_perm_b32 v56, v28, v170, s65
  v_lshlrev_b32 v24, 16, v32
  v_and_b32 v25, 0xffff0000, v32
  v_perm_b32 v57, v28, v170, s66
  v_pk_mul_f32 v[24:25], v[24:25], s[56:57] op_sel_hi:[1,0]
  v_cvt_pk_bf16_f32 v32, v24, v25
  v_lshlrev_b32 v24, 16, v32
  v_perm_b32 v60, v29, v171, s65
  v_and_b32 v25, 0xffff0000, v32
  ds_write_b64 v3, v[24:25] offset:3080
  v_pk_add_f32 v[26:27], v[24:25], v[4:5] op_sel_hi:[1,0] neg_lo:[0,1] neg_hi:[0,1]
  v_pk_mul_f32 v[26:27], v[26:27], s[56:57] op_sel:[0,1] op_sel_hi:[1,1]
  v_perm_b32 v61, v29, v171, s66
  v_max_f32 v20, v26, v27
  v_and_b32 v28, s64, v173
  v_cmp_lt_f32 vcc, 0, v20
  s_getpc_b64 s[74:75]
  s_cbranch_vccnz L_remax
  v_exp_f32 v26, v26
  v_exp_f32 v27, v27
  v_alignbit_b32 v29, v173, v173, 4
  v_pk_mul_f32 v[24:25], v[26:27], s[40:41] op_sel:[0,1] op_sel_hi:[1,1]
  v_add_f32 v32, v26, v27
  v_and_b32 v29, s64, v29
  v_cvt_pk_bf16_f32 v20, v24, 0
  v_cvt_pk_bf16_f32 v21, v24, 0
  v_perm_b32 v58, v28, v174, s65
  v_cvt_pk_bf16_f32 v23, v25, 0
  v_cvt_pk_bf16_f32 v22, v25, 0
  v_cvt_pk_bf16_f32 v24, 0, v24
  v_perm_b32 v59, v28, v174, s66
  v_cvt_pk_bf16_f32 v25, 0, v25
  v_add_f32 v5, v5, v32
  v_perm_b32 v62, v29, v175, s65
  v_mov_b32_dpp v20, v24 row_ror:4 row_mask:0xf bank_mask:0xa
  v_mov_b32_dpp v21, v24 row_ror:4 row_mask:0xf bank_mask:0x5
  v_perm_b32 v63, v29, v175, s66
  v_mov_b32_dpp v23, v25 row_ror:4 row_mask:0xf bank_mask:0xa
  v_mov_b32_dpp v22, v25 row_ror:4 row_mask:0xf bank_mask:0x5
  ds_read_b64 v[24:25], v3 offset:4096
  s_waitcnt vmcnt(40)
  s_xor_b32 s72, s49, 212992
  buffer_load_dwordx4 a[0:3], v2, s[12:15], s72 offen nt
  v_and_b32_dpp v32, v20, v6 quad_perm:[0,1,2,3] row_mask:0xf bank_mask:0xf
  v_and_b32_dpp v33, v20, v7 row_ror:8 row_mask:0xf bank_mask:0xf
  v_and_b32_dpp v34, v21, v6 row_ror:12 row_mask:0xf bank_mask:0xf
  v_and_b32_dpp v35, v21, v7 row_ror:4 row_mask:0xf bank_mask:0xf
  v_and_b32_dpp v36, v20, v6 row_ror:8 row_mask:0xf bank_mask:0xf
  v_and_b32_dpp v37, v20, v7 quad_perm:[0,1,2,3] row_mask:0xf bank_mask:0xf
  v_mfma_f32_16x16x32_bf16 v[12:15], v[32:35], v[48:51], v[12:15]
  v_and_b32_dpp v38, v21, v6 row_ror:4 row_mask:0xf bank_mask:0xf
  v_and_b32_dpp v39, v21, v7 row_ror:12 row_mask:0xf bank_mask:0xf
  v_mfma_f32_16x16x32_bf16 v[16:19], v[32:35], v[52:55], v[16:19]
  v_and_b32_dpp v40, v23, v6 quad_perm:[0,1,2,3] row_mask:0xf bank_mask:0xf
  v_and_b32_dpp v41, v23, v7 row_ror:8 row_mask:0xf bank_mask:0xf
  v_mfma_f32_16x16x32_bf16 v[12:15], v[36:39], v[56:59], v[12:15]
  v_and_b32_dpp v42, v22, v6 row_ror:12 row_mask:0xf bank_mask:0xf
  v_and_b32_dpp v43, v22, v7 row_ror:4 row_mask:0xf bank_mask:0xf
  v_mfma_f32_16x16x32_bf16 v[16:19], v[36:39], v[60:63], v[16:19]
  v_and_b32_dpp v44, v23, v6 row_ror:8 row_mask:0xf bank_mask:0xf
  v_and_b32_dpp v45, v23, v7 quad_perm:[0,1,2,3] row_mask:0xf bank_mask:0xf
  v_and_b32_dpp v46, v22, v6 row_ror:4 row_mask:0xf bank_mask:0xf
  v_and_b32_dpp v47, v22, v7 row_ror:12 row_mask:0xf bank_mask:0xf
  v_and_b32 v28, s64, v254
  v_alignbit_b32 v29, v254, v254, 4
  v_and_b32 v29, s64, v29
  v_perm_b32 v48, v28, v252, s65
  v_perm_b32 v49, v28, v252, s66
  v_perm_b32 v52, v29, v253, s65
  v_perm_b32 v53, v29, v253, s66
  v_and_b32 v28, s64, v255
  v_alignbit_b32 v29, v255, v255, 4
  v_and_b32 v29, s64, v29
  v_perm_b32 v50, v28, v184, s65
  v_perm_b32 v51, v28, v184, s66
  v_perm_b32 v54, v29, v185, s65
  v_perm_b32 v55, v29, v185, s66
  v_mfma_f32_16x16x32_bf16 v[12:15], v[40:43], v[48:51], v[12:15]
  v_and_b32 v28, s64, v188
  v_alignbit_b32 v29, v188, v188, 4
  v_mfma_f32_16x16x32_bf16 v[16:19], v[40:43], v[52:55], v[16:19]
  v_and_b32 v29, s64, v29
  v_perm_b32 v56, v28, v186, s65
  v_perm_b32 v57, v28, v186, s66
  v_perm_b32 v60, v29, v187, s65
  v_perm_b32 v61, v29, v187, s66
  v_and_b32 v28, s64, v189
  v_alignbit_b32 v29, v189, v189, 4
  v_and_b32 v29, s64, v29
  v_perm_b32 v58, v28, v190, s65
  v_perm_b32 v59, v28, v190, s66
  v_perm_b32 v62, v29, v191, s65
  v_perm_b32 v63, v29, v191, s66
  v_mfma_f32_16x16x32_bf16 v[12:15], v[44:47], v[56:59], v[12:15]
  s_waitcnt vmcnt(40)
  buffer_load_dwordx4 a[4:7], v2, s[12:15], s72 offen offset:1024 nt
  v_mfma_f32_16x16x32_bf16 v[16:19], v[44:47], v[60:63], v[16:19]
  s_waitcnt vmcnt(40)
  buffer_load_dwordx4 a[8:11], v2, s[12:15], s72 offen offset:2048 nt
  v_and_b32 v28, s64, v78
  v_alignbit_b32 v29, v78, v78, 4
  v_and_b32 v29, s64, v29
  v_perm_b32 v48, v28, v76, s65
  v_perm_b32 v49, v28, v76, s66
  v_perm_b32 v50, v29, v77, s65
  v_perm_b32 v51, v29, v77, s66
  v_and_b32 v28, s64, v79
  v_alignbit_b32 v29, v79, v79, 4
  v_mfma_f32_16x16x32_bf16 v[32:35], v[48:51], v[8:11], 0
  v_and_b32 v29, s64, v29
  v_perm_b32 v52, v28, v108, s65
  v_perm_b32 v53, v28, v108, s66
  v_perm_b32 v54, v29, v109, s65
  v_perm_b32 v55, v29, v109, s66
  v_and_b32 v28, s64, v112
  v_alignbit_b32 v29, v112, v112, 4
  v_mfma_f32_16x16x32_bf16 v[36:39], v[52:55], v[8:11], 0
  v_and_b32 v29, s64, v29
  v_perm_b32 v56, v28, v110, s65
  v_perm_b32 v57, v28, v110, s66
  v_perm_b32 v58, v29, v111, s65
  v_perm_b32 v59, v29, v111, s66
  v_and_b32 v28, s64, v113
  v_alignbit_b32 v29, v113, v113, 4
  v_mfma_f32_16x16x32_bf16 v[40:43], v[56:59], v[8:11], 0
  v_and_b32 v29, s64, v29
  v_perm_b32 v60, v28, v114, s65
  v_perm_b32 v61, v28, v114, s66
  v_perm_b32 v62, v29, v115, s65
  v_perm_b32 v63, v29, v115, s66
  s_waitcnt lgkmcnt(0)
  ds_read_b128 v[52:55], v3 offset:33792
  v_mfma_f32_16x16x32_bf16 v[44:47], v[60:63], v[8:11], 0
  ds_read_b128 v[56:59], v3 offset:34816
  ds_read_b128 v[60:63], v3 offset:35840
  s_waitcnt vmcnt(40)
  buffer_load_dwordx4 v[216:219], v2, s[12:15], s72 offen offset:3072 nt
  v_add_f32_dpp v24, v32, v24 quad_perm:[0,1,2,3] row_mask:0xf bank_mask:0x1
  v_mov_b32_dpp v26, v34 row_ror:8 row_mask:0xf bank_mask:0x1
  s_waitcnt vmcnt(40)
  v_add_f32_dpp v24, v36, v24 row_ror:4 row_mask:0xf bank_mask:0x2
  v_mov_b32_dpp v26, v38 row_ror:12 row_mask:0xf bank_mask:0x2
  s_mov_b32 s10, 0x8000000
  v_add_f32_dpp v24, v40, v24 row_ror:8 row_mask:0xf bank_mask:0x4
  v_mov_b32_dpp v26, v42 quad_perm:[0,1,2,3] row_mask:0xf bank_mask:0x4
  s_xor_b32 s72, s49, 229376
  v_add_f32_dpp v24, v44, v24 row_ror:12 row_mask:0xf bank_mask:0x8
  v_mov_b32_dpp v26, v46 row_ror:4 row_mask:0xf bank_mask:0x8
  buffer_load_dwordx4 v[220:223], v1, s[8:11], s72 offen nt
  v_add_f32_dpp v24, v33, v24 row_ror:12 row_mask:0xf bank_mask:0x1
  v_add_f32_dpp v26, v35, v26 row_ror:4 row_mask:0xf bank_mask:0x1
  s_waitcnt vmcnt(40)
  v_add_f32_dpp v24, v37, v24 quad_perm:[0,1,2,3] row_mask:0xf bank_mask:0x2
  v_add_f32_dpp v26, v39, v26 row_ror:8 row_mask:0xf bank_mask:0x2
  buffer_load_dwordx4 v[224:227], v1, s[8:11], s72 offen offset:1024 nt
  v_add_f32_dpp v24, v41, v24 row_ror:4 row_mask:0xf bank_mask:0x4
  v_add_f32_dpp v26, v43, v26 row_ror:12 row_mask:0xf bank_mask:0x4
  s_nop 0
  v_add_f32_dpp v24, v45, v24 row_ror:8 row_mask:0xf bank_mask:0x8
  v_add_f32_dpp v26, v47, v26 quad_perm:[0,1,2,3] row_mask:0xf bank_mask:0x8
  v_add_f32 v24, v24, v26
  s_waitcnt lgkmcnt(0)
  v_and_b32 v28, s64, v54
  v_alignbit_b32 v29, v54, v54, 4
  v_and_b32 v29, s64, v29
  v_perm_b32 v48, v28, v52, s65
  v_perm_b32 v49, v28, v52, s66
  v_perm_b32 v50, v29, v53, s65
  v_perm_b32 v51, v29, v53, s66
  v_and_b32 v28, s64, v55
  v_alignbit_b32 v29, v55, v55, 4
  v_mfma_f32_16x16x32_bf16 v[32:35], v[48:51], v[8:11], 0
  v_and_b32 v29, s64, v29
  v_perm_b32 v52, v28, v56, s65
  v_perm_b32 v53, v28, v56, s66
  v_perm_b32 v54, v29, v57, s65
  v_perm_b32 v55, v29, v57, s66
  v_and_b32 v28, s64, v60
  v_alignbit_b32 v29, v60, v60, 4
  v_mfma_f32_16x16x32_bf16 v[36:39], v[52:55], v[8:11], 0
  v_and_b32 v29, s64, v29
  v_perm_b32 v56, v28, v58, s65
  v_perm_b32 v57, v28, v58, s66
  v_perm_b32 v58, v29, v59, s65
  v_perm_b32 v59, v29, v59, s66
  v_and_b32 v28, s64, v61
  v_alignbit_b32 v29, v61, v61, 4
  v_mfma_f32_16x16x32_bf16 v[40:43], v[56:59], v[8:11], 0
  v_and_b32 v29, s64, v29
  v_perm_b32 v60, v28, v62, s65
  v_perm_b32 v61, v28, v62, s66
  v_perm_b32 v62, v29, v63, s65
  v_perm_b32 v63, v29, v63, s66
  v_add_f32_dpp v25, v32, v25 quad_perm:[0,1,2,3] row_mask:0xf bank_mask:0x1
  v_and_b32 v28, s64, v162
  v_mfma_f32_16x16x32_bf16 v[44:47], v[60:63], v[8:11], 0
  v_mov_b32_dpp v27, v34 row_ror:8 row_mask:0xf bank_mask:0x1
  v_alignbit_b32 v29, v162, v162, 4
  v_add_f32_dpp v25, v36, v25 row_ror:4 row_mask:0xf bank_mask:0x2
  v_and_b32 v29, s64, v29
  v_mov_b32_dpp v27, v38 row_ror:12 row_mask:0xf bank_mask:0x2
  v_perm_b32 v48, v28, v160, s65
  v_add_f32_dpp v25, v40, v25 row_ror:8 row_mask:0xf bank_mask:0x4
  v_perm_b32 v49, v28, v160, s66
  v_mov_b32_dpp v27, v42 quad_perm:[0,1,2,3] row_mask:0xf bank_mask:0x4
  v_perm_b32 v52, v29, v161, s65
  v_add_f32_dpp v25, v44, v25 row_ror:12 row_mask:0xf bank_mask:0x8
  v_perm_b32 v53, v29, v161, s66
  v_mov_b32_dpp v27, v46 row_ror:4 row_mask:0xf bank_mask:0x8
  v_and_b32 v28, s64, v163
  v_add_f32_dpp v25, v33, v25 row_ror:12 row_mask:0xf bank_mask:0x1
  v_alignbit_b32 v29, v163, v163, 4
  v_add_f32_dpp v27, v35, v27 row_ror:4 row_mask:0xf bank_mask:0x1
  v_and_b32 v29, s64, v29
  v_add_f32_dpp v25, v37, v25 quad_perm:[0,1,2,3] row_mask:0xf bank_mask:0x2
  v_perm_b32 v50, v28, v176, s65
  v_add_f32_dpp v27, v39, v27 row_ror:8 row_mask:0xf bank_mask:0x2
  v_perm_b32 v51, v28, v176, s66
  v_add_f32_dpp v25, v41, v25 row_ror:4 row_mask:0xf bank_mask:0x4
  v_perm_b32 v54, v29, v177, s65
  v_add_f32_dpp v27, v43, v27 row_ror:12 row_mask:0xf bank_mask:0x4
  v_perm_b32 v55, v29, v177, s66
  v_add_f32_dpp v25, v45, v25 row_ror:8 row_mask:0xf bank_mask:0x8
  v_and_b32 v28, s64, v180
  v_add_f32_dpp v27, v47, v27 quad_perm:[0,1,2,3] row_mask:0xf bank_mask:0x8
  v_alignbit_b32 v29, v180, v180, 4
  v_and_b32 v29, s64, v29
  v_add_f32 v25, v25, v27
  v_cvt_pk_bf16_f32 v32, v24, v25
  v_perm_b32 v56, v28, v178, s65
  v_lshlrev_b32 v24, 16, v32
  v_and_b32 v25, 0xffff0000, v32
  v_perm_b32 v57, v28, v178, s66
  v_pk_mul_f32 v[24:25], v[24:25], s[56:57] op_sel_hi:[1,0]
  v_cvt_pk_bf16_f32 v32, v24, v25
  v_lshlrev_b32 v24, 16, v32
  v_perm_b32 v60, v29, v179, s65
  v_and_b32 v25, 0xffff0000, v32
  ds_write_b64 v3, v[24:25] offset:4096
  v_pk_add_f32 v[26:27], v[24:25], v[4:5] op_sel_hi:[1,0] neg_lo:[0,1] neg_hi:[0,1]
  v_pk_mul_f32 v[26:27], v[26:27], s[56:57] op_sel:[0,1] op_sel_hi:[1,1]
  v_perm_b32 v61, v29, v179, s66
  v_max_f32 v20, v26, v27
  v_and_b32 v28, s64, v181
  v_cmp_lt_f32 vcc, 0, v20
  s_getpc_b64 s[74:75]
  s_cbranch_vccnz L_remax
  v_exp_f32 v26, v26
  v_exp_f32 v27, v27
  v_alignbit_b32 v29, v181, v181, 4
  v_pk_mul_f32 v[24:25], v[26:27], s[40:41] op_sel:[0,1] op_sel_hi:[1,1]
  v_add_f32 v32, v26, v27
  v_and_b32 v29, s64, v29
  v_cvt_pk_bf16_f32 v20, v24, 0
  v_cvt_pk_bf16_f32 v21, v24, 0
  v_perm_b32 v58, v28, v182, s65
  v_cvt_pk_bf16_f32 v23, v25, 0
  v_cvt_pk_bf16_f32 v22, v25, 0
  v_cvt_pk_bf16_f32 v24, 0, v24
  v_perm_b32 v59, v28, v182, s66
  v_cvt_pk_bf16_f32 v25, 0, v25
  v_add_f32 v5, v5, v32
  v_perm_b32 v62, v29, v183, s65
  v_mov_b32_dpp v20, v24 row_ror:4 row_mask:0xf bank_mask:0xa
  v_mov_b32_dpp v21, v24 row_ror:4 row_mask:0xf bank_mask:0x5
  v_perm_b32 v63, v29, v183, s66
  v_mov_b32_dpp v23, v25 row_ror:4 row_mask:0xf bank_mask:0xa
  v_mov_b32_dpp v22, v25 row_ror:4 row_mask:0xf bank_mask:0x5
  ds_read_b64 v[24:25], v3 offset:4104
  s_waitcnt vmcnt(40)
  buffer_load_dwordx4 v[64:67], v1, s[8:11], s72 offen offset:2048 nt
  v_and_b32_dpp v32, v20, v6 quad_perm:[0,1,2,3] row_mask:0xf bank_mask:0xf
  v_and_b32_dpp v33, v20, v7 row_ror:8 row_mask:0xf bank_mask:0xf
  v_and_b32_dpp v34, v21, v6 row_ror:12 row_mask:0xf bank_mask:0xf
  v_and_b32_dpp v35, v21, v7 row_ror:4 row_mask:0xf bank_mask:0xf
  v_and_b32_dpp v36, v20, v6 row_ror:8 row_mask:0xf bank_mask:0xf
  v_and_b32_dpp v37, v20, v7 quad_perm:[0,1,2,3] row_mask:0xf bank_mask:0xf
  v_mfma_f32_16x16x32_bf16 v[12:15], v[32:35], v[48:51], v[12:15]
  v_and_b32_dpp v38, v21, v6 row_ror:4 row_mask:0xf bank_mask:0xf
  v_and_b32_dpp v39, v21, v7 row_ror:12 row_mask:0xf bank_mask:0xf
  v_mfma_f32_16x16x32_bf16 v[16:19], v[32:35], v[52:55], v[16:19]
  v_and_b32_dpp v40, v23, v6 quad_perm:[0,1,2,3] row_mask:0xf bank_mask:0xf
  v_and_b32_dpp v41, v23, v7 row_ror:8 row_mask:0xf bank_mask:0xf
  v_mfma_f32_16x16x32_bf16 v[12:15], v[36:39], v[56:59], v[12:15]
  v_and_b32_dpp v42, v22, v6 row_ror:12 row_mask:0xf bank_mask:0xf
  v_and_b32_dpp v43, v22, v7 row_ror:4 row_mask:0xf bank_mask:0xf
  v_mfma_f32_16x16x32_bf16 v[16:19], v[36:39], v[60:63], v[16:19]
  v_and_b32_dpp v44, v23, v6 row_ror:8 row_mask:0xf bank_mask:0xf
  v_and_b32_dpp v45, v23, v7 quad_perm:[0,1,2,3] row_mask:0xf bank_mask:0xf
  v_and_b32_dpp v46, v22, v6 row_ror:4 row_mask:0xf bank_mask:0xf
  v_and_b32_dpp v47, v22, v7 row_ror:12 row_mask:0xf bank_mask:0xf
  v_and_b32 v28, s64, v206
  v_alignbit_b32 v29, v206, v206, 4
  v_and_b32 v29, s64, v29
  v_perm_b32 v48, v28, v204, s65
  v_perm_b32 v49, v28, v204, s66
  v_perm_b32 v52, v29, v205, s65
  v_perm_b32 v53, v29, v205, s66
  v_and_b32 v28, s64, v207
  v_alignbit_b32 v29, v207, v207, 4
  v_and_b32 v29, s64, v29
  v_perm_b32 v50, v28, v192, s65
  v_perm_b32 v51, v28, v192, s66
  v_perm_b32 v54, v29, v193, s65
  v_perm_b32 v55, v29, v193, s66
  v_mfma_f32_16x16x32_bf16 v[12:15], v[40:43], v[48:51], v[12:15]
  v_and_b32 v28, s64, v236
  v_alignbit_b32 v29, v236, v236, 4
  v_mfma_f32_16x16x32_bf16 v[16:19], v[40:43], v[52:55], v[16:19]
  v_and_b32 v29, s64, v29
  v_perm_b32 v56, v28, v194, s65
  v_perm_b32 v57, v28, v194, s66
  v_perm_b32 v60, v29, v195, s65
  v_perm_b32 v61, v29, v195, s66
  v_and_b32 v28, s64, v237
  v_alignbit_b32 v29, v237, v237, 4
  v_and_b32 v29, s64, v29
  v_perm_b32 v58, v28, v238, s65
  v_perm_b32 v59, v28, v238, s66
  v_perm_b32 v62, v29, v239, s65
  v_perm_b32 v63, v29, v239, s66
  v_mfma_f32_16x16x32_bf16 v[12:15], v[44:47], v[56:59], v[12:15]
  s_waitcnt vmcnt(40)
  buffer_load_dwordx4 v[68:71], v1, s[8:11], s72 offen offset:3072 nt
  v_mfma_f32_16x16x32_bf16 v[16:19], v[44:47], v[60:63], v[16:19]
  v_and_b32 v28, s64, v246
  v_alignbit_b32 v29, v246, v246, 4
  v_and_b32 v29, s64, v29
  v_perm_b32 v48, v28, v244, s65
  v_perm_b32 v49, v28, v244, s66
  v_perm_b32 v50, v29, v245, s65
  v_perm_b32 v51, v29, v245, s66
  v_and_b32 v28, s64, v247
  v_alignbit_b32 v29, v247, v247, 4
  v_mfma_f32_16x16x32_bf16 v[32:35], v[48:51], v[8:11], 0
  v_and_b32 v29, s64, v29
  v_perm_b32 v52, v28, v116, s65
  v_perm_b32 v53, v28, v116, s66
  v_perm_b32 v54, v29, v117, s65
  v_perm_b32 v55, v29, v117, s66
  v_accvgpr_read_b32 v29, a80
  v_and_b32 v28, s64, v29
  v_mfma_f32_16x16x32_bf16 v[36:39], v[52:55], v[8:11], 0
  v_alignbit_b32 v29, v29, v29, 4
  v_and_b32 v29, s64, v29
  v_perm_b32 v56, v28, v118, s65
  v_perm_b32 v57, v28, v118, s66
  v_perm_b32 v58, v29, v119, s65
  v_perm_b32 v59, v29, v119, s66
  v_accvgpr_read_b32 v29, a81
  v_and_b32 v28, s64, v29
  v_mfma_f32_16x16x32_bf16 v[40:43], v[56:59], v[8:11], 0
  v_alignbit_b32 v29, v29, v29, 4
  v_and_b32 v29, s64, v29
  v_accvgpr_read_b32 v61, a82
  v_perm_b32 v60, v28, v61, s65
  v_perm_b32 v61, v28, v61, s66
  v_accvgpr_read_b32 v63, a83
  v_perm_b32 v62, v29, v63, s65
  v_perm_b32 v63, v29, v63, s66
  s_waitcnt lgkmcnt(0)
  s_waitcnt vmcnt(40)
  v_mfma_f32_16x16x32_bf16 v[44:47], v[60:63], v[8:11], 0
  s_bitcmp1_b32 s2, 0
  s_cselect_b32 s10, 0, 0x8000000
  ds_read_b128 v[52:55], v3 offset:32768
  s_xor_b32 s72, s49, 1032192
  buffer_load_dwordx4 a[80:83], v1, s[8:11], s72 offen nt
  s_waitcnt vmcnt(40)
  buffer_load_dwordx4 v[72:75], v1, s[8:11], s72 offen offset:1024 nt
  v_add_f32_dpp v24, v32, v24 quad_perm:[0,1,2,3] row_mask:0xf bank_mask:0x1
  v_mov_b32_dpp v26, v34 row_ror:8 row_mask:0xf bank_mask:0x1
  v_accvgpr_read_b32 v57, a106
  v_add_f32_dpp v24, v36, v24 row_ror:4 row_mask:0xf bank_mask:0x2
  v_mov_b32_dpp v26, v38 row_ror:12 row_mask:0xf bank_mask:0x2
  v_accvgpr_read_b32 v59, a107
  v_add_f32_dpp v24, v40, v24 row_ror:8 row_mask:0xf bank_mask:0x4
  v_mov_b32_dpp v26, v42 quad_perm:[0,1,2,3] row_mask:0xf bank_mask:0x4
  v_accvgpr_read_b32 v61, a122
  v_add_f32_dpp v24, v44, v24 row_ror:12 row_mask:0xf bank_mask:0x8
  v_mov_b32_dpp v26, v46 row_ror:4 row_mask:0xf bank_mask:0x8
  v_accvgpr_read_b32 v63, a123
  v_add_f32_dpp v24, v33, v24 row_ror:12 row_mask:0xf bank_mask:0x1
  v_add_f32_dpp v26, v35, v26 row_ror:4 row_mask:0xf bank_mask:0x1
  s_waitcnt vmcnt(40)
  v_add_f32_dpp v24, v37, v24 quad_perm:[0,1,2,3] row_mask:0xf bank_mask:0x2
  v_add_f32_dpp v26, v39, v26 row_ror:8 row_mask:0xf bank_mask:0x2
  s_nop 0
  v_add_f32_dpp v24, v41, v24 row_ror:4 row_mask:0xf bank_mask:0x4
  v_add_f32_dpp v26, v43, v26 row_ror:12 row_mask:0xf bank_mask:0x4
  s_nop 0
  v_add_f32_dpp v24, v45, v24 row_ror:8 row_mask:0xf bank_mask:0x8
  v_add_f32_dpp v26, v47, v26 quad_perm:[0,1,2,3] row_mask:0xf bank_mask:0x8
  v_add_f32 v24, v24, v26
  s_waitcnt lgkmcnt(0)
  v_and_b32 v28, s64, v54
  v_alignbit_b32 v29, v54, v54, 4
  v_and_b32 v29, s64, v29
  v_perm_b32 v48, v28, v52, s65
  v_perm_b32 v49, v28, v52, s66
  v_perm_b32 v50, v29, v53, s65
  v_perm_b32 v51, v29, v53, s66
  v_and_b32 v28, s64, v55
  v_alignbit_b32 v29, v55, v55, 4
  v_mfma_f32_16x16x32_bf16 v[32:35], v[48:51], v[8:11], 0
  v_and_b32 v29, s64, v29
  v_accvgpr_read_b32 v53, a104
  v_perm_b32 v52, v28, v53, s65
  v_perm_b32 v53, v28, v53, s66
  v_accvgpr_read_b32 v55, a105
  v_perm_b32 v54, v29, v55, s65
  v_perm_b32 v55, v29, v55, s66
  v_accvgpr_read_b32 v29, a120
  v_and_b32 v28, s64, v29
  v_mfma_f32_16x16x32_bf16 v[36:39], v[52:55], v[8:11], 0
  v_alignbit_b32 v29, v29, v29, 4
  v_and_b32 v29, s64, v29
  v_perm_b32 v56, v28, v57, s65
  v_perm_b32 v57, v28, v57, s66
  v_perm_b32 v58, v29, v59, s65
  v_perm_b32 v59, v29, v59, s66
  v_accvgpr_read_b32 v29, a121
  v_and_b32 v28, s64, v29
  v_mfma_f32_16x16x32_bf16 v[40:43], v[56:59], v[8:11], 0
  v_alignbit_b32 v29, v29, v29, 4
  v_and_b32 v29, s64, v29
  v_perm_b32 v60, v28, v61, s65
  v_perm_b32 v61, v28, v61, s66
  v_perm_b32 v62, v29, v63, s65
  v_perm_b32 v63, v29, v63, s66
  buffer_load_dwordx4 a[104:107], v1, s[8:11], s72 offen offset:2048 nt
  v_add_f32_dpp v25, v32, v25 quad_perm:[0,1,2,3] row_mask:0xf bank_mask:0x1
  v_mfma_f32_16x16x32_bf16 v[44:47], v[60:63], v[8:11], 0
  v_and_b32 v28, s64, v146
  v_mov_b32_dpp v27, v34 row_ror:8 row_mask:0xf bank_mask:0x1
  v_alignbit_b32 v29, v146, v146, 4
  v_add_f32_dpp v25, v36, v25 row_ror:4 row_mask:0xf bank_mask:0x2
  v_and_b32 v29, s64, v29
  v_mov_b32_dpp v27, v38 row_ror:12 row_mask:0xf bank_mask:0x2
  v_perm_b32 v48, v28, v144, s65
  v_add_f32_dpp v25, v40, v25 row_ror:8 row_mask:0xf bank_mask:0x4
  v_perm_b32 v49, v28, v144, s66
  v_mov_b32_dpp v27, v42 quad_perm:[0,1,2,3] row_mask:0xf bank_mask:0x4
  v_perm_b32 v52, v29, v145, s65
  v_add_f32_dpp v25, v44, v25 row_ror:12 row_mask:0xf bank_mask:0x8
  v_perm_b32 v53, v29, v145, s66
  v_mov_b32_dpp v27, v46 row_ror:4 row_mask:0xf bank_mask:0x8
  v_and_b32 v28, s64, v147
  v_add_f32_dpp v25, v33, v25 row_ror:12 row_mask:0xf bank_mask:0x1
  v_alignbit_b32 v29, v147, v147, 4
  v_add_f32_dpp v27, v35, v27 row_ror:4 row_mask:0xf bank_mask:0x1
  v_and_b32 v29, s64, v29
  v_add_f32_dpp v25, v37, v25 quad_perm:[0,1,2,3] row_mask:0xf bank_mask:0x2
  v_perm_b32 v50, v28, v200, s65
  v_add_f32_dpp v27, v39, v27 row_ror:8 row_mask:0xf bank_mask:0x2
  v_perm_b32 v51, v28, v200, s66
  v_add_f32_dpp v25, v41, v25 row_ror:4 row_mask:0xf bank_mask:0x4
  v_perm_b32 v54, v29, v201, s65
  v_add_f32_dpp v27, v43, v27 row_ror:12 row_mask:0xf bank_mask:0x4
  v_perm_b32 v55, v29, v201, s66
  v_add_f32_dpp v25, v45, v25 row_ror:8 row_mask:0xf bank_mask:0x8
  v_accvgpr_read_b32 v29, a128
  v_add_f32_dpp v27, v47, v27 quad_perm:[0,1,2,3] row_mask:0xf bank_mask:0x8
  v_and_b32 v28, s64, v29
  v_alignbit_b32 v29, v29, v29, 4
  v_add_f32 v25, v25, v27
  v_and_b32 v29, s64, v29
  v_cvt_pk_bf16_f32 v32, v24, v25
  v_lshlrev_b32 v24, 16, v32
  v_perm_b32 v56, v28, v202, s65
  v_and_b32 v25, 0xffff0000, v32
  v_pk_mul_f32 v[24:25], v[24:25], s[56:57] op_sel_hi:[1,0]
  v_perm_b32 v57, v28, v202, s66
  v_cvt_pk_bf16_f32 v32, v24, v25
  v_lshlrev_b32 v24, 16, v32
  v_perm_b32 v60, v29, v203, s65
  v_and_b32 v25, 0xffff0000, v32
  ds_write_b64 v3, v[24:25] offset:4104
  v_perm_b32 v61, v29, v203, s66
  v_pk_add_f32 v[26:27], v[24:25], v[4:5] op_sel_hi:[1,0] neg_lo:[0,1] neg_hi:[0,1]
  v_pk_mul_f32 v[26:27], v[26:27], s[56:57] op_sel:[0,1] op_sel_hi:[1,1]
  v_max_f32 v20, v26, v27
  v_accvgpr_read_b32 v29, a129
  v_cmp_lt_f32 vcc, 0, v20
  s_getpc_b64 s[74:75]
  s_cbranch_vccnz L_remax
  v_and_b32 v28, s64, v29
  v_exp_f32 v26, v26
  v_exp_f32 v27, v27
  v_alignbit_b32 v29, v29, v29, 4
  v_pk_mul_f32 v[24:25], v[26:27], s[40:41] op_sel:[0,1] op_sel_hi:[1,1]
  v_and_b32 v29, s64, v29
  v_add_f32 v32, v26, v27
  v_cvt_pk_bf16_f32 v20, v24, 0
  v_accvgpr_read_b32 v59, a130
  v_cvt_pk_bf16_f32 v21, v24, 0
  v_cvt_pk_bf16_f32 v23, v25, 0
  v_perm_b32 v58, v28, v59, s65
  v_cvt_pk_bf16_f32 v22, v25, 0
  v_cvt_pk_bf16_f32 v24, 0, v24
  v_perm_b32 v59, v28, v59, s66
  v_cvt_pk_bf16_f32 v25, 0, v25
  v_accvgpr_read_b32 v63, a131
  v_add_f32 v5, v5, v32
  v_mov_b32_dpp v20, v24 row_ror:4 row_mask:0xf bank_mask:0xa
  v_perm_b32 v62, v29, v63, s65
  v_mov_b32_dpp v21, v24 row_ror:4 row_mask:0xf bank_mask:0x5
  v_mov_b32_dpp v23, v25 row_ror:4 row_mask:0xf bank_mask:0xa
  v_perm_b32 v63, v29, v63, s66
  v_mov_b32_dpp v22, v25 row_ror:4 row_mask:0xf bank_mask:0x5
  ds_read_b64 v[24:25], v3 offset:5120
  s_waitcnt vmcnt(40)
  buffer_load_dwordx4 a[120:123], v1, s[8:11], s72 offen offset:3072 nt
  s_waitcnt vmcnt(40)
  s_mov_b32 s10, 0x8000000
  s_xor_b32 s72, s49, 245760
  buffer_load_dwordx4 a[128:131], v1, s[8:11], s72 offen nt
  v_and_b32_dpp v32, v20, v6 quad_perm:[0,1,2,3] row_mask:0xf bank_mask:0xf
  v_and_b32_dpp v33, v20, v7 row_ror:8 row_mask:0xf bank_mask:0xf
  v_and_b32_dpp v34, v21, v6 row_ror:12 row_mask:0xf bank_mask:0xf
  v_and_b32_dpp v35, v21, v7 row_ror:4 row_mask:0xf bank_mask:0xf
  v_and_b32_dpp v36, v20, v6 row_ror:8 row_mask:0xf bank_mask:0xf
  v_and_b32_dpp v37, v20, v7 quad_perm:[0,1,2,3] row_mask:0xf bank_mask:0xf
  v_mfma_f32_16x16x32_bf16 v[12:15], v[32:35], v[48:51], v[12:15]
  v_and_b32_dpp v38, v21, v6 row_ror:4 row_mask:0xf bank_mask:0xf
  v_and_b32_dpp v39, v21, v7 row_ror:12 row_mask:0xf bank_mask:0xf
  v_mfma_f32_16x16x32_bf16 v[16:19], v[32:35], v[52:55], v[16:19]
  v_and_b32_dpp v40, v23, v6 quad_perm:[0,1,2,3] row_mask:0xf bank_mask:0xf
  v_and_b32_dpp v41, v23, v7 row_ror:8 row_mask:0xf bank_mask:0xf
  v_mfma_f32_16x16x32_bf16 v[12:15], v[36:39], v[56:59], v[12:15]
  v_and_b32_dpp v42, v22, v6 row_ror:12 row_mask:0xf bank_mask:0xf
  v_and_b32_dpp v43, v22, v7 row_ror:4 row_mask:0xf bank_mask:0xf
  v_mfma_f32_16x16x32_bf16 v[16:19], v[36:39], v[60:63], v[16:19]
  v_and_b32_dpp v44, v23, v6 row_ror:8 row_mask:0xf bank_mask:0xf
  v_and_b32_dpp v45, v23, v7 quad_perm:[0,1,2,3] row_mask:0xf bank_mask:0xf
  v_and_b32_dpp v46, v22, v6 row_ror:4 row_mask:0xf bank_mask:0xf
  v_and_b32_dpp v47, v22, v7 row_ror:12 row_mask:0xf bank_mask:0xf
  v_and_b32 v28, s64, v242
  v_alignbit_b32 v29, v242, v242, 4
  v_and_b32 v29, s64, v29
  v_perm_b32 v48, v28, v240, s65
  v_perm_b32 v49, v28, v240, s66
  v_perm_b32 v52, v29, v241, s65
  v_perm_b32 v53, v29, v241, s66
  v_and_b32 v28, s64, v243
  v_alignbit_b32 v29, v243, v243, 4
  v_and_b32 v29, s64, v29
  v_accvgpr_read_b32 v51, a168
  v_perm_b32 v50, v28, v51, s65
  v_perm_b32 v51, v28, v51, s66
  v_accvgpr_read_b32 v55, a169
  v_perm_b32 v54, v29, v55, s65
  v_mfma_f32_16x16x32_bf16 v[12:15], v[40:43], v[48:51], v[12:15]
  v_perm_b32 v55, v29, v55, s66
  v_accvgpr_read_b32 v29, a172
  v_and_b32 v28, s64, v29
  v_mfma_f32_16x16x32_bf16 v[16:19], v[40:43], v[52:55], v[16:19]
  v_alignbit_b32 v29, v29, v29, 4
  v_and_b32 v29, s64, v29
  v_accvgpr_read_b32 v57, a170
  v_perm_b32 v56, v28, v57, s65
  v_perm_b32 v57, v28, v57, s66
  v_accvgpr_read_b32 v61, a171
  v_perm_b32 v60, v29, v61, s65
  v_perm_b32 v61, v29, v61, s66
  v_accvgpr_read_b32 v29, a173
  v_and_b32 v28, s64, v29
  v_alignbit_b32 v29, v29, v29, 4
  v_and_b32 v29, s64, v29
  v_accvgpr_read_b32 v59, a174
  v_perm_b32 v58, v28, v59, s65
  v_perm_b32 v59, v28, v59, s66
  v_accvgpr_read_b32 v63, a175
  v_perm_b32 v62, v29, v63, s65
  v_mfma_f32_16x16x32_bf16 v[12:15], v[44:47], v[56:59], v[12:15]
  v_perm_b32 v63, v29, v63, s66
  s_waitcnt vmcnt(40)
  buffer_load_dwordx4 a[168:171], v1, s[8:11], s72 offen offset:1024 nt
  v_mfma_f32_16x16x32_bf16 v[16:19], v[44:47], v[60:63], v[16:19]
  v_accvgpr_read_b32 v29, a202
  v_and_b32 v28, s64, v29
  v_alignbit_b32 v29, v29, v29, 4
  v_and_b32 v29, s64, v29
  v_accvgpr_read_b32 v49, a200
  v_perm_b32 v48, v28, v49, s65
  v_perm_b32 v49, v28, v49, s66
  v_accvgpr_read_b32 v51, a201
  v_perm_b32 v50, v29, v51, s65
  v_perm_b32 v51, v29, v51, s66
  v_accvgpr_read_b32 v29, a203
  v_and_b32 v28, s64, v29
  v_mfma_f32_16x16x32_bf16 v[32:35], v[48:51], v[8:11], 0
  v_alignbit_b32 v29, v29, v29, 4
  v_and_b32 v29, s64, v29
  v_accvgpr_read_b32 v53, a216
  v_perm_b32 v52, v28, v53, s65
  v_perm_b32 v53, v28, v53, s66
  v_accvgpr_read_b32 v55, a217
  v_perm_b32 v54, v29, v55, s65
  v_perm_b32 v55, v29, v55, s66
  v_accvgpr_read_b32 v29, a232
  v_and_b32 v28, s64, v29
  v_mfma_f32_16x16x32_bf16 v[36:39], v[52:55], v[8:11], 0
  v_alignbit_b32 v29, v29, v29, 4
  v_and_b32 v29, s64, v29
  v_accvgpr_read_b32 v57, a218
  v_perm_b32 v56, v28, v57, s65
  v_perm_b32 v57, v28, v57, s66
  v_accvgpr_read_b32 v59, a219
  v_perm_b32 v58, v29, v59, s65
  v_perm_b32 v59, v29, v59, s66
  v_accvgpr_read_b32 v29, a233
  v_and_b32 v28, s64, v29
  v_mfma_f32_16x16x32_bf16 v[40:43], v[56:59], v[8:11], 0
  v_alignbit_b32 v29, v29, v29, 4
  v_and_b32 v29, s64, v29
  v_accvgpr_read_b32 v61, a234
  v_perm_b32 v60, v28, v61, s65
  v_perm_b32 v61, v28, v61, s66
  v_accvgpr_read_b32 v63, a235
  v_perm_b32 v62, v29, v63, s65
  v_perm_b32 v63, v29, v63, s66
  s_waitcnt lgkmcnt(0)
  ds_read_b128 v[52:55], v3 offset:30720
  v_mfma_f32_16x16x32_bf16 v[44:47], v[60:63], v[8:11], 0
  s_waitcnt vmcnt(40)
  buffer_load_dwordx4 a[172:175], v1, s[8:11], s72 offen offset:2048 nt
  s_waitcnt vmcnt(40)
  buffer_load_dwordx4 a[200:203], v1, s[8:11], s72 offen offset:3072 nt
  v_add_f32_dpp v24, v32, v24 quad_perm:[0,1,2,3] row_mask:0xf bank_mask:0x1
  v_mov_b32_dpp v26, v34 row_ror:8 row_mask:0xf bank_mask:0x1
  s_waitcnt vmcnt(40)
  v_add_f32_dpp v24, v36, v24 row_ror:4 row_mask:0xf bank_mask:0x2
  v_mov_b32_dpp v26, v38 row_ror:12 row_mask:0xf bank_mask:0x2
  s_xor_b32 s72, s49, 229376
  v_add_f32_dpp v24, v40, v24 row_ror:8 row_mask:0xf bank_mask:0x4
  v_mov_b32_dpp v26, v42 quad_perm:[0,1,2,3] row_mask:0xf bank_mask:0x4
  buffer_load_dwordx4 a[216:219], v2, s[12:15], s72 offen nt
  v_add_f32_dpp v24, v44, v24 row_ror:12 row_mask:0xf bank_mask:0x8
  v_mov_b32_dpp v26, v46 row_ror:4 row_mask:0xf bank_mask:0x8
  s_nop 0
  v_add_f32_dpp v24, v33, v24 row_ror:12 row_mask:0xf bank_mask:0x1
  v_add_f32_dpp v26, v35, v26 row_ror:4 row_mask:0xf bank_mask:0x1
  s_nop 0
  v_add_f32_dpp v24, v37, v24 quad_perm:[0,1,2,3] row_mask:0xf bank_mask:0x2
  v_add_f32_dpp v26, v39, v26 row_ror:8 row_mask:0xf bank_mask:0x2
  s_nop 0
  v_add_f32_dpp v24, v41, v24 row_ror:4 row_mask:0xf bank_mask:0x4
  v_add_f32_dpp v26, v43, v26 row_ror:12 row_mask:0xf bank_mask:0x4
  s_nop 0
  v_add_f32_dpp v24, v45, v24 row_ror:8 row_mask:0xf bank_mask:0x8
  v_add_f32_dpp v26, v47, v26 quad_perm:[0,1,2,3] row_mask:0xf bank_mask:0x8
  v_add_f32 v24, v24, v26
  s_waitcnt lgkmcnt(0)
  v_and_b32 v28, s64, v54
  v_alignbit_b32 v29, v54, v54, 4
  v_and_b32 v29, s64, v29
  v_perm_b32 v48, v28, v52, s65
  v_perm_b32 v49, v28, v52, s66
  v_perm_b32 v50, v29, v53, s65
  v_perm_b32 v51, v29, v53, s66
  v_and_b32 v28, s64, v55
  v_alignbit_b32 v29, v55, v55, 4
  v_mfma_f32_16x16x32_bf16 v[32:35], v[48:51], v[8:11], 0
  v_and_b32 v29, s64, v29
  v_perm_b32 v52, v28, v132, s65
  v_perm_b32 v53, v28, v132, s66
  v_perm_b32 v54, v29, v133, s65
  v_perm_b32 v55, v29, v133, s66
  v_and_b32 v28, s64, v136
  v_alignbit_b32 v29, v136, v136, 4
  v_mfma_f32_16x16x32_bf16 v[36:39], v[52:55], v[8:11], 0
  ds_read_b64 v[54:55], v3 offset:31744
  v_and_b32 v29, s64, v29
  v_perm_b32 v56, v28, v134, s65
  v_perm_b32 v57, v28, v134, s66
  v_perm_b32 v58, v29, v135, s65
  v_perm_b32 v59, v29, v135, s66
  v_and_b32 v28, s64, v137
  v_alignbit_b32 v29, v137, v137, 4
  v_mfma_f32_16x16x32_bf16 v[40:43], v[56:59], v[8:11], 0
  v_and_b32 v29, s64, v29
  v_perm_b32 v60, v28, v138, s65
  v_perm_b32 v61, v28, v138, s66
  v_perm_b32 v62, v29, v139, s65
  v_perm_b32 v63, v29, v139, s66
  v_add_f32_dpp v25, v32, v25 quad_perm:[0,1,2,3] row_mask:0xf bank_mask:0x1
  v_mov_b32_dpp v27, v34 row_ror:8 row_mask:0xf bank_mask:0x1
  v_mfma_f32_16x16x32_bf16 v[44:47], v[60:63], v[8:11], 0
  ds_read_b64 v[60:61], v3 offset:31752
  ds_read_b64 v[58:59], v3 offset:36864
  ds_read_b64 v[62:63], v3 offset:36872
  v_add_f32_dpp v25, v36, v25 row_ror:4 row_mask:0xf bank_mask:0x2
  v_mov_b32_dpp v27, v38 row_ror:12 row_mask:0xf bank_mask:0x2
  v_and_b32 v28, s64, v142
  v_add_f32_dpp v25, v40, v25 row_ror:8 row_mask:0xf bank_mask:0x4
  v_mov_b32_dpp v27, v42 quad_perm:[0,1,2,3] row_mask:0xf bank_mask:0x4
  v_alignbit_b32 v29, v142, v142, 4
  v_add_f32_dpp v25, v44, v25 row_ror:12 row_mask:0xf bank_mask:0x8
  v_mov_b32_dpp v27, v46 row_ror:4 row_mask:0xf bank_mask:0x8
  v_and_b32 v29, s64, v29
  v_add_f32_dpp v25, v33, v25 row_ror:12 row_mask:0xf bank_mask:0x1
  v_add_f32_dpp v27, v35, v27 row_ror:4 row_mask:0xf bank_mask:0x1
  v_perm_b32 v48, v28, v140, s65
  v_add_f32_dpp v25, v37, v25 quad_perm:[0,1,2,3] row_mask:0xf bank_mask:0x2
  v_add_f32_dpp v27, v39, v27 row_ror:8 row_mask:0xf bank_mask:0x2
  v_perm_b32 v49, v28, v140, s66
  v_add_f32_dpp v25, v41, v25 row_ror:4 row_mask:0xf bank_mask:0x4
  v_add_f32_dpp v27, v43, v27 row_ror:12 row_mask:0xf bank_mask:0x4
  v_perm_b32 v52, v29, v141, s65
  v_add_f32_dpp v25, v45, v25 row_ror:8 row_mask:0xf bank_mask:0x8
  v_add_f32_dpp v27, v47, v27 quad_perm:[0,1,2,3] row_mask:0xf bank_mask:0x8
  v_add_f32 v25, v25, v27
  v_cvt_pk_bf16_f32 v32, v24, v25
  v_lshlrev_b32 v24, 16, v32
  v_and_b32 v25, 0xffff0000, v32
  v_pk_mul_f32 v[24:25], v[24:25], s[56:57] op_sel_hi:[1,0]
  v_cvt_pk_bf16_f32 v32, v24, v25
  v_perm_b32 v53, v29, v141, s66
  v_lshlrev_b32 v24, 16, v32
  v_and_b32 v28, s64, v143
  v_and_b32 v25, 0xffff0000, v32
  v_alignbit_b32 v29, v143, v143, 4
  v_pk_add_f32 v[26:27], v[24:25], v[4:5] op_sel_hi:[1,0] neg_lo:[0,1] neg_hi:[0,1]
  v_pk_mul_f32 v[26:27], v[26:27], s[56:57] op_sel:[0,1] op_sel_hi:[1,1]
  v_and_b32 v29, s64, v29
  s_waitcnt lgkmcnt(0)
  ds_write_b64 v3, v[24:25] offset:5120
  v_max_f32 v20, v26, v27
  v_perm_b32 v50, v28, v54, s65
  v_perm_b32 v51, v28, v54, s66
  v_cmp_lt_f32 vcc, 0, v20
  s_getpc_b64 s[74:75]
  s_cbranch_vccnz L_remax
  v_perm_b32 v54, v29, v55, s65
  v_exp_f32 v26, v26
  v_perm_b32 v55, v29, v55, s66
  v_exp_f32 v27, v27
  v_and_b32 v28, s64, v58
  v_mul_f32 v24, s41, v26
  v_alignbit_b32 v29, v58, v58, 4
  v_add_f32 v32, v26, v27
  v_and_b32 v29, s64, v29
  v_cvt_pk_bf16_f32 v20, v24, 0
  v_perm_b32 v56, v28, v60, s65
  v_cvt_pk_bf16_f32 v21, v24, 0
  v_perm_b32 v57, v28, v60, s66
  v_cvt_pk_bf16_f32 v23, v27, 0
  v_perm_b32 v60, v29, v61, s65
  v_cvt_pk_bf16_f32 v22, v27, 0
  v_perm_b32 v61, v29, v61, s66
  v_cvt_pk_bf16_f32 v24, 0, v24
  v_and_b32 v28, s64, v59
  v_cvt_pk_bf16_f32 v25, 0, v27
  v_alignbit_b32 v29, v59, v59, 4
  v_add_f32 v5, v5, v32
  v_and_b32 v29, s64, v29
  v_mov_b32_dpp v20, v24 row_ror:4 row_mask:0xf bank_mask:0xa
  v_perm_b32 v58, v28, v62, s65
  v_mov_b32_dpp v21, v24 row_ror:4 row_mask:0xf bank_mask:0x5
  v_perm_b32 v59, v28, v62, s66
  v_mov_b32_dpp v23, v25 row_ror:4 row_mask:0xf bank_mask:0xa
  v_perm_b32 v62, v29, v63, s65
  v_mov_b32_dpp v22, v25 row_ror:4 row_mask:0xf bank_mask:0x5
  v_perm_b32 v63, v29, v63, s66
  s_waitcnt vmcnt(40)
  buffer_load_dwordx4 a[232:235], v2, s[12:15], s72 offen offset:1024 nt
  s_waitcnt vmcnt(40)
  buffer_load_dwordx4 v[92:95], v2, s[12:15], s72 offen offset:2048 nt
  v_and_b32_dpp v32, v20, v6 quad_perm:[0,1,2,3] row_mask:0xf bank_mask:0xf
  v_and_b32_dpp v33, v20, v7 row_ror:8 row_mask:0xf bank_mask:0xf
  v_and_b32_dpp v34, v21, v6 row_ror:12 row_mask:0xf bank_mask:0xf
  v_and_b32_dpp v35, v21, v7 row_ror:4 row_mask:0xf bank_mask:0xf
  v_and_b32_dpp v36, v20, v6 row_ror:8 row_mask:0xf bank_mask:0xf
  v_and_b32_dpp v37, v20, v7 quad_perm:[0,1,2,3] row_mask:0xf bank_mask:0xf
  v_mfma_f32_16x16x32_bf16 v[12:15], v[32:35], v[48:51], v[12:15]
  v_and_b32_dpp v38, v21, v6 row_ror:4 row_mask:0xf bank_mask:0xf
  v_and_b32_dpp v39, v21, v7 row_ror:12 row_mask:0xf bank_mask:0xf
  v_mfma_f32_16x16x32_bf16 v[16:19], v[32:35], v[52:55], v[16:19]
  v_and_b32_dpp v40, v23, v6 quad_perm:[0,1,2,3] row_mask:0xf bank_mask:0xf
  v_and_b32_dpp v41, v23, v7 row_ror:8 row_mask:0xf bank_mask:0xf
  v_mfma_f32_16x16x32_bf16 v[12:15], v[36:39], v[56:59], v[12:15]
  v_and_b32_dpp v42, v22, v6 row_ror:12 row_mask:0xf bank_mask:0xf
  v_and_b32_dpp v43, v22, v7 row_ror:4 row_mask:0xf bank_mask:0xf
  v_mfma_f32_16x16x32_bf16 v[16:19], v[36:39], v[60:63], v[16:19]
  v_and_b32_dpp v44, v23, v6 row_ror:8 row_mask:0xf bank_mask:0xf
  v_and_b32_dpp v45, v23, v7 quad_perm:[0,1,2,3] row_mask:0xf bank_mask:0xf
  v_mfma_f32_16x16x16_bf16 v[12:15], v[40:41], a[164:165], v[12:15]
  v_and_b32_dpp v46, v22, v6 row_ror:4 row_mask:0xf bank_mask:0xf
  v_and_b32_dpp v47, v22, v7 row_ror:12 row_mask:0xf bank_mask:0xf
  v_mfma_f32_16x16x16_bf16 v[16:19], v[40:41], a[166:167], v[16:19]
  s_waitcnt vmcnt(40)
  buffer_load_dwordx4 a[164:167], v2, s[12:15], s72 offen offset:3072 nt
  v_mfma_f32_16x16x16_bf16 v[12:15], v[42:43], a[188:189], v[12:15]
  v_and_b32 v20, 0x7fff7fff, v8
  v_and_b32 v21, 0x7fff7fff, v9
  v_mfma_f32_16x16x16_bf16 v[16:19], v[42:43], a[190:191], v[16:19]
  v_and_b32 v22, 0x7fff7fff, v10
  v_and_b32 v23, 0x7fff7fff, v11
  v_mfma_f32_16x16x16_bf16 v[12:15], v[44:45], a[192:193], v[12:15]
  v_pk_min_u16 v20, v20, 1 op_sel_hi:[1,0]
  v_pk_min_u16 v21, v21, 1 op_sel_hi:[1,0]
  v_mfma_f32_16x16x16_bf16 v[16:19], v[44:45], a[194:195], v[16:19]
  v_pk_min_u16 v22, v22, 1 op_sel_hi:[1,0]
  v_pk_min_u16 v23, v23, 1 op_sel_hi:[1,0]
  v_mfma_f32_16x16x16_bf16 v[12:15], v[46:47], a[196:197], v[12:15]
  v_pk_mul_lo_u16 v20, v20, s42
  v_pk_mul_lo_u16 v21, v21, s42
  v_mfma_f32_16x16x16_bf16 v[16:19], v[46:47], a[198:199], v[16:19]
  v_pk_mul_lo_u16 v22, v22, s42
  v_pk_mul_lo_u16 v23, v23, s42
  v_pk_sub_u16 v8, v8, v20
  v_pk_sub_u16 v9, v9, v21
  v_pk_sub_u16 v10, v10, v22
  v_pk_sub_u16 v11, v11, v23
  v_bfe_u32 v21, v31, 6, 3
  v_and_b32 v20, 15, v31
  v_mfma_f32_16x16x32_bf16 v[32:35], a[12:15], v[8:11], 0
  v_lshlrev_b32 v21, 10, v21
  v_lshl_add_u32 v21, v20, 6, v21
  v_mfma_f32_16x16x32_bf16 v[36:39], a[28:31], v[8:11], 0
  v_bfe_u32 v20, v31, 4, 2
  v_lshl_add_u32 v21, v20, 2, v21
  v_mfma_f32_16x16x32_bf16 v[40:43], a[44:47], v[8:11], 0
  v_add_u32 v21, s61, v21
  ds_read_b32 v24, v21
  ds_read_b32 v25, v21 offset:16
  ds_read_b32 v26, v21 offset:32
  ds_read_b32 v27, v21 offset:48
  v_mfma_f32_16x16x32_bf16 v[44:47], a[48:51], v[8:11], 0
  s_lshl_b32 s51, s3, 11
  v_add_u32 v20, s51, v2
  s_waitcnt vmcnt(40)
  s_xor_b32 s72, s49, 245760
  buffer_load_dwordx4 a[188:191], v2, s[12:15], s72 offen nt
  s_waitcnt vmcnt(40)
  v_mfma_f32_16x16x32_bf16 v[48:51], a[132:135], v[8:11], 0
  buffer_load_dwordx4 a[192:195], v2, s[12:15], s72 offen offset:1024 nt
  s_waitcnt vmcnt(40)
  v_mfma_f32_16x16x32_bf16 v[52:55], a[148:151], v[8:11], 0
  buffer_load_dwordx4 a[196:199], v2, s[12:15], s72 offen offset:2048 nt
  v_mfma_f32_16x16x32_bf16 v[56:59], a[16:19], v[8:11], 0
  v_mfma_f32_16x16x32_bf16 v[60:63], a[20:23], v[8:11], 0
  s_waitcnt lgkmcnt(0)
  ds_write_b128 v20, v[24:27]
  v_mov_b32_dpp v24, v32 quad_perm:[0,1,2,3] row_mask:0xf bank_mask:0x1
  v_mov_b32_dpp v25, v48 quad_perm:[0,1,2,3] row_mask:0xf bank_mask:0x1
  v_mov_b32_dpp v26, v34 row_ror:8 row_mask:0xf bank_mask:0x1
  v_mov_b32_dpp v27, v50 row_ror:8 row_mask:0xf bank_mask:0x1
  v_mov_b32_dpp v24, v36 row_ror:4 row_mask:0xf bank_mask:0x2
  v_mov_b32_dpp v25, v52 row_ror:4 row_mask:0xf bank_mask:0x2
  v_mov_b32_dpp v26, v38 row_ror:12 row_mask:0xf bank_mask:0x2
  v_mov_b32_dpp v27, v54 row_ror:12 row_mask:0xf bank_mask:0x2
  v_mov_b32_dpp v24, v40 row_ror:8 row_mask:0xf bank_mask:0x4
  v_mov_b32_dpp v25, v56 row_ror:8 row_mask:0xf bank_mask:0x4
  v_mov_b32_dpp v26, v42 quad_perm:[0,1,2,3] row_mask:0xf bank_mask:0x4
  v_mov_b32_dpp v27, v58 quad_perm:[0,1,2,3] row_mask:0xf bank_mask:0x4
  v_mov_b32_dpp v24, v44 row_ror:12 row_mask:0xf bank_mask:0x8
  v_mov_b32_dpp v25, v60 row_ror:12 row_mask:0xf bank_mask:0x8
  v_mov_b32_dpp v26, v46 row_ror:4 row_mask:0xf bank_mask:0x8
  v_mov_b32_dpp v27, v62 row_ror:4 row_mask:0xf bank_mask:0x8
  v_add_f32_dpp v24, v33, v24 row_ror:12 row_mask:0xf bank_mask:0x1
  v_add_f32_dpp v25, v49, v25 row_ror:12 row_mask:0xf bank_mask:0x1
  v_add_f32_dpp v26, v35, v26 row_ror:4 row_mask:0xf bank_mask:0x1
  v_add_f32_dpp v27, v51, v27 row_ror:4 row_mask:0xf bank_mask:0x1
  v_add_f32_dpp v24, v37, v24 quad_perm:[0,1,2,3] row_mask:0xf bank_mask:0x2
  v_add_f32_dpp v25, v53, v25 quad_perm:[0,1,2,3] row_mask:0xf bank_mask:0x2
  v_add_f32_dpp v26, v39, v26 row_ror:8 row_mask:0xf bank_mask:0x2
  v_add_f32_dpp v27, v55, v27 row_ror:8 row_mask:0xf bank_mask:0x2
  v_add_f32_dpp v24, v41, v24 row_ror:4 row_mask:0xf bank_mask:0x4
  v_add_f32_dpp v25, v57, v25 row_ror:4 row_mask:0xf bank_mask:0x4
  v_add_f32_dpp v26, v43, v26 row_ror:12 row_mask:0xf bank_mask:0x4
  v_add_f32_dpp v27, v59, v27 row_ror:12 row_mask:0xf bank_mask:0x4
  v_add_f32_dpp v24, v45, v24 row_ror:8 row_mask:0xf bank_mask:0x8
  v_add_f32_dpp v25, v61, v25 row_ror:8 row_mask:0xf bank_mask:0x8
  v_add_f32_dpp v26, v47, v26 quad_perm:[0,1,2,3] row_mask:0xf bank_mask:0x8
  v_add_f32_dpp v27, v63, v27 quad_perm:[0,1,2,3] row_mask:0xf bank_mask:0x8
  v_add_f32 v24, v24, v26
  v_add_f32 v25, v25, v27
  v_cvt_pk_bf16_f32 v32, v24, v25
  v_lshlrev_b32 v24, 16, v32
  v_and_b32 v25, 0xffff0000, v32
  v_pk_mul_f32 v[24:25], v[24:25], s[56:57] op_sel_hi:[1,0]
  v_cvt_pk_bf16_f32 v32, v24, v25
  v_lshlrev_b32 v24, 16, v32
  v_and_b32 v25, 0xffff0000, v32
  v_pk_add_f32 v[26:27], v[24:25], v[4:5] op_sel_hi:[1,0] neg_lo:[0,1] neg_hi:[0,1]
  v_pk_mul_f32 v[26:27], v[26:27], s[56:57] op_sel:[0,1] op_sel_hi:[1,1]
  v_max_f32 v20, v26, v27
  v_cmp_lt_f32 vcc, 0, v20
  s_getpc_b64 s[74:75]
  s_cbranch_vccnz L_remax
  v_exp_f32 v26, v26
  v_exp_f32 v27, v27
  v_cvt_pk_bf16_f32 v20, v26, 0
  v_add_f32 v32, v26, v27
  v_cvt_pk_bf16_f32 v21, v26, 0
  v_cvt_pk_bf16_f32 v23, v27, 0
  v_cvt_pk_bf16_f32 v22, v27, 0
  v_cvt_pk_bf16_f32 v24, 0, v26
  v_cvt_pk_bf16_f32 v25, 0, v27
  v_add_f32 v5, v5, v32
  v_mov_b32_dpp v20, v24 row_ror:4 row_mask:0xf bank_mask:0xa
  v_mov_b32_dpp v21, v24 row_ror:4 row_mask:0xf bank_mask:0x5
  v_mov_b32_dpp v23, v25 row_ror:4 row_mask:0xf bank_mask:0xa
  v_mov_b32_dpp v22, v25 row_ror:4 row_mask:0xf bank_mask:0x5
  v_and_b32_dpp v32, v20, v6 quad_perm:[0,1,2,3] row_mask:0xf bank_mask:0xf
  v_and_b32_dpp v33, v20, v7 row_ror:8 row_mask:0xf bank_mask:0xf
  v_and_b32_dpp v34, v21, v6 row_ror:12 row_mask:0xf bank_mask:0xf
  v_and_b32_dpp v35, v21, v7 row_ror:4 row_mask:0xf bank_mask:0xf
  v_mfma_f32_16x16x16_bf16 v[12:15], v[32:33], a[24:25], v[12:15]
  v_and_b32_dpp v36, v20, v6 row_ror:8 row_mask:0xf bank_mask:0xf
  v_and_b32_dpp v37, v20, v7 quad_perm:[0,1,2,3] row_mask:0xf bank_mask:0xf
  v_mfma_f32_16x16x16_bf16 v[16:19], v[32:33], a[26:27], v[16:19]
  v_and_b32_dpp v38, v21, v6 row_ror:4 row_mask:0xf bank_mask:0xf
  v_and_b32_dpp v39, v21, v7 row_ror:12 row_mask:0xf bank_mask:0xf
  v_mfma_f32_16x16x16_bf16 v[12:15], v[34:35], a[32:33], v[12:15]
  v_and_b32_dpp v40, v23, v6 quad_perm:[0,1,2,3] row_mask:0xf bank_mask:0xf
  v_and_b32_dpp v41, v23, v7 row_ror:8 row_mask:0xf bank_mask:0xf
  v_mfma_f32_16x16x16_bf16 v[16:19], v[34:35], a[34:35], v[16:19]
  v_and_b32_dpp v42, v22, v6 row_ror:12 row_mask:0xf bank_mask:0xf
  v_and_b32_dpp v43, v22, v7 row_ror:4 row_mask:0xf bank_mask:0xf
  v_mfma_f32_16x16x16_bf16 v[12:15], v[36:37], a[36:37], v[12:15]
  v_and_b32_dpp v44, v23, v6 row_ror:8 row_mask:0xf bank_mask:0xf
  v_and_b32_dpp v45, v23, v7 quad_perm:[0,1,2,3] row_mask:0xf bank_mask:0xf
  v_mfma_f32_16x16x16_bf16 v[16:19], v[36:37], a[38:39], v[16:19]
  v_and_b32_dpp v46, v22, v6 row_ror:4 row_mask:0xf bank_mask:0xf
  v_and_b32_dpp v47, v22, v7 row_ror:12 row_mask:0xf bank_mask:0xf
  v_mfma_f32_16x16x16_bf16 v[12:15], v[38:39], a[40:41], v[12:15]
  s_waitcnt vmcnt(40)
  buffer_load_dwordx4 a[12:15], v2, s[12:15], s72 offen offset:3072 nt
  v_mfma_f32_16x16x16_bf16 v[16:19], v[38:39], a[42:43], v[16:19]
  s_waitcnt vmcnt(40)
  v_mfma_f32_16x16x16_bf16 v[12:15], v[40:41], a[72:73], v[12:15]
  v_mfma_f32_16x16x16_bf16 v[16:19], v[40:41], a[74:75], v[16:19]
  v_mfma_f32_16x16x16_bf16 v[12:15], v[42:43], a[76:77], v[12:15]
  v_mfma_f32_16x16x16_bf16 v[16:19], v[42:43], a[78:79], v[16:19]
  v_mfma_f32_16x16x16_bf16 v[12:15], v[44:45], a[84:85], v[12:15]
  v_mfma_f32_16x16x16_bf16 v[16:19], v[44:45], a[86:87], v[16:19]
  v_mfma_f32_16x16x16_bf16 v[12:15], v[46:47], a[88:89], v[12:15]
  v_mfma_f32_16x16x16_bf16 v[16:19], v[46:47], a[90:91], v[16:19]
  s_bitcmp1_b32 s2, 0
  s_cselect_b32 s14, 0, 0x8000000
  s_xor_b32 s72, s49, 1015808
  buffer_load_dwordx4 a[28:31], v2, s[12:15], s72 offen nt
  s_waitcnt vmcnt(40)
  buffer_load_dwordx4 a[44:47], v2, s[12:15], s72 offen offset:1024 nt
  s_bitcmp1_b32 s2, 0
  s_cselect_b32 s51, 0xff800000, 0
  v_mfma_f32_16x16x32_bf16 v[32:35], a[52:55], v[8:11], 0
  s_waitcnt vmcnt(40)
  buffer_load_dwordx4 a[48:51], v2, s[12:15], s72 offen offset:2048 nt
  v_mfma_f32_16x16x32_bf16 v[36:39], a[96:99], v[8:11], 0
  s_waitcnt vmcnt(40)
  buffer_load_dwordx4 a[132:135], v2, s[12:15], s72 offen offset:3072 nt
  v_mfma_f32_16x16x32_bf16 v[40:43], a[100:103], v[8:11], 0
  s_waitcnt vmcnt(40)
  s_xor_b32 s72, s49, 1032192
  v_mfma_f32_16x16x32_bf16 v[44:47], a[124:127], v[8:11], 0
  buffer_load_dwordx4 a[148:151], v2, s[12:15], s72 offen nt
  v_mov_b32_dpp v24, v32 quad_perm:[0,1,2,3] row_mask:0xf bank_mask:0x1
  v_mfma_f32_16x16x32_bf16 v[48:51], a[56:59], v[8:11], 0
  v_mov_b32_dpp v26, v34 row_ror:8 row_mask:0xf bank_mask:0x1
  v_mov_b32_dpp v24, v36 row_ror:4 row_mask:0xf bank_mask:0x2
  v_mfma_f32_16x16x32_bf16 v[52:55], a[60:63], v[8:11], 0
  v_mov_b32_dpp v26, v38 row_ror:12 row_mask:0xf bank_mask:0x2
  v_mov_b32_dpp v24, v40 row_ror:8 row_mask:0xf bank_mask:0x4
  v_mfma_f32_16x16x32_bf16 v[56:59], a[64:67], v[8:11], 0
  v_mov_b32_dpp v26, v42 quad_perm:[0,1,2,3] row_mask:0xf bank_mask:0x4
  v_mov_b32_dpp v24, v44 row_ror:12 row_mask:0xf bank_mask:0x8
  v_mfma_f32_16x16x32_bf16 v[60:63], a[68:71], v[8:11], 0
  v_mov_b32_dpp v25, v48 quad_perm:[0,1,2,3] row_mask:0xf bank_mask:0x1
  v_mov_b32_dpp v27, v50 row_ror:8 row_mask:0xf bank_mask:0x1
  v_mov_b32_dpp v26, v46 row_ror:4 row_mask:0xf bank_mask:0x8
  v_mov_b32_dpp v25, v52 row_ror:4 row_mask:0xf bank_mask:0x2
  v_mov_b32_dpp v27, v54 row_ror:12 row_mask:0xf bank_mask:0x2
  v_add_f32_dpp v24, v33, v24 row_ror:12 row_mask:0xf bank_mask:0x1
  v_mov_b32_dpp v25, v56 row_ror:8 row_mask:0xf bank_mask:0x4
  v_mov_b32_dpp v27, v58 quad_perm:[0,1,2,3] row_mask:0xf bank_mask:0x4
  v_add_f32_dpp v26, v35, v26 row_ror:4 row_mask:0xf bank_mask:0x1
  v_mov_b32_dpp v25, v60 row_ror:12 row_mask:0xf bank_mask:0x8
  v_mov_b32_dpp v27, v62 row_ror:4 row_mask:0xf bank_mask:0x8
  v_add_f32_dpp v24, v37, v24 quad_perm:[0,1,2,3] row_mask:0xf bank_mask:0x2
  v_add_f32_dpp v25, v49, v25 row_ror:12 row_mask:0xf bank_mask:0x1
  v_add_f32_dpp v27, v51, v27 row_ror:4 row_mask:0xf bank_mask:0x1
  v_add_f32_dpp v26, v39, v26 row_ror:8 row_mask:0xf bank_mask:0x2
  v_add_f32_dpp v25, v53, v25 quad_perm:[0,1,2,3] row_mask:0xf bank_mask:0x2
  v_add_f32_dpp v27, v55, v27 row_ror:8 row_mask:0xf bank_mask:0x2
  v_add_f32_dpp v24, v41, v24 row_ror:4 row_mask:0xf bank_mask:0x4
  v_add_f32_dpp v25, v57, v25 row_ror:4 row_mask:0xf bank_mask:0x4
  v_add_f32_dpp v26, v43, v26 row_ror:12 row_mask:0xf bank_mask:0x4
  v_add_f32_dpp v27, v59, v27 row_ror:12 row_mask:0xf bank_mask:0x4
  v_add_f32_dpp v24, v45, v24 row_ror:8 row_mask:0xf bank_mask:0x8
  v_add_f32_dpp v25, v61, v25 row_ror:8 row_mask:0xf bank_mask:0x8
  v_add_f32_dpp v26, v47, v26 quad_perm:[0,1,2,3] row_mask:0xf bank_mask:0x8
  v_add_f32_dpp v27, v63, v27 quad_perm:[0,1,2,3] row_mask:0xf bank_mask:0x8
  v_add_f32 v24, v24, v26
  v_add_f32 v25, v25, v27
  v_cvt_pk_bf16_f32 v32, v24, v25
  v_lshlrev_b32 v24, 16, v32
  v_and_b32 v25, 0xffff0000, v32
  v_pk_mul_f32 v[24:25], v[24:25], s[56:57] op_sel_hi:[1,0]
  v_cvt_pk_bf16_f32 v32, v24, v25
  v_lshlrev_b32 v24, 16, v32
  v_and_b32 v25, 0xffff0000, v32
  v_add_f32 v24, s51, v24
  v_add_f32 v25, s51, v25
  v_pk_add_f32 v[26:27], v[24:25], v[4:5] op_sel_hi:[1,0] neg_lo:[0,1] neg_hi:[0,1]
  v_pk_mul_f32 v[26:27], v[26:27], s[56:57] op_sel:[0,1] op_sel_hi:[1,1]
  v_max_f32 v20, v26, v27
  v_cmp_lt_f32 vcc, 0, v20
  s_getpc_b64 s[74:75]
  s_cbranch_vccnz L_remax
  v_exp_f32 v26, v26
  v_exp_f32 v27, v27
  v_cvt_pk_bf16_f32 v20, v26, 0
  v_add_f32 v32, v26, v27
  v_cvt_pk_bf16_f32 v21, v26, 0
  v_cvt_pk_bf16_f32 v23, v27, 0
  v_cvt_pk_bf16_f32 v22, v27, 0
  v_cvt_pk_bf16_f32 v24, 0, v26
  v_cvt_pk_bf16_f32 v25, 0, v27
  v_add_f32 v5, v5, v32
  v_mov_b32_dpp v20, v24 row_ror:4 row_mask:0xf bank_mask:0xa
  v_mov_b32_dpp v21, v24 row_ror:4 row_mask:0xf bank_mask:0x5
  v_mov_b32_dpp v23, v25 row_ror:4 row_mask:0xf bank_mask:0xa
  v_mov_b32_dpp v22, v25 row_ror:4 row_mask:0xf bank_mask:0x5
  v_and_b32_dpp v32, v20, v6 quad_perm:[0,1,2,3] row_mask:0xf bank_mask:0xf
  v_and_b32_dpp v33, v20, v7 row_ror:8 row_mask:0xf bank_mask:0xf
  v_and_b32_dpp v34, v21, v6 row_ror:12 row_mask:0xf bank_mask:0xf
  v_and_b32_dpp v35, v21, v7 row_ror:4 row_mask:0xf bank_mask:0xf
  v_mfma_f32_16x16x16_bf16 v[12:15], v[32:33], a[92:93], v[12:15]
  v_and_b32_dpp v36, v20, v6 row_ror:8 row_mask:0xf bank_mask:0xf
  v_and_b32_dpp v37, v20, v7 quad_perm:[0,1,2,3] row_mask:0xf bank_mask:0xf
  v_mfma_f32_16x16x16_bf16 v[16:19], v[32:33], a[94:95], v[16:19]
  v_and_b32_dpp v38, v21, v6 row_ror:4 row_mask:0xf bank_mask:0xf
  v_and_b32_dpp v39, v21, v7 row_ror:12 row_mask:0xf bank_mask:0xf
  v_mfma_f32_16x16x16_bf16 v[12:15], v[34:35], a[108:109], v[12:15]
  v_and_b32_dpp v40, v23, v6 quad_perm:[0,1,2,3] row_mask:0xf bank_mask:0xf
  v_and_b32_dpp v41, v23, v7 row_ror:8 row_mask:0xf bank_mask:0xf
  v_mfma_f32_16x16x16_bf16 v[16:19], v[34:35], a[110:111], v[16:19]
  v_and_b32_dpp v42, v22, v6 row_ror:12 row_mask:0xf bank_mask:0xf
  v_and_b32_dpp v43, v22, v7 row_ror:4 row_mask:0xf bank_mask:0xf
  v_mfma_f32_16x16x16_bf16 v[12:15], v[36:37], a[112:113], v[12:15]
  v_and_b32_dpp v44, v23, v6 row_ror:8 row_mask:0xf bank_mask:0xf
  v_and_b32_dpp v45, v23, v7 quad_perm:[0,1,2,3] row_mask:0xf bank_mask:0xf
  v_mfma_f32_16x16x16_bf16 v[16:19], v[36:37], a[114:115], v[16:19]
  v_and_b32_dpp v46, v22, v6 row_ror:4 row_mask:0xf bank_mask:0xf
  v_and_b32_dpp v47, v22, v7 row_ror:12 row_mask:0xf bank_mask:0xf
  v_mfma_f32_16x16x16_bf16 v[12:15], v[38:39], a[116:117], v[12:15]
  s_waitcnt vmcnt(40)
  buffer_load_dwordx4 a[16:19], v2, s[12:15], s72 offen offset:1024 nt
  v_mfma_f32_16x16x16_bf16 v[16:19], v[38:39], a[118:119], v[16:19]
  s_waitcnt vmcnt(38)
  buffer_load_dwordx4 a[20:23], v2, s[12:15], s72 offen offset:2048 nt
  v_mfma_f32_16x16x16_bf16 v[12:15], v[40:41], a[184:185], v[12:15]
  buffer_load_dwordx4 a[24:27], v2, s[12:15], s72 offen offset:3072 nt
  s_waitcnt vmcnt(36)
  v_mfma_f32_16x16x16_bf16 v[16:19], v[40:41], a[186:187], v[16:19]
  v_mfma_f32_16x16x16_bf16 v[12:15], v[42:43], a[204:205], v[12:15]
  v_mfma_f32_16x16x16_bf16 v[16:19], v[42:43], a[206:207], v[16:19]
  v_mfma_f32_16x16x16_bf16 v[12:15], v[44:45], a[208:209], v[12:15]
  v_mfma_f32_16x16x16_bf16 v[16:19], v[44:45], a[210:211], v[16:19]
  v_mfma_f32_16x16x16_bf16 v[12:15], v[46:47], a[212:213], v[12:15]
  s_waitcnt vmcnt(28)
  v_mfma_f32_16x16x16_bf16 v[16:19], v[46:47], a[214:215], v[16:19]
  v_mfma_f32_16x16x32_bf16 v[32:35], a[136:139], v[8:11], 0
  v_mfma_f32_16x16x32_bf16 v[36:39], a[140:143], v[8:11], 0
  v_mfma_f32_16x16x32_bf16 v[40:43], a[144:147], v[8:11], 0
  v_mfma_f32_16x16x32_bf16 v[44:47], a[152:155], v[8:11], 0
  v_mfma_f32_16x16x32_bf16 v[48:51], a[156:159], v[8:11], 0
  v_mfma_f32_16x16x32_bf16 v[52:55], a[160:163], v[8:11], 0
  s_waitcnt vmcnt(24)
  v_mfma_f32_16x16x32_bf16 v[56:59], a[176:179], v[8:11], 0
  s_nop 0
  v_mov_b32_dpp v24, v32 quad_perm:[0,1,2,3] row_mask:0xf bank_mask:0x1
  v_mfma_f32_16x16x32_bf16 v[60:63], a[180:183], v[8:11], 0
  v_mov_b32_dpp v26, v34 row_ror:8 row_mask:0xf bank_mask:0x1
  v_mov_b32_dpp v24, v36 row_ror:4 row_mask:0xf bank_mask:0x2
  v_mov_b32_dpp v25, v48 quad_perm:[0,1,2,3] row_mask:0xf bank_mask:0x1
  v_mov_b32_dpp v27, v50 row_ror:8 row_mask:0xf bank_mask:0x1
  v_mov_b32_dpp v26, v38 row_ror:12 row_mask:0xf bank_mask:0x2
  v_mov_b32_dpp v25, v52 row_ror:4 row_mask:0xf bank_mask:0x2
  v_mov_b32_dpp v27, v54 row_ror:12 row_mask:0xf bank_mask:0x2
  v_mov_b32_dpp v24, v40 row_ror:8 row_mask:0xf bank_mask:0x4
  v_mov_b32_dpp v25, v56 row_ror:8 row_mask:0xf bank_mask:0x4
  v_mov_b32_dpp v26, v42 quad_perm:[0,1,2,3] row_mask:0xf bank_mask:0x4
  v_mov_b32_dpp v27, v58 quad_perm:[0,1,2,3] row_mask:0xf bank_mask:0x4
  v_mov_b32_dpp v24, v44 row_ror:12 row_mask:0xf bank_mask:0x8
  v_mov_b32_dpp v25, v60 row_ror:12 row_mask:0xf bank_mask:0x8
  v_mov_b32_dpp v26, v46 row_ror:4 row_mask:0xf bank_mask:0x8
  v_mov_b32_dpp v27, v62 row_ror:4 row_mask:0xf bank_mask:0x8
  v_add_f32_dpp v24, v33, v24 row_ror:12 row_mask:0xf bank_mask:0x1
  v_add_f32_dpp v25, v49, v25 row_ror:12 row_mask:0xf bank_mask:0x1
  v_add_f32_dpp v26, v35, v26 row_ror:4 row_mask:0xf bank_mask:0x1
  v_add_f32_dpp v27, v51, v27 row_ror:4 row_mask:0xf bank_mask:0x1
  v_add_f32_dpp v24, v37, v24 quad_perm:[0,1,2,3] row_mask:0xf bank_mask:0x2
  v_add_f32_dpp v25, v53, v25 quad_perm:[0,1,2,3] row_mask:0xf bank_mask:0x2
  v_add_f32_dpp v26, v39, v26 row_ror:8 row_mask:0xf bank_mask:0x2
  v_add_f32_dpp v27, v55, v27 row_ror:8 row_mask:0xf bank_mask:0x2
  v_add_f32_dpp v24, v41, v24 row_ror:4 row_mask:0xf bank_mask:0x4
  v_add_f32_dpp v25, v57, v25 row_ror:4 row_mask:0xf bank_mask:0x4
  v_add_f32_dpp v26, v43, v26 row_ror:12 row_mask:0xf bank_mask:0x4
  v_add_f32_dpp v27, v59, v27 row_ror:12 row_mask:0xf bank_mask:0x4
  v_add_f32_dpp v24, v45, v24 row_ror:8 row_mask:0xf bank_mask:0x8
  v_add_f32_dpp v25, v61, v25 row_ror:8 row_mask:0xf bank_mask:0x8
  v_add_f32_dpp v26, v47, v26 quad_perm:[0,1,2,3] row_mask:0xf bank_mask:0x8
  v_add_f32_dpp v27, v63, v27 quad_perm:[0,1,2,3] row_mask:0xf bank_mask:0x8
  v_add_f32 v24, v24, v26
  v_add_f32 v25, v25, v27
  v_cvt_pk_bf16_f32 v32, v24, v25
  v_lshlrev_b32 v24, 16, v32
  v_and_b32 v25, 0xffff0000, v32
  v_pk_mul_f32 v[24:25], v[24:25], s[56:57] op_sel_hi:[1,0]
  v_cvt_pk_bf16_f32 v32, v24, v25
  v_lshlrev_b32 v24, 16, v32
  v_and_b32 v25, 0xffff0000, v32
  v_pk_add_f32 v[26:27], v[24:25], v[4:5] op_sel_hi:[1,0] neg_lo:[0,1] neg_hi:[0,1]
  v_pk_mul_f32 v[26:27], v[26:27], s[56:57] op_sel:[0,1] op_sel_hi:[1,1]
  v_max_f32 v20, v26, v27
  v_cmp_lt_f32 vcc, 0, v20
  s_getpc_b64 s[74:75]
  s_cbranch_vccnz L_remax
  v_exp_f32 v26, v26
  v_exp_f32 v27, v27
  v_cvt_pk_bf16_f32 v20, v26, 0
  v_add_f32 v32, v26, v27
  v_cvt_pk_bf16_f32 v21, v26, 0
  v_cvt_pk_bf16_f32 v23, v27, 0
  v_cvt_pk_bf16_f32 v22, v27, 0
  v_cvt_pk_bf16_f32 v24, 0, v26
  v_cvt_pk_bf16_f32 v25, 0, v27
  v_add_f32 v5, v5, v32
  v_mov_b32_dpp v20, v24 row_ror:4 row_mask:0xf bank_mask:0xa
  v_mov_b32_dpp v21, v24 row_ror:4 row_mask:0xf bank_mask:0x5
  v_mov_b32_dpp v23, v25 row_ror:4 row_mask:0xf bank_mask:0xa
  v_mov_b32_dpp v22, v25 row_ror:4 row_mask:0xf bank_mask:0x5
  v_and_b32_dpp v32, v20, v6 quad_perm:[0,1,2,3] row_mask:0xf bank_mask:0xf
  v_and_b32_dpp v33, v20, v7 row_ror:8 row_mask:0xf bank_mask:0xf
  v_and_b32_dpp v34, v21, v6 row_ror:12 row_mask:0xf bank_mask:0xf
  v_and_b32_dpp v35, v21, v7 row_ror:4 row_mask:0xf bank_mask:0xf
  v_mfma_f32_16x16x16_bf16 v[12:15], v[32:33], a[220:221], v[12:15]
  v_and_b32_dpp v36, v20, v6 row_ror:8 row_mask:0xf bank_mask:0xf
  v_and_b32_dpp v37, v20, v7 quad_perm:[0,1,2,3] row_mask:0xf bank_mask:0xf
  v_mfma_f32_16x16x16_bf16 v[16:19], v[32:33], a[222:223], v[16:19]
  v_and_b32_dpp v38, v21, v6 row_ror:4 row_mask:0xf bank_mask:0xf
  v_and_b32_dpp v39, v21, v7 row_ror:12 row_mask:0xf bank_mask:0xf
  v_mfma_f32_16x16x16_bf16 v[12:15], v[34:35], a[224:225], v[12:15]
  v_and_b32_dpp v40, v23, v6 quad_perm:[0,1,2,3] row_mask:0xf bank_mask:0xf
  v_and_b32_dpp v41, v23, v7 row_ror:8 row_mask:0xf bank_mask:0xf
  v_mfma_f32_16x16x16_bf16 v[16:19], v[34:35], a[226:227], v[16:19]
  v_and_b32_dpp v42, v22, v6 row_ror:12 row_mask:0xf bank_mask:0xf
  v_and_b32_dpp v43, v22, v7 row_ror:4 row_mask:0xf bank_mask:0xf
  v_mfma_f32_16x16x16_bf16 v[12:15], v[36:37], a[228:229], v[12:15]
  v_and_b32_dpp v44, v23, v6 row_ror:8 row_mask:0xf bank_mask:0xf
  v_and_b32_dpp v45, v23, v7 quad_perm:[0,1,2,3] row_mask:0xf bank_mask:0xf
  v_mfma_f32_16x16x16_bf16 v[16:19], v[36:37], a[230:231], v[16:19]
  v_and_b32_dpp v46, v22, v6 row_ror:4 row_mask:0xf bank_mask:0xf
  v_and_b32_dpp v47, v22, v7 row_ror:12 row_mask:0xf bank_mask:0xf
  v_mfma_f32_16x16x16_bf16 v[12:15], v[38:39], a[244:245], v[12:15]
  s_waitcnt vmcnt(16)
  s_waitcnt vmcnt(12)
  v_mfma_f32_16x16x16_bf16 v[16:19], v[38:39], a[246:247], v[16:19]
  v_mfma_f32_16x16x16_bf16 v[12:15], v[40:41], a[0:1], v[12:15]
  v_mfma_f32_16x16x16_bf16 v[16:19], v[40:41], a[2:3], v[16:19]
  v_mfma_f32_16x16x16_bf16 v[12:15], v[42:43], a[4:5], v[12:15]
  v_mfma_f32_16x16x16_bf16 v[16:19], v[42:43], a[6:7], v[16:19]
  v_mfma_f32_16x16x16_bf16 v[12:15], v[44:45], a[8:9], v[12:15]
  v_mfma_f32_16x16x16_bf16 v[16:19], v[44:45], a[10:11], v[16:19]
  v_mfma_f32_16x16x16_bf16 v[12:15], v[46:47], v[216:217], v[12:15]
  s_waitcnt vmcnt(8)
  v_mfma_f32_16x16x16_bf16 v[16:19], v[46:47], v[218:219], v[16:19]
  v_mfma_f32_16x16x32_bf16 v[32:35], v[220:223], v[8:11], 0
  v_mfma_f32_16x16x32_bf16 v[36:39], v[224:227], v[8:11], 0
  v_mfma_f32_16x16x32_bf16 v[40:43], v[64:67], v[8:11], 0
  v_mfma_f32_16x16x32_bf16 v[44:47], v[68:71], v[8:11], 0
  v_mfma_f32_16x16x32_bf16 v[48:51], a[128:131], v[8:11], 0
  v_mfma_f32_16x16x32_bf16 v[52:55], a[168:171], v[8:11], 0
  v_mfma_f32_16x16x32_bf16 v[56:59], a[172:175], v[8:11], 0
  v_mfma_f32_16x16x32_bf16 v[60:63], a[200:203], v[8:11], 0
  s_nop 0
  v_mov_b32_dpp v24, v32 quad_perm:[0,1,2,3] row_mask:0xf bank_mask:0x1
  v_mov_b32_dpp v26, v34 row_ror:8 row_mask:0xf bank_mask:0x1
  s_nop 0
  v_mov_b32_dpp v24, v36 row_ror:4 row_mask:0xf bank_mask:0x2
  v_mov_b32_dpp v25, v48 quad_perm:[0,1,2,3] row_mask:0xf bank_mask:0x1
  v_mov_b32_dpp v27, v50 row_ror:8 row_mask:0xf bank_mask:0x1
  v_mov_b32_dpp v26, v38 row_ror:12 row_mask:0xf bank_mask:0x2
  v_mov_b32_dpp v25, v52 row_ror:4 row_mask:0xf bank_mask:0x2
  v_mov_b32_dpp v27, v54 row_ror:12 row_mask:0xf bank_mask:0x2
  v_mov_b32_dpp v24, v40 row_ror:8 row_mask:0xf bank_mask:0x4
  v_mov_b32_dpp v25, v56 row_ror:8 row_mask:0xf bank_mask:0x4
  v_mov_b32_dpp v26, v42 quad_perm:[0,1,2,3] row_mask:0xf bank_mask:0x4
  v_mov_b32_dpp v27, v58 quad_perm:[0,1,2,3] row_mask:0xf bank_mask:0x4
  v_mov_b32_dpp v24, v44 row_ror:12 row_mask:0xf bank_mask:0x8
  v_mov_b32_dpp v25, v60 row_ror:12 row_mask:0xf bank_mask:0x8
  v_mov_b32_dpp v26, v46 row_ror:4 row_mask:0xf bank_mask:0x8
  v_mov_b32_dpp v27, v62 row_ror:4 row_mask:0xf bank_mask:0x8
  v_add_f32_dpp v24, v33, v24 row_ror:12 row_mask:0xf bank_mask:0x1
  v_add_f32_dpp v25, v49, v25 row_ror:12 row_mask:0xf bank_mask:0x1
  v_add_f32_dpp v26, v35, v26 row_ror:4 row_mask:0xf bank_mask:0x1
  v_add_f32_dpp v27, v51, v27 row_ror:4 row_mask:0xf bank_mask:0x1
  v_add_f32_dpp v24, v37, v24 quad_perm:[0,1,2,3] row_mask:0xf bank_mask:0x2
  v_add_f32_dpp v25, v53, v25 quad_perm:[0,1,2,3] row_mask:0xf bank_mask:0x2
  v_add_f32_dpp v26, v39, v26 row_ror:8 row_mask:0xf bank_mask:0x2
  v_add_f32_dpp v27, v55, v27 row_ror:8 row_mask:0xf bank_mask:0x2
  v_add_f32_dpp v24, v41, v24 row_ror:4 row_mask:0xf bank_mask:0x4
  v_add_f32_dpp v25, v57, v25 row_ror:4 row_mask:0xf bank_mask:0x4
  v_add_f32_dpp v26, v43, v26 row_ror:12 row_mask:0xf bank_mask:0x4
  v_add_f32_dpp v27, v59, v27 row_ror:12 row_mask:0xf bank_mask:0x4
  v_add_f32_dpp v24, v45, v24 row_ror:8 row_mask:0xf bank_mask:0x8
  v_add_f32_dpp v25, v61, v25 row_ror:8 row_mask:0xf bank_mask:0x8
  v_add_f32_dpp v26, v47, v26 quad_perm:[0,1,2,3] row_mask:0xf bank_mask:0x8
  v_add_f32_dpp v27, v63, v27 quad_perm:[0,1,2,3] row_mask:0xf bank_mask:0x8
  v_add_f32 v24, v24, v26
  v_add_f32 v25, v25, v27
  v_cvt_pk_bf16_f32 v32, v24, v25
  v_lshlrev_b32 v24, 16, v32
  v_and_b32 v25, 0xffff0000, v32
  v_pk_mul_f32 v[24:25], v[24:25], s[56:57] op_sel_hi:[1,0]
  v_cvt_pk_bf16_f32 v32, v24, v25
  v_lshlrev_b32 v24, 16, v32
  v_and_b32 v25, 0xffff0000, v32
  v_pk_add_f32 v[26:27], v[24:25], v[4:5] op_sel_hi:[1,0] neg_lo:[0,1] neg_hi:[0,1]
  v_pk_mul_f32 v[26:27], v[26:27], s[56:57] op_sel:[0,1] op_sel_hi:[1,1]
  v_max_f32 v20, v26, v27
  v_cmp_lt_f32 vcc, 0, v20
  s_getpc_b64 s[74:75]
  s_cbranch_vccnz L_remax
  v_exp_f32 v26, v26
  v_exp_f32 v27, v27
  v_cvt_pk_bf16_f32 v20, v26, 0
  v_add_f32 v32, v26, v27
  v_cvt_pk_bf16_f32 v21, v26, 0
  v_cvt_pk_bf16_f32 v23, v27, 0
  v_cvt_pk_bf16_f32 v22, v27, 0
  v_cvt_pk_bf16_f32 v24, 0, v26
  v_cvt_pk_bf16_f32 v25, 0, v27
  v_add_f32 v5, v5, v32
  v_mov_b32_dpp v20, v24 row_ror:4 row_mask:0xf bank_mask:0xa
  v_mov_b32_dpp v21, v24 row_ror:4 row_mask:0xf bank_mask:0x5
  v_mov_b32_dpp v23, v25 row_ror:4 row_mask:0xf bank_mask:0xa
  v_mov_b32_dpp v22, v25 row_ror:4 row_mask:0xf bank_mask:0x5
  v_and_b32_dpp v32, v20, v6 quad_perm:[0,1,2,3] row_mask:0xf bank_mask:0xf
  v_and_b32_dpp v33, v20, v7 row_ror:8 row_mask:0xf bank_mask:0xf
  v_and_b32_dpp v34, v21, v6 row_ror:12 row_mask:0xf bank_mask:0xf
  v_and_b32_dpp v35, v21, v7 row_ror:4 row_mask:0xf bank_mask:0xf
  v_mfma_f32_16x16x16_bf16 v[12:15], v[32:33], a[216:217], v[12:15]
  v_and_b32_dpp v36, v20, v6 row_ror:8 row_mask:0xf bank_mask:0xf
  v_and_b32_dpp v37, v20, v7 quad_perm:[0,1,2,3] row_mask:0xf bank_mask:0xf
  v_mfma_f32_16x16x16_bf16 v[16:19], v[32:33], a[218:219], v[16:19]
  v_and_b32_dpp v38, v21, v6 row_ror:4 row_mask:0xf bank_mask:0xf
  v_and_b32_dpp v39, v21, v7 row_ror:12 row_mask:0xf bank_mask:0xf
  v_mfma_f32_16x16x16_bf16 v[12:15], v[34:35], a[232:233], v[12:15]
  v_and_b32_dpp v40, v23, v6 quad_perm:[0,1,2,3] row_mask:0xf bank_mask:0xf
  v_and_b32_dpp v41, v23, v7 row_ror:8 row_mask:0xf bank_mask:0xf
  v_mfma_f32_16x16x16_bf16 v[16:19], v[34:35], a[234:235], v[16:19]
  v_and_b32_dpp v42, v22, v6 row_ror:12 row_mask:0xf bank_mask:0xf
  v_and_b32_dpp v43, v22, v7 row_ror:4 row_mask:0xf bank_mask:0xf
  v_mfma_f32_16x16x16_bf16 v[12:15], v[36:37], v[92:93], v[12:15]
  v_and_b32_dpp v44, v23, v6 row_ror:8 row_mask:0xf bank_mask:0xf
  v_and_b32_dpp v45, v23, v7 quad_perm:[0,1,2,3] row_mask:0xf bank_mask:0xf
  v_mfma_f32_16x16x16_bf16 v[16:19], v[36:37], v[94:95], v[16:19]
  v_and_b32_dpp v46, v22, v6 row_ror:4 row_mask:0xf bank_mask:0xf
  v_and_b32_dpp v47, v22, v7 row_ror:12 row_mask:0xf bank_mask:0xf
  v_mfma_f32_16x16x16_bf16 v[12:15], v[38:39], a[164:165], v[12:15]
  v_mfma_f32_16x16x16_bf16 v[16:19], v[38:39], a[166:167], v[16:19]
  v_mfma_f32_16x16x16_bf16 v[12:15], v[40:41], a[188:189], v[12:15]
  v_mfma_f32_16x16x16_bf16 v[16:19], v[40:41], a[190:191], v[16:19]
  v_mfma_f32_16x16x16_bf16 v[12:15], v[42:43], a[192:193], v[12:15]
  v_mfma_f32_16x16x16_bf16 v[16:19], v[42:43], a[194:195], v[16:19]
  v_mfma_f32_16x16x16_bf16 v[12:15], v[44:45], a[196:197], v[12:15]
  v_mfma_f32_16x16x16_bf16 v[16:19], v[44:45], a[198:199], v[16:19]
  v_mfma_f32_16x16x16_bf16 v[12:15], v[46:47], a[12:13], v[12:15]
  v_mfma_f32_16x16x16_bf16 v[16:19], v[46:47], a[14:15], v[16:19]
  s_bitcmp1_b32 s2, 0
  s_cselect_b32 s51, 0xff800000, 0
  v_mfma_f32_16x16x32_bf16 v[32:35], a[248:251], v[8:11], 0
  s_waitcnt vmcnt(4)
  s_waitcnt vmcnt(0)
  v_mfma_f32_16x16x32_bf16 v[36:39], a[252:255], v[8:11], 0
  v_mfma_f32_16x16x32_bf16 v[40:43], a[236:239], v[8:11], 0
  v_mfma_f32_16x16x32_bf16 v[44:47], a[240:243], v[8:11], 0
  v_mfma_f32_16x16x32_bf16 v[48:51], a[80:83], v[8:11], 0
  v_mfma_f32_16x16x32_bf16 v[52:55], v[72:75], v[8:11], 0
  s_nop 0
  v_mov_b32_dpp v24, v32 quad_perm:[0,1,2,3] row_mask:0xf bank_mask:0x1
  v_mfma_f32_16x16x32_bf16 v[56:59], a[104:107], v[8:11], 0
  v_mov_b32_dpp v26, v34 row_ror:8 row_mask:0xf bank_mask:0x1
  v_mov_b32_dpp v24, v36 row_ror:4 row_mask:0xf bank_mask:0x2
  v_mfma_f32_16x16x32_bf16 v[60:63], a[120:123], v[8:11], 0
  v_mov_b32_dpp v26, v38 row_ror:12 row_mask:0xf bank_mask:0x2
  v_mov_b32_dpp v25, v48 quad_perm:[0,1,2,3] row_mask:0xf bank_mask:0x1
  v_mov_b32_dpp v27, v50 row_ror:8 row_mask:0xf bank_mask:0x1
  v_mov_b32_dpp v24, v40 row_ror:8 row_mask:0xf bank_mask:0x4
  v_mov_b32_dpp v25, v52 row_ror:4 row_mask:0xf bank_mask:0x2
  v_mov_b32_dpp v27, v54 row_ror:12 row_mask:0xf bank_mask:0x2
  v_mov_b32_dpp v26, v42 quad_perm:[0,1,2,3] row_mask:0xf bank_mask:0x4
  v_mov_b32_dpp v25, v56 row_ror:8 row_mask:0xf bank_mask:0x4
  v_mov_b32_dpp v27, v58 quad_perm:[0,1,2,3] row_mask:0xf bank_mask:0x4
  v_mov_b32_dpp v24, v44 row_ror:12 row_mask:0xf bank_mask:0x8
  v_mov_b32_dpp v25, v60 row_ror:12 row_mask:0xf bank_mask:0x8
  v_mov_b32_dpp v26, v46 row_ror:4 row_mask:0xf bank_mask:0x8
  v_mov_b32_dpp v27, v62 row_ror:4 row_mask:0xf bank_mask:0x8
  v_add_f32_dpp v24, v33, v24 row_ror:12 row_mask:0xf bank_mask:0x1
  v_add_f32_dpp v25, v49, v25 row_ror:12 row_mask:0xf bank_mask:0x1
  v_add_f32_dpp v26, v35, v26 row_ror:4 row_mask:0xf bank_mask:0x1
  v_add_f32_dpp v27, v51, v27 row_ror:4 row_mask:0xf bank_mask:0x1
  v_add_f32_dpp v24, v37, v24 quad_perm:[0,1,2,3] row_mask:0xf bank_mask:0x2
  v_add_f32_dpp v25, v53, v25 quad_perm:[0,1,2,3] row_mask:0xf bank_mask:0x2
  v_add_f32_dpp v26, v39, v26 row_ror:8 row_mask:0xf bank_mask:0x2
  v_add_f32_dpp v27, v55, v27 row_ror:8 row_mask:0xf bank_mask:0x2
  v_add_f32_dpp v24, v41, v24 row_ror:4 row_mask:0xf bank_mask:0x4
  v_add_f32_dpp v25, v57, v25 row_ror:4 row_mask:0xf bank_mask:0x4
  v_add_f32_dpp v26, v43, v26 row_ror:12 row_mask:0xf bank_mask:0x4
  v_add_f32_dpp v27, v59, v27 row_ror:12 row_mask:0xf bank_mask:0x4
  v_add_f32_dpp v24, v45, v24 row_ror:8 row_mask:0xf bank_mask:0x8
  v_add_f32_dpp v25, v61, v25 row_ror:8 row_mask:0xf bank_mask:0x8
  v_add_f32_dpp v26, v47, v26 quad_perm:[0,1,2,3] row_mask:0xf bank_mask:0x8
  v_add_f32_dpp v27, v63, v27 quad_perm:[0,1,2,3] row_mask:0xf bank_mask:0x8
  v_add_f32 v24, v24, v26
  v_add_f32 v25, v25, v27
  v_cvt_pk_bf16_f32 v32, v24, v25
  v_lshlrev_b32 v24, 16, v32
  v_and_b32 v25, 0xffff0000, v32
  v_pk_mul_f32 v[24:25], v[24:25], s[56:57] op_sel_hi:[1,0]
  v_cvt_pk_bf16_f32 v32, v24, v25
  v_lshlrev_b32 v24, 16, v32
  v_and_b32 v25, 0xffff0000, v32
  v_add_f32 v24, s51, v24
  v_add_f32 v25, s51, v25
  v_pk_add_f32 v[26:27], v[24:25], v[4:5] op_sel_hi:[1,0] neg_lo:[0,1] neg_hi:[0,1]
  v_pk_mul_f32 v[26:27], v[26:27], s[56:57] op_sel:[0,1] op_sel_hi:[1,1]
  v_max_f32 v20, v26, v27
  v_cmp_lt_f32 vcc, 0, v20
  s_getpc_b64 s[74:75]
  s_cbranch_vccnz L_remax
  v_exp_f32 v26, v26
  v_exp_f32 v27, v27
  v_cvt_pk_bf16_f32 v20, v26, 0
  v_add_f32 v32, v26, v27
  v_cvt_pk_bf16_f32 v21, v26, 0
  v_cvt_pk_bf16_f32 v23, v27, 0
  v_cvt_pk_bf16_f32 v22, v27, 0
  v_cvt_pk_bf16_f32 v24, 0, v26
  v_cvt_pk_bf16_f32 v25, 0, v27
  v_add_f32 v5, v5, v32
  v_mov_b32_dpp v20, v24 row_ror:4 row_mask:0xf bank_mask:0xa
  v_mov_b32_dpp v21, v24 row_ror:4 row_mask:0xf bank_mask:0x5
  v_mov_b32_dpp v23, v25 row_ror:4 row_mask:0xf bank_mask:0xa
  v_mov_b32_dpp v22, v25 row_ror:4 row_mask:0xf bank_mask:0x5
  v_and_b32_dpp v32, v20, v6 quad_perm:[0,1,2,3] row_mask:0xf bank_mask:0xf
  v_and_b32_dpp v33, v20, v7 row_ror:8 row_mask:0xf bank_mask:0xf
  v_and_b32_dpp v34, v21, v6 row_ror:12 row_mask:0xf bank_mask:0xf
  v_and_b32_dpp v35, v21, v7 row_ror:4 row_mask:0xf bank_mask:0xf
  v_mfma_f32_16x16x16_bf16 v[12:15], v[32:33], a[28:29], v[12:15]
  v_and_b32_dpp v36, v20, v6 row_ror:8 row_mask:0xf bank_mask:0xf
  v_and_b32_dpp v37, v20, v7 quad_perm:[0,1,2,3] row_mask:0xf bank_mask:0xf
  v_mfma_f32_16x16x16_bf16 v[16:19], v[32:33], a[30:31], v[16:19]
  v_and_b32_dpp v38, v21, v6 row_ror:4 row_mask:0xf bank_mask:0xf
  v_and_b32_dpp v39, v21, v7 row_ror:12 row_mask:0xf bank_mask:0xf
  v_mfma_f32_16x16x16_bf16 v[12:15], v[34:35], a[44:45], v[12:15]
  v_and_b32_dpp v40, v23, v6 quad_perm:[0,1,2,3] row_mask:0xf bank_mask:0xf
  v_and_b32_dpp v41, v23, v7 row_ror:8 row_mask:0xf bank_mask:0xf
  v_mfma_f32_16x16x16_bf16 v[16:19], v[34:35], a[46:47], v[16:19]
  v_and_b32_dpp v42, v22, v6 row_ror:12 row_mask:0xf bank_mask:0xf
  v_and_b32_dpp v43, v22, v7 row_ror:4 row_mask:0xf bank_mask:0xf
  v_mfma_f32_16x16x16_bf16 v[12:15], v[36:37], a[48:49], v[12:15]
  v_and_b32_dpp v44, v23, v6 row_ror:8 row_mask:0xf bank_mask:0xf
  v_and_b32_dpp v45, v23, v7 quad_perm:[0,1,2,3] row_mask:0xf bank_mask:0xf
  v_mfma_f32_16x16x16_bf16 v[16:19], v[36:37], a[50:51], v[16:19]
  v_and_b32_dpp v46, v22, v6 row_ror:4 row_mask:0xf bank_mask:0xf
  v_and_b32_dpp v47, v22, v7 row_ror:12 row_mask:0xf bank_mask:0xf
  v_mfma_f32_16x16x16_bf16 v[12:15], v[38:39], a[132:133], v[12:15]
  v_mfma_f32_16x16x16_bf16 v[16:19], v[38:39], a[134:135], v[16:19]
  v_mfma_f32_16x16x16_bf16 v[12:15], v[40:41], a[148:149], v[12:15]
  v_mfma_f32_16x16x16_bf16 v[16:19], v[40:41], a[150:151], v[16:19]
  v_mfma_f32_16x16x16_bf16 v[12:15], v[42:43], a[16:17], v[12:15]
  v_mfma_f32_16x16x16_bf16 v[16:19], v[42:43], a[18:19], v[16:19]
  v_mfma_f32_16x16x16_bf16 v[12:15], v[44:45], a[20:21], v[12:15]
  v_mfma_f32_16x16x16_bf16 v[16:19], v[44:45], a[22:23], v[16:19]
  v_mfma_f32_16x16x16_bf16 v[12:15], v[46:47], a[24:25], v[12:15]
  v_mfma_f32_16x16x16_bf16 v[16:19], v[46:47], a[26:27], v[16:19]
  s_nop 9
L_vdel:
  s_lshl_b32 s69, s3, 11
  v_add_u32 v36, s69, v2
  ds_read_b128 v[32:35], v36
  s_sub_u32 s51, 64, s40
  s_bfm_b64 s[86:87], s40, s51
  v_bfe_u32 v36, v31, 9, 7
  v_lshlrev_b32 v36, 2, v36
  v_add_u32 v36, s69, v36
  v_and_b32 v37, 0xffff0000, v31
  s_waitcnt lgkmcnt(0)
  v_subrev_f32_dpp v32, v4, v32 quad_perm:[0,0,0,0] row_mask:0xf bank_mask:0xf
  v_subrev_f32_dpp v33, v4, v33 quad_perm:[1,1,1,1] row_mask:0xf bank_mask:0xf
  v_subrev_f32_dpp v34, v4, v34 quad_perm:[2,2,2,2] row_mask:0xf bank_mask:0xf
  v_subrev_f32_dpp v35, v4, v35 quad_perm:[3,3,3,3] row_mask:0xf bank_mask:0xf
  v_mul_f32 v32, s57, v32
  v_mul_f32 v33, s57, v33
  v_mul_f32 v34, s57, v34
  v_mul_f32 v35, s57, v35
  v_exp_f32 v32, v32
  v_exp_f32 v33, v33
  v_exp_f32 v34, v34
  v_exp_f32 v35, v35
  v_cvt_pk_bf16_f32 v32, 0, v32
  v_cvt_pk_bf16_f32 v33, 0, v33
  v_cvt_pk_bf16_f32 v34, 0, v34
  v_cvt_pk_bf16_f32 v35, 0, v35
  v_mul_f32 v32, v32, v37
  v_mul_f32 v33, v33, v37
  v_mul_f32 v34, v34, v37
  v_mul_f32 v35, v35, v37
  s_branch L_passend
L_remax:
  v_max3_f32 v20, v24, v25, v4
  s_add_u32 s74, s74, 4
  s_addc_u32 s75, s75, 0
  s_nop 0
  v_max_f32_dpp v20, v20, v20 row_ror:4 row_mask:0xf bank_mask:0xf
  s_nop 1
  v_max_f32_dpp v20, v20, v20 row_ror:8 row_mask:0xf bank_mask:0xf
  v_mov_b32 v21, v20
  s_nop 1
  v_permlane32_swap_b32 v20, v21
  v_max_f32 v20, v20, v21
  v_mov_b32 v21, v20
  s_nop 1
  v_permlane16_swap_b32 v20, v21
  v_max_f32 v20, v20, v21
  v_cmp_gt_f32 vcc, v20, v4
  v_add_f32 v21, 0x40ddce9e, v20
  s_nop 0
  v_cndmask_b32 v20, v4, v21, vcc
  v_sub_f32 v22, v4, v20
  v_mul_f32 v22, s57, v22
  v_exp_f32 v22, v22
  v_mov_b32 v4, v20
  v_pk_add_f32 v[26:27], v[24:25], v[4:5] op_sel_hi:[1,0] neg_lo:[0,1] neg_hi:[0,1]
  v_pk_mul_f32 v[26:27], v[26:27], s[56:57] op_sel:[0,1] op_sel_hi:[1,1]
  v_mul_f32 v5, v5, v22
  v_mul_f32_dpp v12, v22, v12 quad_perm:[0,0,0,0] row_mask:0xf bank_mask:0xf
  v_mul_f32_dpp v13, v22, v13 quad_perm:[1,1,1,1] row_mask:0xf bank_mask:0xf
  v_mul_f32_dpp v14, v22, v14 quad_perm:[2,2,2,2] row_mask:0xf bank_mask:0xf
  v_mul_f32_dpp v15, v22, v15 quad_perm:[3,3,3,3] row_mask:0xf bank_mask:0xf
  v_mul_f32_dpp v16, v22, v16 quad_perm:[0,0,0,0] row_mask:0xf bank_mask:0xf
  v_mul_f32_dpp v17, v22, v17 quad_perm:[1,1,1,1] row_mask:0xf bank_mask:0xf
  v_mul_f32_dpp v18, v22, v18 quad_perm:[2,2,2,2] row_mask:0xf bank_mask:0xf
  v_mul_f32_dpp v19, v22, v19 quad_perm:[3,3,3,3] row_mask:0xf bank_mask:0xf
  s_nop 1
  s_setpc_b64 s[74:75]
  s_nop 9
L_pgen1:
  s_mov_b32 s5, 1
  s_waitcnt vmcnt(0)
  s_nop 9
L_pgen:
  s_mov_b32 s10, 0x8000000
  s_mov_b32 s14, 0x8000000
  s_mov_b32 s73, 0
  s_nop 9
L_pgl:
  s_min_u32 s51, s73, 15
  s_lshl_b32 s51, s51, 15
  s_lshr_b32 s52, s73, 4
  s_lshl_b32 s52, s52, 19
  s_or_b32 s51, s51, s52
  s_xor_b32 s51, s49, s51
  s_xor_b32 s72, s51, 0
  buffer_load_dwordx4 a[0:3], v1, s[8:11], s72 offen nt
  buffer_load_dwordx4 a[4:7], v1, s[8:11], s72 offen offset:1024 nt
  buffer_load_dwordx4 a[8:11], v1, s[8:11], s72 offen offset:2048 nt
  buffer_load_dwordx4 a[12:15], v1, s[8:11], s72 offen offset:3072 nt
  s_xor_b32 s72, s51, 16384
  buffer_load_dwordx4 a[16:19], v1, s[8:11], s72 offen nt
  buffer_load_dwordx4 a[20:23], v1, s[8:11], s72 offen offset:1024 nt
  buffer_load_dwordx4 a[24:27], v1, s[8:11], s72 offen offset:2048 nt
  buffer_load_dwordx4 a[28:31], v1, s[8:11], s72 offen offset:3072 nt
  s_xor_b32 s72, s51, 0
  buffer_load_dwordx4 a[32:35], v2, s[12:15], s72 offen nt
  buffer_load_dwordx4 a[36:39], v2, s[12:15], s72 offen offset:1024 nt
  buffer_load_dwordx4 a[40:43], v2, s[12:15], s72 offen offset:2048 nt
  buffer_load_dwordx4 a[44:47], v2, s[12:15], s72 offen offset:3072 nt
  s_xor_b32 s72, s51, 16384
  buffer_load_dwordx4 a[48:51], v2, s[12:15], s72 offen nt
  buffer_load_dwordx4 a[52:55], v2, s[12:15], s72 offen offset:1024 nt
  buffer_load_dwordx4 a[56:59], v2, s[12:15], s72 offen offset:2048 nt
  buffer_load_dwordx4 a[60:63], v2, s[12:15], s72 offen offset:3072 nt
  s_waitcnt vmcnt(0)
  v_mfma_f32_16x16x32_bf16 v[32:35], a[0:3], v[8:11], 0
  v_mfma_f32_16x16x32_bf16 v[36:39], a[4:7], v[8:11], 0
  v_mfma_f32_16x16x32_bf16 v[40:43], a[8:11], v[8:11], 0
  v_mfma_f32_16x16x32_bf16 v[44:47], a[12:15], v[8:11], 0
  v_mfma_f32_16x16x32_bf16 v[48:51], a[16:19], v[8:11], 0
  v_mfma_f32_16x16x32_bf16 v[52:55], a[20:23], v[8:11], 0
  v_mfma_f32_16x16x32_bf16 v[56:59], a[24:27], v[8:11], 0
  v_mfma_f32_16x16x32_bf16 v[60:63], a[28:31], v[8:11], 0
  s_nop 0
  v_mov_b32_dpp v24, v32 quad_perm:[0,1,2,3] row_mask:0xf bank_mask:0x1
  s_nop 2
  v_mov_b32_dpp v25, v48 quad_perm:[0,1,2,3] row_mask:0xf bank_mask:0x1
  v_mov_b32_dpp v26, v34 row_ror:8 row_mask:0xf bank_mask:0x1
  v_mov_b32_dpp v27, v50 row_ror:8 row_mask:0xf bank_mask:0x1
  v_mov_b32_dpp v24, v36 row_ror:4 row_mask:0xf bank_mask:0x2
  v_mov_b32_dpp v25, v52 row_ror:4 row_mask:0xf bank_mask:0x2
  v_mov_b32_dpp v26, v38 row_ror:12 row_mask:0xf bank_mask:0x2
  v_mov_b32_dpp v27, v54 row_ror:12 row_mask:0xf bank_mask:0x2
  v_mov_b32_dpp v24, v40 row_ror:8 row_mask:0xf bank_mask:0x4
  v_mov_b32_dpp v25, v56 row_ror:8 row_mask:0xf bank_mask:0x4
  v_mov_b32_dpp v26, v42 quad_perm:[0,1,2,3] row_mask:0xf bank_mask:0x4
  v_mov_b32_dpp v27, v58 quad_perm:[0,1,2,3] row_mask:0xf bank_mask:0x4
  v_mov_b32_dpp v24, v44 row_ror:12 row_mask:0xf bank_mask:0x8
  v_mov_b32_dpp v25, v60 row_ror:12 row_mask:0xf bank_mask:0x8
  v_mov_b32_dpp v26, v46 row_ror:4 row_mask:0xf bank_mask:0x8
  v_mov_b32_dpp v27, v62 row_ror:4 row_mask:0xf bank_mask:0x8
  v_add_f32_dpp v24, v33, v24 row_ror:12 row_mask:0xf bank_mask:0x1
  v_add_f32_dpp v25, v49, v25 row_ror:12 row_mask:0xf bank_mask:0x1
  v_add_f32_dpp v26, v35, v26 row_ror:4 row_mask:0xf bank_mask:0x1
  v_add_f32_dpp v27, v51, v27 row_ror:4 row_mask:0xf bank_mask:0x1
  v_add_f32_dpp v24, v37, v24 quad_perm:[0,1,2,3] row_mask:0xf bank_mask:0x2
  v_add_f32_dpp v25, v53, v25 quad_perm:[0,1,2,3] row_mask:0xf bank_mask:0x2
  v_add_f32_dpp v26, v39, v26 row_ror:8 row_mask:0xf bank_mask:0x2
  v_add_f32_dpp v27, v55, v27 row_ror:8 row_mask:0xf bank_mask:0x2
  v_add_f32_dpp v24, v41, v24 row_ror:4 row_mask:0xf bank_mask:0x4
  v_add_f32_dpp v25, v57, v25 row_ror:4 row_mask:0xf bank_mask:0x4
  v_add_f32_dpp v26, v43, v26 row_ror:12 row_mask:0xf bank_mask:0x4
  v_add_f32_dpp v27, v59, v27 row_ror:12 row_mask:0xf bank_mask:0x4
  v_add_f32_dpp v24, v45, v24 row_ror:8 row_mask:0xf bank_mask:0x8
  v_add_f32_dpp v25, v61, v25 row_ror:8 row_mask:0xf bank_mask:0x8
  v_add_f32_dpp v26, v47, v26 quad_perm:[0,1,2,3] row_mask:0xf bank_mask:0x8
  v_add_f32_dpp v27, v63, v27 quad_perm:[0,1,2,3] row_mask:0xf bank_mask:0x8
  v_add_f32 v24, v24, v26
  v_add_f32 v25, v25, v27
  v_cvt_pk_bf16_f32 v32, v24, v25
  v_lshlrev_b32 v24, 16, v32
  v_and_b32 v25, 0xffff0000, v32
  v_pk_mul_f32 v[24:25], v[24:25], s[56:57] op_sel_hi:[1,0]
  v_cvt_pk_bf16_f32 v32, v24, v25
  v_lshlrev_b32 v24, 16, v32
  v_and_b32 v25, 0xffff0000, v32
  v_pk_add_f32 v[26:27], v[24:25], v[4:5] op_sel_hi:[1,0] neg_lo:[0,1] neg_hi:[0,1]
  v_pk_mul_f32 v[26:27], v[26:27], s[56:57] op_sel:[0,1] op_sel_hi:[1,1]
  v_max_f32 v20, v26, v27
  v_cmp_lt_f32 vcc, 0, v20
  s_getpc_b64 s[74:75]
  s_cbranch_vccnz L_remax
  v_exp_f32 v26, v26
  v_exp_f32 v27, v27
  s_nop 0
  v_add_f32 v32, v26, v27
  v_cvt_pk_bf16_f32 v20, v26, 0
  v_cvt_pk_bf16_f32 v21, v26, 0
  v_cvt_pk_bf16_f32 v23, v27, 0
  v_cvt_pk_bf16_f32 v22, v27, 0
  v_cvt_pk_bf16_f32 v24, 0, v26
  v_cvt_pk_bf16_f32 v25, 0, v27
  v_add_f32 v5, v5, v32
  v_mov_b32_dpp v20, v24 row_ror:4 row_mask:0xf bank_mask:0xa
  v_mov_b32_dpp v21, v24 row_ror:4 row_mask:0xf bank_mask:0x5
  v_mov_b32_dpp v23, v25 row_ror:4 row_mask:0xf bank_mask:0xa
  v_mov_b32_dpp v22, v25 row_ror:4 row_mask:0xf bank_mask:0x5
  v_and_b32_dpp v32, v20, v6 quad_perm:[0,1,2,3] row_mask:0xf bank_mask:0xf
  v_and_b32_dpp v33, v20, v7 row_ror:8 row_mask:0xf bank_mask:0xf
  v_and_b32_dpp v34, v21, v6 row_ror:12 row_mask:0xf bank_mask:0xf
  v_and_b32_dpp v35, v21, v7 row_ror:4 row_mask:0xf bank_mask:0xf
  v_and_b32_dpp v36, v20, v6 row_ror:8 row_mask:0xf bank_mask:0xf
  v_and_b32_dpp v37, v20, v7 quad_perm:[0,1,2,3] row_mask:0xf bank_mask:0xf
  v_and_b32_dpp v38, v21, v6 row_ror:4 row_mask:0xf bank_mask:0xf
  v_and_b32_dpp v39, v21, v7 row_ror:12 row_mask:0xf bank_mask:0xf
  v_mfma_f32_16x16x16_bf16 v[12:15], v[32:33], a[32:33], v[12:15]
  v_and_b32_dpp v40, v23, v6 quad_perm:[0,1,2,3] row_mask:0xf bank_mask:0xf
  v_mfma_f32_16x16x16_bf16 v[16:19], v[32:33], a[34:35], v[16:19]
  v_and_b32_dpp v41, v23, v7 row_ror:8 row_mask:0xf bank_mask:0xf
  v_mfma_f32_16x16x16_bf16 v[12:15], v[34:35], a[36:37], v[12:15]
  v_and_b32_dpp v42, v22, v6 row_ror:12 row_mask:0xf bank_mask:0xf
  v_mfma_f32_16x16x16_bf16 v[16:19], v[34:35], a[38:39], v[16:19]
  v_and_b32_dpp v43, v22, v7 row_ror:4 row_mask:0xf bank_mask:0xf
  v_mfma_f32_16x16x16_bf16 v[12:15], v[36:37], a[40:41], v[12:15]
  v_and_b32_dpp v44, v23, v6 row_ror:8 row_mask:0xf bank_mask:0xf
  v_mfma_f32_16x16x16_bf16 v[16:19], v[36:37], a[42:43], v[16:19]
  v_and_b32_dpp v45, v23, v7 quad_perm:[0,1,2,3] row_mask:0xf bank_mask:0xf
  v_mfma_f32_16x16x16_bf16 v[12:15], v[38:39], a[44:45], v[12:15]
  v_and_b32_dpp v46, v22, v6 row_ror:4 row_mask:0xf bank_mask:0xf
  v_mfma_f32_16x16x16_bf16 v[16:19], v[38:39], a[46:47], v[16:19]
  v_and_b32_dpp v47, v22, v7 row_ror:12 row_mask:0xf bank_mask:0xf
  v_mfma_f32_16x16x16_bf16 v[12:15], v[40:41], a[48:49], v[12:15]
  v_mfma_f32_16x16x16_bf16 v[16:19], v[40:41], a[50:51], v[16:19]
  v_mfma_f32_16x16x16_bf16 v[12:15], v[42:43], a[52:53], v[12:15]
  v_mfma_f32_16x16x16_bf16 v[16:19], v[42:43], a[54:55], v[16:19]
  v_mfma_f32_16x16x16_bf16 v[12:15], v[44:45], a[56:57], v[12:15]
  v_mfma_f32_16x16x16_bf16 v[16:19], v[44:45], a[58:59], v[16:19]
  v_mfma_f32_16x16x16_bf16 v[12:15], v[46:47], a[60:61], v[12:15]
  v_mfma_f32_16x16x16_bf16 v[16:19], v[46:47], a[62:63], v[16:19]
  s_add_u32 s73, s73, 1
  s_bitcmp1_b32 s2, 0
  s_cselect_b32 s51, 15, 17
  s_cmp_lt_u32 s73, s51
  s_cbranch_scc1 L_pgl
  s_nop 9
L_passend:
  v_mov_b32 v3, v31
  v_add_f32_dpp v5, v5, v5 row_ror:4 row_mask:0xf bank_mask:0xf
  s_nop 1
  v_add_f32_dpp v5, v5, v5 row_ror:8 row_mask:0xf bank_mask:0xf
  v_mov_b32 v25, v5
  s_nop 1
  v_permlane32_swap_b32 v5, v25
  v_add_f32 v5, v5, v25
  v_mov_b32 v25, v5
  s_nop 1
  v_permlane16_swap_b32 v5, v25
  v_add_f32 v5, v5, v25
  v_and_b32 v24, 63, v0
  s_lshl_b32 s51, s3, 5
  v_lshl_add_u32 v27, v24, 3, s51
  v_and_b32 v28, 15, v24
  v_lshlrev_b32 v28, 5, v28
  v_lshrrev_b32 v26, 4, v24
  v_lshl_add_u32 v28, v26, 2, v28
  s_lshl_b32 s51, s3, 11
  v_add_u32 v28, s51, v28
  ds_write_b32 v28, v12
  ds_write_b32 v28, v13 offset:512
  ds_write_b32 v28, v14 offset:1024
  ds_write_b32 v28, v15 offset:1536
  ds_write_b32 v28, v16 offset:16
  ds_write_b32 v28, v17 offset:528
  ds_write_b32 v28, v18 offset:1040
  ds_write_b32 v28, v19 offset:1552
  s_cmp_eq_u64 s[86:87], 0
  s_cbranch_scc1 L_novd
  s_mov_b64 exec, s[86:87]
  ds_add_f32 v36, v32 offset:0
  ds_add_f32 v36, v33 offset:512
  ds_add_f32 v36, v34 offset:1024
  ds_add_f32 v36, v35 offset:1536
L_novd:
  s_mov_b32 exec_lo, 0xf
  s_mov_b32 exec_hi, 0x0
  ds_write_b64 v27, v[4:5] offset:11264
  s_mov_b64 exec, -1
  s_lshl_b32 s51, s3, 3
  v_mov_b32 v27, s51
  v_lshlrev_b32 v28, 3, v0
  s_lshr_b32 s51, s2, 5
  s_lshl_b32 s51, s51, 2
  s_add_u32 s51, s51, s3
  s_lshl_b32 s51, s51, 5
  s_and_b32 s52, s2, 31
  s_add_u32 s51, s51, s52
  s_lshl_b32 s52, s51, 9
  s_add_u32 s52, s52, s53
  s_add_u32 s52, s52, 0x40000
  s_lshl_b32 s60, s51, 3
  s_add_u32 s60, s60, s53
  s_add_u32 s60, s60, 0x3c000
  s_waitcnt lgkmcnt(0)
  s_barrier
  ds_read_b64 v[32:33], v27 offset:11264
  ds_read_b64 v[40:41], v28
  ds_read_b64 v[34:35], v27 offset:11296
  ds_read_b64 v[42:43], v28 offset:2048
  ds_read_b64 v[36:37], v27 offset:11328
  ds_read_b64 v[44:45], v28 offset:4096
  ds_read_b64 v[38:39], v27 offset:11360
  ds_read_b64 v[46:47], v28 offset:6144
  v_lshlrev_b32 v28, 3, v24
  v_mov_b32 v29, 0
  s_waitcnt lgkmcnt(0)
  v_max3_f32 v8, v32, v34, v36
  v_max_f32 v8, v8, v38
  v_sub_f32 v32, v32, v8
  v_sub_f32 v34, v34, v8
  v_sub_f32 v36, v36, v8
  v_sub_f32 v38, v38, v8
  v_mul_f32 v32, s57, v32
  v_mul_f32 v34, s57, v34
  v_mul_f32 v36, s57, v36
  v_mul_f32 v38, s57, v38
  v_exp_f32 v32, v32
  v_exp_f32 v34, v34
  v_exp_f32 v36, v36
  v_exp_f32 v38, v38
  v_mul_f32 v9, v32, v33
  v_mul_f32 v10, v32, v40
  v_mul_f32 v11, v32, v41
  v_fmac_f32 v9, v34, v35
  v_fmac_f32 v10, v34, v42
  v_fmac_f32 v11, v34, v43
  v_fmac_f32 v9, v36, v37
  v_fmac_f32 v10, v36, v44
  v_fmac_f32 v11, v36, v45
  v_fmac_f32 v9, v38, v39
  v_fmac_f32 v10, v38, v46
  v_fmac_f32 v11, v38, v47
  v_min_u32 v10, 0xfffffffe, v10
  v_min_u32 v11, 0xfffffffe, v11
  v_min_u32 v8, 0xfffffffe, v8
  v_min_u32 v9, 0xfffffffe, v9
  buffer_store_dwordx2 v[10:11], v28, s[36:39], s52 offen sc1
  s_mov_b32 exec_lo, 0x1
  s_mov_b32 exec_hi, 0x0
  buffer_store_dwordx2 v[8:9], v29, s[36:39], s60 offen sc1
  s_mov_b64 exec, -1
  v_and_b32 v30, 63, v0
  v_lshrrev_b32 v29, 2, v30
  s_mov_b32 s63, 1024
  v_mul_lo_u32 v29, v29, s63
  v_and_b32 v30, 3, v30
  v_lshl_add_u32 v29, v30, 4, v29
  s_and_b32 s52, s4, 15
  s_lshl_b32 s52, s52, 6
  s_lshr_b32 s51, s4, 4
  s_lshl_b32 s51, s51, 18
  s_add_u32 s51, s51, s52
  s_lshl_b32 s52, s3, 16
  s_add_u32 s51, s51, s52
  buffer_load_dwordx4 v[48:51], v29, s[20:23], s51 offen
  s_add_u32 s51, s51, 16384
  buffer_load_dwordx4 v[52:55], v29, s[20:23], s51 offen
  s_add_u32 s51, s51, 16384
  buffer_load_dwordx4 v[56:59], v29, s[20:23], s51 offen
  s_add_u32 s51, s51, 16384
  buffer_load_dwordx4 v[60:63], v29, s[20:23], s51 offen
  s_lshr_b32 s60, s4, 4
  s_lshl_b32 s60, s60, 1
  s_lshr_b32 s62, s3, 1
  s_add_u32 s60, s60, s62
  v_and_b32 v27, 127, v0
  v_lshlrev_b32 v27, 2, v27
  v_and_b32 v28, 31, v0
  v_lshlrev_b32 v28, 3, v28
  s_lshl_b32 s62, s60, 14
  s_add_u32 s62, s62, s53
  s_add_u32 s62, s62, 0x40000
  s_lshl_b32 s63, s60, 8
  s_add_u32 s63, s63, s53
  s_add_u32 s63, s63, 0x3c000
  s_nop 9
L_poll3:
  buffer_load_dwordx2 v[4:5], v28, s[36:39], s63 offen sc1
  s_add_u32 s51, s62, 0
  buffer_load_dword v8, v27, s[36:39], s51 offen sc1
  buffer_load_dword v9, v27, s[36:39], s51 offen offset:512 sc1
  buffer_load_dword v10, v27, s[36:39], s51 offen offset:1024 sc1
  buffer_load_dword v11, v27, s[36:39], s51 offen offset:1536 sc1
  buffer_load_dword v12, v27, s[36:39], s51 offen offset:2048 sc1
  buffer_load_dword v13, v27, s[36:39], s51 offen offset:2560 sc1
  buffer_load_dword v14, v27, s[36:39], s51 offen offset:3072 sc1
  buffer_load_dword v15, v27, s[36:39], s51 offen offset:3584 sc1
  s_add_u32 s51, s62, 4096
  buffer_load_dword v16, v27, s[36:39], s51 offen sc1
  buffer_load_dword v17, v27, s[36:39], s51 offen offset:512 sc1
  buffer_load_dword v18, v27, s[36:39], s51 offen offset:1024 sc1
  buffer_load_dword v19, v27, s[36:39], s51 offen offset:1536 sc1
  buffer_load_dword v20, v27, s[36:39], s51 offen offset:2048 sc1
  buffer_load_dword v21, v27, s[36:39], s51 offen offset:2560 sc1
  buffer_load_dword v22, v27, s[36:39], s51 offen offset:3072 sc1
  buffer_load_dword v23, v27, s[36:39], s51 offen offset:3584 sc1
  s_add_u32 s51, s62, 8192
  buffer_load_dword v32, v27, s[36:39], s51 offen sc1
  buffer_load_dword v33, v27, s[36:39], s51 offen offset:512 sc1
  buffer_load_dword v34, v27, s[36:39], s51 offen offset:1024 sc1
  buffer_load_dword v35, v27, s[36:39], s51 offen offset:1536 sc1
  buffer_load_dword v36, v27, s[36:39], s51 offen offset:2048 sc1
  buffer_load_dword v37, v27, s[36:39], s51 offen offset:2560 sc1
  buffer_load_dword v38, v27, s[36:39], s51 offen offset:3072 sc1
  buffer_load_dword v39, v27, s[36:39], s51 offen offset:3584 sc1
  s_add_u32 s51, s62, 12288
  buffer_load_dword v40, v27, s[36:39], s51 offen sc1
  buffer_load_dword v41, v27, s[36:39], s51 offen offset:512 sc1
  buffer_load_dword v42, v27, s[36:39], s51 offen offset:1024 sc1
  buffer_load_dword v43, v27, s[36:39], s51 offen offset:1536 sc1
  buffer_load_dword v44, v27, s[36:39], s51 offen offset:2048 sc1
  buffer_load_dword v45, v27, s[36:39], s51 offen offset:2560 sc1
  buffer_load_dword v46, v27, s[36:39], s51 offen offset:3072 sc1
  buffer_load_dword v47, v27, s[36:39], s51 offen offset:3584 sc1
  s_waitcnt vmcnt(0)
  v_max_u32 v31, v8, v9
  v_max3_u32 v31, v31, v10, v11
  v_max3_u32 v31, v31, v12, v13
  v_max3_u32 v31, v31, v14, v15
  v_max3_u32 v31, v31, v16, v17
  v_max3_u32 v31, v31, v18, v19
  v_max3_u32 v31, v31, v20, v21
  v_max3_u32 v31, v31, v22, v23
  v_max3_u32 v31, v31, v32, v33
  v_max3_u32 v31, v31, v34, v35
  v_max3_u32 v31, v31, v36, v37
  v_max3_u32 v31, v31, v38, v39
  v_max3_u32 v31, v31, v40, v41
  v_max3_u32 v31, v31, v42, v43
  v_max3_u32 v31, v31, v44, v45
  v_max3_u32 v31, v31, v46, v47
  v_max3_u32 v31, v31, v4, v5
  v_cmp_eq_u32 vcc, -1, v31
  s_nop 0
  s_cbranch_vccz L_pdone3
  s_sub_u32 s55, s55, 1
  s_cmp_le_i32 s55, 0
  s_cbranch_scc1 L_pdone3
  s_sleep 1
  s_branch L_poll3
  s_nop 9
L_pdone3:
  v_mov_b32 v24, v4
  s_nop 1
  v_max_f32_dpp v24, v24, v24 quad_perm:[1,0,3,2] row_mask:0xf bank_mask:0xf
  s_nop 1
  v_max_f32_dpp v24, v24, v24 quad_perm:[2,3,0,1] row_mask:0xf bank_mask:0xf
  s_nop 1
  v_max_f32_dpp v24, v24, v24 row_half_mirror row_mask:0xf bank_mask:0xf
  s_nop 1
  v_max_f32_dpp v24, v24, v24 row_mirror row_mask:0xf bank_mask:0xf
  v_mov_b32 v25, v24
  s_nop 1
  v_permlane16_swap_b32 v24, v25
  v_max_f32 v24, v24, v25
  v_sub_f32 v4, v4, v24
  v_mul_f32 v4, s57, v4
  v_exp_f32 v4, v4
  s_nop 0
  v_mul_f32 v5, v5, v4
  s_nop 1
  v_add_f32_dpp v5, v5, v5 quad_perm:[1,0,3,2] row_mask:0xf bank_mask:0xf
  s_nop 1
  v_add_f32_dpp v5, v5, v5 quad_perm:[2,3,0,1] row_mask:0xf bank_mask:0xf
  s_nop 1
  v_add_f32_dpp v5, v5, v5 row_half_mirror row_mask:0xf bank_mask:0xf
  s_nop 1
  v_add_f32_dpp v5, v5, v5 row_mirror row_mask:0xf bank_mask:0xf
  v_mov_b32 v25, v5
  s_nop 1
  v_permlane16_swap_b32 v5, v25
  v_add_f32 v5, v5, v25
  v_rcp_f32 v5, v5
  s_nop 0
  v_mul_f32 v4, v4, v5
  s_nop 0
  v_readlane_b32 s64, v4, 0
  v_readlane_b32 s65, v4, 1
  v_readlane_b32 s66, v4, 2
  v_readlane_b32 s67, v4, 3
  v_readlane_b32 s68, v4, 4
  v_readlane_b32 s69, v4, 5
  v_readlane_b32 s70, v4, 6
  v_readlane_b32 s71, v4, 7
  v_readlane_b32 s72, v4, 8
  v_readlane_b32 s73, v4, 9
  v_readlane_b32 s74, v4, 10
  v_readlane_b32 s75, v4, 11
  v_readlane_b32 s76, v4, 12
  v_readlane_b32 s77, v4, 13
  v_readlane_b32 s78, v4, 14
  v_readlane_b32 s79, v4, 15
  v_readlane_b32 s80, v4, 16
  v_readlane_b32 s81, v4, 17
  v_readlane_b32 s82, v4, 18
  v_readlane_b32 s83, v4, 19
  v_readlane_b32 s84, v4, 20
  v_readlane_b32 s85, v4, 21
  v_readlane_b32 s86, v4, 22
  v_readlane_b32 s87, v4, 23
  v_readlane_b32 s88, v4, 24
  v_readlane_b32 s89, v4, 25
  v_readlane_b32 s90, v4, 26
  v_readlane_b32 s91, v4, 27
  v_readlane_b32 s92, v4, 28
  v_readlane_b32 s93, v4, 29
  v_readlane_b32 s94, v4, 30
  v_readlane_b32 s95, v4, 31
  v_mul_f32 v24, s64, v8
  v_mul_f32 v25, s65, v9
  v_fmac_f32 v24, s66, v10
  v_fmac_f32 v25, s67, v11
  v_fmac_f32 v24, s68, v12
  v_fmac_f32 v25, s69, v13
  v_fmac_f32 v24, s70, v14
  v_fmac_f32 v25, s71, v15
  v_fmac_f32 v24, s72, v16
  v_fmac_f32 v25, s73, v17
  v_fmac_f32 v24, s74, v18
  v_fmac_f32 v25, s75, v19
  v_fmac_f32 v24, s76, v20
  v_fmac_f32 v25, s77, v21
  v_fmac_f32 v24, s78, v22
  v_fmac_f32 v25, s79, v23
  v_fmac_f32 v24, s80, v32
  v_fmac_f32 v25, s81, v33
  v_fmac_f32 v24, s82, v34
  v_fmac_f32 v25, s83, v35
  v_fmac_f32 v24, s84, v36
  v_fmac_f32 v25, s85, v37
  v_fmac_f32 v24, s86, v38
  v_fmac_f32 v25, s87, v39
  v_fmac_f32 v24, s88, v40
  v_fmac_f32 v25, s89, v41
  v_fmac_f32 v24, s90, v42
  v_fmac_f32 v25, s91, v43
  v_fmac_f32 v24, s92, v44
  v_fmac_f32 v25, s93, v45
  v_fmac_f32 v24, s94, v46
  v_fmac_f32 v25, s95, v47
  v_add_f32 v24, v24, v25
  v_cvt_pk_bf16_f32 v26, v24, v24
  v_lshlrev_b32 v24, 16, v26
  v_and_b32 v27, 60, v0
  v_add_u32 v12, 0, v27
  v_add_u32 v13, 64, v27
  v_add_u32 v14, 128, v27
  v_add_u32 v15, 192, v27
  ds_bpermute_b32 v8, v12, v24
  ds_bpermute_b32 v9, v13, v24
  ds_bpermute_b32 v10, v14, v24
  ds_bpermute_b32 v11, v15, v24
  v_and_b32 v30, 63, v0
  v_lshrrev_b32 v29, 3, v30
  s_mov_b32 s63, 7168
  v_mul_lo_u32 v29, v29, s63
  v_and_b32 v30, 7, v30
  v_lshl_add_u32 v29, v30, 4, v29
  s_and_b32 s62, s4, 63
  s_lshr_b32 s60, s4, 6
  s_lshl_b32 s60, s60, 1
  s_cmp_ge_u32 s62, 28
  s_addc_u32 s60, s60, 0
  s_cmp_ge_u32 s62, 28
  s_cselect_b32 s63, 28, 0
  s_sub_u32 s62, s62, s63
  s_lshl_b32 s51, s60, 2
  s_add_u32 s51, s51, s3
  s_mul_i32 s51, s51, 57344
  s_lshl_b32 s52, s62, 7
  s_add_u32 s51, s51, s52
  s_add_u32 s52, s51, 3584
  buffer_load_dwordx4 v[32:35], v29, s[24:27], s51 offen
  buffer_load_dwordx4 v[36:39], v29, s[24:27], s52 offen
  buffer_load_dwordx4 v[40:43], v29, s[28:31], s51 offen
  buffer_load_dwordx4 v[44:47], v29, s[28:31], s52 offen
  v_lshrrev_b32 v27, 4, v0
  v_lshlrev_b32 v27, 7, v27
  v_and_b32 v28, 3, v0
  v_lshl_add_u32 v27, v28, 5, v27
  s_waitcnt lgkmcnt(0)
  v_lshrrev_b32 v12, 16, v8
  v_lshrrev_b32 v13, 16, v9
  v_lshrrev_b32 v14, 16, v10
  v_lshrrev_b32 v15, 16, v11
  v_dot2_f32_bf16 v16, v48, v12, 0
  v_dot2_f32_bf16 v17, v48, v8, 0
  v_dot2_f32_bf16 v18, v49, v12, 0
  v_dot2_f32_bf16 v19, v49, v8, 0
  v_dot2_f32_bf16 v20, v50, v12, 0
  v_dot2_f32_bf16 v21, v50, v8, 0
  v_dot2_f32_bf16 v22, v51, v12, 0
  v_dot2_f32_bf16 v23, v51, v8, 0
  v_dot2_f32_bf16 v16, v52, v13, v16
  v_dot2_f32_bf16 v17, v52, v9, v17
  v_dot2_f32_bf16 v18, v53, v13, v18
  v_dot2_f32_bf16 v19, v53, v9, v19
  v_dot2_f32_bf16 v20, v54, v13, v20
  v_dot2_f32_bf16 v21, v54, v9, v21
  v_dot2_f32_bf16 v22, v55, v13, v22
  v_dot2_f32_bf16 v23, v55, v9, v23
  v_dot2_f32_bf16 v16, v56, v14, v16
  v_dot2_f32_bf16 v17, v56, v10, v17
  v_dot2_f32_bf16 v18, v57, v14, v18
  v_dot2_f32_bf16 v19, v57, v10, v19
  v_dot2_f32_bf16 v20, v58, v14, v20
  v_dot2_f32_bf16 v21, v58, v10, v21
  v_dot2_f32_bf16 v22, v59, v14, v22
  v_dot2_f32_bf16 v23, v59, v10, v23
  v_dot2_f32_bf16 v16, v60, v15, v16
  v_dot2_f32_bf16 v17, v60, v11, v17
  v_dot2_f32_bf16 v18, v61, v15, v18
  v_dot2_f32_bf16 v19, v61, v11, v19
  v_dot2_f32_bf16 v20, v62, v15, v20
  v_dot2_f32_bf16 v21, v62, v11, v21
  v_dot2_f32_bf16 v22, v63, v15, v22
  v_dot2_f32_bf16 v23, v63, v11, v23
  v_add_f32_dpp v16, v16, v16 row_ror:4 row_mask:0xf bank_mask:0xf
  v_add_f32_dpp v17, v17, v17 row_ror:4 row_mask:0xf bank_mask:0xf
  v_add_f32_dpp v18, v18, v18 row_ror:4 row_mask:0xf bank_mask:0xf
  v_add_f32_dpp v19, v19, v19 row_ror:4 row_mask:0xf bank_mask:0xf
  v_add_f32_dpp v20, v20, v20 row_ror:4 row_mask:0xf bank_mask:0xf
  v_add_f32_dpp v21, v21, v21 row_ror:4 row_mask:0xf bank_mask:0xf
  v_add_f32_dpp v22, v22, v22 row_ror:4 row_mask:0xf bank_mask:0xf
  v_add_f32_dpp v23, v23, v23 row_ror:4 row_mask:0xf bank_mask:0xf
  v_add_f32_dpp v16, v16, v16 row_ror:8 row_mask:0xf bank_mask:0xf
  v_add_f32_dpp v17, v17, v17 row_ror:8 row_mask:0xf bank_mask:0xf
  v_add_f32_dpp v18, v18, v18 row_ror:8 row_mask:0xf bank_mask:0xf
  v_add_f32_dpp v19, v19, v19 row_ror:8 row_mask:0xf bank_mask:0xf
  v_add_f32_dpp v20, v20, v20 row_ror:8 row_mask:0xf bank_mask:0xf
  v_add_f32_dpp v21, v21, v21 row_ror:8 row_mask:0xf bank_mask:0xf
  v_add_f32_dpp v22, v22, v22 row_ror:8 row_mask:0xf bank_mask:0xf
  v_add_f32_dpp v23, v23, v23 row_ror:8 row_mask:0xf bank_mask:0xf
  s_mov_b32 exec_lo, 0xf000f
  s_mov_b32 exec_hi, 0xf000f
  ds_write_b128 v27, v[16:19]
  ds_write_b128 v27, v[20:23] offset:16
  s_mov_b64 exec, -1
  v_and_b32 v30, 63, v0
  v_lshrrev_b32 v29, 2, v30
  s_mov_b32 s63, 1024
  v_mul_lo_u32 v29, v29, s63
  v_and_b32 v30, 3, v30
  v_lshl_add_u32 v29, v30, 4, v29
  s_and_b32 s52, s4, 15
  s_lshl_b32 s52, s52, 6
  s_lshr_b32 s51, s4, 4
  s_lshl_b32 s51, s51, 2
  s_add_u32 s51, s51, s3
  s_mul_i32 s51, s51, 28672
  s_add_u32 s51, s51, s52
  s_add_u32 s52, s51, 16384
  buffer_load_dwordx4 v[48:51], v29, s[32:35], s51 offen
  buffer_load_dwordx4 v[52:55], v29, s[32:35], s52 offen
  v_bfe_u32 v29, v0, 3, 3
  v_lshlrev_b32 v29, 3, v29
  s_lshl_b32 s52, s3, 6
  v_add_u32 v29, s52, v29
  ds_read_b64 v[56:57], v29 offset:9728
  ds_read_b64 v[58:59], v29 offset:9984
  s_waitcnt lgkmcnt(0)
  s_barrier
  s_cmp_lg_u32 s3, 0
  s_cbranch_scc1 L_skipO
  v_and_b32 v27, 31, v0
  v_lshlrev_b32 v27, 2, v27
  v_bfe_u32 v28, v0, 4, 1
  v_lshlrev_b32 v28, 7, v28
  v_bfe_u32 v29, v0, 1, 3
  v_lshl_add_u32 v28, v29, 4, v28
  v_and_b32 v29, 1, v0
  v_lshl_add_u32 v28, v29, 2, v28
  s_bfe_u32 s52, s4, 0x20002
  s_lshl_b32 s52, s52, 9
  s_and_b32 s60, s4, 1
  s_lshl_b32 s60, s60, 8
  s_add_u32 s52, s52, s60
  s_and_b32 s60, s4, 2
  s_lshl_b32 s60, s60, 2
  s_add_u32 s52, s52, s60
  s_lshr_b32 s51, s4, 4
  s_lshl_b32 s51, s51, 11
  s_add_u32 s51, s51, s52
  s_add_u32 s51, s51, s53
  s_add_u32 s51, s51, 0x18000
  ds_read_b32 v8, v27
  ds_read_b32 v9, v27 offset:128
  ds_read_b32 v10, v27 offset:256
  ds_read_b32 v11, v27 offset:384
  ds_read_b32 v12, v27 offset:512
  ds_read_b32 v13, v27 offset:640
  ds_read_b32 v14, v27 offset:768
  ds_read_b32 v15, v27 offset:896
  ds_read_b32 v16, v27 offset:1024
  ds_read_b32 v17, v27 offset:1152
  ds_read_b32 v18, v27 offset:1280
  ds_read_b32 v19, v27 offset:1408
  ds_read_b32 v20, v27 offset:1536
  ds_read_b32 v21, v27 offset:1664
  ds_read_b32 v22, v27 offset:1792
  ds_read_b32 v23, v27 offset:1920
  s_waitcnt lgkmcnt(0)
  v_add_f32 v8, v8, v16
  v_add_f32 v9, v9, v17
  v_add_f32 v10, v10, v18
  v_add_f32 v11, v11, v19
  v_add_f32 v12, v12, v20
  v_add_f32 v13, v13, v21
  v_add_f32 v14, v14, v22
  v_add_f32 v15, v15, v23
  v_add_f32 v8, v8, v12
  v_add_f32 v9, v9, v13
  v_add_f32 v10, v10, v14
  v_add_f32 v11, v11, v15
  v_add_f32 v8, v8, v10
  v_add_f32 v9, v9, v11
  v_add_f32 v8, v8, v9
  v_mov_b32 v24, v8
  v_min_u32 v24, 0xfffffffe, v24
  s_mov_b32 exec_lo, 0xffffffff
  s_mov_b32 exec_hi, 0x0
  buffer_store_dword v24, v28, s[36:39], s51 offen sc1
  s_mov_b64 exec, -1
  s_nop 9
L_skipO:
  s_and_b32 s65, s4, 63
  s_lshr_b32 s64, s4, 6
  s_lshl_b32 s64, s64, 1
  s_cmp_ge_u32 s65, 28
  s_addc_u32 s64, s64, 0
  s_cmp_ge_u32 s65, 28
  s_cselect_b32 s63, 28, 0
  s_sub_u32 s65, s65, s63
  s_bitcmp1_b32 s64, 0
  s_cselect_b64 s[66:67], -1, 0
  s_mov_b64 s[92:93], 0
  s_mov_b32 s95, 0
  v_mov_b32 v7, 0
  s_cmp_lg_u32 s48, 0
  s_cbranch_scc1 L_nocs
  v_and_b32 v30, 7, v0
  v_lshlrev_b32 v29, 5, v30
  v_bfe_u32 v30, v0, 4, 2
  v_lshl_add_u32 v29, v30, 3, v29
  s_mul_i32 s63, s3, 1024
  v_add_u32 v29, s63, v29
  s_waitcnt vmcnt(2)
  v_dot2_f32_bf16 v8, v32, s6, 0
  v_dot2_f32_bf16 v9, v32, s7, 0
  v_dot2_f32_bf16 v10, v33, s6, 0
  v_dot2_f32_bf16 v11, v33, s7, 0
  v_dot2_f32_bf16 v12, v34, s6, 0
  v_dot2_f32_bf16 v13, v34, s7, 0
  v_dot2_f32_bf16 v14, v35, s6, 0
  v_dot2_f32_bf16 v15, v35, s7, 0
  v_dot2_f32_bf16 v16, v40, s6, 0
  v_dot2_f32_bf16 v17, v40, s7, 0
  v_dot2_f32_bf16 v18, v41, s6, 0
  v_dot2_f32_bf16 v19, v41, s7, 0
  v_dot2_f32_bf16 v20, v42, s6, 0
  v_dot2_f32_bf16 v21, v42, s7, 0
  v_dot2_f32_bf16 v22, v43, s6, 0
  v_dot2_f32_bf16 v23, v43, s7, 0
  v_dot2_f32_bf16 v8, v36, s6, v8
  v_dot2_f32_bf16 v9, v36, s7, v9
  v_dot2_f32_bf16 v10, v37, s6, v10
  v_dot2_f32_bf16 v11, v37, s7, v11
  v_dot2_f32_bf16 v12, v38, s6, v12
  v_dot2_f32_bf16 v13, v38, s7, v13
  v_dot2_f32_bf16 v14, v39, s6, v14
  v_dot2_f32_bf16 v15, v39, s7, v15
  v_dot2_f32_bf16 v16, v44, s6, v16
  v_dot2_f32_bf16 v17, v44, s7, v17
  v_dot2_f32_bf16 v18, v45, s6, v18
  v_dot2_f32_bf16 v19, v45, s7, v19
  v_dot2_f32_bf16 v20, v46, s6, v20
  v_dot2_f32_bf16 v21, v46, s7, v21
  v_dot2_f32_bf16 v22, v47, s6, v22
  v_dot2_f32_bf16 v23, v47, s7, v23
  v_permlane32_swap_b32 v8, v12
  v_permlane32_swap_b32 v9, v13
  v_permlane32_swap_b32 v10, v14
  v_permlane32_swap_b32 v11, v15
  v_permlane32_swap_b32 v16, v20
  v_permlane32_swap_b32 v17, v21
  v_permlane32_swap_b32 v18, v22
  v_permlane32_swap_b32 v19, v23
  v_add_f32 v8, v8, v12
  v_add_f32 v9, v9, v13
  v_add_f32 v10, v10, v14
  v_add_f32 v11, v11, v15
  v_add_f32 v16, v16, v20
  v_add_f32 v17, v17, v21
  v_add_f32 v18, v18, v22
  v_add_f32 v19, v19, v23
  v_permlane16_swap_b32 v8, v10
  v_permlane16_swap_b32 v9, v11
  v_permlane16_swap_b32 v16, v18
  v_permlane16_swap_b32 v17, v19
  v_add_f32 v8, v8, v10
  v_add_f32 v9, v9, v11
  v_add_f32 v16, v16, v18
  v_add_f32 v17, v17, v19
  v_add_f32_dpp v8, v8, v8 row_ror:8 row_mask:0xf bank_mask:0xf
  v_add_f32_dpp v9, v9, v9 row_ror:8 row_mask:0xf bank_mask:0xf
  v_add_f32_dpp v16, v16, v16 row_ror:8 row_mask:0xf bank_mask:0xf
  v_add_f32_dpp v17, v17, v17 row_ror:8 row_mask:0xf bank_mask:0xf
  s_mov_b32 exec_lo, 0xff00ff
  s_mov_b32 exec_hi, 0xff00ff
  ds_write_b64 v29, v[8:9] offset:4096
  ds_write_b64 v29, v[16:17] offset:4352
  s_mov_b64 exec, -1
  s_waitcnt lgkmcnt(0)
  s_barrier
  s_cmp_ge_u32 s3, 2
  s_cbranch_scc1 L_nocs
  s_and_b32 s52, s4, 63
  s_cmp_ge_u32 s52, 56
  s_cbranch_scc1 L_nocs
  v_lshlrev_b32 v29, 2, v0
  ds_read_b32 v8, v29 offset:4096
  ds_read_b32 v9, v29 offset:5120
  ds_read_b32 v10, v29 offset:6144
  ds_read_b32 v11, v29 offset:7168
  s_waitcnt lgkmcnt(0)
  v_add_f32 v8, v8, v9
  v_add_f32 v10, v10, v11
  v_add_f32 v24, v8, v10
  v_min_u32 v6, 0xfffffffe, v24
  v_and_b32 v7, 63, v0
  v_lshlrev_b32 v7, 2, v7
  s_mul_i32 s51, s64, 14336
  s_mul_i32 s52, s3, 7168
  s_add_u32 s51, s51, s52
  s_lshl_b32 s52, s65, 8
  s_add_u32 s51, s51, s52
  s_add_u32 s95, s51, 0xc0000
  s_mov_b64 s[92:93], -1
  s_nop 9
L_nocs:
  v_and_b32 v27, 7, v0
  v_lshlrev_b32 v27, 12, v27
  v_bfe_u32 v28, v0, 3, 3
  v_lshl_add_u32 v27, v28, 4, v27
  s_lshr_b32 s62, s4, 6
  s_lshl_b32 s62, s62, 9
  s_lshl_b32 s63, s3, 7
  s_add_u32 s62, s62, s63
  s_add_u32 s62, s62, s53
  s_add_u32 s62, s62, 0x18000
  s_cmp_eq_u32 s48, 0
  s_cbranch_scc1 L_ns4
  s_sleep 8
L_ns4:
  buffer_load_dwordx4 v[8:11], v27, s[36:39], s62 offen sc1
  buffer_load_dwordx4 v[12:15], v27, s[36:39], s62 offen offset:2048 sc1
  s_mov_b64 exec, s[92:93]
  buffer_store_dword v6, v7, s[36:39], s95 offen sc1
  s_mov_b64 exec, -1
  s_waitcnt vmcnt(1)
  v_max3_u32 v30, v8, v9, v10
  v_max_u32 v30, v30, v11
  v_cmp_eq_u32 s[68:69], -1, v30
  v_max3_u32 v31, v12, v13, v14
  v_max_u32 v31, v31, v15
  v_cmp_eq_u32 s[70:71], -1, v31
  s_nop 0
  s_or_b64 vcc, s[68:69], s[70:71]
  s_cbranch_scc0 L_id4
L_il4:
  s_mov_b64 exec, s[68:69]
  buffer_load_dwordx4 v[8:11], v27, s[36:39], s62 offen sc1
  s_mov_b64 exec, s[70:71]
  buffer_load_dwordx4 v[12:15], v27, s[36:39], s62 offen offset:2048 sc1
  s_mov_b64 exec, -1
  s_waitcnt vmcnt(0)
  v_max3_u32 v30, v8, v9, v10
  v_max_u32 v30, v30, v11
  v_cmp_eq_u32 s[68:69], -1, v30
  v_max3_u32 v31, v12, v13, v14
  v_max_u32 v31, v31, v15
  v_cmp_eq_u32 s[70:71], -1, v31
  s_nop 0
  s_or_b64 vcc, s[68:69], s[70:71]
  s_cbranch_scc0 L_id4
  s_sub_u32 s55, s55, 1
  s_cmp_gt_i32 s55, 0
  s_cbranch_scc1 L_il4
L_id4:
  s_nop 1
  v_add_f32 v8, v8, v12
  v_add_f32 v9, v9, v13
  v_add_f32 v10, v10, v14
  v_add_f32 v11, v11, v15
  v_add_f32_dpp v8, v8, v8 quad_perm:[1,0,3,2] row_mask:0xf bank_mask:0xf
  v_add_f32_dpp v9, v9, v9 quad_perm:[1,0,3,2] row_mask:0xf bank_mask:0xf
  v_add_f32_dpp v10, v10, v10 quad_perm:[1,0,3,2] row_mask:0xf bank_mask:0xf
  v_add_f32_dpp v11, v11, v11 quad_perm:[1,0,3,2] row_mask:0xf bank_mask:0xf
  v_add_f32_dpp v8, v8, v8 quad_perm:[2,3,0,1] row_mask:0xf bank_mask:0xf
  v_add_f32_dpp v9, v9, v9 quad_perm:[2,3,0,1] row_mask:0xf bank_mask:0xf
  v_add_f32_dpp v10, v10, v10 quad_perm:[2,3,0,1] row_mask:0xf bank_mask:0xf
  v_add_f32_dpp v11, v11, v11 quad_perm:[2,3,0,1] row_mask:0xf bank_mask:0xf
  v_add_f32_dpp v8, v8, v8 row_half_mirror row_mask:0xf bank_mask:0xf
  v_add_f32_dpp v9, v9, v9 row_half_mirror row_mask:0xf bank_mask:0xf
  v_add_f32_dpp v10, v10, v10 row_half_mirror row_mask:0xf bank_mask:0xf
  v_add_f32_dpp v11, v11, v11 row_half_mirror row_mask:0xf bank_mask:0xf
  v_cvt_pk_bf16_f32 v24, v8, v9
  v_lshlrev_b32 v8, 16, v24
  v_and_b32 v9, 0xffff0000, v24
  v_cvt_pk_bf16_f32 v25, v10, v11
  v_lshlrev_b32 v10, 16, v25
  v_and_b32 v11, 0xffff0000, v25
  v_add_f32 v56, v56, v8
  v_add_f32 v57, v57, v9
  v_add_f32 v58, v58, v10
  v_add_f32 v59, v59, v11
  v_cvt_pk_bf16_f32 v24, v56, v57
  v_lshlrev_b32 v56, 16, v24
  v_and_b32 v57, 0xffff0000, v24
  v_cvt_pk_bf16_f32 v25, v58, v59
  v_lshlrev_b32 v58, 16, v25
  v_and_b32 v59, 0xffff0000, v25
  s_and_b32 s51, s4, 63
  s_cmp_lt_u32 s51, 56
  s_cbranch_scc1 L_doG
  s_cmp_lg_u32 s48, 0
  s_cbranch_scc1 L_nwq5
  v_and_b32 v30, 63, v0
  v_lshrrev_b32 v29, 3, v30
  s_mov_b32 s63, 16384
  v_mul_lo_u32 v29, v29, s63
  v_and_b32 v30, 7, v30
  v_lshl_add_u32 v29, v30, 4, v29
  s_lshr_b32 s51, s4, 6
  s_lshl_b32 s51, s51, 20
  s_lshl_b32 s52, s3, 17
  s_add_u32 s51, s51, s52
  s_and_b32 s52, s4, 63
  s_lshl_b32 s52, s52, 7
  s_add_u32 s51, s51, s52
  buffer_load_dwordx4 v[32:35], v29, s[16:19], s51 offen
  s_add_u32 s51, s51, 8192
  buffer_load_dwordx4 v[36:39], v29, s[16:19], s51 offen
  s_add_u32 s51, s51, 516096
  buffer_load_dwordx4 v[40:43], v29, s[16:19], s51 offen
  s_add_u32 s51, s51, 8192
  buffer_load_dwordx4 v[44:47], v29, s[16:19], s51 offen
L_nwq5:
  s_branch L_skipG
L_doG:
  v_cndmask_b32 v60, v56, v58, s[66:67]
  v_cndmask_b32 v61, v57, v59, s[66:67]
  v_lshrrev_b32 v62, 16, v60
  v_lshrrev_b32 v63, 16, v61
  v_dot2_f32_bf16 v8, v32, v62, 0
  v_dot2_f32_bf16 v9, v32, v60, 0
  v_dot2_f32_bf16 v10, v33, v62, 0
  v_dot2_f32_bf16 v11, v33, v60, 0
  v_dot2_f32_bf16 v12, v34, v62, 0
  v_dot2_f32_bf16 v13, v34, v60, 0
  v_dot2_f32_bf16 v14, v35, v62, 0
  v_dot2_f32_bf16 v15, v35, v60, 0
  v_dot2_f32_bf16 v16, v40, v62, 0
  v_dot2_f32_bf16 v17, v40, v60, 0
  v_dot2_f32_bf16 v18, v41, v62, 0
  v_dot2_f32_bf16 v19, v41, v60, 0
  v_dot2_f32_bf16 v20, v42, v62, 0
  v_dot2_f32_bf16 v21, v42, v60, 0
  v_dot2_f32_bf16 v22, v43, v62, 0
  v_dot2_f32_bf16 v23, v43, v60, 0
  v_dot2_f32_bf16 v8, v36, v63, v8
  v_dot2_f32_bf16 v9, v36, v61, v9
  v_dot2_f32_bf16 v10, v37, v63, v10
  v_dot2_f32_bf16 v11, v37, v61, v11
  v_dot2_f32_bf16 v12, v38, v63, v12
  v_dot2_f32_bf16 v13, v38, v61, v13
  v_dot2_f32_bf16 v14, v39, v63, v14
  v_dot2_f32_bf16 v15, v39, v61, v15
  v_dot2_f32_bf16 v16, v44, v63, v16
  v_dot2_f32_bf16 v17, v44, v61, v17
  v_dot2_f32_bf16 v18, v45, v63, v18
  v_dot2_f32_bf16 v19, v45, v61, v19
  v_dot2_f32_bf16 v20, v46, v63, v20
  v_dot2_f32_bf16 v21, v46, v61, v21
  v_dot2_f32_bf16 v22, v47, v63, v22
  v_dot2_f32_bf16 v23, v47, v61, v23
  v_permlane32_swap_b32 v8, v12
  v_permlane32_swap_b32 v9, v13
  v_permlane32_swap_b32 v10, v14
  v_permlane32_swap_b32 v11, v15
  v_permlane32_swap_b32 v16, v20
  v_permlane32_swap_b32 v17, v21
  v_permlane32_swap_b32 v18, v22
  v_permlane32_swap_b32 v19, v23
  v_add_f32 v8, v8, v12
  v_add_f32 v9, v9, v13
  v_add_f32 v10, v10, v14
  v_add_f32 v11, v11, v15
  v_add_f32 v16, v16, v20
  v_add_f32 v17, v17, v21
  v_add_f32 v18, v18, v22
  v_add_f32 v19, v19, v23
  v_permlane16_swap_b32 v8, v10
  v_permlane16_swap_b32 v9, v11
  v_permlane16_swap_b32 v16, v18
  v_permlane16_swap_b32 v17, v19
  v_add_f32 v8, v8, v10
  v_add_f32 v9, v9, v11
  v_add_f32 v16, v16, v18
  v_add_f32 v17, v17, v19
  v_add_f32_dpp v8, v8, v8 row_ror:8 row_mask:0xf bank_mask:0xf
  v_add_f32_dpp v9, v9, v9 row_ror:8 row_mask:0xf bank_mask:0xf
  v_add_f32_dpp v16, v16, v16 row_ror:8 row_mask:0xf bank_mask:0xf
  v_add_f32_dpp v17, v17, v17 row_ror:8 row_mask:0xf bank_mask:0xf
  v_and_b32 v30, 7, v0
  v_lshlrev_b32 v29, 5, v30
  v_bfe_u32 v30, v0, 4, 2
  v_lshl_add_u32 v29, v30, 3, v29
  s_mul_i32 s63, s3, 512
  v_add_u32 v29, s63, v29
  s_mov_b32 exec_lo, 0xff00ff
  s_mov_b32 exec_hi, 0xff00ff
  ds_write_b64 v29, v[8:9] offset:2048
  ds_write_b64 v29, v[16:17] offset:2304
  s_mov_b64 exec, -1
  v_add_f32 v4, v60, v61
  v_mul_f32 v5, v60, v60
  v_fmac_f32 v5, v61, v61
  v_add_f32_dpp v4, v4, v4 row_ror:8 row_mask:0xf bank_mask:0xf
  s_nop 0
  v_add_f32_dpp v5, v5, v5 row_ror:8 row_mask:0xf bank_mask:0xf
  v_mov_b32 v24, v4
  v_mov_b32 v25, v5
  s_nop 0
  v_permlane16_swap_b32 v4, v24
  v_permlane16_swap_b32 v5, v25
  v_add_f32 v4, v4, v24
  v_add_f32 v5, v5, v25
  v_mov_b32 v24, v4
  v_mov_b32 v25, v5
  s_nop 0
  v_permlane32_swap_b32 v4, v24
  v_permlane32_swap_b32 v5, v25
  v_add_f32 v4, v4, v24
  v_add_f32 v5, v5, v25
  s_lshl_b32 s63, s3, 3
  v_mov_b32 v24, s63
  s_mov_b32 exec_lo, 0x1
  s_mov_b32 exec_hi, 0x0
  ds_write_b64 v24, v[4:5] offset:11392
  s_mov_b64 exec, -1
  s_cmp_lg_u32 s48, 0
  s_cbranch_scc1 L_nwq6
  v_and_b32 v30, 63, v0
  v_lshrrev_b32 v29, 3, v30
  s_mov_b32 s63, 16384
  v_mul_lo_u32 v29, v29, s63
  v_and_b32 v30, 7, v30
  v_lshl_add_u32 v29, v30, 4, v29
  s_lshr_b32 s51, s4, 6
  s_lshl_b32 s51, s51, 20
  s_lshl_b32 s52, s3, 17
  s_add_u32 s51, s51, s52
  s_and_b32 s52, s4, 63
  s_lshl_b32 s52, s52, 7
  s_add_u32 s51, s51, s52
  buffer_load_dwordx4 v[32:35], v29, s[16:19], s51 offen
  s_add_u32 s51, s51, 8192
  buffer_load_dwordx4 v[36:39], v29, s[16:19], s51 offen
  s_add_u32 s51, s51, 516096
  buffer_load_dwordx4 v[40:43], v29, s[16:19], s51 offen
  s_add_u32 s51, s51, 8192
  buffer_load_dwordx4 v[44:47], v29, s[16:19], s51 offen
L_nwq6:
  s_waitcnt lgkmcnt(0)
  s_barrier
  s_cmp_lt_u32 s3, 2
  s_cbranch_scc1 L_pubG
  s_cmp_eq_u32 s3, 3
  s_cbranch_scc1 L_skipG
  s_lshl_b32 s51, s65, 3
  s_add_u32 s51, s51, s64
  s_lshl_b32 s51, s51, 6
  s_lshl_b32 s52, s48, 14
  s_add_u32 s51, s51, s52
  s_add_u32 s51, s51, 0xe0000
  v_mov_b32 v29, 0
  ds_read_b128 v[8:11], v29 offset:11392
  ds_read_b128 v[12:15], v29 offset:11408
  s_waitcnt lgkmcnt(0)
  v_add_f32 v8, v8, v10
  v_add_f32 v12, v12, v14
  v_add_f32 v9, v9, v11
  v_add_f32 v13, v13, v15
  v_add_f32 v8, v8, v12
  v_add_f32 v9, v9, v13
  v_min_u32 v8, 0xfffffffe, v8
  v_min_u32 v9, 0xfffffffe, v9
  s_mov_b32 exec_lo, 0x1
  s_mov_b32 exec_hi, 0x0
  buffer_store_dwordx2 v[8:9], v29, s[36:39], s51 offen sc1
  s_mov_b64 exec, -1
  s_branch L_skipG
L_pubG:
  v_lshlrev_b32 v29, 2, v0
  v_and_b32 v28, 63, v0
  v_lshlrev_b32 v28, 2, v28
  s_mul_i32 s51, s64, 14336
  s_mul_i32 s52, s3, 7168
  s_add_u32 s51, s51, s52
  s_lshl_b32 s52, s65, 8
  s_add_u32 s51, s51, s52
  s_add_u32 s51, s51, s53
  s_add_u32 s51, s51, 0x20000
  ds_read_b32 v8, v29 offset:2048
  ds_read_b32 v9, v29 offset:2560
  ds_read_b32 v10, v29 offset:3072
  ds_read_b32 v11, v29 offset:3584
  s_waitcnt lgkmcnt(0)
  v_add_f32 v8, v8, v9
  v_add_f32 v10, v10, v11
  v_add_f32 v24, v8, v10
  v_min_u32 v24, 0xfffffffe, v24
  buffer_store_dword v24, v28, s[36:39], s51 offen sc1
  s_nop 9
L_skipG:
  v_and_b32 v28, 31, v0
  v_min_u32 v27, 27, v28
  v_lshlrev_b32 v27, 2, v27
  v_bfe_u32 v29, v0, 5, 1
  s_mov_b32 s63, 7168
  v_mul_lo_u32 v29, v29, s63
  v_add_u32 v27, v27, v29
  v_and_b32 v29, 7, v0
  v_lshlrev_b32 v29, 6, v29
  s_lshr_b32 s62, s4, 4
  s_lshl_b32 s62, s62, 2
  s_add_u32 s62, s62, s3
  s_mul_i32 s62, s62, 112
  s_lshr_b32 s63, s62, 8
  s_lshl_b32 s63, s63, 9
  s_lshl_b32 s60, s48, 14
  s_add_u32 s63, s63, s60
  s_add_u32 s63, s63, 0xe0000
  s_add_u32 s60, s62, 0xc0000
  s_add_u32 s62, s62, s53
  s_add_u32 s62, s62, 0x20000
  v_lshlrev_b32 v26, 2, v0
  s_cmp_eq_u32 s48, 0
  s_cbranch_scc1 L_cs0
  ds_read_b32 v16, v26 offset:10240
  s_branch L_cs1
L_cs0:
  s_add_u32 s51, s60, 0
  buffer_load_dword v16, v27, s[36:39], s51 offen sc1
  s_add_u32 s51, s60, 14336
  buffer_load_dword v17, v27, s[36:39], s51 offen sc1
  s_add_u32 s51, s60, 28672
  buffer_load_dword v18, v27, s[36:39], s51 offen sc1
  s_add_u32 s51, s60, 43008
  buffer_load_dword v19, v27, s[36:39], s51 offen sc1
  s_add_u32 s51, s60, 57344
  buffer_load_dword v20, v27, s[36:39], s51 offen sc1
  s_add_u32 s51, s60, 71680
  buffer_load_dword v21, v27, s[36:39], s51 offen sc1
  s_add_u32 s51, s60, 86016
  buffer_load_dword v22, v27, s[36:39], s51 offen sc1
  s_add_u32 s51, s60, 100352
  buffer_load_dword v23, v27, s[36:39], s51 offen sc1
L_cs1:
  s_add_u32 s86, s62, 0
  s_add_u32 s87, s62, 14336
  s_add_u32 s88, s62, 28672
  s_add_u32 s89, s62, 43008
  s_add_u32 s90, s62, 57344
  s_add_u32 s91, s62, 71680
  s_add_u32 s92, s62, 86016
  s_add_u32 s93, s62, 100352
  s_sleep 3
  buffer_load_dwordx2 v[4:5], v29, s[36:39], s63 offen sc1
  buffer_load_dword v8, v27, s[36:39], s86 offen sc1
  buffer_load_dword v9, v27, s[36:39], s87 offen sc1
  buffer_load_dword v10, v27, s[36:39], s88 offen sc1
  buffer_load_dword v11, v27, s[36:39], s89 offen sc1
  buffer_load_dword v12, v27, s[36:39], s90 offen sc1
  buffer_load_dword v13, v27, s[36:39], s91 offen sc1
  buffer_load_dword v14, v27, s[36:39], s92 offen sc1
  buffer_load_dword v15, v27, s[36:39], s93 offen sc1
  s_waitcnt vmcnt(0)
  v_max_u32 v30, v4, v5
  v_cmp_eq_u32 s[68:69], -1, v30
  v_cmp_eq_u32 s[70:71], -1, v8
  v_cmp_eq_u32 s[72:73], -1, v9
  v_cmp_eq_u32 s[74:75], -1, v10
  v_cmp_eq_u32 s[76:77], -1, v11
  v_cmp_eq_u32 s[78:79], -1, v12
  v_cmp_eq_u32 s[80:81], -1, v13
  v_cmp_eq_u32 s[82:83], -1, v14
  v_cmp_eq_u32 s[84:85], -1, v15
  s_or_b64 vcc, s[68:69], s[70:71]
  s_or_b64 vcc, vcc, s[72:73]
  s_or_b64 vcc, vcc, s[74:75]
  s_or_b64 vcc, vcc, s[76:77]
  s_or_b64 vcc, vcc, s[78:79]
  s_or_b64 vcc, vcc, s[80:81]
  s_or_b64 vcc, vcc, s[82:83]
  s_or_b64 vcc, vcc, s[84:85]
  s_cbranch_scc0 L_id7
L_il7:
  s_mov_b64 exec, s[68:69]
  buffer_load_dwordx2 v[4:5], v29, s[36:39], s63 offen sc1
  s_mov_b64 exec, s[70:71]
  buffer_load_dword v8, v27, s[36:39], s86 offen sc1
  s_mov_b64 exec, s[72:73]
  buffer_load_dword v9, v27, s[36:39], s87 offen sc1
  s_mov_b64 exec, s[74:75]
  buffer_load_dword v10, v27, s[36:39], s88 offen sc1
  s_mov_b64 exec, s[76:77]
  buffer_load_dword v11, v27, s[36:39], s89 offen sc1
  s_mov_b64 exec, s[78:79]
  buffer_load_dword v12, v27, s[36:39], s90 offen sc1
  s_mov_b64 exec, s[80:81]
  buffer_load_dword v13, v27, s[36:39], s91 offen sc1
  s_mov_b64 exec, s[82:83]
  buffer_load_dword v14, v27, s[36:39], s92 offen sc1
  s_mov_b64 exec, s[84:85]
  buffer_load_dword v15, v27, s[36:39], s93 offen sc1
  s_mov_b64 exec, -1
  s_waitcnt vmcnt(0)
  v_max_u32 v30, v4, v5
  v_cmp_eq_u32 s[68:69], -1, v30
  v_cmp_eq_u32 s[70:71], -1, v8
  v_cmp_eq_u32 s[72:73], -1, v9
  v_cmp_eq_u32 s[74:75], -1, v10
  v_cmp_eq_u32 s[76:77], -1, v11
  v_cmp_eq_u32 s[78:79], -1, v12
  v_cmp_eq_u32 s[80:81], -1, v13
  v_cmp_eq_u32 s[82:83], -1, v14
  v_cmp_eq_u32 s[84:85], -1, v15
  s_or_b64 vcc, s[68:69], s[70:71]
  s_or_b64 vcc, vcc, s[72:73]
  s_or_b64 vcc, vcc, s[74:75]
  s_or_b64 vcc, vcc, s[76:77]
  s_or_b64 vcc, vcc, s[78:79]
  s_or_b64 vcc, vcc, s[80:81]
  s_or_b64 vcc, vcc, s[82:83]
  s_or_b64 vcc, vcc, s[84:85]
  s_cbranch_scc0 L_id7
  s_sub_u32 s55, s55, 1
  s_cmp_gt_i32 s55, 0
  s_cbranch_scc1 L_il7
L_id7:
  s_nop 1
  s_waitcnt lgkmcnt(0)
  s_cmp_lg_u32 s48, 0
  s_cbranch_scc1 L_cs2
  v_max_u32 v31, v16, v17
  v_max3_u32 v31, v31, v18, v19
  v_max3_u32 v31, v31, v20, v21
  v_max3_u32 v31, v31, v22, v23
  v_cmp_eq_u32 vcc, -1, v31
  s_nop 0
  s_cbranch_vccz L_csok
  s_nop 9
L_poll8:
  s_add_u32 s51, s60, 0
  buffer_load_dword v16, v27, s[36:39], s51 offen sc1
  s_add_u32 s51, s60, 14336
  buffer_load_dword v17, v27, s[36:39], s51 offen sc1
  s_add_u32 s51, s60, 28672
  buffer_load_dword v18, v27, s[36:39], s51 offen sc1
  s_add_u32 s51, s60, 43008
  buffer_load_dword v19, v27, s[36:39], s51 offen sc1
  s_add_u32 s51, s60, 57344
  buffer_load_dword v20, v27, s[36:39], s51 offen sc1
  s_add_u32 s51, s60, 71680
  buffer_load_dword v21, v27, s[36:39], s51 offen sc1
  s_add_u32 s51, s60, 86016
  buffer_load_dword v22, v27, s[36:39], s51 offen sc1
  s_add_u32 s51, s60, 100352
  buffer_load_dword v23, v27, s[36:39], s51 offen sc1
  s_waitcnt vmcnt(0)
  v_max_u32 v31, v16, v17
  v_max3_u32 v31, v31, v18, v19
  v_max3_u32 v31, v31, v20, v21
  v_max3_u32 v31, v31, v22, v23
  v_cmp_eq_u32 vcc, -1, v31
  s_nop 0
  s_cbranch_vccz L_pdone8
  s_sub_u32 s55, s55, 1
  s_cmp_le_i32 s55, 0
  s_cbranch_scc1 L_pdone8
  s_sleep 1
  s_branch L_poll8
  s_nop 9
L_pdone8:
L_csok:
  v_add_f32 v16, v16, v20
  v_add_f32 v17, v17, v21
  v_add_f32 v18, v18, v22
  v_add_f32 v19, v19, v23
  v_add_f32 v16, v16, v18
  v_add_f32 v17, v17, v19
  v_add_f32 v16, v16, v17
  ds_write_b32 v26, v16 offset:10240
L_cs2:
  v_add_f32 v8, v8, v12
  v_add_f32 v9, v9, v13
  v_add_f32 v10, v10, v14
  v_add_f32 v11, v11, v15
  v_add_f32 v8, v8, v10
  v_add_f32 v9, v9, v11
  v_add_f32 v8, v8, v9
  v_add_f32_dpp v4, v4, v4 quad_perm:[1,0,3,2] row_mask:0xf bank_mask:0xf
  v_add_f32_dpp v5, v5, v5 quad_perm:[1,0,3,2] row_mask:0xf bank_mask:0xf
  s_nop 0
  v_add_f32_dpp v4, v4, v4 quad_perm:[2,3,0,1] row_mask:0xf bank_mask:0xf
  v_add_f32_dpp v5, v5, v5 quad_perm:[2,3,0,1] row_mask:0xf bank_mask:0xf
  s_nop 0
  v_add_f32_dpp v4, v4, v4 row_half_mirror row_mask:0xf bank_mask:0xf
  v_add_f32_dpp v5, v5, v5 row_half_mirror row_mask:0xf bank_mask:0xf
  v_mul_f32 v4, 0x3b000000, v4
  v_mul_f32 v5, 0x3b000000, v5
  v_fma_f32 v5, -v4, v4, v5
  v_max_f32 v5, 0, v5
  v_cvt_pk_bf16_f32 v24, v4, v5
  v_lshlrev_b32 v4, 16, v24
  v_and_b32 v5, 0xffff0000, v24
  v_add_f32 v5, 0x3727c5ac, v5
  v_cvt_pk_bf16_f32 v24, v5, v5
  v_lshlrev_b32 v5, 16, v24
  v_sqrt_f32 v5, v5
  s_nop 0
  v_cvt_pk_bf16_f32 v24, v5, v5
  v_lshlrev_b32 v5, 16, v24
  v_rcp_f32 v5, v5
  v_fma_f32 v8, -v4, v16, v8
  v_mul_f32 v8, v8, v5
  v_cvt_pk_bf16_f32 v24, v8, v8
  v_lshlrev_b32 v8, 16, v24
  v_mov_b32 v9, v8
  s_nop 1
  v_permlane32_swap_b32 v8, v9
  v_cmp_lt_f32 vcc, 0, v8
  s_nop 1
  v_cndmask_b32 v24, 0, 1.0, vcc
  v_mul_f32 v8, v8, v24
  v_mul_f32 v8, v8, v9
  v_cvt_pk_bf16_f32 v24, v8, v8
  v_lshlrev_b32 v8, 16, v24
  v_cmp_gt_u32 vcc, 28, v28
  s_nop 1
  v_cndmask_b32 v8, 0, v8, vcc
  v_and_b32 v27, 60, v0
  v_add_u32 v29, 64, v27
  ds_bpermute_b32 v10, v27, v8
  ds_bpermute_b32 v11, v29, v8
  v_and_b32 v30, 3, v0
  v_lshlrev_b32 v29, 5, v30
  v_bfe_u32 v30, v0, 4, 2
  v_lshl_add_u32 v29, v30, 3, v29
  s_mul_i32 s63, s3, 128
  v_add_u32 v29, s63, v29
  s_waitcnt lgkmcnt(0)
  v_lshrrev_b32 v12, 16, v10
  v_lshrrev_b32 v13, 16, v11
  v_dot2_f32_bf16 v16, v48, v12, 0
  v_dot2_f32_bf16 v17, v48, v10, 0
  v_dot2_f32_bf16 v18, v49, v12, 0
  v_dot2_f32_bf16 v19, v49, v10, 0
  v_dot2_f32_bf16 v20, v50, v12, 0
  v_dot2_f32_bf16 v21, v50, v10, 0
  v_dot2_f32_bf16 v22, v51, v12, 0
  v_dot2_f32_bf16 v23, v51, v10, 0
  v_dot2_f32_bf16 v16, v52, v13, v16
  v_dot2_f32_bf16 v17, v52, v11, v17
  v_dot2_f32_bf16 v18, v53, v13, v18
  v_dot2_f32_bf16 v19, v53, v11, v19
  v_dot2_f32_bf16 v20, v54, v13, v20
  v_dot2_f32_bf16 v21, v54, v11, v21
  v_dot2_f32_bf16 v22, v55, v13, v22
  v_dot2_f32_bf16 v23, v55, v11, v23
  v_permlane32_swap_b32 v16, v20
  v_permlane32_swap_b32 v17, v21
  v_permlane32_swap_b32 v18, v22
  v_permlane32_swap_b32 v19, v23
  v_add_f32 v16, v16, v20
  v_add_f32 v17, v17, v21
  v_add_f32 v18, v18, v22
  v_add_f32 v19, v19, v23
  s_nop 0
  v_permlane16_swap_b32 v16, v18
  v_permlane16_swap_b32 v17, v19
  v_add_f32 v16, v16, v18
  v_add_f32 v17, v17, v19
  s_nop 0
  v_add_f32_dpp v16, v16, v16 row_ror:4 row_mask:0xf bank_mask:0xf
  v_add_f32_dpp v17, v17, v17 row_ror:4 row_mask:0xf bank_mask:0xf
  s_nop 0
  v_add_f32_dpp v16, v16, v16 row_ror:8 row_mask:0xf bank_mask:0xf
  v_add_f32_dpp v17, v17, v17 row_ror:8 row_mask:0xf bank_mask:0xf
  s_mov_b32 exec_lo, 0xf000f
  s_mov_b32 exec_hi, 0xf000f
  ds_write_b64 v29, v[16:17] offset:9216
  s_mov_b64 exec, -1
  s_waitcnt lgkmcnt(0)
  s_barrier
  s_cmp_lg_u32 s3, 0
  s_cbranch_scc1 L_skipD
  v_and_b32 v29, 31, v0
  v_lshlrev_b32 v29, 2, v29
  v_bfe_u32 v28, v0, 4, 1
  v_lshlrev_b32 v28, 7, v28
  v_bfe_u32 v30, v0, 1, 3
  v_lshl_add_u32 v28, v30, 4, v28
  v_and_b32 v30, 1, v0
  v_lshl_add_u32 v28, v30, 2, v28
  s_bfe_u32 s52, s4, 0x20002
  s_lshl_b32 s52, s52, 9
  s_and_b32 s60, s4, 1
  s_lshl_b32 s60, s60, 8
  s_add_u32 s52, s52, s60
  s_and_b32 s60, s4, 2
  s_lshl_b32 s60, s60, 2
  s_add_u32 s52, s52, s60
  s_lshr_b32 s51, s4, 4
  s_lshl_b32 s51, s51, 11
  s_add_u32 s51, s51, s52
  s_add_u32 s51, s51, s53
  s_add_u32 s51, s51, 0x10000
  ds_read_b32 v8, v29 offset:9216
  ds_read_b32 v9, v29 offset:9344
  ds_read_b32 v10, v29 offset:9472
  ds_read_b32 v11, v29 offset:9600
  s_waitcnt lgkmcnt(0)
  v_add_f32 v8, v8, v9
  v_add_f32 v10, v10, v11
  v_add_f32 v24, v8, v10
  v_min_u32 v24, 0xfffffffe, v24
  s_mov_b32 exec_lo, 0xffffffff
  s_mov_b32 exec_hi, 0x0
  buffer_store_dword v24, v28, s[36:39], s51 offen sc1
  s_mov_b64 exec, -1
  s_nop 9
L_skipD:
  s_and_b32 s51, s4, 63
  s_mul_i32 s51, s51, s48
  s_cmp_lg_u32 s51, 0
  s_cbranch_scc1 L_end
  s_lshr_b32 s60, s2, 5
  s_lshl_b32 s60, s60, 11
  s_add_u32 s54, s60, 0x100000
  s_cmp_lg_u32 s48, 0
  s_cbranch_scc1 L_nocq
  s_lshl_b32 s62, s3, 14
  s_add_u32 s60, s62, s60
  s_add_u32 s60, s60, 0x210000
  buffer_load_dwordx4 v[16:19], v2, s[36:39], s60 offen sc1
  buffer_load_dwordx4 v[20:23], v2, s[36:39], s60 offen offset:1024 sc1
  s_nop 9
L_nocq:
  v_and_b32 v27, 7, v0
  v_lshlrev_b32 v27, 12, v27
  v_bfe_u32 v28, v0, 3, 3
  v_lshl_add_u32 v27, v28, 4, v27
  s_lshr_b32 s62, s4, 6
  s_lshl_b32 s62, s62, 9
  s_lshl_b32 s63, s3, 7
  s_add_u32 s62, s62, s63
  s_add_u32 s62, s62, s53
  s_add_u32 s62, s62, 0x10000
  s_sleep 10
  buffer_load_dwordx4 v[8:11], v27, s[36:39], s62 offen sc1
  buffer_load_dwordx4 v[12:15], v27, s[36:39], s62 offen offset:2048 sc1
  s_waitcnt vmcnt(0)
  v_max3_u32 v30, v8, v9, v10
  v_max_u32 v30, v30, v11
  v_cmp_eq_u32 s[68:69], -1, v30
  v_max3_u32 v31, v12, v13, v14
  v_max_u32 v31, v31, v15
  v_cmp_eq_u32 s[70:71], -1, v31
  s_nop 0
  s_or_b64 vcc, s[68:69], s[70:71]
  s_cbranch_scc0 L_id9
L_il9:
  s_mov_b64 exec, s[68:69]
  buffer_load_dwordx4 v[8:11], v27, s[36:39], s62 offen sc1
  s_mov_b64 exec, s[70:71]
  buffer_load_dwordx4 v[12:15], v27, s[36:39], s62 offen offset:2048 sc1
  s_mov_b64 exec, -1
  s_waitcnt vmcnt(0)
  v_max3_u32 v30, v8, v9, v10
  v_max_u32 v30, v30, v11
  v_cmp_eq_u32 s[68:69], -1, v30
  v_max3_u32 v31, v12, v13, v14
  v_max_u32 v31, v31, v15
  v_cmp_eq_u32 s[70:71], -1, v31
  s_nop 0
  s_or_b64 vcc, s[68:69], s[70:71]
  s_cbranch_scc0 L_id9
  s_sub_u32 s55, s55, 1
  s_cmp_gt_i32 s55, 0
  s_cbranch_scc1 L_il9
L_id9:
  s_nop 1
  v_add_f32 v8, v8, v12
  v_add_f32 v9, v9, v13
  v_add_f32 v10, v10, v14
  v_add_f32 v11, v11, v15
  v_add_f32_dpp v8, v8, v8 quad_perm:[1,0,3,2] row_mask:0xf bank_mask:0xf
  v_add_f32_dpp v9, v9, v9 quad_perm:[1,0,3,2] row_mask:0xf bank_mask:0xf
  v_add_f32_dpp v10, v10, v10 quad_perm:[1,0,3,2] row_mask:0xf bank_mask:0xf
  v_add_f32_dpp v11, v11, v11 quad_perm:[1,0,3,2] row_mask:0xf bank_mask:0xf
  v_add_f32_dpp v8, v8, v8 quad_perm:[2,3,0,1] row_mask:0xf bank_mask:0xf
  v_add_f32_dpp v9, v9, v9 quad_perm:[2,3,0,1] row_mask:0xf bank_mask:0xf
  v_add_f32_dpp v10, v10, v10 quad_perm:[2,3,0,1] row_mask:0xf bank_mask:0xf
  v_add_f32_dpp v11, v11, v11 quad_perm:[2,3,0,1] row_mask:0xf bank_mask:0xf
  v_add_f32_dpp v8, v8, v8 row_half_mirror row_mask:0xf bank_mask:0xf
  v_add_f32_dpp v9, v9, v9 row_half_mirror row_mask:0xf bank_mask:0xf
  v_add_f32_dpp v10, v10, v10 row_half_mirror row_mask:0xf bank_mask:0xf
  v_add_f32_dpp v11, v11, v11 row_half_mirror row_mask:0xf bank_mask:0xf
  v_cvt_pk_bf16_f32 v24, v8, v9
  v_lshlrev_b32 v8, 16, v24
  v_and_b32 v9, 0xffff0000, v24
  v_cvt_pk_bf16_f32 v25, v10, v11
  v_lshlrev_b32 v10, 16, v25
  v_and_b32 v11, 0xffff0000, v25
  v_add_f32 v56, v56, v8
  v_add_f32 v57, v57, v9
  v_add_f32 v58, v58, v10
  v_add_f32 v59, v59, v11
  v_cvt_pk_bf16_f32 v24, v56, v57
  v_lshlrev_b32 v56, 16, v24
  v_and_b32 v57, 0xffff0000, v24
  v_cvt_pk_bf16_f32 v25, v58, v59
  v_lshlrev_b32 v58, 16, v25
  v_and_b32 v59, 0xffff0000, v25
  s_cmp_eq_u32 s48, 0
  s_cbranch_scc1 L_stQ
  v_cvt_pk_bf16_f32 v24, v56, v57
  v_cvt_pk_bf16_f32 v25, v58, v59
  v_bfe_u32 v27, v0, 3, 3
  v_lshlrev_b32 v27, 3, v27
  s_lshl_b32 s52, s3, 6
  s_lshr_b32 s51, s4, 6
  s_lshl_b32 s51, s51, 9
  s_add_u32 s52, s51, s52
  v_add_u32 v27, s52, v27
  v_lshrrev_b32 v27, 1, v27
  s_mov_b32 exec_lo, 0x1010101
  s_mov_b32 exec_hi, 0x1010101
  buffer_store_dword v24, v27, s[44:47], 0 offen
  buffer_store_dword v25, v27, s[44:47], 0 offen offset:128
  s_mov_b64 exec, -1
  s_branch L_end
L_stQ:
  v_lshrrev_b32 v60, 16, v56
  v_lshrrev_b32 v61, 16, v57
  v_lshrrev_b32 v62, 16, v58
  v_lshrrev_b32 v63, 16, v59
  v_dot2_f32_bf16 v8, v32, v60, 0
  v_dot2_f32_bf16 v9, v32, v56, 0
  v_dot2_f32_bf16 v10, v33, v60, 0
  v_dot2_f32_bf16 v11, v33, v56, 0
  v_dot2_f32_bf16 v12, v34, v60, 0
  v_dot2_f32_bf16 v13, v34, v56, 0
  v_dot2_f32_bf16 v14, v35, v60, 0
  v_dot2_f32_bf16 v15, v35, v56, 0
  v_dot2_f32_bf16 v8, v36, v61, v8
  v_dot2_f32_bf16 v9, v36, v57, v9
  v_dot2_f32_bf16 v10, v37, v61, v10
  v_dot2_f32_bf16 v11, v37, v57, v11
  v_dot2_f32_bf16 v12, v38, v61, v12
  v_dot2_f32_bf16 v13, v38, v57, v13
  v_dot2_f32_bf16 v14, v39, v61, v14
  v_dot2_f32_bf16 v15, v39, v57, v15
  v_dot2_f32_bf16 v8, v40, v62, v8
  v_dot2_f32_bf16 v9, v40, v58, v9
  v_dot2_f32_bf16 v10, v41, v62, v10
  v_dot2_f32_bf16 v11, v41, v58, v11
  v_dot2_f32_bf16 v12, v42, v62, v12
  v_dot2_f32_bf16 v13, v42, v58, v13
  v_dot2_f32_bf16 v14, v43, v62, v14
  v_dot2_f32_bf16 v15, v43, v58, v15
  v_dot2_f32_bf16 v8, v44, v63, v8
  v_dot2_f32_bf16 v9, v44, v59, v9
  v_dot2_f32_bf16 v10, v45, v63, v10
  v_dot2_f32_bf16 v11, v45, v59, v11
  v_dot2_f32_bf16 v12, v46, v63, v12
  v_dot2_f32_bf16 v13, v46, v59, v13
  v_dot2_f32_bf16 v14, v47, v63, v14
  v_dot2_f32_bf16 v15, v47, v59, v15
  v_permlane32_swap_b32 v8, v12
  v_permlane32_swap_b32 v9, v13
  v_permlane32_swap_b32 v10, v14
  v_permlane32_swap_b32 v11, v15
  v_add_f32 v8, v8, v12
  v_add_f32 v9, v9, v13
  v_add_f32 v10, v10, v14
  v_add_f32 v11, v11, v15
  s_nop 0
  v_permlane16_swap_b32 v8, v10
  v_permlane16_swap_b32 v9, v11
  v_add_f32 v8, v8, v10
  v_add_f32 v9, v9, v11
  s_nop 0
  v_add_f32_dpp v8, v8, v8 row_ror:8 row_mask:0xf bank_mask:0xf
  v_add_f32_dpp v9, v9, v9 row_ror:8 row_mask:0xf bank_mask:0xf
  v_and_b32 v30, 7, v0
  v_lshlrev_b32 v29, 5, v30
  v_bfe_u32 v30, v0, 4, 2
  v_lshl_add_u32 v29, v30, 3, v29
  s_mul_i32 s63, s3, 256
  v_add_u32 v29, s63, v29
  s_mov_b32 exec_lo, 0xff00ff
  s_mov_b32 exec_hi, 0xff00ff
  ds_write_b64 v29, v[8:9] offset:8192
  s_mov_b64 exec, -1
  v_add_f32 v4, v56, v57
  v_mul_f32 v5, v56, v56
  v_fmac_f32 v5, v57, v57
  v_add_f32 v4, v4, v58
  v_fmac_f32 v5, v58, v58
  v_add_f32 v4, v4, v59
  v_fmac_f32 v5, v59, v59
  s_nop 0
  v_add_f32_dpp v4, v4, v4 row_ror:8 row_mask:0xf bank_mask:0xf
  v_add_f32_dpp v5, v5, v5 row_ror:8 row_mask:0xf bank_mask:0xf
  v_mov_b32 v24, v4
  v_mov_b32 v25, v5
  s_nop 0
  v_permlane16_swap_b32 v4, v24
  v_permlane16_swap_b32 v5, v25
  v_add_f32 v4, v4, v24
  v_add_f32 v5, v5, v25
  v_mov_b32 v24, v4
  v_mov_b32 v25, v5
  s_nop 0
  v_permlane32_swap_b32 v4, v24
  v_permlane32_swap_b32 v5, v25
  v_add_f32 v4, v4, v24
  v_add_f32 v5, v5, v25
  s_lshl_b32 s63, s3, 3
  v_mov_b32 v24, s63
  s_mov_b32 exec_lo, 0x1
  s_mov_b32 exec_hi, 0x0
  ds_write_b64 v24, v[4:5] offset:11392
  s_mov_b64 exec, -1
  s_lshl_b32 s63, s3, 11
  v_add_u32 v28, s63, v2
  ds_write_b128 v28, v[16:19]
  ds_write_b128 v28, v[20:23] offset:1024
  v_bfe_u32 v29, v0, 3, 3
  v_lshlrev_b32 v29, 3, v29
  s_lshl_b32 s52, s3, 6
  v_add_u32 v29, s52, v29
  s_mov_b32 exec_lo, 0x1010101
  s_mov_b32 exec_hi, 0x1010101
  ds_write_b64 v29, v[56:57] offset:9728
  ds_write_b64 v29, v[58:59] offset:9984
  s_mov_b64 exec, -1
  s_waitcnt lgkmcnt(0)
  s_barrier
  s_cmp_lg_u32 s3, 0
  s_cbranch_scc1 L_skipQ
  v_and_b32 v29, 63, v0
  v_lshlrev_b32 v29, 2, v29
  s_lshr_b32 s51, s4, 6
  s_lshl_b32 s51, s51, 14
  s_add_u32 s51, s51, 0x100000
  v_bfe_u32 v28, v0, 2, 1
  v_lshlrev_b32 v28, 10, v28
  v_bfe_u32 v30, v0, 5, 1
  v_lshl_add_u32 v28, v30, 8, v28
  v_bfe_u32 v30, v0, 3, 2
  v_lshl_add_u32 v28, v30, 6, v28
  v_and_b32 v30, 3, v0
  v_lshl_add_u32 v28, v30, 2, v28
  s_bfe_u32 s52, s4, 0x30003
  s_lshl_b32 s52, s52, 11
  s_add_u32 s51, s51, s52
  s_and_b32 s52, s4, 1
  s_lshl_b32 s52, s52, 9
  s_add_u32 s51, s51, s52
  s_and_b32 s52, s4, 6
  s_lshl_b32 s52, s52, 3
  s_add_u32 s51, s51, s52
  ds_read_b32 v8, v29 offset:8192
  ds_read_b32 v9, v29 offset:8448
  ds_read_b32 v10, v29 offset:8704
  ds_read_b32 v11, v29 offset:8960
  s_waitcnt lgkmcnt(0)
  v_add_f32 v8, v8, v9
  v_add_f32 v10, v10, v11
  v_add_f32 v24, v8, v10
  v_min_u32 v24, 0xfffffffe, v24
  buffer_store_dword v24, v28, s[36:39], s51 offen sc1
L_skipQ:
  s_cmp_lg_u32 s3, 1
  s_cbranch_scc1 L_nostq
  s_and_b32 s51, s4, 63
  s_lshl_b32 s51, s51, 2
  s_lshr_b32 s52, s4, 6
  s_add_u32 s51, s51, s52
  s_lshl_b32 s51, s51, 6
  s_add_u32 s51, s51, 0xdc000
  v_mov_b32 v29, 0
  ds_read_b128 v[8:11], v29 offset:11392
  ds_read_b128 v[12:15], v29 offset:11408
  s_waitcnt lgkmcnt(0)
  v_add_f32 v8, v8, v10
  v_add_f32 v12, v12, v14
  v_add_f32 v9, v9, v11
  v_add_f32 v13, v13, v15
  v_add_f32 v8, v8, v12
  v_add_f32 v9, v9, v13
  v_min_u32 v8, 0xfffffffe, v8
  v_min_u32 v9, 0xfffffffe, v9
  s_mov_b32 exec_lo, 0x1
  s_mov_b32 exec_hi, 0x0
  buffer_store_dwordx2 v[8:9], v29, s[36:39], s51 offen sc1
  s_mov_b64 exec, -1
  s_nop 9
L_nostq:
  s_mov_b32 s48, 1
  s_mov_b32 s53, 0x100000
  ds_read_b128 v[8:11], v2
  ds_read_b128 v[12:15], v2 offset:1024
  ds_read_b128 v[16:19], v2 offset:2048
  ds_read_b128 v[20:23], v2 offset:3072
  ds_read_b128 v[32:35], v2 offset:4096
  ds_read_b128 v[36:39], v2 offset:5120
  ds_read_b128 v[40:43], v2 offset:6144
  ds_read_b128 v[44:47], v2 offset:7168
  v_and_b32 v29, 3, v0
  v_lshlrev_b32 v29, 6, v29
  s_lshr_b32 s63, s2, 5
  s_lshl_b32 s63, s63, 11
  s_add_u32 s63, s63, 0xdc000
  s_add_u32 s86, s54, 0
  s_add_u32 s87, s54, 16384
  s_add_u32 s88, s54, 32768
  s_add_u32 s89, s54, 49152
  s_waitcnt lgkmcnt(0)
  s_barrier
  v_add_f32 v8, v8, v16
  v_add_f32 v32, v32, v40
  v_add_f32 v9, v9, v17
  v_add_f32 v33, v33, v41
  v_add_f32 v10, v10, v18
  v_add_f32 v34, v34, v42
  v_add_f32 v11, v11, v19
  v_add_f32 v35, v35, v43
  v_add_f32 v12, v12, v20
  v_add_f32 v36, v36, v44
  v_add_f32 v13, v13, v21
  v_add_f32 v37, v37, v45
  v_add_f32 v14, v14, v22
  v_add_f32 v38, v38, v46
  v_add_f32 v15, v15, v23
  v_add_f32 v39, v39, v47
  v_add_f32 v8, v8, v32
  v_add_f32 v9, v9, v33
  v_add_f32 v10, v10, v34
  v_add_f32 v11, v11, v35
  v_add_f32 v12, v12, v36
  v_add_f32 v13, v13, v37
  v_add_f32 v14, v14, v38
  v_add_f32 v15, v15, v39
  s_sleep 8
  buffer_load_dwordx2 v[4:5], v29, s[36:39], s63 offen sc1
  buffer_load_dwordx4 v[32:35], v2, s[36:39], s86 offen sc1
  buffer_load_dwordx4 v[36:39], v2, s[36:39], s86 offen offset:1024 sc1
  buffer_load_dwordx4 v[40:43], v2, s[36:39], s87 offen sc1
  buffer_load_dwordx4 v[44:47], v2, s[36:39], s87 offen offset:1024 sc1
  buffer_load_dwordx4 v[48:51], v2, s[36:39], s88 offen sc1
  buffer_load_dwordx4 v[52:55], v2, s[36:39], s88 offen offset:1024 sc1
  buffer_load_dwordx4 v[56:59], v2, s[36:39], s89 offen sc1
  buffer_load_dwordx4 v[60:63], v2, s[36:39], s89 offen offset:1024 sc1
  s_waitcnt vmcnt(0)
  v_max_u32 v30, v4, v5
  v_cmp_eq_u32 s[68:69], -1, v30
  v_max3_u32 v31, v32, v33, v34
  v_max_u32 v31, v31, v35
  v_cmp_eq_u32 s[70:71], -1, v31
  v_max3_u32 v30, v36, v37, v38
  v_max_u32 v30, v30, v39
  v_cmp_eq_u32 s[72:73], -1, v30
  v_max3_u32 v31, v40, v41, v42
  v_max_u32 v31, v31, v43
  v_cmp_eq_u32 s[74:75], -1, v31
  v_max3_u32 v30, v44, v45, v46
  v_max_u32 v30, v30, v47
  v_cmp_eq_u32 s[76:77], -1, v30
  v_max3_u32 v31, v48, v49, v50
  v_max_u32 v31, v31, v51
  v_cmp_eq_u32 s[78:79], -1, v31
  v_max3_u32 v30, v52, v53, v54
  v_max_u32 v30, v30, v55
  v_cmp_eq_u32 s[80:81], -1, v30
  v_max3_u32 v31, v56, v57, v58
  v_max_u32 v31, v31, v59
  v_cmp_eq_u32 s[82:83], -1, v31
  v_max3_u32 v30, v60, v61, v62
  v_max_u32 v30, v30, v63
  v_cmp_eq_u32 s[84:85], -1, v30
  s_or_b64 vcc, s[68:69], s[70:71]
  s_or_b64 vcc, vcc, s[72:73]
  s_or_b64 vcc, vcc, s[74:75]
  s_or_b64 vcc, vcc, s[76:77]
  s_or_b64 vcc, vcc, s[78:79]
  s_or_b64 vcc, vcc, s[80:81]
  s_or_b64 vcc, vcc, s[82:83]
  s_or_b64 vcc, vcc, s[84:85]
  s_cbranch_scc0 L_id10
L_il10:
  s_mov_b64 exec, s[68:69]
  buffer_load_dwordx2 v[4:5], v29, s[36:39], s63 offen sc1
  s_mov_b64 exec, s[70:71]
  buffer_load_dwordx4 v[32:35], v2, s[36:39], s86 offen sc1
  s_mov_b64 exec, s[72:73]
  buffer_load_dwordx4 v[36:39], v2, s[36:39], s86 offen offset:1024 sc1
  s_mov_b64 exec, s[74:75]
  buffer_load_dwordx4 v[40:43], v2, s[36:39], s87 offen sc1
  s_mov_b64 exec, s[76:77]
  buffer_load_dwordx4 v[44:47], v2, s[36:39], s87 offen offset:1024 sc1
  s_mov_b64 exec, s[78:79]
  buffer_load_dwordx4 v[48:51], v2, s[36:39], s88 offen sc1
  s_mov_b64 exec, s[80:81]
  buffer_load_dwordx4 v[52:55], v2, s[36:39], s88 offen offset:1024 sc1
  s_mov_b64 exec, s[82:83]
  buffer_load_dwordx4 v[56:59], v2, s[36:39], s89 offen sc1
  s_mov_b64 exec, s[84:85]
  buffer_load_dwordx4 v[60:63], v2, s[36:39], s89 offen offset:1024 sc1
  s_mov_b64 exec, -1
  s_waitcnt vmcnt(0)
  v_max_u32 v30, v4, v5
  v_cmp_eq_u32 s[68:69], -1, v30
  v_max3_u32 v31, v32, v33, v34
  v_max_u32 v31, v31, v35
  v_cmp_eq_u32 s[70:71], -1, v31
  v_max3_u32 v30, v36, v37, v38
  v_max_u32 v30, v30, v39
  v_cmp_eq_u32 s[72:73], -1, v30
  v_max3_u32 v31, v40, v41, v42
  v_max_u32 v31, v31, v43
  v_cmp_eq_u32 s[74:75], -1, v31
  v_max3_u32 v30, v44, v45, v46
  v_max_u32 v30, v30, v47
  v_cmp_eq_u32 s[76:77], -1, v30
  v_max3_u32 v31, v48, v49, v50
  v_max_u32 v31, v31, v51
  v_cmp_eq_u32 s[78:79], -1, v31
  v_max3_u32 v30, v52, v53, v54
  v_max_u32 v30, v30, v55
  v_cmp_eq_u32 s[80:81], -1, v30
  v_max3_u32 v31, v56, v57, v58
  v_max_u32 v31, v31, v59
  v_cmp_eq_u32 s[82:83], -1, v31
  v_max3_u32 v30, v60, v61, v62
  v_max_u32 v30, v30, v63
  v_cmp_eq_u32 s[84:85], -1, v30
  s_or_b64 vcc, s[68:69], s[70:71]
  s_or_b64 vcc, vcc, s[72:73]
  s_or_b64 vcc, vcc, s[74:75]
  s_or_b64 vcc, vcc, s[76:77]
  s_or_b64 vcc, vcc, s[78:79]
  s_or_b64 vcc, vcc, s[80:81]
  s_or_b64 vcc, vcc, s[82:83]
  s_or_b64 vcc, vcc, s[84:85]
  s_cbranch_scc0 L_id10
  s_sub_u32 s55, s55, 1
  s_cmp_gt_i32 s55, 0
  s_cbranch_scc1 L_il10
L_id10:
  s_nop 1
  v_add_f32 v32, v32, v40
  v_add_f32 v48, v48, v56
  v_add_f32 v33, v33, v41
  v_add_f32 v49, v49, v57
  v_add_f32 v34, v34, v42
  v_add_f32 v50, v50, v58
  v_add_f32 v35, v35, v43
  v_add_f32 v51, v51, v59
  v_add_f32 v36, v36, v44
  v_add_f32 v52, v52, v60
  v_add_f32 v37, v37, v45
  v_add_f32 v53, v53, v61
  v_add_f32 v38, v38, v46
  v_add_f32 v54, v54, v62
  v_add_f32 v39, v39, v47
  v_add_f32 v55, v55, v63
  v_add_f32_dpp v4, v4, v4 quad_perm:[1,0,3,2] row_mask:0xf bank_mask:0xf
  v_add_f32_dpp v5, v5, v5 quad_perm:[1,0,3,2] row_mask:0xf bank_mask:0xf
  s_nop 0
  v_add_f32_dpp v4, v4, v4 quad_perm:[2,3,0,1] row_mask:0xf bank_mask:0xf
  v_add_f32_dpp v5, v5, v5 quad_perm:[2,3,0,1] row_mask:0xf bank_mask:0xf
  v_mul_f32 v4, 0x3b000000, v4
  v_mul_f32 v5, 0x3b000000, v5
  v_fma_f32 v5, -v4, v4, v5
  v_max_f32 v5, 0, v5
  v_cvt_pk_bf16_f32 v24, v4, v5
  v_lshlrev_b32 v4, 16, v24
  v_and_b32 v5, 0xffff0000, v24
  v_add_f32 v5, 0x3727c5ac, v5
  v_cvt_pk_bf16_f32 v24, v5, v5
  v_lshlrev_b32 v5, 16, v24
  v_sqrt_f32 v5, v5
  s_nop 0
  v_cvt_pk_bf16_f32 v24, v5, v5
  v_lshlrev_b32 v5, 16, v24
  v_rcp_f32 v5, v5
  v_add_f32 v32, v32, v48
  v_add_f32 v33, v33, v49
  v_add_f32 v34, v34, v50
  v_add_f32 v35, v35, v51
  v_add_f32 v36, v36, v52
  v_add_f32 v37, v37, v53
  v_add_f32 v38, v38, v54
  v_add_f32 v39, v39, v55
  v_fma_f32 v32, -v4, v8, v32
  v_fma_f32 v33, -v4, v9, v33
  v_fma_f32 v34, -v4, v10, v34
  v_fma_f32 v35, -v4, v11, v35
  v_fma_f32 v36, -v4, v12, v36
  v_fma_f32 v37, -v4, v13, v37
  v_fma_f32 v38, -v4, v14, v38
  v_fma_f32 v39, -v4, v15, v39
  v_mul_f32 v32, v32, v5
  v_mul_f32 v33, v33, v5
  v_mul_f32 v34, v34, v5
  v_mul_f32 v35, v35, v5
  v_mul_f32 v36, v36, v5
  v_mul_f32 v37, v37, v5
  v_mul_f32 v38, v38, v5
  v_mul_f32 v39, v39, v5
  v_cvt_pk_bf16_f32 v8, v32, v33
  v_cvt_pk_bf16_f32 v9, v34, v35
  v_cvt_pk_bf16_f32 v10, v36, v37
  v_cvt_pk_bf16_f32 v11, v38, v39
  s_branch L_pass
L_end:
  s_endpgm
.section .rodata,"a"
.p2align 6
.amdhsa_kernel interleave_layers__gqa_block_cached__glu_gated_reglu__decode_kernel
  .amdhsa_next_free_vgpr 512
  .amdhsa_next_free_sgpr 102
  .amdhsa_accum_offset 256
  .amdhsa_group_segment_fixed_size 0
  .amdhsa_kernarg_size 96
  .amdhsa_user_sgpr_count 2
  .amdhsa_user_sgpr_kernarg_segment_ptr 1
  .amdhsa_system_sgpr_workgroup_id_x 1
.end_amdhsa_kernel
```
